```python
import torch

def _softmax(x, axis=-1):
    return torch.softmax(x, dim=axis)
def _gelu(x):
    return torch.nn.functional.gelu(x, approximate="tanh")
def _silu(x):
    return torch.nn.functional.silu(x)
def _sigmoid(x):
    return torch.sigmoid(x)
def _layernorm(x, axis=-1, eps=1e-5):
    m = x.mean(dim=axis, keepdim=True)
    v = x.var(dim=axis, keepdim=True, unbiased=False)
    return (x - m) / torch.sqrt(v + eps)
def _scatter_add(tgt, idx, src, axis=0):
    return tgt.clone().index_add_(axis, idx, src)
def _segment_sum(src, seg, n):
    out = torch.zeros((n,) + src.shape[1:], dtype=src.dtype)
    return out.index_add_(0, seg, src)
def _pad(x, pw):
    flat = tuple(v for pair in reversed(pw) for v in pair)
    return torch.nn.functional.pad(x, flat)

kernel_name = 'recurrent_scan__spectral_gfnet__dense_activation_gelu__prompt'

def setup_inputs():

    _w = (lambda a: (lambda t: t.to(torch.bfloat16) if t.is_floating_point() else t)(torch.as_tensor(a)))
    def _A_setup():
        B, S, D = 1, 2048, 576
        Df = D // 2 + 1
        return {
            "x": _w((lambda *s: torch.randn(*s, dtype=torch.bfloat16) * 0.05)(B, S, D)),
            "w_r": _w((lambda *s: torch.randn(*s, dtype=torch.bfloat16) * 3.2)(S, Df) * 0.02),
            "w_i": _w((lambda *s: torch.randn(*s, dtype=torch.bfloat16) * 3.2)(S, Df) * 0.02),
        }
    _A_in = _A_setup()

    def _B_setup():
        B, S, D, F = 1, 2048, 576, 4608
        return {
            "x": _w((lambda *s: torch.randn(*s, dtype=torch.bfloat16) * 0.05)(B, S, D)),
            "w1": _w((lambda *s: torch.randn(*s, dtype=torch.bfloat16) * 3.2)(D, F) * (D ** -0.5)),
            "b1": _w((lambda *s: torch.randn(*s, dtype=torch.bfloat16) * 3.2)(F) * 0.01),
            "w2": _w((lambda *s: torch.randn(*s, dtype=torch.bfloat16) * 0.4)(F, D) * (F ** -0.5)),
            "b2": _w((lambda *s: torch.randn(*s, dtype=torch.bfloat16) * 0.4)(D) * 0.01),
        }
    _B_in = _B_setup()

    return {
        "A_x": _A_in["x"],
        "A_w_r": _A_in["w_r"],
        "A_w_i": _A_in["w_i"],
        "B_x": _B_in["x"],
        "B_w1": _B_in["w1"],
        "B_b1": _B_in["b1"],
        "B_w2": _B_in["w2"],
        "B_b2": _B_in["b2"],
    }

def reference(A_x, A_w_r, A_w_i, B_x, B_w1, B_b1, B_w2, B_b2):
    def _A_ref(x, w_r, w_i):
        B, S, D = x.shape
        X = (lambda x, axes=(-2,-1): torch.fft.rfft2(x.float(), dim=axes))(x, axes=(-2, -1))
        W = w_r + 1j * w_i
        X = X * W
        y = (lambda x, s, axes=(-2,-1): torch.fft.irfft2(x, s=s, dim=axes).to(torch.bfloat16))(X, (S, D), axes=(-2, -1))
        return y

    def _B_ref(x, w1, b1, w2, b2):
        h = torch.einsum("bsd,df->bsf", x, w1) + b1
        h = _gelu(h)
        return torch.einsum("bsf,fd->bsd", h, w2) + b2

    x = A_x
    xn = _layernorm(x, axis=-1)
    s = _A_ref(xn, A_w_r, A_w_i)
    g = _silu(_B_ref(xn, B_w1, B_b1, B_w2, B_b2))
    return x + s * g
```

```asm
; @launch grid=(256,1,1) block=(512,1,1) lds=163840
.amdgcn_target "amdgcn-amd-amdhsa--gfx950"
.text
.globl recurrent_scan__spectral_gfnet__dense_activation_gelu__prompt_kernel
.p2align 8
.type recurrent_scan__spectral_gfnet__dense_activation_gelu__prompt_kernel,@function
recurrent_scan__spectral_gfnet__dense_activation_gelu__prompt_kernel:
  s_load_dwordx16 s[36:51], s[0:1], 0
  s_load_dwordx4 s[52:55], s[0:1], 64
  s_load_dwordx2 s[56:57], s[0:1], 80
  s_lshr_b32 s64, s2, 3
  s_getpc_b64 s[66:67]
L_pc:
  s_mul_i32 s65, s64, 3584
  v_lshl_add_u32 v2, v0, 7, s65
  s_add_u32 s65, s65, 3584
  s_min_u32 s65, s65, L_codeend - L_pc - 4
  v_cmp_gt_u32 vcc, s65, v2
  s_nop 0
  s_and_saveexec_b64 s[68:69], vcc
  s_cbranch_execz L_nocpf
  v_mov_b32 v3, s67
  v_add_co_u32 v2, vcc, s66, v2
  s_nop 1
  v_addc_co_u32 v3, vcc, 0, v3, vcc
  global_load_dword v250, v[2:3], off
L_nocpf:
  s_mov_b64 exec, s[68:69]
  v_lshrrev_b32 v1, 6, v0
  s_nop 0
  v_readfirstlane_b32 s60, v1
  s_cmp_lt_u32 s2, 192
  s_cbranch_scc0 L_fft
  s_and_b32 s63, s2, 7
  s_mul_hi_u32 s65, s64, 0x55555556
  s_mul_i32 s66, s65, 3
  s_sub_u32 s66, s64, s66
  s_mov_b32 s70, s66
  s_and_b32 s61, s63, 1
  s_lshl_b32 s61, s61, 3
  s_add_u32 s61, s61, s65
  s_lshr_b32 s62, s63, 1
  s_mul_i32 s62, s62, 3
  s_add_u32 s62, s62, s66
  v_and_b32 v1, 63, v0
  s_lshr_b32 s64, s60, 2
  s_and_b32 s63, s60, 3
  s_and_b32 s65, s61, 1
  s_lshl_b32 s65, s65, 4
  s_add_u32 s65, s65, s63
  s_lshl_b32 s65, s65, 6
  s_lshr_b32 s66, s61, 3
  s_add_u32 s65, s65, s66
  s_and_b32 s66, s61, 4
  s_lshl_b32 s66, s66, 3
  s_add_u32 s65, s65, s66
  s_and_b32 s66, s61, 2
  s_lshl_b32 s66, s66, 2
  s_add_u32 s65, s65, s66
  s_mov_b32 s66, s64
  s_and_b32 s78, s66, 3
  s_xor_b32 s79, s78, 2
  s_mul_i32 s78, s78, 294912
  s_mul_i32 s79, s79, 294912
  v_lshrrev_b32 v14, 5, v1
  v_lshl_add_u32 v14, v14, 4, s65
  v_bfe_u32 v15, v1, 3, 2
  v_lshl_add_u32 v14, v15, 1, v14
  v_mul_u32_u24 v14, 1152, v14
  v_and_b32 v15, 7, v1
  v_lshl_add_u32 v2, v15, 4, v14
  s_waitcnt lgkmcnt(0)
  s_mov_b32 s4, s36
  s_and_b32 s5, s37, 0xffff
  s_mov_b32 s6, 2359296
  s_mov_b32 s7, 0x00020000
  buffer_load_dwordx4 v[16:19], v2, s[4:7], s78 offen offset:0
  buffer_load_dwordx4 v[20:23], v2, s[4:7], s78 offen offset:128
  buffer_load_dwordx4 v[24:27], v2, s[4:7], s78 offen offset:256
  buffer_load_dwordx4 v[28:31], v2, s[4:7], s78 offen offset:384
  buffer_load_dwordx4 v[32:35], v2, s[4:7], s78 offen offset:512
  buffer_load_dwordx4 v[36:39], v2, s[4:7], s78 offen offset:640
  buffer_load_dwordx4 v[40:43], v2, s[4:7], s78 offen offset:768
  buffer_load_dwordx4 v[44:47], v2, s[4:7], s78 offen offset:896
  buffer_load_dwordx4 v[48:51], v2, s[4:7], s78 offen offset:1024
  s_mov_b32 s16, s56
  s_and_b32 s17, s57, 0xffff
  s_mov_b32 s18, 67108864
  s_mov_b32 s19, 0x00020000
  s_mov_b32 s8, s44
  s_and_b32 s9, s45, 0xffff
  s_mov_b32 s10, 5308416
  s_mov_b32 s11, 0x00020000
  s_mov_b32 s12, s48
  s_and_b32 s13, s49, 0xffff
  s_mov_b32 s14, 5308416
  s_mov_b32 s15, 0x00020000
  s_mov_b32 s20, s46
  s_and_b32 s21, s47, 0xffff
  s_mov_b32 s22, 9216
  s_mov_b32 s23, 0x00020000
  s_lshl_b32 s67, s60, 10
  s_mul_i32 s68, s62, 768
  s_mul_i32 s69, s62, 442368
  s_and_b32 s66, s61, 7
  s_cmp_ge_u32 s66, 6
  s_cselect_b32 s74, 6, 0
  s_sub_u32 s66, s66, s74
  s_lshl_b32 s74, s66, 7
  s_add_u32 s28, s68, s74
  s_mul_i32 s74, s66, 73728
  s_add_u32 s80, s69, s74
  s_add_u32 s66, s66, 1
  s_cmp_ge_u32 s66, 6
  s_cselect_b32 s74, 6, 0
  s_sub_u32 s66, s66, s74
  s_lshl_b32 s74, s66, 7
  s_add_u32 s29, s68, s74
  s_mul_i32 s74, s66, 73728
  s_add_u32 s81, s69, s74
  s_add_u32 s66, s66, 1
  s_cmp_ge_u32 s66, 6
  s_cselect_b32 s74, 6, 0
  s_sub_u32 s66, s66, s74
  s_lshl_b32 s74, s66, 7
  s_add_u32 s30, s68, s74
  s_mul_i32 s74, s66, 73728
  s_add_u32 s82, s69, s74
  s_add_u32 s66, s66, 1
  s_cmp_ge_u32 s66, 6
  s_cselect_b32 s74, 6, 0
  s_sub_u32 s66, s66, s74
  s_lshl_b32 s74, s66, 7
  s_add_u32 s31, s68, s74
  s_mul_i32 s74, s66, 73728
  s_add_u32 s83, s69, s74
  s_add_u32 s66, s66, 1
  s_cmp_ge_u32 s66, 6
  s_cselect_b32 s74, 6, 0
  s_sub_u32 s66, s66, s74
  s_lshl_b32 s74, s66, 7
  s_add_u32 s32, s68, s74
  s_mul_i32 s74, s66, 73728
  s_add_u32 s84, s69, s74
  s_add_u32 s66, s66, 1
  s_cmp_ge_u32 s66, 6
  s_cselect_b32 s74, 6, 0
  s_sub_u32 s66, s66, s74
  s_lshl_b32 s74, s66, 7
  s_add_u32 s33, s68, s74
  s_mul_i32 s74, s66, 73728
  s_add_u32 s85, s69, s74
  s_add_u32 s66, s66, 1
  s_mul_hi_u32 s66, s61, 0x55555556
  s_mul_i32 s66, s66, 3
  s_sub_u32 s66, s61, s66
  s_mul_i32 s65, s70, 3
  s_cmp_ge_u32 s66, 3
  s_cselect_b32 s74, 3, 0
  s_sub_u32 s66, s66, s74
  s_add_u32 s74, s65, s66
  s_lshl_b32 s86, s74, 7
  s_add_u32 s66, s66, 1
  s_cmp_ge_u32 s66, 3
  s_cselect_b32 s74, 3, 0
  s_sub_u32 s66, s66, s74
  s_add_u32 s74, s65, s66
  s_lshl_b32 s87, s74, 7
  s_add_u32 s66, s66, 1
  s_cmp_ge_u32 s66, 3
  s_cselect_b32 s74, 3, 0
  s_sub_u32 s66, s66, s74
  s_add_u32 s74, s65, s66
  s_lshl_b32 s88, s74, 7
  s_add_u32 s66, s66, 1
  s_mul_i32 s35, s61, 12
  s_add_u32 s35, s35, s62
  s_add_u32 s66, s70, 1
  s_cmp_ge_u32 s66, 3
  s_cselect_b32 s66, -2, 1
  s_mul_i32 s74, s66, 442368
  s_add_u32 s89, s86, s74
  s_add_u32 s90, s87, s74
  s_add_u32 s91, s88, s74
  s_add_u32 s34, s35, s66
  s_add_u32 s66, s70, 2
  s_cmp_ge_u32 s66, 3
  s_cselect_b32 s66, -1, 2
  s_mul_i32 s74, s66, 442368
  s_add_u32 s92, s86, s74
  s_add_u32 s93, s87, s74
  s_add_u32 s94, s88, s74
  s_add_u32 s3, s35, s66
  v_lshrrev_b32 v14, 2, v1
  v_lshrrev_b32 v15, 4, v1
  v_xor_b32 v14, v14, v15
  v_and_b32 v14, 1, v14
  v_lshlrev_b32 v14, 6, v14
  v_and_b32 v15, 3, v1
  v_lshl_add_u32 v14, v15, 4, v14
  v_lshrrev_b32 v15, 3, v0
  v_mul_u32_u24 v3, 9216, v15
  v_add_u32 v3, v3, v14
  v_mul_u32_u24 v4, 1152, v15
  v_add_u32 v4, v4, v14
  v_bfe_u32 v14, v1, 3, 1
  v_xor_b32 v14, s64, v14
  v_lshlrev_b32 v14, 6, v14
  v_bfe_u32 v15, v1, 4, 1
  v_lshl_add_u32 v14, v15, 5, v14
  v_and_b32 v15, 3, v1
  v_lshl_add_u32 v14, v15, 3, v14
  v_bfe_u32 v15, v1, 2, 2
  v_lshl_add_u32 v14, v15, 7, v14
  v_lshrrev_b32 v15, 5, v1
  v_lshl_add_u32 v5, v15, 10, v14
  v_and_b32 v14, 0xffffffc7, v14
  v_lshl_add_u32 v14, v15, 9, v14
  v_and_b32 v15, 1, v1
  v_lshl_add_u32 v14, v15, 5, v14
  v_bfe_u32 v15, v1, 4, 1
  v_lshl_add_u32 v14, v15, 4, v14
  v_bfe_u32 v15, v1, 1, 1
  v_lshl_add_u32 v8, v15, 3, v14
  v_add_u32 v6, 0x10000, v5
  v_add_u32 v7, 0x20000, v5
  v_add_u32 v9, 0x10000, v8
  v_add_u32 v10, 0x20000, v8
  s_lshl_b32 s66, s63, 10
  v_lshl_add_u32 v104, v1, 4, s66
  v_add_u32 v104, 0x10000, v104
  v_add_u32 v105, 0x10000, v104
  s_lshl_b32 s66, s64, 13
  v_add_u32 v106, s66, v104
  v_add_u32 v107, s66, v105
  v_lshlrev_b32 v12, 4, v1
  s_lshl_b32 s75, s61, 2
  s_add_u32 s75, s75, s63
  s_mul_i32 s75, s75, 147584
  s_lshl_b32 s66, s64, 13
  s_add_u32 s75, s75, s66
  s_mul_hi_u32 s66, s62, 0x55555556
  s_lshl_b32 s66, s66, 10
  s_add_u32 s75, s75, s66
  s_mov_b32 s71, 0xffff0000
  s_mov_b32 s72, 0x409d30fc
  s_mov_b32 s73, 0x3eeff558
  v_bfe_u32 v14, v1, 1, 2
  v_mul_u32_u24 v14, 2208, v14
  v_and_b32 v15, 1, v1
  v_mul_u32_u24 v15, 528, v15
  v_add_u32 v14, v14, v15
  v_lshrrev_b32 v15, 3, v1
  v_lshl_add_u32 v14, v15, 4, v14
  s_mul_i32 s76, s64, 1056
  s_lshl_b32 s66, s63, 7
  s_add_u32 s76, s76, s66
  s_add_u32 s76, s76, 81920
  v_add_u32 v108, s76, v14
  v_add_u32 v109, 35328, v108
  s_mov_b32 s77, s63
  s_and_b32 s66, s77, 1
  s_mul_i32 s66, s66, 1056
  s_add_u32 s66, s66, 81920
  s_bfe_u32 s77, s77, 0x10001
  v_lshrrev_b32 v14, 5, v1
  v_mul_u32_u24 v14, 528, v14
  v_and_b32 v15, 31, v1
  v_lshl_add_u32 v14, v15, 4, v14
  v_add_u32 v110, s66, v14
  v_add_u32 v111, 39744, v110
  v_and_b32 v14, 15, v1
  v_lshrrev_b32 v15, 4, v1
  v_lshlrev_b32 v15, 2, v15
  v_cmp_eq_u32 vcc, v14, v15
  v_mov_b32 v14, 0
  v_mov_b32 v15, 0x3f803f80
  v_cndmask_b32 v100, v14, v15, vcc
  v_cndmask_b32 v101, v14, v15, vcc
  v_cndmask_b32 v102, v14, v15, vcc
  v_cndmask_b32 v103, v14, v15, vcc
  s_cmp_eq_u32 s60, 0
  s_cbranch_scc0 L_pt0_0
  s_call_b64 s[58:59], L_stub2
L_pt0_0:
  s_cmp_eq_u32 s60, 1
  s_cbranch_scc0 L_pt0_1
  s_call_b64 s[58:59], L_stub3
L_pt0_1:
  s_cmp_eq_u32 s60, 2
  s_cbranch_scc0 L_pt0_2
  s_call_b64 s[58:59], L_stub4
L_pt0_2:
  s_cmp_eq_u32 s60, 3
  s_cbranch_scc0 L_pt0_3
  s_call_b64 s[58:59], L_stub5
L_pt0_3:
  s_cmp_eq_u32 s60, 4
  s_cbranch_scc0 L_pt0_4
  s_call_b64 s[58:59], L_stub6
L_pt0_4:
  s_cmp_eq_u32 s60, 5
  s_cbranch_scc0 L_pt0_5
  s_call_b64 s[58:59], L_stub7
L_pt0_5:
  s_cmp_eq_u32 s60, 6
  s_cbranch_scc0 L_pt0_6
  s_call_b64 s[58:59], L_stub8
L_pt0_6:
  s_cmp_eq_u32 s60, 7
  s_cbranch_scc0 L_pt0_7
  s_call_b64 s[58:59], L_stub9
L_pt0_7:
  s_cmp_eq_u32 s60, 0
  s_cbranch_scc0 L_pt0_8
  s_call_b64 s[58:59], L_stub10
L_pt0_8:
  s_cmp_eq_u32 s60, 1
  s_cbranch_scc0 L_pt0_9
  s_call_b64 s[58:59], L_stub11
L_pt0_9:
  s_cmp_eq_u32 s60, 2
  s_cbranch_scc0 L_pt0_10
  s_call_b64 s[58:59], L_stub12
L_pt0_10:
  s_cmp_eq_u32 s60, 3
  s_cbranch_scc0 L_pt0_11
  s_call_b64 s[58:59], L_stub13
L_pt0_11:
  s_cmp_eq_u32 s60, 4
  s_cbranch_scc0 L_pt0_12
  s_call_b64 s[58:59], L_stub14
L_pt0_12:
  s_branch L_ln
  .p2align 12
L_stub1:
  s_setpc_b64 s[58:59]
  s_nop 0
L_ln:
  s_mov_b32 s70, 0x3f803f80
  v_mov_b32 v88, 0
  v_mov_b32 v89, 0
  v_mov_b32 v90, 0
  v_mov_b32 v91, 0
  s_waitcnt vmcnt(8)
  v_dot2_f32_bf16 v90, v16, v16, v90
  v_dot2_f32_bf16 v91, v17, v17, v91
  v_dot2_f32_bf16 v90, v18, v18, v90
  v_dot2_f32_bf16 v91, v19, v19, v91
  buffer_load_dwordx4 v[52:55], v2, s[4:7], s79 offen offset:0
  s_waitcnt vmcnt(8)
  v_dot2_f32_bf16 v90, v20, v20, v90
  v_dot2_f32_bf16 v91, v21, v21, v91
  v_dot2_f32_bf16 v90, v22, v22, v90
  v_dot2_f32_bf16 v91, v23, v23, v91
  buffer_load_dwordx4 v[56:59], v2, s[4:7], s79 offen offset:128
  s_waitcnt vmcnt(8)
  v_dot2_f32_bf16 v90, v24, v24, v90
  v_dot2_f32_bf16 v91, v25, v25, v91
  v_dot2_f32_bf16 v90, v26, v26, v90
  v_dot2_f32_bf16 v91, v27, v27, v91
  buffer_load_dwordx4 v[60:63], v2, s[4:7], s79 offen offset:256
  s_waitcnt vmcnt(8)
  v_dot2_f32_bf16 v90, v28, v28, v90
  v_dot2_f32_bf16 v91, v29, v29, v91
  v_dot2_f32_bf16 v90, v30, v30, v90
  v_dot2_f32_bf16 v91, v31, v31, v91
  buffer_load_dwordx4 v[64:67], v2, s[4:7], s79 offen offset:384
  s_waitcnt vmcnt(8)
  v_dot2_f32_bf16 v90, v32, v32, v90
  v_dot2_f32_bf16 v91, v33, v33, v91
  v_dot2_f32_bf16 v90, v34, v34, v90
  v_dot2_f32_bf16 v91, v35, v35, v91
  buffer_load_dwordx4 v[68:71], v2, s[4:7], s79 offen offset:512
  s_waitcnt vmcnt(8)
  v_dot2_f32_bf16 v90, v36, v36, v90
  v_dot2_f32_bf16 v91, v37, v37, v91
  v_dot2_f32_bf16 v90, v38, v38, v90
  v_dot2_f32_bf16 v91, v39, v39, v91
  buffer_load_dwordx4 v[72:75], v2, s[4:7], s79 offen offset:640
  s_waitcnt vmcnt(8)
  v_dot2_f32_bf16 v90, v40, v40, v90
  v_dot2_f32_bf16 v91, v41, v41, v91
  v_dot2_f32_bf16 v90, v42, v42, v90
  v_dot2_f32_bf16 v91, v43, v43, v91
  buffer_load_dwordx4 v[76:79], v2, s[4:7], s79 offen offset:768
  s_waitcnt vmcnt(8)
  v_dot2_f32_bf16 v90, v44, v44, v90
  v_dot2_f32_bf16 v91, v45, v45, v91
  v_dot2_f32_bf16 v90, v46, v46, v90
  v_dot2_f32_bf16 v91, v47, v47, v91
  buffer_load_dwordx4 v[80:83], v2, s[4:7], s79 offen offset:896
  s_waitcnt vmcnt(8)
  v_dot2_f32_bf16 v90, v48, v48, v90
  v_dot2_f32_bf16 v91, v49, v49, v91
  v_dot2_f32_bf16 v90, v50, v50, v90
  v_dot2_f32_bf16 v91, v51, v51, v91
  buffer_load_dwordx4 v[84:87], v2, s[4:7], s79 offen offset:1024
  v_mfma_f32_16x16x32_bf16 v[92:95], v[100:103], v[16:19], 0
  v_mfma_f32_16x16x32_bf16 v[92:95], v[100:103], v[20:23], v[92:95]
  v_mfma_f32_16x16x32_bf16 v[92:95], v[100:103], v[24:27], v[92:95]
  v_mfma_f32_16x16x32_bf16 v[92:95], v[100:103], v[28:31], v[92:95]
  v_mfma_f32_16x16x32_bf16 v[92:95], v[100:103], v[32:35], v[92:95]
  v_mfma_f32_16x16x32_bf16 v[92:95], v[100:103], v[36:39], v[92:95]
  v_mfma_f32_16x16x32_bf16 v[92:95], v[100:103], v[40:43], v[92:95]
  v_mfma_f32_16x16x32_bf16 v[92:95], v[100:103], v[44:47], v[92:95]
  v_mfma_f32_16x16x32_bf16 v[92:95], v[100:103], v[48:51], v[92:95]
  v_add_f32 v90, v90, v91
  s_nop 6
  v_mov_b32 v88, v92
  s_nop 1
  v_add_f32_dpp v88, v88, v88 quad_perm:[1,0,3,2] row_mask:0xf bank_mask:0xf
  v_add_f32_dpp v90, v90, v90 quad_perm:[1,0,3,2] row_mask:0xf bank_mask:0xf
  s_nop 0
  v_add_f32_dpp v88, v88, v88 quad_perm:[2,3,0,1] row_mask:0xf bank_mask:0xf
  v_add_f32_dpp v90, v90, v90 quad_perm:[2,3,0,1] row_mask:0xf bank_mask:0xf
  s_nop 0
  v_add_f32_dpp v88, v88, v88 row_half_mirror row_mask:0xf bank_mask:0xf
  v_add_f32_dpp v90, v90, v90 row_half_mirror row_mask:0xf bank_mask:0xf
  v_mul_f32 v88, 0x3ae38e39, v88
  v_mul_f32 v90, 0x3ae38e39, v90
  v_fma_f32 v90, -v88, v88, v90
  v_max_f32 v90, 0, v90
  v_cvt_pk_bf16_f32 v90, 0, v90
  v_cvt_pk_bf16_f32 v88, 0, v88
  v_add_f32 v90, 0x3727c5ac, v90
  v_cvt_pk_bf16_f32 v90, 0, v90
  v_sqrt_f32 v90, v90
  s_nop 0
  v_cvt_pk_bf16_f32 v90, 0, v90
  v_rcp_f32 v89, v90
  s_nop 0
  v_mul_f32 v89, 0x3eeff558, v89
  v_cvt_pk_bf16_f32 v89, 0, v89
  v_mul_f32 v90, v88, v89
  v_sub_f32 v90, 0, v90
  v_lshrrev_b32 v88, 16, v89
  v_dot2_f32_bf16 v92, v16, v88, v90
  v_dot2_f32_bf16 v93, v16, v89, v90
  v_dot2_f32_bf16 v94, v17, v88, v90
  v_dot2_f32_bf16 v95, v17, v89, v90
  v_dot2_f32_bf16 v96, v18, v88, v90
  v_dot2_f32_bf16 v97, v18, v89, v90
  v_dot2_f32_bf16 v98, v19, v88, v90
  v_dot2_f32_bf16 v99, v19, v89, v90
  v_cvt_pk_bf16_f32 v16, v92, v93
  v_cvt_pk_bf16_f32 v17, v94, v95
  v_cvt_pk_bf16_f32 v18, v96, v97
  v_cvt_pk_bf16_f32 v19, v98, v99
  ds_write_b128 v108, v[16:19] offset:0
  v_dot2_f32_bf16 v92, v20, v88, v90
  v_dot2_f32_bf16 v93, v20, v89, v90
  v_dot2_f32_bf16 v94, v21, v88, v90
  v_dot2_f32_bf16 v95, v21, v89, v90
  v_dot2_f32_bf16 v96, v22, v88, v90
  v_dot2_f32_bf16 v97, v22, v89, v90
  v_dot2_f32_bf16 v98, v23, v88, v90
  v_dot2_f32_bf16 v99, v23, v89, v90
  v_cvt_pk_bf16_f32 v20, v92, v93
  v_cvt_pk_bf16_f32 v21, v94, v95
  v_cvt_pk_bf16_f32 v22, v96, v97
  v_cvt_pk_bf16_f32 v23, v98, v99
  ds_write_b128 v108, v[20:23] offset:8832
  v_dot2_f32_bf16 v92, v24, v88, v90
  v_dot2_f32_bf16 v93, v24, v89, v90
  v_dot2_f32_bf16 v94, v25, v88, v90
  v_dot2_f32_bf16 v95, v25, v89, v90
  v_dot2_f32_bf16 v96, v26, v88, v90
  v_dot2_f32_bf16 v97, v26, v89, v90
  v_dot2_f32_bf16 v98, v27, v88, v90
  v_dot2_f32_bf16 v99, v27, v89, v90
  v_cvt_pk_bf16_f32 v24, v92, v93
  v_cvt_pk_bf16_f32 v25, v94, v95
  v_cvt_pk_bf16_f32 v26, v96, v97
  v_cvt_pk_bf16_f32 v27, v98, v99
  ds_write_b128 v108, v[24:27] offset:17664
  v_dot2_f32_bf16 v92, v28, v88, v90
  v_dot2_f32_bf16 v93, v28, v89, v90
  v_dot2_f32_bf16 v94, v29, v88, v90
  v_dot2_f32_bf16 v95, v29, v89, v90
  v_dot2_f32_bf16 v96, v30, v88, v90
  v_dot2_f32_bf16 v97, v30, v89, v90
  v_dot2_f32_bf16 v98, v31, v88, v90
  v_dot2_f32_bf16 v99, v31, v89, v90
  v_cvt_pk_bf16_f32 v28, v92, v93
  v_cvt_pk_bf16_f32 v29, v94, v95
  v_cvt_pk_bf16_f32 v30, v96, v97
  v_cvt_pk_bf16_f32 v31, v98, v99
  ds_write_b128 v108, v[28:31] offset:26496
  v_dot2_f32_bf16 v92, v32, v88, v90
  v_dot2_f32_bf16 v93, v32, v89, v90
  v_dot2_f32_bf16 v94, v33, v88, v90
  v_dot2_f32_bf16 v95, v33, v89, v90
  v_dot2_f32_bf16 v96, v34, v88, v90
  v_dot2_f32_bf16 v97, v34, v89, v90
  v_dot2_f32_bf16 v98, v35, v88, v90
  v_dot2_f32_bf16 v99, v35, v89, v90
  v_cvt_pk_bf16_f32 v32, v92, v93
  v_cvt_pk_bf16_f32 v33, v94, v95
  v_cvt_pk_bf16_f32 v34, v96, v97
  v_cvt_pk_bf16_f32 v35, v98, v99
  ds_write_b128 v109, v[32:35] offset:0
  v_dot2_f32_bf16 v92, v36, v88, v90
  v_dot2_f32_bf16 v93, v36, v89, v90
  v_dot2_f32_bf16 v94, v37, v88, v90
  v_dot2_f32_bf16 v95, v37, v89, v90
  v_dot2_f32_bf16 v96, v38, v88, v90
  v_dot2_f32_bf16 v97, v38, v89, v90
  v_dot2_f32_bf16 v98, v39, v88, v90
  v_dot2_f32_bf16 v99, v39, v89, v90
  v_cvt_pk_bf16_f32 v36, v92, v93
  v_cvt_pk_bf16_f32 v37, v94, v95
  v_cvt_pk_bf16_f32 v38, v96, v97
  v_cvt_pk_bf16_f32 v39, v98, v99
  ds_write_b128 v109, v[36:39] offset:8832
  v_dot2_f32_bf16 v92, v40, v88, v90
  v_dot2_f32_bf16 v93, v40, v89, v90
  v_dot2_f32_bf16 v94, v41, v88, v90
  v_dot2_f32_bf16 v95, v41, v89, v90
  v_dot2_f32_bf16 v96, v42, v88, v90
  v_dot2_f32_bf16 v97, v42, v89, v90
  v_dot2_f32_bf16 v98, v43, v88, v90
  v_dot2_f32_bf16 v99, v43, v89, v90
  v_cvt_pk_bf16_f32 v40, v92, v93
  v_cvt_pk_bf16_f32 v41, v94, v95
  v_cvt_pk_bf16_f32 v42, v96, v97
  v_cvt_pk_bf16_f32 v43, v98, v99
  ds_write_b128 v109, v[40:43] offset:17664
  v_dot2_f32_bf16 v92, v44, v88, v90
  v_dot2_f32_bf16 v93, v44, v89, v90
  v_dot2_f32_bf16 v94, v45, v88, v90
  v_dot2_f32_bf16 v95, v45, v89, v90
  v_dot2_f32_bf16 v96, v46, v88, v90
  v_dot2_f32_bf16 v97, v46, v89, v90
  v_dot2_f32_bf16 v98, v47, v88, v90
  v_dot2_f32_bf16 v99, v47, v89, v90
  v_cvt_pk_bf16_f32 v44, v92, v93
  v_cvt_pk_bf16_f32 v45, v94, v95
  v_cvt_pk_bf16_f32 v46, v96, v97
  v_cvt_pk_bf16_f32 v47, v98, v99
  ds_write_b128 v109, v[44:47] offset:26496
  s_add_u32 m0, s67, 65536
  s_add_u32 s74, s28, 0
  buffer_load_dwordx4 v3, s[8:11], s74 offen lds
  v_dot2_f32_bf16 v92, v48, v88, v90
  v_dot2_f32_bf16 v93, v48, v89, v90
  v_dot2_f32_bf16 v94, v49, v88, v90
  v_dot2_f32_bf16 v95, v49, v89, v90
  v_dot2_f32_bf16 v96, v50, v88, v90
  v_dot2_f32_bf16 v97, v50, v89, v90
  v_dot2_f32_bf16 v98, v51, v88, v90
  v_dot2_f32_bf16 v99, v51, v89, v90
  v_cvt_pk_bf16_f32 v48, v92, v93
  v_cvt_pk_bf16_f32 v49, v94, v95
  v_cvt_pk_bf16_f32 v50, v96, v97
  v_cvt_pk_bf16_f32 v51, v98, v99
  ds_write_b128 v109, v[48:51] offset:35328
  s_add_u32 m0, s67, 73728
  s_add_u32 s74, s28, 589824
  buffer_load_dwordx4 v3, s[8:11], s74 offen lds
  s_waitcnt lgkmcnt(0)
  s_barrier
  s_cmp_eq_u32 s77, 0
  s_cbranch_scc0 L_nerA
  ds_read_b128 v[112:115], v110 offset:0
  ds_read_b128 v[116:119], v110 offset:2208
  ds_read_b128 v[120:123], v110 offset:4416
  ds_read_b128 v[124:127], v110 offset:6624
  ds_read_b128 v[128:131], v110 offset:8832
  ds_read_b128 v[132:135], v110 offset:11040
  ds_read_b128 v[136:139], v110 offset:13248
  ds_read_b128 v[140:143], v110 offset:15456
  ds_read_b128 v[144:147], v110 offset:17664
  ds_read_b128 v[148:151], v110 offset:19872
  ds_read_b128 v[152:155], v110 offset:22080
  ds_read_b128 v[156:159], v110 offset:24288
  ds_read_b128 v[160:163], v110 offset:26496
  ds_read_b128 v[164:167], v110 offset:28704
  ds_read_b128 v[168:171], v110 offset:30912
  ds_read_b128 v[172:175], v110 offset:33120
  ds_read_b128 v[176:179], v110 offset:35328
  ds_read_b128 v[180:183], v110 offset:37536
  ds_read_b128 v[184:187], v111 offset:0
  ds_read_b128 v[188:191], v111 offset:2208
  ds_read_b128 v[192:195], v111 offset:4416
  ds_read_b128 v[196:199], v111 offset:6624
  ds_read_b128 v[200:203], v111 offset:8832
  ds_read_b128 v[204:207], v111 offset:11040
  ds_read_b128 v[208:211], v111 offset:13248
  ds_read_b128 v[212:215], v111 offset:15456
  ds_read_b128 v[216:219], v111 offset:17664
  ds_read_b128 v[220:223], v111 offset:19872
  ds_read_b128 v[224:227], v111 offset:22080
  ds_read_b128 v[228:231], v111 offset:24288
  ds_read_b128 v[232:235], v111 offset:26496
  ds_read_b128 v[236:239], v111 offset:28704
  ds_read_b128 v[240:243], v111 offset:30912
  ds_read_b128 v[244:247], v111 offset:33120
  ds_read_b128 v[248:251], v111 offset:35328
  ds_read_b128 v[252:255], v111 offset:37536
L_nerA:
  s_add_u32 m0, s67, 0
  s_add_u32 s74, s28, 1179648
  buffer_load_dwordx4 v3, s[8:11], s74 offen lds
  s_add_u32 m0, s67, 8192
  s_add_u32 s74, s28, 1769472
  buffer_load_dwordx4 v3, s[8:11], s74 offen lds
  s_add_u32 m0, s67, 16384
  s_add_u32 s74, s28, 2359296
  buffer_load_dwordx4 v3, s[8:11], s74 offen lds
  s_add_u32 m0, s67, 24576
  s_add_u32 s74, s28, 2949120
  buffer_load_dwordx4 v3, s[8:11], s74 offen lds
  s_mov_b32 s70, 0x3f803f80
  v_mov_b32 v88, 0
  v_mov_b32 v89, 0
  v_mov_b32 v90, 0
  v_mov_b32 v91, 0
  s_waitcnt vmcnt(14)
  v_dot2_f32_bf16 v90, v52, v52, v90
  v_dot2_f32_bf16 v91, v53, v53, v91
  v_dot2_f32_bf16 v90, v54, v54, v90
  v_dot2_f32_bf16 v91, v55, v55, v91
  s_waitcnt vmcnt(13)
  v_dot2_f32_bf16 v90, v56, v56, v90
  v_dot2_f32_bf16 v91, v57, v57, v91
  v_dot2_f32_bf16 v90, v58, v58, v90
  v_dot2_f32_bf16 v91, v59, v59, v91
  s_waitcnt vmcnt(12)
  v_dot2_f32_bf16 v90, v60, v60, v90
  v_dot2_f32_bf16 v91, v61, v61, v91
  v_dot2_f32_bf16 v90, v62, v62, v90
  v_dot2_f32_bf16 v91, v63, v63, v91
  s_waitcnt vmcnt(11)
  v_dot2_f32_bf16 v90, v64, v64, v90
  v_dot2_f32_bf16 v91, v65, v65, v91
  v_dot2_f32_bf16 v90, v66, v66, v90
  v_dot2_f32_bf16 v91, v67, v67, v91
  s_waitcnt vmcnt(10)
  v_dot2_f32_bf16 v90, v68, v68, v90
  v_dot2_f32_bf16 v91, v69, v69, v91
  v_dot2_f32_bf16 v90, v70, v70, v90
  v_dot2_f32_bf16 v91, v71, v71, v91
  s_waitcnt vmcnt(9)
  v_dot2_f32_bf16 v90, v72, v72, v90
  v_dot2_f32_bf16 v91, v73, v73, v91
  v_dot2_f32_bf16 v90, v74, v74, v90
  v_dot2_f32_bf16 v91, v75, v75, v91
  s_waitcnt vmcnt(8)
  v_dot2_f32_bf16 v90, v76, v76, v90
  v_dot2_f32_bf16 v91, v77, v77, v91
  v_dot2_f32_bf16 v90, v78, v78, v90
  v_dot2_f32_bf16 v91, v79, v79, v91
  s_waitcnt vmcnt(7)
  v_dot2_f32_bf16 v90, v80, v80, v90
  v_dot2_f32_bf16 v91, v81, v81, v91
  v_dot2_f32_bf16 v90, v82, v82, v90
  v_dot2_f32_bf16 v91, v83, v83, v91
  s_waitcnt vmcnt(6)
  v_dot2_f32_bf16 v90, v84, v84, v90
  v_dot2_f32_bf16 v91, v85, v85, v91
  v_dot2_f32_bf16 v90, v86, v86, v90
  v_dot2_f32_bf16 v91, v87, v87, v91
  v_mfma_f32_16x16x32_bf16 v[92:95], v[100:103], v[52:55], 0
  v_mfma_f32_16x16x32_bf16 v[92:95], v[100:103], v[56:59], v[92:95]
  v_mfma_f32_16x16x32_bf16 v[92:95], v[100:103], v[60:63], v[92:95]
  v_mfma_f32_16x16x32_bf16 v[92:95], v[100:103], v[64:67], v[92:95]
  v_mfma_f32_16x16x32_bf16 v[92:95], v[100:103], v[68:71], v[92:95]
  v_mfma_f32_16x16x32_bf16 v[92:95], v[100:103], v[72:75], v[92:95]
  v_mfma_f32_16x16x32_bf16 v[92:95], v[100:103], v[76:79], v[92:95]
  v_mfma_f32_16x16x32_bf16 v[92:95], v[100:103], v[80:83], v[92:95]
  v_mfma_f32_16x16x32_bf16 v[92:95], v[100:103], v[84:87], v[92:95]
  v_add_f32 v90, v90, v91
  s_nop 6
  v_mov_b32 v88, v92
  s_nop 1
  v_add_f32_dpp v88, v88, v88 quad_perm:[1,0,3,2] row_mask:0xf bank_mask:0xf
  v_add_f32_dpp v90, v90, v90 quad_perm:[1,0,3,2] row_mask:0xf bank_mask:0xf
  s_nop 0
  v_add_f32_dpp v88, v88, v88 quad_perm:[2,3,0,1] row_mask:0xf bank_mask:0xf
  v_add_f32_dpp v90, v90, v90 quad_perm:[2,3,0,1] row_mask:0xf bank_mask:0xf
  s_nop 0
  v_add_f32_dpp v88, v88, v88 row_half_mirror row_mask:0xf bank_mask:0xf
  v_add_f32_dpp v90, v90, v90 row_half_mirror row_mask:0xf bank_mask:0xf
  v_mul_f32 v88, 0x3ae38e39, v88
  v_mul_f32 v90, 0x3ae38e39, v90
  v_fma_f32 v90, -v88, v88, v90
  v_max_f32 v90, 0, v90
  v_cvt_pk_bf16_f32 v90, 0, v90
  v_cvt_pk_bf16_f32 v88, 0, v88
  v_add_f32 v90, 0x3727c5ac, v90
  v_cvt_pk_bf16_f32 v90, 0, v90
  v_sqrt_f32 v90, v90
  s_nop 0
  v_cvt_pk_bf16_f32 v90, 0, v90
  v_rcp_f32 v89, v90
  s_nop 0
  v_mul_f32 v89, 0x3eeff558, v89
  v_cvt_pk_bf16_f32 v89, 0, v89
  v_mul_f32 v90, v88, v89
  v_sub_f32 v90, 0, v90
  v_lshrrev_b32 v88, 16, v89
  v_lshlrev_b32 v14, 1, v1
  s_lshl_b32 s66, s64, 6
  v_add_u32 v14, s66, v14
  v_cmp_gt_u32 vcc, 32, v1
  v_mov_b32 v15, 0x40000000
  s_nop 0
  v_cndmask_b32 v14, v15, v14, vcc
  buffer_load_ushort v40, v14, s[20:23], s28 offen
  buffer_load_ushort v41, v14, s[20:23], s29 offen
  buffer_load_ushort v42, v14, s[20:23], s30 offen
  buffer_load_ushort v43, v14, s[20:23], s31 offen
  buffer_load_ushort v44, v14, s[20:23], s32 offen
  buffer_load_ushort v45, v14, s[20:23], s33 offen
  v_dot2_f32_bf16 v92, v52, v88, v90
  v_dot2_f32_bf16 v93, v52, v89, v90
  v_dot2_f32_bf16 v94, v53, v88, v90
  v_dot2_f32_bf16 v95, v53, v89, v90
  v_dot2_f32_bf16 v96, v54, v88, v90
  v_dot2_f32_bf16 v97, v54, v89, v90
  v_dot2_f32_bf16 v98, v55, v88, v90
  v_dot2_f32_bf16 v99, v55, v89, v90
  v_cvt_pk_bf16_f32 v52, v92, v93
  v_cvt_pk_bf16_f32 v53, v94, v95
  v_cvt_pk_bf16_f32 v54, v96, v97
  v_cvt_pk_bf16_f32 v55, v98, v99
  s_waitcnt lgkmcnt(0)
  s_barrier
  ds_write_b128 v108, v[52:55] offset:0
  v_dot2_f32_bf16 v92, v56, v88, v90
  v_dot2_f32_bf16 v93, v56, v89, v90
  v_dot2_f32_bf16 v94, v57, v88, v90
  v_dot2_f32_bf16 v95, v57, v89, v90
  v_dot2_f32_bf16 v96, v58, v88, v90
  v_dot2_f32_bf16 v97, v58, v89, v90
  v_dot2_f32_bf16 v98, v59, v88, v90
  v_dot2_f32_bf16 v99, v59, v89, v90
  v_cvt_pk_bf16_f32 v56, v92, v93
  v_cvt_pk_bf16_f32 v57, v94, v95
  v_cvt_pk_bf16_f32 v58, v96, v97
  v_cvt_pk_bf16_f32 v59, v98, v99
  s_add_u32 m0, s67, 32768
  s_add_u32 s74, s28, 3538944
  buffer_load_dwordx4 v3, s[8:11], s74 offen lds
  ds_write_b128 v108, v[56:59] offset:8832
  v_dot2_f32_bf16 v92, v60, v88, v90
  v_dot2_f32_bf16 v93, v60, v89, v90
  v_dot2_f32_bf16 v94, v61, v88, v90
  v_dot2_f32_bf16 v95, v61, v89, v90
  v_dot2_f32_bf16 v96, v62, v88, v90
  v_dot2_f32_bf16 v97, v62, v89, v90
  v_dot2_f32_bf16 v98, v63, v88, v90
  v_dot2_f32_bf16 v99, v63, v89, v90
  v_cvt_pk_bf16_f32 v60, v92, v93
  v_cvt_pk_bf16_f32 v61, v94, v95
  v_cvt_pk_bf16_f32 v62, v96, v97
  v_cvt_pk_bf16_f32 v63, v98, v99
  s_add_u32 m0, s67, 40960
  s_add_u32 s74, s28, 4128768
  buffer_load_dwordx4 v3, s[8:11], s74 offen lds
  ds_write_b128 v108, v[60:63] offset:17664
  v_dot2_f32_bf16 v92, v64, v88, v90
  v_dot2_f32_bf16 v93, v64, v89, v90
  v_dot2_f32_bf16 v94, v65, v88, v90
  v_dot2_f32_bf16 v95, v65, v89, v90
  v_dot2_f32_bf16 v96, v66, v88, v90
  v_dot2_f32_bf16 v97, v66, v89, v90
  v_dot2_f32_bf16 v98, v67, v88, v90
  v_dot2_f32_bf16 v99, v67, v89, v90
  v_cvt_pk_bf16_f32 v64, v92, v93
  v_cvt_pk_bf16_f32 v65, v94, v95
  v_cvt_pk_bf16_f32 v66, v96, v97
  v_cvt_pk_bf16_f32 v67, v98, v99
  s_add_u32 m0, s67, 49152
  s_add_u32 s74, s28, 4718592
  buffer_load_dwordx4 v3, s[8:11], s74 offen lds
  ds_write_b128 v108, v[64:67] offset:26496
  v_dot2_f32_bf16 v92, v68, v88, v90
  v_dot2_f32_bf16 v93, v68, v89, v90
  v_dot2_f32_bf16 v94, v69, v88, v90
  v_dot2_f32_bf16 v95, v69, v89, v90
  v_dot2_f32_bf16 v96, v70, v88, v90
  v_dot2_f32_bf16 v97, v70, v89, v90
  v_dot2_f32_bf16 v98, v71, v88, v90
  v_dot2_f32_bf16 v99, v71, v89, v90
  v_cvt_pk_bf16_f32 v68, v92, v93
  v_cvt_pk_bf16_f32 v69, v94, v95
  v_cvt_pk_bf16_f32 v70, v96, v97
  v_cvt_pk_bf16_f32 v71, v98, v99
  s_add_u32 m0, s67, 57344
  s_add_u32 s74, s29, 0
  buffer_load_dwordx4 v3, s[8:11], s74 offen lds
  ds_write_b128 v109, v[68:71] offset:0
  v_dot2_f32_bf16 v92, v72, v88, v90
  v_dot2_f32_bf16 v93, v72, v89, v90
  v_dot2_f32_bf16 v94, v73, v88, v90
  v_dot2_f32_bf16 v95, v73, v89, v90
  v_dot2_f32_bf16 v96, v74, v88, v90
  v_dot2_f32_bf16 v97, v74, v89, v90
  v_dot2_f32_bf16 v98, v75, v88, v90
  v_dot2_f32_bf16 v99, v75, v89, v90
  v_cvt_pk_bf16_f32 v72, v92, v93
  v_cvt_pk_bf16_f32 v73, v94, v95
  v_cvt_pk_bf16_f32 v74, v96, v97
  v_cvt_pk_bf16_f32 v75, v98, v99
  ds_write_b128 v109, v[72:75] offset:8832
  v_dot2_f32_bf16 v92, v76, v88, v90
  v_dot2_f32_bf16 v93, v76, v89, v90
  v_dot2_f32_bf16 v94, v77, v88, v90
  v_dot2_f32_bf16 v95, v77, v89, v90
  v_dot2_f32_bf16 v96, v78, v88, v90
  v_dot2_f32_bf16 v97, v78, v89, v90
  v_dot2_f32_bf16 v98, v79, v88, v90
  v_dot2_f32_bf16 v99, v79, v89, v90
  v_cvt_pk_bf16_f32 v76, v92, v93
  v_cvt_pk_bf16_f32 v77, v94, v95
  v_cvt_pk_bf16_f32 v78, v96, v97
  v_cvt_pk_bf16_f32 v79, v98, v99
  ds_write_b128 v109, v[76:79] offset:17664
  v_dot2_f32_bf16 v92, v80, v88, v90
  v_dot2_f32_bf16 v93, v80, v89, v90
  v_dot2_f32_bf16 v94, v81, v88, v90
  v_dot2_f32_bf16 v95, v81, v89, v90
  v_dot2_f32_bf16 v96, v82, v88, v90
  v_dot2_f32_bf16 v97, v82, v89, v90
  v_dot2_f32_bf16 v98, v83, v88, v90
  v_dot2_f32_bf16 v99, v83, v89, v90
  v_cvt_pk_bf16_f32 v80, v92, v93
  v_cvt_pk_bf16_f32 v81, v94, v95
  v_cvt_pk_bf16_f32 v82, v96, v97
  v_cvt_pk_bf16_f32 v83, v98, v99
  ds_write_b128 v109, v[80:83] offset:26496
  v_dot2_f32_bf16 v92, v84, v88, v90
  v_dot2_f32_bf16 v93, v84, v89, v90
  v_dot2_f32_bf16 v94, v85, v88, v90
  v_dot2_f32_bf16 v95, v85, v89, v90
  v_dot2_f32_bf16 v96, v86, v88, v90
  v_dot2_f32_bf16 v97, v86, v89, v90
  v_dot2_f32_bf16 v98, v87, v88, v90
  v_dot2_f32_bf16 v99, v87, v89, v90
  v_cvt_pk_bf16_f32 v84, v92, v93
  v_cvt_pk_bf16_f32 v85, v94, v95
  v_cvt_pk_bf16_f32 v86, v96, v97
  v_cvt_pk_bf16_f32 v87, v98, v99
  ds_write_b128 v109, v[84:87] offset:35328
  s_waitcnt lgkmcnt(0)
  s_waitcnt vmcnt(4)
  v_lshl_or_b32 v96, v40, 16, v40
  v_lshl_or_b32 v97, v41, 16, v41
  v_lshl_or_b32 v98, v42, 16, v42
  v_lshl_or_b32 v99, v43, 16, v43
  v_lshl_or_b32 v100, v44, 16, v44
  v_lshl_or_b32 v101, v45, 16, v45
  v_mov_b32 v89, 0
  v_mov_b32 v93, 0
  v_mov_b32 v90, 0
  v_mov_b32 v94, 0
  v_mov_b32 v91, 0
  v_mov_b32 v95, 0
  v_mov_b32 v92, 0xb8ab3ef0
  v_mov_b32 v88, v96
  s_barrier
  ds_read_b64_tr_b16 v[48:49], v6 offset:0
  ds_read_b64_tr_b16 v[50:51], v6 offset:512
  ds_read_b64_tr_b16 v[52:53], v6 offset:2048
  ds_read_b64_tr_b16 v[54:55], v6 offset:2560
  ds_read_b64_tr_b16 v[56:57], v6 offset:4096
  ds_read_b64_tr_b16 v[58:59], v6 offset:4608
  ds_read_b64_tr_b16 v[60:61], v6 offset:6144
  ds_read_b64_tr_b16 v[62:63], v6 offset:6656
  s_cmp_eq_u32 s64, 0
  s_cbranch_scc0 L_roleB
  s_cmp_eq_u32 s77, 0
  s_cbranch_scc1 L_early0
  s_setprio 1
  ds_read_b128 v[112:115], v110 offset:0
  ds_read_b128 v[116:119], v110 offset:2208
  ds_read_b128 v[120:123], v110 offset:4416
  ds_read_b128 v[124:127], v110 offset:6624
  v_mfma_f32_32x32x16_bf16 v[16:31], v[88:91], v[92:95], 0
  s_waitcnt lgkmcnt(3)
  v_mfma_f32_32x32x16_bf16 v[16:31], v[48:51], v[112:115], v[16:31]
  ds_read_b128 v[128:131], v110 offset:8832
  ds_read_b128 v[132:135], v110 offset:11040
  ds_read_b128 v[136:139], v110 offset:13248
  ds_read_b128 v[140:143], v110 offset:15456
  ds_read_b64_tr_b16 v[64:65], v6 offset:8192
  ds_read_b64_tr_b16 v[66:67], v6 offset:8704
  s_waitcnt lgkmcnt(8)
  v_mfma_f32_32x32x16_bf16 v[16:31], v[52:55], v[116:119], v[16:31]
  ds_read_b128 v[144:147], v110 offset:17664
  ds_read_b128 v[148:151], v110 offset:19872
  ds_read_b128 v[152:155], v110 offset:22080
  s_branch L_pj2
  .p2align 12
L_stub2:
  s_setpc_b64 s[58:59]
  s_nop 0
L_pj2:
  ds_read_b128 v[156:159], v110 offset:24288
  ds_read_b64_tr_b16 v[68:69], v6 offset:10240
  ds_read_b64_tr_b16 v[70:71], v6 offset:10752
  s_waitcnt lgkmcnt(13)
  v_mfma_f32_32x32x16_bf16 v[16:31], v[56:59], v[120:123], v[16:31]
  ds_read_b128 v[160:163], v110 offset:26496
  ds_read_b128 v[164:167], v110 offset:28704
  ds_read_b128 v[168:171], v110 offset:30912
  ds_read_b128 v[172:175], v110 offset:33120
  ds_read_b64_tr_b16 v[48:49], v6 offset:12288
  ds_read_b64_tr_b16 v[50:51], v6 offset:12800
  s_waitcnt lgkmcnt(15)
  v_mfma_f32_32x32x16_bf16 v[16:31], v[60:63], v[124:127], v[16:31]
  ds_read_b128 v[176:179], v110 offset:35328
  ds_read_b128 v[180:183], v110 offset:37536
  ds_read_b128 v[184:187], v111 offset:0
  ds_read_b128 v[188:191], v111 offset:2208
  ds_read_b64_tr_b16 v[52:53], v6 offset:14336
  ds_read_b64_tr_b16 v[54:55], v6 offset:14848
  s_waitcnt lgkmcnt(15)
  v_mfma_f32_32x32x16_bf16 v[16:31], v[64:67], v[128:131], v[16:31]
  ds_read_b128 v[192:195], v111 offset:4416
  ds_read_b128 v[196:199], v111 offset:6624
  ds_read_b128 v[200:203], v111 offset:8832
  ds_read_b128 v[204:207], v111 offset:11040
  ds_read_b64_tr_b16 v[56:57], v5 offset:0
  ds_read_b64_tr_b16 v[58:59], v5 offset:512
  s_waitcnt lgkmcnt(15)
  v_mfma_f32_32x32x16_bf16 v[16:31], v[68:71], v[132:135], v[16:31]
  ds_read_b128 v[208:211], v111 offset:13248
  ds_read_b128 v[212:215], v111 offset:15456
  ds_read_b128 v[216:219], v111 offset:17664
  ds_read_b128 v[220:223], v111 offset:19872
  ds_read_b64_tr_b16 v[60:61], v5 offset:2048
  ds_read_b64_tr_b16 v[62:63], v5 offset:2560
  s_waitcnt lgkmcnt(15)
  v_mfma_f32_32x32x16_bf16 v[16:31], v[48:51], v[136:139], v[16:31]
  ds_read_b128 v[224:227], v111 offset:22080
  ds_read_b128 v[228:231], v111 offset:24288
  ds_read_b128 v[232:235], v111 offset:26496
  ds_read_b128 v[236:239], v111 offset:28704
  ds_read_b64_tr_b16 v[64:65], v5 offset:4096
  ds_read_b64_tr_b16 v[66:67], v5 offset:4608
  s_waitcnt lgkmcnt(15)
  v_mfma_f32_32x32x16_bf16 v[16:31], v[52:55], v[140:143], v[16:31]
  ds_read_b128 v[240:243], v111 offset:30912
  ds_read_b128 v[244:247], v111 offset:33120
  ds_read_b128 v[248:251], v111 offset:35328
  ds_read_b128 v[252:255], v111 offset:37536
  ds_read_b64_tr_b16 v[68:69], v5 offset:6144
  ds_read_b64_tr_b16 v[70:71], v5 offset:6656
  s_waitcnt lgkmcnt(15)
  v_mfma_f32_32x32x16_bf16 v[16:31], v[56:59], v[144:147], v[16:31]
  ds_read_b64_tr_b16 v[48:49], v5 offset:8192
  ds_read_b64_tr_b16 v[50:51], v5 offset:8704
  s_waitcnt lgkmcnt(14)
  v_mfma_f32_32x32x16_bf16 v[16:31], v[60:63], v[148:151], v[16:31]
  ds_read_b64_tr_b16 v[52:53], v5 offset:10240
  ds_read_b64_tr_b16 v[54:55], v5 offset:10752
  s_waitcnt lgkmcnt(10)
  v_mfma_f32_32x32x16_bf16 v[16:31], v[64:67], v[152:155], v[16:31]
  ds_read_b64_tr_b16 v[56:57], v5 offset:12288
  ds_read_b64_tr_b16 v[58:59], v5 offset:12800
  s_waitcnt lgkmcnt(6)
  v_mfma_f32_32x32x16_bf16 v[16:31], v[68:71], v[156:159], v[16:31]
  ds_read_b64_tr_b16 v[60:61], v5 offset:14336
  ds_read_b64_tr_b16 v[62:63], v5 offset:14848
  s_setprio 0
  s_waitcnt vmcnt(3)
  s_barrier
  s_branch L_join0
L_early0:
  s_setprio 1
  v_mfma_f32_32x32x16_bf16 v[16:31], v[88:91], v[92:95], 0
  s_waitcnt lgkmcnt(6)
  v_mfma_f32_32x32x16_bf16 v[16:31], v[48:51], v[112:115], v[16:31]
  ds_read_b64_tr_b16 v[64:65], v6 offset:8192
  ds_read_b64_tr_b16 v[66:67], v6 offset:8704
  s_waitcnt lgkmcnt(6)
  v_mfma_f32_32x32x16_bf16 v[16:31], v[52:55], v[116:119], v[16:31]
  ds_read_b64_tr_b16 v[68:69], v6 offset:10240
  ds_read_b64_tr_b16 v[70:71], v6 offset:10752
  s_waitcnt lgkmcnt(6)
  v_mfma_f32_32x32x16_bf16 v[16:31], v[56:59], v[120:123], v[16:31]
  ds_read_b64_tr_b16 v[48:49], v6 offset:12288
  ds_read_b64_tr_b16 v[50:51], v6 offset:12800
  s_waitcnt lgkmcnt(6)
  v_mfma_f32_32x32x16_bf16 v[16:31], v[60:63], v[124:127], v[16:31]
  ds_read_b64_tr_b16 v[52:53], v6 offset:14336
  ds_read_b64_tr_b16 v[54:55], v6 offset:14848
  s_waitcnt lgkmcnt(6)
  v_mfma_f32_32x32x16_bf16 v[16:31], v[64:67], v[128:131], v[16:31]
  ds_read_b64_tr_b16 v[56:57], v5 offset:0
  ds_read_b64_tr_b16 v[58:59], v5 offset:512
  s_waitcnt lgkmcnt(6)
  v_mfma_f32_32x32x16_bf16 v[16:31], v[68:71], v[132:135], v[16:31]
  ds_read_b64_tr_b16 v[60:61], v5 offset:2048
  ds_read_b64_tr_b16 v[62:63], v5 offset:2560
  s_waitcnt lgkmcnt(6)
  v_mfma_f32_32x32x16_bf16 v[16:31], v[48:51], v[136:139], v[16:31]
  ds_read_b64_tr_b16 v[64:65], v5 offset:4096
  ds_read_b64_tr_b16 v[66:67], v5 offset:4608
  s_waitcnt lgkmcnt(6)
  v_mfma_f32_32x32x16_bf16 v[16:31], v[52:55], v[140:143], v[16:31]
  ds_read_b64_tr_b16 v[68:69], v5 offset:6144
  ds_read_b64_tr_b16 v[70:71], v5 offset:6656
  s_waitcnt lgkmcnt(6)
  v_mfma_f32_32x32x16_bf16 v[16:31], v[56:59], v[144:147], v[16:31]
  ds_read_b64_tr_b16 v[48:49], v5 offset:8192
  ds_read_b64_tr_b16 v[50:51], v5 offset:8704
  s_waitcnt lgkmcnt(6)
  v_mfma_f32_32x32x16_bf16 v[16:31], v[60:63], v[148:151], v[16:31]
  ds_read_b64_tr_b16 v[52:53], v5 offset:10240
  ds_read_b64_tr_b16 v[54:55], v5 offset:10752
  s_waitcnt lgkmcnt(6)
  v_mfma_f32_32x32x16_bf16 v[16:31], v[64:67], v[152:155], v[16:31]
  ds_read_b64_tr_b16 v[56:57], v5 offset:12288
  ds_read_b64_tr_b16 v[58:59], v5 offset:12800
  s_waitcnt lgkmcnt(6)
  v_mfma_f32_32x32x16_bf16 v[16:31], v[68:71], v[156:159], v[16:31]
  ds_read_b64_tr_b16 v[60:61], v5 offset:14336
  ds_read_b64_tr_b16 v[62:63], v5 offset:14848
  s_setprio 0
  s_waitcnt vmcnt(3)
  s_barrier
L_join0:
  s_setprio 1
  s_waitcnt lgkmcnt(6)
  v_mfma_f32_32x32x16_bf16 v[16:31], v[48:51], v[160:163], v[16:31]
  ds_read_b64_tr_b16 v[64:65], v5 offset:16384
  ds_read_b64_tr_b16 v[66:67], v5 offset:16896
  s_waitcnt lgkmcnt(6)
  v_mfma_f32_32x32x16_bf16 v[16:31], v[52:55], v[164:167], v[16:31]
  ds_read_b64_tr_b16 v[68:69], v5 offset:18432
  ds_read_b64_tr_b16 v[70:71], v5 offset:18944
  s_waitcnt lgkmcnt(6)
  v_mfma_f32_32x32x16_bf16 v[16:31], v[56:59], v[168:171], v[16:31]
  ds_read_b64_tr_b16 v[48:49], v5 offset:20480
  ds_read_b64_tr_b16 v[50:51], v5 offset:20992
  s_waitcnt lgkmcnt(6)
  v_mfma_f32_32x32x16_bf16 v[16:31], v[60:63], v[172:175], v[16:31]
  ds_read_b64_tr_b16 v[52:53], v5 offset:22528
  ds_read_b64_tr_b16 v[54:55], v5 offset:23040
  s_waitcnt lgkmcnt(6)
  v_mfma_f32_32x32x16_bf16 v[16:31], v[64:67], v[176:179], v[16:31]
  ds_read_b64_tr_b16 v[56:57], v5 offset:24576
  ds_read_b64_tr_b16 v[58:59], v5 offset:25088
  s_waitcnt lgkmcnt(6)
  v_mfma_f32_32x32x16_bf16 v[16:31], v[68:71], v[180:183], v[16:31]
  ds_read_b64_tr_b16 v[60:61], v5 offset:26624
  ds_read_b64_tr_b16 v[62:63], v5 offset:27136
  s_waitcnt lgkmcnt(6)
  v_mfma_f32_32x32x16_bf16 v[16:31], v[48:51], v[184:187], v[16:31]
  ds_read_b64_tr_b16 v[64:65], v5 offset:28672
  ds_read_b64_tr_b16 v[66:67], v5 offset:29184
  s_waitcnt lgkmcnt(6)
  v_mfma_f32_32x32x16_bf16 v[16:31], v[52:55], v[188:191], v[16:31]
  ds_read_b64_tr_b16 v[68:69], v5 offset:30720
  ds_read_b64_tr_b16 v[70:71], v5 offset:31232
  s_waitcnt lgkmcnt(6)
  v_mfma_f32_32x32x16_bf16 v[16:31], v[56:59], v[192:195], v[16:31]
  ds_read_b64_tr_b16 v[48:49], v5 offset:32768
  ds_read_b64_tr_b16 v[50:51], v5 offset:33280
  s_waitcnt lgkmcnt(6)
  v_mfma_f32_32x32x16_bf16 v[16:31], v[60:63], v[196:199], v[16:31]
  ds_read_b64_tr_b16 v[52:53], v5 offset:34816
  ds_read_b64_tr_b16 v[54:55], v5 offset:35328
  s_waitcnt lgkmcnt(6)
  v_mfma_f32_32x32x16_bf16 v[16:31], v[64:67], v[200:203], v[16:31]
  ds_read_b64_tr_b16 v[56:57], v5 offset:36864
  ds_read_b64_tr_b16 v[58:59], v5 offset:37376
  s_waitcnt lgkmcnt(6)
  v_mfma_f32_32x32x16_bf16 v[16:31], v[68:71], v[204:207], v[16:31]
  ds_read_b64_tr_b16 v[60:61], v5 offset:38912
  ds_read_b64_tr_b16 v[62:63], v5 offset:39424
  s_setprio 0
  s_add_u32 m0, s67, 65536
  s_add_u32 s74, s29, 589824
  buffer_load_dwordx4 v3, s[8:11], s74 offen lds
  s_add_u32 m0, s67, 73728
  s_add_u32 s74, s29, 1179648
  buffer_load_dwordx4 v3, s[8:11], s74 offen lds
  s_add_u32 m0, s67, 81920
  s_add_u32 s74, s29, 1769472
  buffer_load_dwordx4 v3, s[8:11], s74 offen lds
  s_add_u32 m0, s67, 90112
  s_add_u32 s74, s29, 2359296
  buffer_load_dwordx4 v3, s[8:11], s74 offen lds
  s_add_u32 m0, s67, 98304
  s_add_u32 s74, s29, 2949120
  buffer_load_dwordx4 v3, s[8:11], s74 offen lds
  v_mov_b32 v88, v97
  s_mov_b32 s24, s54
  s_and_b32 s25, s55, 0xffff
  s_mov_b32 s26, 256
  s_mov_b32 s27, 0x00020000
  v_cmp_eq_u32 vcc, 0, v1
  v_mov_b32 v108, 0
  v_mov_b32 v109, 0x40000000
  v_cndmask_b32 v109, v109, v108, vcc
  v_and_b32 v108, 7, v1
  v_lshlrev_b32 v108, 5, v108
  s_cmp_eq_u32 s63, 0
  s_cselect_b32 s77, 0, 0x1000
  buffer_load_dword v110, v108, s[24:27], s77 offen sc1
  s_waitcnt vmcnt(6)
  s_barrier
  s_setprio 1
  s_waitcnt lgkmcnt(6)
  v_mfma_f32_32x32x16_bf16 v[16:31], v[48:51], v[208:211], v[16:31]
  ds_read_b64_tr_b16 v[64:65], v5 offset:40960
  ds_read_b64_tr_b16 v[66:67], v5 offset:41472
  s_waitcnt lgkmcnt(6)
  v_mfma_f32_32x32x16_bf16 v[16:31], v[52:55], v[212:215], v[16:31]
  ds_read_b64_tr_b16 v[68:69], v5 offset:43008
  ds_read_b64_tr_b16 v[70:71], v5 offset:43520
  s_waitcnt lgkmcnt(6)
  v_mfma_f32_32x32x16_bf16 v[16:31], v[56:59], v[216:219], v[16:31]
  ds_read_b64_tr_b16 v[48:49], v5 offset:45056
  ds_read_b64_tr_b16 v[50:51], v5 offset:45568
  s_waitcnt lgkmcnt(6)
  v_mfma_f32_32x32x16_bf16 v[16:31], v[60:63], v[220:223], v[16:31]
  ds_read_b64_tr_b16 v[52:53], v5 offset:47104
  ds_read_b64_tr_b16 v[54:55], v5 offset:47616
  s_waitcnt lgkmcnt(6)
  v_mfma_f32_32x32x16_bf16 v[16:31], v[64:67], v[224:227], v[16:31]
  ds_read_b64_tr_b16 v[56:57], v5 offset:49152
  ds_read_b64_tr_b16 v[58:59], v5 offset:49664
  s_waitcnt lgkmcnt(6)
  v_mfma_f32_32x32x16_bf16 v[16:31], v[68:71], v[228:231], v[16:31]
  ds_read_b64_tr_b16 v[60:61], v5 offset:51200
  ds_read_b64_tr_b16 v[62:63], v5 offset:51712
  s_waitcnt lgkmcnt(6)
  v_mfma_f32_32x32x16_bf16 v[16:31], v[48:51], v[232:235], v[16:31]
  ds_read_b64_tr_b16 v[64:65], v5 offset:53248
  ds_read_b64_tr_b16 v[66:67], v5 offset:53760
  s_waitcnt lgkmcnt(6)
  v_mfma_f32_32x32x16_bf16 v[16:31], v[52:55], v[236:239], v[16:31]
  ds_read_b64_tr_b16 v[68:69], v5 offset:55296
  ds_read_b64_tr_b16 v[70:71], v5 offset:55808
  s_waitcnt lgkmcnt(6)
  v_mfma_f32_32x32x16_bf16 v[16:31], v[56:59], v[240:243], v[16:31]
  ds_read_b64_tr_b16 v[48:49], v5 offset:57344
  ds_read_b64_tr_b16 v[50:51], v5 offset:57856
  s_waitcnt lgkmcnt(6)
  v_mfma_f32_32x32x16_bf16 v[16:31], v[60:63], v[244:247], v[16:31]
  ds_read_b64_tr_b16 v[52:53], v5 offset:59392
  ds_read_b64_tr_b16 v[54:55], v5 offset:59904
  s_waitcnt lgkmcnt(6)
  v_mfma_f32_32x32x16_bf16 v[16:31], v[64:67], v[248:251], v[16:31]
  ds_read_b64_tr_b16 v[56:57], v5 offset:61440
  ds_read_b64_tr_b16 v[58:59], v5 offset:61952
  s_waitcnt lgkmcnt(6)
  v_mfma_f32_32x32x16_bf16 v[16:31], v[68:71], v[252:255], v[16:31]
  ds_read_b64_tr_b16 v[60:61], v5 offset:63488
  ds_read_b64_tr_b16 v[62:63], v5 offset:64000
  s_setprio 0
  s_add_u32 m0, s67, 106496
  s_add_u32 s74, s29, 3538944
  buffer_load_dwordx4 v3, s[8:11], s74 offen lds
  s_add_u32 m0, s67, 114688
  s_add_u32 s74, s29, 4128768
  buffer_load_dwordx4 v3, s[8:11], s74 offen lds
  s_add_u32 m0, s67, 122880
  s_add_u32 s74, s29, 4718592
  buffer_load_dwordx4 v3, s[8:11], s74 offen lds
  s_add_u32 m0, s67, 131072
  s_add_u32 s74, s30, 0
  buffer_load_dwordx4 v3, s[8:11], s74 offen lds
  s_add_u32 m0, s67, 139264
  s_add_u32 s74, s30, 589824
  buffer_load_dwordx4 v3, s[8:11], s74 offen lds
  s_lshl_b32 s79, s35, 7
  s_add_u32 s79, s79, 49414144
  s_cmp_eq_u32 s60, 0
  s_cselect_b32 s79, s79, 1879048192
  s_mov_b32 s76, 49414144
  s_cselect_b32 s76, s76, 1879048192
  v_mov_b32 v14, s34
  v_mov_b32 v15, s3
  v_cmp_gt_u32 vcc, 32, v1
  s_nop 1
  v_cndmask_b32 v2, v15, v14, vcc
  v_lshlrev_b32 v2, 7, v2
  s_mul_i32 s34, s34, 98304
  s_add_u32 s34, s34, 10485760
  s_add_u32 s34, s34, s67
  s_mul_i32 s3, s3, 98304
  s_add_u32 s3, s3, 10485760
  s_add_u32 s3, s3, s67
  s_mul_i32 s35, s35, 98304
  s_add_u32 s35, s35, 10485760
  s_add_u32 s59, s35, s67
  s_lshl_b32 s66, s64, 13
  s_add_u32 s35, s35, s66
  s_lshl_b32 s66, s63, 10
  s_add_u32 s35, s35, s66
  v_add_u32 v13, 0xffff0000, v104
  s_waitcnt vmcnt(8)
  s_barrier
  s_setprio 1
  v_mfma_f32_32x32x16_bf16 v[32:47], v[88:91], v[92:95], 0
  s_waitcnt lgkmcnt(6)
  v_mfma_f32_32x32x16_bf16 v[32:47], v[48:51], v[112:115], v[32:47]
  ds_read_b64_tr_b16 v[64:65], v6 offset:0
  ds_read_b64_tr_b16 v[66:67], v6 offset:512
  s_waitcnt lgkmcnt(6)
  v_mfma_f32_32x32x16_bf16 v[32:47], v[52:55], v[116:119], v[32:47]
  ds_read_b64_tr_b16 v[68:69], v6 offset:2048
  ds_read_b64_tr_b16 v[70:71], v6 offset:2560
  s_waitcnt lgkmcnt(6)
  v_mfma_f32_32x32x16_bf16 v[32:47], v[56:59], v[120:123], v[32:47]
  ds_read_b64_tr_b16 v[48:49], v6 offset:4096
  ds_read_b64_tr_b16 v[50:51], v6 offset:4608
  s_waitcnt lgkmcnt(6)
  v_mfma_f32_32x32x16_bf16 v[32:47], v[60:63], v[124:127], v[32:47]
  ds_read_b64_tr_b16 v[52:53], v6 offset:6144
  ds_read_b64_tr_b16 v[54:55], v6 offset:6656
  s_waitcnt lgkmcnt(6)
  v_mfma_f32_32x32x16_bf16 v[32:47], v[64:67], v[128:131], v[32:47]
  ds_read_b64_tr_b16 v[56:57], v6 offset:8192
  ds_read_b64_tr_b16 v[58:59], v6 offset:8704
  s_waitcnt lgkmcnt(6)
  v_mfma_f32_32x32x16_bf16 v[32:47], v[68:71], v[132:135], v[32:47]
  ds_read_b64_tr_b16 v[60:61], v6 offset:10240
  ds_read_b64_tr_b16 v[62:63], v6 offset:10752
  s_waitcnt lgkmcnt(6)
  v_mfma_f32_32x32x16_bf16 v[32:47], v[48:51], v[136:139], v[32:47]
  ds_read_b64_tr_b16 v[64:65], v6 offset:12288
  ds_read_b64_tr_b16 v[66:67], v6 offset:12800
  s_waitcnt lgkmcnt(6)
  v_mfma_f32_32x32x16_bf16 v[32:47], v[52:55], v[140:143], v[32:47]
  ds_read_b64_tr_b16 v[68:69], v6 offset:14336
  ds_read_b64_tr_b16 v[70:71], v6 offset:14848
  s_waitcnt lgkmcnt(6)
  v_mfma_f32_32x32x16_bf16 v[32:47], v[56:59], v[144:147], v[32:47]
  ds_read_b64_tr_b16 v[48:49], v6 offset:16384
  ds_read_b64_tr_b16 v[50:51], v6 offset:16896
  s_waitcnt lgkmcnt(6)
  v_mfma_f32_32x32x16_bf16 v[32:47], v[60:63], v[148:151], v[32:47]
  ds_read_b64_tr_b16 v[52:53], v6 offset:18432
  ds_read_b64_tr_b16 v[54:55], v6 offset:18944
  s_waitcnt lgkmcnt(6)
  v_mfma_f32_32x32x16_bf16 v[32:47], v[64:67], v[152:155], v[32:47]
  ds_read_b64_tr_b16 v[56:57], v6 offset:20480
  ds_read_b64_tr_b16 v[58:59], v6 offset:20992
  s_waitcnt lgkmcnt(6)
  v_mfma_f32_32x32x16_bf16 v[32:47], v[68:71], v[156:159], v[32:47]
  ds_read_b64_tr_b16 v[60:61], v6 offset:22528
  ds_read_b64_tr_b16 v[62:63], v6 offset:23040
  s_setprio 0
  s_add_u32 m0, s67, 147456
  s_add_u32 s74, s30, 1179648
  buffer_load_dwordx4 v3, s[8:11], s74 offen lds
  s_add_u32 m0, s67, 155648
  s_add_u32 s74, s30, 1769472
  buffer_load_dwordx4 v3, s[8:11], s74 offen lds
  s_add_u32 m0, s67, 0
  s_add_u32 s74, s30, 2359296
  buffer_load_dwordx4 v3, s[8:11], s74 offen lds
  s_add_u32 m0, s67, 8192
  s_add_u32 s74, s30, 2949120
  buffer_load_dwordx4 v3, s[8:11], s74 offen lds
  s_add_u32 m0, s67, 16384
  s_add_u32 s74, s30, 3538944
  buffer_load_dwordx4 v3, s[8:11], s74 offen lds
  v_fma_f32 v72, v16, v16, s72
  v_fma_f32 v73, v17, v17, s72
  v_fma_f32 v74, v18, v18, s72
  v_fma_f32 v75, v19, v19, s72
  v_mul_f32 v72, v72, v16
  v_mul_f32 v73, v73, v17
  v_mul_f32 v74, v74, v18
  v_mul_f32 v75, v75, v19
  v_exp_f32 v72, -v72
  v_exp_f32 v73, -v73
  v_exp_f32 v74, -v74
  v_exp_f32 v75, -v75
  v_fma_f32 v72, v72, s73, s73
  v_fma_f32 v73, v73, s73, s73
  v_fma_f32 v74, v74, s73, s73
  v_fma_f32 v75, v75, s73, s73
  v_rcp_f32 v72, v72
  v_rcp_f32 v73, v73
  v_rcp_f32 v74, v74
  v_rcp_f32 v75, v75
  v_mul_f32 v72, v72, v16
  v_mul_f32 v73, v73, v17
  v_mul_f32 v74, v74, v18
  v_mul_f32 v75, v75, v19
  v_cvt_pk_bf16_f32 v80, v72, v73
  v_cvt_pk_bf16_f32 v81, v74, v75
  v_fma_f32 v72, v20, v20, s72
  v_fma_f32 v73, v21, v21, s72
  v_fma_f32 v74, v22, v22, s72
  v_fma_f32 v75, v23, v23, s72
  v_mul_f32 v72, v72, v20
  v_mul_f32 v73, v73, v21
  v_mul_f32 v74, v74, v22
  v_mul_f32 v75, v75, v23
  v_exp_f32 v72, -v72
  v_exp_f32 v73, -v73
  v_exp_f32 v74, -v74
  v_exp_f32 v75, -v75
  v_fma_f32 v72, v72, s73, s73
  v_fma_f32 v73, v73, s73, s73
  s_waitcnt vmcnt(9)
  s_barrier
  s_setprio 1
  s_waitcnt lgkmcnt(6)
  v_mfma_f32_32x32x16_bf16 v[32:47], v[48:51], v[160:163], v[32:47]
  ds_read_b64_tr_b16 v[64:65], v6 offset:24576
  ds_read_b64_tr_b16 v[66:67], v6 offset:25088
  s_waitcnt lgkmcnt(6)
  v_mfma_f32_32x32x16_bf16 v[32:47], v[52:55], v[164:167], v[32:47]
  ds_read_b64_tr_b16 v[68:69], v6 offset:26624
  ds_read_b64_tr_b16 v[70:71], v6 offset:27136
  s_waitcnt lgkmcnt(6)
  v_mfma_f32_32x32x16_bf16 v[32:47], v[56:59], v[168:171], v[32:47]
  ds_read_b64_tr_b16 v[48:49], v6 offset:28672
  ds_read_b64_tr_b16 v[50:51], v6 offset:29184
  s_waitcnt lgkmcnt(6)
  v_mfma_f32_32x32x16_bf16 v[32:47], v[60:63], v[172:175], v[32:47]
  ds_read_b64_tr_b16 v[52:53], v6 offset:30720
  ds_read_b64_tr_b16 v[54:55], v6 offset:31232
  s_waitcnt lgkmcnt(6)
  v_mfma_f32_32x32x16_bf16 v[32:47], v[64:67], v[176:179], v[32:47]
  ds_read_b64_tr_b16 v[56:57], v6 offset:32768
  ds_read_b64_tr_b16 v[58:59], v6 offset:33280
  s_waitcnt lgkmcnt(6)
  v_mfma_f32_32x32x16_bf16 v[32:47], v[68:71], v[180:183], v[32:47]
  ds_read_b64_tr_b16 v[60:61], v6 offset:34816
  ds_read_b64_tr_b16 v[62:63], v6 offset:35328
  s_waitcnt lgkmcnt(6)
  v_mfma_f32_32x32x16_bf16 v[32:47], v[48:51], v[184:187], v[32:47]
  ds_read_b64_tr_b16 v[64:65], v6 offset:36864
  ds_read_b64_tr_b16 v[66:67], v6 offset:37376
  s_waitcnt lgkmcnt(6)
  v_mfma_f32_32x32x16_bf16 v[32:47], v[52:55], v[188:191], v[32:47]
  ds_read_b64_tr_b16 v[68:69], v6 offset:38912
  ds_read_b64_tr_b16 v[70:71], v6 offset:39424
  s_waitcnt lgkmcnt(6)
  v_mfma_f32_32x32x16_bf16 v[32:47], v[56:59], v[192:195], v[32:47]
  ds_read_b64_tr_b16 v[48:49], v6 offset:40960
  ds_read_b64_tr_b16 v[50:51], v6 offset:41472
  s_waitcnt lgkmcnt(6)
  v_mfma_f32_32x32x16_bf16 v[32:47], v[60:63], v[196:199], v[32:47]
  ds_read_b64_tr_b16 v[52:53], v6 offset:43008
  ds_read_b64_tr_b16 v[54:55], v6 offset:43520
  s_waitcnt lgkmcnt(6)
  v_mfma_f32_32x32x16_bf16 v[32:47], v[64:67], v[200:203], v[32:47]
  ds_read_b64_tr_b16 v[56:57], v6 offset:45056
  ds_read_b64_tr_b16 v[58:59], v6 offset:45568
  s_waitcnt lgkmcnt(6)
  v_mfma_f32_32x32x16_bf16 v[32:47], v[68:71], v[204:207], v[32:47]
  ds_read_b64_tr_b16 v[60:61], v6 offset:47104
  ds_read_b64_tr_b16 v[62:63], v6 offset:47616
  s_setprio 0
  s_add_u32 m0, s67, 24576
  s_add_u32 s74, s30, 4128768
  buffer_load_dwordx4 v3, s[8:11], s74 offen lds
  v_mov_b32 v88, v98
  v_fma_f32 v74, v74, s73, s73
  v_fma_f32 v75, v75, s73, s73
  v_rcp_f32 v72, v72
  v_rcp_f32 v73, v73
  v_rcp_f32 v74, v74
  v_rcp_f32 v75, v75
  v_mul_f32 v72, v72, v20
  v_mul_f32 v73, v73, v21
  v_mul_f32 v74, v74, v22
  v_mul_f32 v75, v75, v23
  v_cvt_pk_bf16_f32 v82, v72, v73
  v_cvt_pk_bf16_f32 v83, v74, v75
  v_fma_f32 v72, v24, v24, s72
  v_fma_f32 v73, v25, v25, s72
  v_fma_f32 v74, v26, v26, s72
  v_fma_f32 v75, v27, v27, s72
  v_mul_f32 v72, v72, v24
  v_mul_f32 v73, v73, v25
  v_mul_f32 v74, v74, v26
  v_mul_f32 v75, v75, v27
  v_exp_f32 v72, -v72
  v_exp_f32 v73, -v73
  v_exp_f32 v74, -v74
  v_exp_f32 v75, -v75
  v_fma_f32 v72, v72, s73, s73
  v_fma_f32 v73, v73, s73, s73
  v_fma_f32 v74, v74, s73, s73
  v_fma_f32 v75, v75, s73, s73
  v_rcp_f32 v72, v72
  v_rcp_f32 v73, v73
  v_rcp_f32 v74, v74
  s_add_u32 s74, s35, 0
  buffer_store_dwordx4 v[80:83], v12, s[16:19], s74 offen sc1
  ds_write_b128 v106, v[80:83] offset:0
  s_waitcnt vmcnt(8)
  s_barrier
  s_setprio 1
  s_waitcnt lgkmcnt(7)
  v_mfma_f32_32x32x16_bf16 v[32:47], v[48:51], v[208:211], v[32:47]
  ds_read_b64_tr_b16 v[64:65], v6 offset:49152
  ds_read_b64_tr_b16 v[66:67], v6 offset:49664
  s_waitcnt lgkmcnt(7)
  v_mfma_f32_32x32x16_bf16 v[32:47], v[52:55], v[212:215], v[32:47]
  ds_read_b64_tr_b16 v[68:69], v6 offset:51200
  ds_read_b64_tr_b16 v[70:71], v6 offset:51712
  s_waitcnt lgkmcnt(7)
  v_mfma_f32_32x32x16_bf16 v[32:47], v[56:59], v[216:219], v[32:47]
  ds_read_b64_tr_b16 v[48:49], v6 offset:53248
  ds_read_b64_tr_b16 v[50:51], v6 offset:53760
  s_waitcnt lgkmcnt(7)
  v_mfma_f32_32x32x16_bf16 v[32:47], v[60:63], v[220:223], v[32:47]
  ds_read_b64_tr_b16 v[52:53], v6 offset:55296
  ds_read_b64_tr_b16 v[54:55], v6 offset:55808
  s_waitcnt lgkmcnt(6)
  v_mfma_f32_32x32x16_bf16 v[32:47], v[64:67], v[224:227], v[32:47]
  ds_read_b64_tr_b16 v[56:57], v6 offset:57344
  ds_read_b64_tr_b16 v[58:59], v6 offset:57856
  s_waitcnt lgkmcnt(6)
  v_mfma_f32_32x32x16_bf16 v[32:47], v[68:71], v[228:231], v[32:47]
  ds_read_b64_tr_b16 v[60:61], v6 offset:59392
  ds_read_b64_tr_b16 v[62:63], v6 offset:59904
  s_waitcnt lgkmcnt(6)
  v_mfma_f32_32x32x16_bf16 v[32:47], v[48:51], v[232:235], v[32:47]
  ds_read_b64_tr_b16 v[64:65], v6 offset:61440
  ds_read_b64_tr_b16 v[66:67], v6 offset:61952
  s_waitcnt lgkmcnt(6)
  v_mfma_f32_32x32x16_bf16 v[32:47], v[52:55], v[236:239], v[32:47]
  ds_read_b64_tr_b16 v[68:69], v6 offset:63488
  ds_read_b64_tr_b16 v[70:71], v6 offset:64000
  s_waitcnt lgkmcnt(6)
  v_mfma_f32_32x32x16_bf16 v[32:47], v[56:59], v[240:243], v[32:47]
  ds_read_b64_tr_b16 v[48:49], v7 offset:0
  ds_read_b64_tr_b16 v[50:51], v7 offset:512
  s_waitcnt lgkmcnt(6)
  v_mfma_f32_32x32x16_bf16 v[32:47], v[60:63], v[244:247], v[32:47]
  ds_read_b64_tr_b16 v[52:53], v7 offset:2048
  ds_read_b64_tr_b16 v[54:55], v7 offset:2560
  s_waitcnt lgkmcnt(6)
  v_mfma_f32_32x32x16_bf16 v[32:47], v[64:67], v[248:251], v[32:47]
  ds_read_b64_tr_b16 v[56:57], v7 offset:4096
  ds_read_b64_tr_b16 v[58:59], v7 offset:4608
  s_waitcnt lgkmcnt(6)
  v_mfma_f32_32x32x16_bf16 v[32:47], v[68:71], v[252:255], v[32:47]
  ds_read_b64_tr_b16 v[60:61], v7 offset:6144
  ds_read_b64_tr_b16 v[62:63], v7 offset:6656
  s_setprio 0
  s_add_u32 m0, s67, 32768
  s_add_u32 s74, s30, 4718592
  buffer_load_dwordx4 v3, s[8:11], s74 offen lds
  s_add_u32 m0, s67, 98304
  s_add_u32 s74, s31, 0
  buffer_load_dwordx4 v3, s[8:11], s74 offen lds
  s_add_u32 m0, s67, 40960
  s_add_u32 s74, s31, 589824
  buffer_load_dwordx4 v3, s[8:11], s74 offen lds
  v_rcp_f32 v75, v75
  v_mul_f32 v72, v72, v24
  v_mul_f32 v73, v73, v25
  v_mul_f32 v74, v74, v26
  v_mul_f32 v75, v75, v27
  v_cvt_pk_bf16_f32 v84, v72, v73
  v_cvt_pk_bf16_f32 v85, v74, v75
  v_fma_f32 v72, v28, v28, s72
  v_fma_f32 v73, v29, v29, s72
  v_fma_f32 v74, v30, v30, s72
  v_fma_f32 v75, v31, v31, s72
  v_mul_f32 v72, v72, v28
  v_mul_f32 v73, v73, v29
  v_mul_f32 v74, v74, v30
  v_mul_f32 v75, v75, v31
  v_exp_f32 v72, -v72
  v_exp_f32 v73, -v73
  v_exp_f32 v74, -v74
  v_exp_f32 v75, -v75
  v_fma_f32 v72, v72, s73, s73
  v_fma_f32 v73, v73, s73, s73
  v_fma_f32 v74, v74, s73, s73
  v_fma_f32 v75, v75, s73, s73
  v_rcp_f32 v72, v72
  v_rcp_f32 v73, v73
  v_rcp_f32 v74, v74
  v_rcp_f32 v75, v75
  v_mul_f32 v72, v72, v28
  v_mul_f32 v73, v73, v29
  v_mul_f32 v74, v74, v30
  v_mul_f32 v75, v75, v31
  v_cvt_pk_bf16_f32 v86, v72, v73
  v_cvt_pk_bf16_f32 v87, v74, v75
  s_add_u32 s74, s35, 4096
  buffer_store_dwordx4 v[84:87], v12, s[16:19], s74 offen sc1
  ds_write_b128 v106, v[84:87] offset:4096
  s_branch L_pj3
  .p2align 12
L_stub3:
  s_setpc_b64 s[58:59]
  s_nop 0
L_pj3:
  s_waitcnt vmcnt(9)
  s_barrier
  s_setprio 1
  v_mfma_f32_32x32x16_bf16 v[16:31], v[88:91], v[92:95], 0
  s_waitcnt lgkmcnt(7)
  v_mfma_f32_32x32x16_bf16 v[16:31], v[48:51], v[112:115], v[16:31]
  ds_read_b64_tr_b16 v[64:65], v7 offset:8192
  ds_read_b64_tr_b16 v[66:67], v7 offset:8704
  s_waitcnt lgkmcnt(7)
  v_mfma_f32_32x32x16_bf16 v[16:31], v[52:55], v[116:119], v[16:31]
  ds_read_b64_tr_b16 v[68:69], v7 offset:10240
  ds_read_b64_tr_b16 v[70:71], v7 offset:10752
  s_waitcnt lgkmcnt(7)
  v_mfma_f32_32x32x16_bf16 v[16:31], v[56:59], v[120:123], v[16:31]
  ds_read_b64_tr_b16 v[48:49], v7 offset:12288
  ds_read_b64_tr_b16 v[50:51], v7 offset:12800
  s_waitcnt lgkmcnt(7)
  v_mfma_f32_32x32x16_bf16 v[16:31], v[60:63], v[124:127], v[16:31]
  ds_read_b64_tr_b16 v[52:53], v7 offset:14336
  ds_read_b64_tr_b16 v[54:55], v7 offset:14848
  s_waitcnt lgkmcnt(6)
  v_mfma_f32_32x32x16_bf16 v[16:31], v[64:67], v[128:131], v[16:31]
  ds_read_b64_tr_b16 v[56:57], v7 offset:16384
  ds_read_b64_tr_b16 v[58:59], v7 offset:16896
  s_waitcnt lgkmcnt(6)
  v_mfma_f32_32x32x16_bf16 v[16:31], v[68:71], v[132:135], v[16:31]
  ds_read_b64_tr_b16 v[60:61], v7 offset:18432
  ds_read_b64_tr_b16 v[62:63], v7 offset:18944
  s_waitcnt lgkmcnt(6)
  v_mfma_f32_32x32x16_bf16 v[16:31], v[48:51], v[136:139], v[16:31]
  ds_read_b64_tr_b16 v[64:65], v7 offset:20480
  ds_read_b64_tr_b16 v[66:67], v7 offset:20992
  s_waitcnt lgkmcnt(6)
  v_mfma_f32_32x32x16_bf16 v[16:31], v[52:55], v[140:143], v[16:31]
  ds_read_b64_tr_b16 v[68:69], v7 offset:22528
  ds_read_b64_tr_b16 v[70:71], v7 offset:23040
  s_waitcnt lgkmcnt(6)
  v_mfma_f32_32x32x16_bf16 v[16:31], v[56:59], v[144:147], v[16:31]
  ds_read_b64_tr_b16 v[48:49], v7 offset:24576
  ds_read_b64_tr_b16 v[50:51], v7 offset:25088
  s_waitcnt lgkmcnt(6)
  v_mfma_f32_32x32x16_bf16 v[16:31], v[60:63], v[148:151], v[16:31]
  ds_read_b64_tr_b16 v[52:53], v7 offset:26624
  ds_read_b64_tr_b16 v[54:55], v7 offset:27136
  s_waitcnt lgkmcnt(6)
  v_mfma_f32_32x32x16_bf16 v[16:31], v[64:67], v[152:155], v[16:31]
  ds_read_b64_tr_b16 v[56:57], v7 offset:28672
  ds_read_b64_tr_b16 v[58:59], v7 offset:29184
  s_waitcnt lgkmcnt(6)
  v_mfma_f32_32x32x16_bf16 v[16:31], v[68:71], v[156:159], v[16:31]
  ds_read_b64_tr_b16 v[60:61], v7 offset:30720
  ds_read_b64_tr_b16 v[62:63], v7 offset:31232
  s_setprio 0
  s_add_u32 m0, s67, 106496
  s_add_u32 s74, s31, 1179648
  buffer_load_dwordx4 v3, s[8:11], s74 offen lds
  s_add_u32 m0, s67, 57344
  s_add_u32 s74, s31, 1769472
  buffer_load_dwordx4 v3, s[8:11], s74 offen lds
  s_add_u32 m0, s67, 49152
  s_add_u32 s74, s31, 2359296
  buffer_load_dwordx4 v3, s[8:11], s74 offen lds
  s_add_u32 m0, s67, 114688
  s_add_u32 s74, s31, 2949120
  buffer_load_dwordx4 v3, s[8:11], s74 offen lds
  v_fma_f32 v72, v32, v32, s72
  v_fma_f32 v73, v33, v33, s72
  v_fma_f32 v74, v34, v34, s72
  v_fma_f32 v75, v35, v35, s72
  v_mul_f32 v72, v72, v32
  v_mul_f32 v73, v73, v33
  v_mul_f32 v74, v74, v34
  v_mul_f32 v75, v75, v35
  v_exp_f32 v72, -v72
  v_exp_f32 v73, -v73
  v_exp_f32 v74, -v74
  v_exp_f32 v75, -v75
  v_fma_f32 v72, v72, s73, s73
  v_fma_f32 v73, v73, s73, s73
  v_fma_f32 v74, v74, s73, s73
  v_fma_f32 v75, v75, s73, s73
  v_rcp_f32 v72, v72
  v_rcp_f32 v73, v73
  v_rcp_f32 v74, v74
  v_rcp_f32 v75, v75
  v_mul_f32 v72, v72, v32
  v_mul_f32 v73, v73, v33
  v_mul_f32 v74, v74, v34
  v_mul_f32 v75, v75, v35
  v_cvt_pk_bf16_f32 v80, v72, v73
  v_cvt_pk_bf16_f32 v81, v74, v75
  v_fma_f32 v72, v36, v36, s72
  v_fma_f32 v73, v37, v37, s72
  v_fma_f32 v74, v38, v38, s72
  v_fma_f32 v75, v39, v39, s72
  v_mul_f32 v72, v72, v36
  v_mul_f32 v73, v73, v37
  v_mul_f32 v74, v74, v38
  v_mul_f32 v75, v75, v39
  v_exp_f32 v72, -v72
  v_exp_f32 v73, -v73
  v_exp_f32 v74, -v74
  v_exp_f32 v75, -v75
  v_fma_f32 v72, v72, s73, s73
  v_fma_f32 v73, v73, s73, s73
  s_waitcnt vmcnt(10)
  s_barrier
  s_setprio 1
  s_waitcnt lgkmcnt(6)
  v_mfma_f32_32x32x16_bf16 v[16:31], v[48:51], v[160:163], v[16:31]
  ds_read_b64_tr_b16 v[64:65], v5 offset:0
  ds_read_b64_tr_b16 v[66:67], v5 offset:512
  s_waitcnt lgkmcnt(6)
  v_mfma_f32_32x32x16_bf16 v[16:31], v[52:55], v[164:167], v[16:31]
  ds_read_b64_tr_b16 v[68:69], v5 offset:2048
  ds_read_b64_tr_b16 v[70:71], v5 offset:2560
  s_waitcnt lgkmcnt(6)
  v_mfma_f32_32x32x16_bf16 v[16:31], v[56:59], v[168:171], v[16:31]
  ds_read_b64_tr_b16 v[48:49], v5 offset:4096
  ds_read_b64_tr_b16 v[50:51], v5 offset:4608
  s_waitcnt lgkmcnt(6)
  v_mfma_f32_32x32x16_bf16 v[16:31], v[60:63], v[172:175], v[16:31]
  ds_read_b64_tr_b16 v[52:53], v5 offset:6144
  ds_read_b64_tr_b16 v[54:55], v5 offset:6656
  s_waitcnt lgkmcnt(6)
  v_mfma_f32_32x32x16_bf16 v[16:31], v[64:67], v[176:179], v[16:31]
  ds_read_b64_tr_b16 v[56:57], v5 offset:8192
  ds_read_b64_tr_b16 v[58:59], v5 offset:8704
  s_waitcnt lgkmcnt(6)
  v_mfma_f32_32x32x16_bf16 v[16:31], v[68:71], v[180:183], v[16:31]
  ds_read_b64_tr_b16 v[60:61], v5 offset:10240
  ds_read_b64_tr_b16 v[62:63], v5 offset:10752
  s_waitcnt lgkmcnt(6)
  v_mfma_f32_32x32x16_bf16 v[16:31], v[48:51], v[184:187], v[16:31]
  ds_read_b64_tr_b16 v[64:65], v5 offset:12288
  ds_read_b64_tr_b16 v[66:67], v5 offset:12800
  s_waitcnt lgkmcnt(6)
  v_mfma_f32_32x32x16_bf16 v[16:31], v[52:55], v[188:191], v[16:31]
  ds_read_b64_tr_b16 v[68:69], v5 offset:14336
  ds_read_b64_tr_b16 v[70:71], v5 offset:14848
  s_waitcnt lgkmcnt(6)
  v_mfma_f32_32x32x16_bf16 v[16:31], v[56:59], v[192:195], v[16:31]
  ds_read_b64_tr_b16 v[48:49], v5 offset:16384
  ds_read_b64_tr_b16 v[50:51], v5 offset:16896
  s_waitcnt lgkmcnt(6)
  v_mfma_f32_32x32x16_bf16 v[16:31], v[60:63], v[196:199], v[16:31]
  ds_read_b64_tr_b16 v[52:53], v5 offset:18432
  ds_read_b64_tr_b16 v[54:55], v5 offset:18944
  s_waitcnt lgkmcnt(6)
  v_mfma_f32_32x32x16_bf16 v[16:31], v[64:67], v[200:203], v[16:31]
  ds_read_b64_tr_b16 v[56:57], v5 offset:20480
  ds_read_b64_tr_b16 v[58:59], v5 offset:20992
  s_waitcnt lgkmcnt(6)
  v_mfma_f32_32x32x16_bf16 v[16:31], v[68:71], v[204:207], v[16:31]
  ds_read_b64_tr_b16 v[60:61], v5 offset:22528
  ds_read_b64_tr_b16 v[62:63], v5 offset:23040
  s_setprio 0
  s_add_u32 m0, s67, 147456
  s_add_u32 s74, s31, 3538944
  buffer_load_dwordx4 v3, s[8:11], s74 offen lds
  s_add_u32 m0, s67, 139264
  s_add_u32 s74, s31, 4128768
  buffer_load_dwordx4 v3, s[8:11], s74 offen lds
  s_add_u32 m0, s67, 131072
  s_add_u32 s74, s31, 4718592
  buffer_load_dwordx4 v3, s[8:11], s74 offen lds
  s_add_u32 m0, s67, 122880
  s_add_u32 s74, s32, 0
  buffer_load_dwordx4 v3, s[8:11], s74 offen lds
  v_mov_b32 v88, v99
  v_fma_f32 v74, v74, s73, s73
  v_fma_f32 v75, v75, s73, s73
  v_rcp_f32 v72, v72
  v_rcp_f32 v73, v73
  v_rcp_f32 v74, v74
  v_rcp_f32 v75, v75
  v_mul_f32 v72, v72, v36
  v_mul_f32 v73, v73, v37
  v_mul_f32 v74, v74, v38
  v_mul_f32 v75, v75, v39
  v_cvt_pk_bf16_f32 v82, v72, v73
  v_cvt_pk_bf16_f32 v83, v74, v75
  v_fma_f32 v72, v40, v40, s72
  v_fma_f32 v73, v41, v41, s72
  v_fma_f32 v74, v42, v42, s72
  v_fma_f32 v75, v43, v43, s72
  v_mul_f32 v72, v72, v40
  v_mul_f32 v73, v73, v41
  v_mul_f32 v74, v74, v42
  v_mul_f32 v75, v75, v43
  v_exp_f32 v72, -v72
  v_exp_f32 v73, -v73
  v_exp_f32 v74, -v74
  v_exp_f32 v75, -v75
  v_fma_f32 v72, v72, s73, s73
  v_fma_f32 v73, v73, s73, s73
  v_fma_f32 v74, v74, s73, s73
  v_fma_f32 v75, v75, s73, s73
  v_rcp_f32 v72, v72
  v_rcp_f32 v73, v73
  v_rcp_f32 v74, v74
  s_add_u32 s74, s35, 16384
  buffer_store_dwordx4 v[80:83], v12, s[16:19], s74 offen sc1
  ds_write_b128 v106, v[80:83] offset:16384
  s_waitcnt vmcnt(11)
  s_barrier
  s_setprio 1
  s_waitcnt lgkmcnt(7)
  v_mfma_f32_32x32x16_bf16 v[16:31], v[48:51], v[208:211], v[16:31]
  ds_read_b64_tr_b16 v[64:65], v5 offset:24576
  ds_read_b64_tr_b16 v[66:67], v5 offset:25088
  s_waitcnt lgkmcnt(7)
  v_mfma_f32_32x32x16_bf16 v[16:31], v[52:55], v[212:215], v[16:31]
  ds_read_b64_tr_b16 v[68:69], v5 offset:26624
  ds_read_b64_tr_b16 v[70:71], v5 offset:27136
  s_waitcnt lgkmcnt(7)
  v_mfma_f32_32x32x16_bf16 v[16:31], v[56:59], v[216:219], v[16:31]
  ds_read_b64_tr_b16 v[48:49], v5 offset:28672
  ds_read_b64_tr_b16 v[50:51], v5 offset:29184
  s_waitcnt lgkmcnt(7)
  v_mfma_f32_32x32x16_bf16 v[16:31], v[60:63], v[220:223], v[16:31]
  ds_read_b64_tr_b16 v[52:53], v5 offset:30720
  ds_read_b64_tr_b16 v[54:55], v5 offset:31232
  s_waitcnt lgkmcnt(6)
  v_mfma_f32_32x32x16_bf16 v[16:31], v[64:67], v[224:227], v[16:31]
  ds_read_b64_tr_b16 v[56:57], v5 offset:32768
  ds_read_b64_tr_b16 v[58:59], v5 offset:33280
  s_waitcnt lgkmcnt(6)
  v_mfma_f32_32x32x16_bf16 v[16:31], v[68:71], v[228:231], v[16:31]
  ds_read_b64_tr_b16 v[60:61], v5 offset:34816
  ds_read_b64_tr_b16 v[62:63], v5 offset:35328
  s_waitcnt lgkmcnt(6)
  v_mfma_f32_32x32x16_bf16 v[16:31], v[48:51], v[232:235], v[16:31]
  ds_read_b64_tr_b16 v[64:65], v5 offset:36864
  ds_read_b64_tr_b16 v[66:67], v5 offset:37376
  s_waitcnt lgkmcnt(6)
  v_mfma_f32_32x32x16_bf16 v[16:31], v[52:55], v[236:239], v[16:31]
  ds_read_b64_tr_b16 v[68:69], v5 offset:38912
  ds_read_b64_tr_b16 v[70:71], v5 offset:39424
  s_waitcnt lgkmcnt(6)
  v_mfma_f32_32x32x16_bf16 v[16:31], v[56:59], v[240:243], v[16:31]
  ds_read_b64_tr_b16 v[48:49], v6 offset:32768
  ds_read_b64_tr_b16 v[50:51], v6 offset:33280
  s_waitcnt lgkmcnt(6)
  v_mfma_f32_32x32x16_bf16 v[16:31], v[60:63], v[244:247], v[16:31]
  ds_read_b64_tr_b16 v[52:53], v6 offset:34816
  ds_read_b64_tr_b16 v[54:55], v6 offset:35328
  s_waitcnt lgkmcnt(6)
  v_mfma_f32_32x32x16_bf16 v[16:31], v[64:67], v[248:251], v[16:31]
  ds_read_b64_tr_b16 v[56:57], v6 offset:36864
  ds_read_b64_tr_b16 v[58:59], v6 offset:37376
  s_waitcnt lgkmcnt(6)
  v_mfma_f32_32x32x16_bf16 v[16:31], v[68:71], v[252:255], v[16:31]
  ds_read_b64_tr_b16 v[60:61], v6 offset:38912
  ds_read_b64_tr_b16 v[62:63], v6 offset:39424
  s_setprio 0
  s_add_u32 m0, s67, 155648
  s_add_u32 s74, s32, 589824
  buffer_load_dwordx4 v3, s[8:11], s74 offen lds
  s_add_u32 m0, s67, 8192
  s_add_u32 s74, s32, 1179648
  buffer_load_dwordx4 v3, s[8:11], s74 offen lds
  v_rcp_f32 v75, v75
  v_mul_f32 v72, v72, v40
  v_mul_f32 v73, v73, v41
  v_mul_f32 v74, v74, v42
  v_mul_f32 v75, v75, v43
  v_cvt_pk_bf16_f32 v84, v72, v73
  v_cvt_pk_bf16_f32 v85, v74, v75
  v_fma_f32 v72, v44, v44, s72
  v_fma_f32 v73, v45, v45, s72
  v_fma_f32 v74, v46, v46, s72
  v_fma_f32 v75, v47, v47, s72
  v_mul_f32 v72, v72, v44
  v_mul_f32 v73, v73, v45
  v_mul_f32 v74, v74, v46
  v_mul_f32 v75, v75, v47
  v_exp_f32 v72, -v72
  v_exp_f32 v73, -v73
  v_exp_f32 v74, -v74
  v_exp_f32 v75, -v75
  v_fma_f32 v72, v72, s73, s73
  v_fma_f32 v73, v73, s73, s73
  v_fma_f32 v74, v74, s73, s73
  v_fma_f32 v75, v75, s73, s73
  v_rcp_f32 v72, v72
  v_rcp_f32 v73, v73
  v_rcp_f32 v74, v74
  v_rcp_f32 v75, v75
  v_mul_f32 v72, v72, v44
  v_mul_f32 v73, v73, v45
  v_mul_f32 v74, v74, v46
  v_mul_f32 v75, v75, v47
  v_cvt_pk_bf16_f32 v86, v72, v73
  v_cvt_pk_bf16_f32 v87, v74, v75
  s_add_u32 s74, s35, 20480
  buffer_store_dwordx4 v[84:87], v12, s[16:19], s74 offen sc1
  ds_write_b128 v106, v[84:87] offset:20480
  s_waitcnt vmcnt(10)
  s_barrier
  s_setprio 1
  v_mfma_f32_32x32x16_bf16 v[32:47], v[88:91], v[92:95], 0
  s_waitcnt lgkmcnt(7)
  v_mfma_f32_32x32x16_bf16 v[32:47], v[48:51], v[112:115], v[32:47]
  ds_read_b64_tr_b16 v[64:65], v5 offset:40960
  ds_read_b64_tr_b16 v[66:67], v5 offset:41472
  s_waitcnt lgkmcnt(7)
  v_mfma_f32_32x32x16_bf16 v[32:47], v[52:55], v[116:119], v[32:47]
  ds_read_b64_tr_b16 v[68:69], v5 offset:43008
  ds_read_b64_tr_b16 v[70:71], v5 offset:43520
  s_waitcnt lgkmcnt(7)
  v_mfma_f32_32x32x16_bf16 v[32:47], v[56:59], v[120:123], v[32:47]
  ds_read_b64_tr_b16 v[48:49], v5 offset:45056
  ds_read_b64_tr_b16 v[50:51], v5 offset:45568
  s_waitcnt lgkmcnt(7)
  v_mfma_f32_32x32x16_bf16 v[32:47], v[60:63], v[124:127], v[32:47]
  ds_read_b64_tr_b16 v[52:53], v5 offset:47104
  ds_read_b64_tr_b16 v[54:55], v5 offset:47616
  s_waitcnt lgkmcnt(6)
  v_mfma_f32_32x32x16_bf16 v[32:47], v[64:67], v[128:131], v[32:47]
  ds_read_b64_tr_b16 v[56:57], v6 offset:40960
  ds_read_b64_tr_b16 v[58:59], v6 offset:41472
  s_waitcnt lgkmcnt(6)
  v_mfma_f32_32x32x16_bf16 v[32:47], v[68:71], v[132:135], v[32:47]
  ds_read_b64_tr_b16 v[60:61], v6 offset:43008
  ds_read_b64_tr_b16 v[62:63], v6 offset:43520
  s_waitcnt lgkmcnt(6)
  v_mfma_f32_32x32x16_bf16 v[32:47], v[48:51], v[136:139], v[32:47]
  ds_read_b64_tr_b16 v[64:65], v6 offset:45056
  ds_read_b64_tr_b16 v[66:67], v6 offset:45568
  s_waitcnt lgkmcnt(6)
  v_mfma_f32_32x32x16_bf16 v[32:47], v[52:55], v[140:143], v[32:47]
  ds_read_b64_tr_b16 v[68:69], v6 offset:47104
  ds_read_b64_tr_b16 v[70:71], v6 offset:47616
  s_waitcnt lgkmcnt(6)
  v_mfma_f32_32x32x16_bf16 v[32:47], v[56:59], v[144:147], v[32:47]
  ds_read_b64_tr_b16 v[48:49], v5 offset:57344
  ds_read_b64_tr_b16 v[50:51], v5 offset:57856
  s_waitcnt lgkmcnt(6)
  v_mfma_f32_32x32x16_bf16 v[32:47], v[60:63], v[148:151], v[32:47]
  ds_read_b64_tr_b16 v[52:53], v5 offset:59392
  ds_read_b64_tr_b16 v[54:55], v5 offset:59904
  s_waitcnt lgkmcnt(6)
  v_mfma_f32_32x32x16_bf16 v[32:47], v[64:67], v[152:155], v[32:47]
  ds_read_b64_tr_b16 v[56:57], v5 offset:61440
  ds_read_b64_tr_b16 v[58:59], v5 offset:61952
  s_waitcnt lgkmcnt(6)
  v_mfma_f32_32x32x16_bf16 v[32:47], v[68:71], v[156:159], v[32:47]
  ds_read_b64_tr_b16 v[60:61], v5 offset:63488
  ds_read_b64_tr_b16 v[62:63], v5 offset:64000
  s_setprio 0
  s_add_u32 m0, s67, 0
  s_add_u32 s74, s32, 1769472
  buffer_load_dwordx4 v3, s[8:11], s74 offen lds
  s_add_u32 m0, s67, 16384
  s_add_u32 s74, s32, 2359296
  buffer_load_dwordx4 v3, s[8:11], s74 offen lds
  s_add_u32 m0, s67, 24576
  s_add_u32 s74, s32, 2949120
  buffer_load_dwordx4 v3, s[8:11], s74 offen lds
  s_add_u32 m0, s67, 32768
  s_add_u32 s74, s32, 3538944
  buffer_load_dwordx4 v3, s[8:11], s74 offen lds
  s_cmp_eq_u32 s63, 0
  s_cbranch_scc0 L_ini0_d
  v_cmp_le_u32 vcc, 1, v110
  s_nop 0
  s_cmp_eq_u64 vcc, -1
  s_cbranch_scc1 L_ini0_d
  s_mov_b32 s76, 400000
L_ini0:
  buffer_load_dword v14, v108, s[24:27], s77 offen sc1
  s_waitcnt vmcnt(0)
  v_cmp_le_u32 vcc, 1, v14
  s_sub_u32 s76, s76, 1
  s_cmp_eq_u64 vcc, -1
  s_cbranch_scc1 L_ini0_d
  s_cmp_eq_u32 s76, 0
  s_cbranch_scc1 L_ini0_d
  s_sleep 8
  s_branch L_ini0
L_ini0_d:
  s_cmp_eq_u32 s60, 0
  s_mov_b32 s76, 49414144
  s_cselect_b32 s76, s76, 1879048192
  v_fma_f32 v72, v16, v16, s72
  v_fma_f32 v73, v17, v17, s72
  v_fma_f32 v74, v18, v18, s72
  v_fma_f32 v75, v19, v19, s72
  v_mul_f32 v72, v72, v16
  v_mul_f32 v73, v73, v17
  v_mul_f32 v74, v74, v18
  v_mul_f32 v75, v75, v19
  v_exp_f32 v72, -v72
  v_exp_f32 v73, -v73
  v_exp_f32 v74, -v74
  v_exp_f32 v75, -v75
  v_fma_f32 v72, v72, s73, s73
  v_fma_f32 v73, v73, s73, s73
  v_fma_f32 v74, v74, s73, s73
  v_fma_f32 v75, v75, s73, s73
  v_rcp_f32 v72, v72
  v_rcp_f32 v73, v73
  v_rcp_f32 v74, v74
  v_rcp_f32 v75, v75
  v_mul_f32 v72, v72, v16
  v_mul_f32 v73, v73, v17
  v_mul_f32 v74, v74, v18
  v_mul_f32 v75, v75, v19
  v_cvt_pk_bf16_f32 v80, v72, v73
  v_cvt_pk_bf16_f32 v81, v74, v75
  v_fma_f32 v72, v20, v20, s72
  v_fma_f32 v73, v21, v21, s72
  v_fma_f32 v74, v22, v22, s72
  v_fma_f32 v75, v23, v23, s72
  v_mul_f32 v72, v72, v20
  v_mul_f32 v73, v73, v21
  v_mul_f32 v74, v74, v22
  v_mul_f32 v75, v75, v23
  v_exp_f32 v72, -v72
  v_exp_f32 v73, -v73
  v_exp_f32 v74, -v74
  v_exp_f32 v75, -v75
  v_fma_f32 v72, v72, s73, s73
  v_fma_f32 v73, v73, s73, s73
  s_waitcnt vmcnt(11)
  s_barrier
  s_setprio 1
  s_waitcnt lgkmcnt(6)
  v_mfma_f32_32x32x16_bf16 v[32:47], v[48:51], v[160:163], v[32:47]
  ds_read_b64_tr_b16 v[64:65], v5 offset:49152
  ds_read_b64_tr_b16 v[66:67], v5 offset:49664
  s_waitcnt lgkmcnt(6)
  v_mfma_f32_32x32x16_bf16 v[32:47], v[52:55], v[164:167], v[32:47]
  ds_read_b64_tr_b16 v[68:69], v5 offset:51200
  ds_read_b64_tr_b16 v[70:71], v5 offset:51712
  s_waitcnt lgkmcnt(6)
  v_mfma_f32_32x32x16_bf16 v[32:47], v[56:59], v[168:171], v[32:47]
  ds_read_b64_tr_b16 v[48:49], v5 offset:53248
  ds_read_b64_tr_b16 v[50:51], v5 offset:53760
  s_waitcnt lgkmcnt(6)
  v_mfma_f32_32x32x16_bf16 v[32:47], v[60:63], v[172:175], v[32:47]
  ds_read_b64_tr_b16 v[52:53], v5 offset:55296
  ds_read_b64_tr_b16 v[54:55], v5 offset:55808
  s_waitcnt lgkmcnt(6)
  v_mfma_f32_32x32x16_bf16 v[32:47], v[64:67], v[176:179], v[32:47]
  ds_read_b64_tr_b16 v[56:57], v6 offset:49152
  ds_read_b64_tr_b16 v[58:59], v6 offset:49664
  s_waitcnt lgkmcnt(6)
  v_mfma_f32_32x32x16_bf16 v[32:47], v[68:71], v[180:183], v[32:47]
  ds_read_b64_tr_b16 v[60:61], v6 offset:51200
  ds_read_b64_tr_b16 v[62:63], v6 offset:51712
  s_waitcnt lgkmcnt(6)
  v_mfma_f32_32x32x16_bf16 v[32:47], v[48:51], v[184:187], v[32:47]
  ds_read_b64_tr_b16 v[64:65], v6 offset:53248
  ds_read_b64_tr_b16 v[66:67], v6 offset:53760
  s_waitcnt lgkmcnt(6)
  v_mfma_f32_32x32x16_bf16 v[32:47], v[52:55], v[188:191], v[32:47]
  ds_read_b64_tr_b16 v[68:69], v6 offset:55296
  ds_read_b64_tr_b16 v[70:71], v6 offset:55808
  s_waitcnt lgkmcnt(6)
  v_mfma_f32_32x32x16_bf16 v[32:47], v[56:59], v[192:195], v[32:47]
  ds_read_b64_tr_b16 v[48:49], v7 offset:16384
  ds_read_b64_tr_b16 v[50:51], v7 offset:16896
  s_waitcnt lgkmcnt(6)
  v_mfma_f32_32x32x16_bf16 v[32:47], v[60:63], v[196:199], v[32:47]
  ds_read_b64_tr_b16 v[52:53], v7 offset:18432
  ds_read_b64_tr_b16 v[54:55], v7 offset:18944
  s_waitcnt lgkmcnt(6)
  v_mfma_f32_32x32x16_bf16 v[32:47], v[64:67], v[200:203], v[32:47]
  ds_read_b64_tr_b16 v[56:57], v7 offset:20480
  ds_read_b64_tr_b16 v[58:59], v7 offset:20992
  s_waitcnt lgkmcnt(6)
  v_mfma_f32_32x32x16_bf16 v[32:47], v[68:71], v[204:207], v[32:47]
  ds_read_b64_tr_b16 v[60:61], v7 offset:22528
  ds_read_b64_tr_b16 v[62:63], v7 offset:23040
  s_setprio 0
  s_add_u32 m0, s67, 40960
  s_add_u32 s74, s32, 4128768
  buffer_load_dwordx4 v3, s[8:11], s74 offen lds
  v_mov_b32 v88, v100
  v_fma_f32 v74, v74, s73, s73
  v_fma_f32 v75, v75, s73, s73
  v_rcp_f32 v72, v72
  v_rcp_f32 v73, v73
  v_rcp_f32 v74, v74
  v_rcp_f32 v75, v75
  v_mul_f32 v72, v72, v20
  v_mul_f32 v73, v73, v21
  v_mul_f32 v74, v74, v22
  v_mul_f32 v75, v75, v23
  v_cvt_pk_bf16_f32 v82, v72, v73
  v_cvt_pk_bf16_f32 v83, v74, v75
  v_fma_f32 v72, v24, v24, s72
  v_fma_f32 v73, v25, v25, s72
  v_fma_f32 v74, v26, v26, s72
  v_fma_f32 v75, v27, v27, s72
  v_mul_f32 v72, v72, v24
  v_mul_f32 v73, v73, v25
  v_mul_f32 v74, v74, v26
  v_mul_f32 v75, v75, v27
  v_exp_f32 v72, -v72
  v_exp_f32 v73, -v73
  v_exp_f32 v74, -v74
  v_exp_f32 v75, -v75
  v_fma_f32 v72, v72, s73, s73
  v_fma_f32 v73, v73, s73, s73
  v_fma_f32 v74, v74, s73, s73
  v_fma_f32 v75, v75, s73, s73
  v_rcp_f32 v72, v72
  v_rcp_f32 v73, v73
  v_rcp_f32 v74, v74
  s_add_u32 s74, s35, 32768
  buffer_store_dwordx4 v[80:83], v12, s[16:19], s74 offen sc1
  ds_write_b128 v106, v[80:83] offset:32768
  s_waitcnt vmcnt(10)
  s_barrier
  s_setprio 1
  s_waitcnt lgkmcnt(7)
  v_mfma_f32_32x32x16_bf16 v[32:47], v[48:51], v[208:211], v[32:47]
  ds_read_b64_tr_b16 v[64:65], v7 offset:8192
  ds_read_b64_tr_b16 v[66:67], v7 offset:8704
  s_waitcnt lgkmcnt(7)
  v_mfma_f32_32x32x16_bf16 v[32:47], v[52:55], v[212:215], v[32:47]
  ds_read_b64_tr_b16 v[68:69], v7 offset:10240
  ds_read_b64_tr_b16 v[70:71], v7 offset:10752
  s_waitcnt lgkmcnt(7)
  v_mfma_f32_32x32x16_bf16 v[32:47], v[56:59], v[216:219], v[32:47]
  ds_read_b64_tr_b16 v[48:49], v7 offset:12288
  ds_read_b64_tr_b16 v[50:51], v7 offset:12800
  s_waitcnt lgkmcnt(7)
  v_mfma_f32_32x32x16_bf16 v[32:47], v[60:63], v[220:223], v[32:47]
  ds_read_b64_tr_b16 v[52:53], v7 offset:14336
  ds_read_b64_tr_b16 v[54:55], v7 offset:14848
  s_waitcnt lgkmcnt(6)
  v_mfma_f32_32x32x16_bf16 v[32:47], v[64:67], v[224:227], v[32:47]
  ds_read_b64_tr_b16 v[56:57], v7 offset:0
  ds_read_b64_tr_b16 v[58:59], v7 offset:512
  s_waitcnt lgkmcnt(6)
  v_mfma_f32_32x32x16_bf16 v[32:47], v[68:71], v[228:231], v[32:47]
  ds_read_b64_tr_b16 v[60:61], v7 offset:2048
  ds_read_b64_tr_b16 v[62:63], v7 offset:2560
  s_waitcnt lgkmcnt(6)
  v_mfma_f32_32x32x16_bf16 v[32:47], v[48:51], v[232:235], v[32:47]
  ds_read_b64_tr_b16 v[64:65], v7 offset:4096
  ds_read_b64_tr_b16 v[66:67], v7 offset:4608
  s_waitcnt lgkmcnt(6)
  v_mfma_f32_32x32x16_bf16 v[32:47], v[52:55], v[236:239], v[32:47]
  ds_read_b64_tr_b16 v[68:69], v7 offset:6144
  ds_read_b64_tr_b16 v[70:71], v7 offset:6656
  s_waitcnt lgkmcnt(6)
  v_mfma_f32_32x32x16_bf16 v[32:47], v[56:59], v[240:243], v[32:47]
  ds_read_b64_tr_b16 v[48:49], v6 offset:57344
  ds_read_b64_tr_b16 v[50:51], v6 offset:57856
  s_waitcnt lgkmcnt(6)
  v_mfma_f32_32x32x16_bf16 v[32:47], v[60:63], v[244:247], v[32:47]
  ds_read_b64_tr_b16 v[52:53], v6 offset:59392
  ds_read_b64_tr_b16 v[54:55], v6 offset:59904
  s_waitcnt lgkmcnt(6)
  v_mfma_f32_32x32x16_bf16 v[32:47], v[64:67], v[248:251], v[32:47]
  ds_read_b64_tr_b16 v[56:57], v6 offset:61440
  ds_read_b64_tr_b16 v[58:59], v6 offset:61952
  s_waitcnt lgkmcnt(6)
  v_mfma_f32_32x32x16_bf16 v[32:47], v[68:71], v[252:255], v[32:47]
  ds_read_b64_tr_b16 v[60:61], v6 offset:63488
  ds_read_b64_tr_b16 v[62:63], v6 offset:64000
  s_setprio 0
  s_add_u32 m0, s67, 49152
  s_add_u32 s74, s32, 4718592
  buffer_load_dwordx4 v3, s[8:11], s74 offen lds
  s_add_u32 m0, s67, 57344
  s_add_u32 s74, s33, 0
  buffer_load_dwordx4 v3, s[8:11], s74 offen lds
  v_rcp_f32 v75, v75
  v_mul_f32 v72, v72, v24
  v_mul_f32 v73, v73, v25
  v_mul_f32 v74, v74, v26
  v_mul_f32 v75, v75, v27
  v_cvt_pk_bf16_f32 v84, v72, v73
  v_cvt_pk_bf16_f32 v85, v74, v75
  v_fma_f32 v72, v28, v28, s72
  v_fma_f32 v73, v29, v29, s72
  v_fma_f32 v74, v30, v30, s72
  v_fma_f32 v75, v31, v31, s72
  v_mul_f32 v72, v72, v28
  v_mul_f32 v73, v73, v29
  v_mul_f32 v74, v74, v30
  v_mul_f32 v75, v75, v31
  v_exp_f32 v72, -v72
  v_exp_f32 v73, -v73
  v_exp_f32 v74, -v74
  v_exp_f32 v75, -v75
  v_fma_f32 v72, v72, s73, s73
  v_fma_f32 v73, v73, s73, s73
  v_fma_f32 v74, v74, s73, s73
  v_fma_f32 v75, v75, s73, s73
  v_rcp_f32 v72, v72
  v_rcp_f32 v73, v73
  v_rcp_f32 v74, v74
  v_rcp_f32 v75, v75
  v_mul_f32 v72, v72, v28
  v_mul_f32 v73, v73, v29
  v_mul_f32 v74, v74, v30
  v_mul_f32 v75, v75, v31
  v_cvt_pk_bf16_f32 v86, v72, v73
  v_cvt_pk_bf16_f32 v87, v74, v75
  s_add_u32 s74, s35, 36864
  buffer_store_dwordx4 v[84:87], v12, s[16:19], s74 offen sc1
  ds_write_b128 v106, v[84:87] offset:36864
  s_branch L_pj4
  .p2align 12
L_stub4:
  s_setpc_b64 s[58:59]
  s_nop 0
L_pj4:
  s_waitcnt vmcnt(8)
  s_barrier
  s_setprio 1
  v_mfma_f32_32x32x16_bf16 v[16:31], v[88:91], v[92:95], 0
  s_waitcnt lgkmcnt(7)
  v_mfma_f32_32x32x16_bf16 v[16:31], v[48:51], v[112:115], v[16:31]
  ds_read_b64_tr_b16 v[64:65], v7 offset:24576
  ds_read_b64_tr_b16 v[66:67], v7 offset:25088
  s_waitcnt lgkmcnt(7)
  v_mfma_f32_32x32x16_bf16 v[16:31], v[52:55], v[116:119], v[16:31]
  ds_read_b64_tr_b16 v[68:69], v7 offset:26624
  ds_read_b64_tr_b16 v[70:71], v7 offset:27136
  s_waitcnt lgkmcnt(7)
  v_mfma_f32_32x32x16_bf16 v[16:31], v[56:59], v[120:123], v[16:31]
  ds_read_b64_tr_b16 v[48:49], v7 offset:28672
  ds_read_b64_tr_b16 v[50:51], v7 offset:29184
  s_waitcnt lgkmcnt(7)
  v_mfma_f32_32x32x16_bf16 v[16:31], v[60:63], v[124:127], v[16:31]
  ds_read_b64_tr_b16 v[52:53], v7 offset:30720
  ds_read_b64_tr_b16 v[54:55], v7 offset:31232
  s_waitcnt lgkmcnt(6)
  v_mfma_f32_32x32x16_bf16 v[16:31], v[64:67], v[128:131], v[16:31]
  ds_read_b64_tr_b16 v[56:57], v5 offset:8192
  ds_read_b64_tr_b16 v[58:59], v5 offset:8704
  s_waitcnt lgkmcnt(6)
  v_mfma_f32_32x32x16_bf16 v[16:31], v[68:71], v[132:135], v[16:31]
  ds_read_b64_tr_b16 v[60:61], v5 offset:10240
  ds_read_b64_tr_b16 v[62:63], v5 offset:10752
  s_waitcnt lgkmcnt(6)
  v_mfma_f32_32x32x16_bf16 v[16:31], v[48:51], v[136:139], v[16:31]
  ds_read_b64_tr_b16 v[64:65], v5 offset:12288
  ds_read_b64_tr_b16 v[66:67], v5 offset:12800
  s_waitcnt lgkmcnt(6)
  v_mfma_f32_32x32x16_bf16 v[16:31], v[52:55], v[140:143], v[16:31]
  ds_read_b64_tr_b16 v[68:69], v5 offset:14336
  ds_read_b64_tr_b16 v[70:71], v5 offset:14848
  s_waitcnt lgkmcnt(6)
  v_mfma_f32_32x32x16_bf16 v[16:31], v[56:59], v[144:147], v[16:31]
  ds_read_b64_tr_b16 v[48:49], v5 offset:0
  ds_read_b64_tr_b16 v[50:51], v5 offset:512
  s_waitcnt lgkmcnt(6)
  v_mfma_f32_32x32x16_bf16 v[16:31], v[60:63], v[148:151], v[16:31]
  ds_read_b64_tr_b16 v[52:53], v5 offset:2048
  ds_read_b64_tr_b16 v[54:55], v5 offset:2560
  s_waitcnt lgkmcnt(6)
  v_mfma_f32_32x32x16_bf16 v[16:31], v[64:67], v[152:155], v[16:31]
  ds_read_b64_tr_b16 v[56:57], v5 offset:4096
  ds_read_b64_tr_b16 v[58:59], v5 offset:4608
  s_waitcnt lgkmcnt(6)
  v_mfma_f32_32x32x16_bf16 v[16:31], v[68:71], v[156:159], v[16:31]
  ds_read_b64_tr_b16 v[60:61], v5 offset:6144
  ds_read_b64_tr_b16 v[62:63], v5 offset:6656
  s_setprio 0
  s_add_u32 m0, s67, 131072
  s_add_u32 s74, s33, 589824
  buffer_load_dwordx4 v3, s[8:11], s74 offen lds
  s_add_u32 m0, s67, 139264
  s_add_u32 s74, s33, 1179648
  buffer_load_dwordx4 v3, s[8:11], s74 offen lds
  s_add_u32 m0, s67, 147456
  s_add_u32 s74, s33, 1769472
  buffer_load_dwordx4 v3, s[8:11], s74 offen lds
  v_fma_f32 v72, v32, v32, s72
  v_fma_f32 v73, v33, v33, s72
  v_fma_f32 v74, v34, v34, s72
  v_fma_f32 v75, v35, v35, s72
  v_mul_f32 v72, v72, v32
  v_mul_f32 v73, v73, v33
  v_mul_f32 v74, v74, v34
  v_mul_f32 v75, v75, v35
  v_exp_f32 v72, -v72
  v_exp_f32 v73, -v73
  v_exp_f32 v74, -v74
  v_exp_f32 v75, -v75
  v_fma_f32 v72, v72, s73, s73
  v_fma_f32 v73, v73, s73, s73
  v_fma_f32 v74, v74, s73, s73
  v_fma_f32 v75, v75, s73, s73
  v_rcp_f32 v72, v72
  v_rcp_f32 v73, v73
  v_rcp_f32 v74, v74
  v_rcp_f32 v75, v75
  v_mul_f32 v72, v72, v32
  v_mul_f32 v73, v73, v33
  v_mul_f32 v74, v74, v34
  v_mul_f32 v75, v75, v35
  v_cvt_pk_bf16_f32 v80, v72, v73
  v_cvt_pk_bf16_f32 v81, v74, v75
  v_fma_f32 v72, v36, v36, s72
  v_fma_f32 v73, v37, v37, s72
  v_fma_f32 v74, v38, v38, s72
  v_fma_f32 v75, v39, v39, s72
  v_mul_f32 v72, v72, v36
  v_mul_f32 v73, v73, v37
  v_mul_f32 v74, v74, v38
  v_mul_f32 v75, v75, v39
  v_exp_f32 v72, -v72
  v_exp_f32 v73, -v73
  v_exp_f32 v74, -v74
  v_exp_f32 v75, -v75
  v_fma_f32 v72, v72, s73, s73
  v_fma_f32 v73, v73, s73, s73
  s_waitcnt vmcnt(3)
  s_barrier
  s_setprio 1
  s_waitcnt lgkmcnt(6)
  v_mfma_f32_32x32x16_bf16 v[16:31], v[48:51], v[160:163], v[16:31]
  ds_read_b64_tr_b16 v[64:65], v5 offset:16384
  ds_read_b64_tr_b16 v[66:67], v5 offset:16896
  s_waitcnt lgkmcnt(6)
  v_mfma_f32_32x32x16_bf16 v[16:31], v[52:55], v[164:167], v[16:31]
  ds_read_b64_tr_b16 v[68:69], v5 offset:18432
  ds_read_b64_tr_b16 v[70:71], v5 offset:18944
  s_waitcnt lgkmcnt(6)
  v_mfma_f32_32x32x16_bf16 v[16:31], v[56:59], v[168:171], v[16:31]
  ds_read_b64_tr_b16 v[48:49], v5 offset:20480
  ds_read_b64_tr_b16 v[50:51], v5 offset:20992
  s_waitcnt lgkmcnt(6)
  v_mfma_f32_32x32x16_bf16 v[16:31], v[60:63], v[172:175], v[16:31]
  ds_read_b64_tr_b16 v[52:53], v5 offset:22528
  ds_read_b64_tr_b16 v[54:55], v5 offset:23040
  s_waitcnt lgkmcnt(6)
  v_mfma_f32_32x32x16_bf16 v[16:31], v[64:67], v[176:179], v[16:31]
  ds_read_b64_tr_b16 v[56:57], v5 offset:24576
  ds_read_b64_tr_b16 v[58:59], v5 offset:25088
  s_waitcnt lgkmcnt(6)
  v_mfma_f32_32x32x16_bf16 v[16:31], v[68:71], v[180:183], v[16:31]
  ds_read_b64_tr_b16 v[60:61], v5 offset:26624
  ds_read_b64_tr_b16 v[62:63], v5 offset:27136
  s_waitcnt lgkmcnt(6)
  v_mfma_f32_32x32x16_bf16 v[16:31], v[48:51], v[184:187], v[16:31]
  ds_read_b64_tr_b16 v[64:65], v5 offset:28672
  ds_read_b64_tr_b16 v[66:67], v5 offset:29184
  s_waitcnt lgkmcnt(6)
  v_mfma_f32_32x32x16_bf16 v[16:31], v[52:55], v[188:191], v[16:31]
  ds_read_b64_tr_b16 v[68:69], v5 offset:30720
  ds_read_b64_tr_b16 v[70:71], v5 offset:31232
  s_waitcnt lgkmcnt(6)
  v_mfma_f32_32x32x16_bf16 v[16:31], v[56:59], v[192:195], v[16:31]
  ds_read_b64_tr_b16 v[48:49], v5 offset:32768
  ds_read_b64_tr_b16 v[50:51], v5 offset:33280
  s_waitcnt lgkmcnt(6)
  v_mfma_f32_32x32x16_bf16 v[16:31], v[60:63], v[196:199], v[16:31]
  ds_read_b64_tr_b16 v[52:53], v5 offset:34816
  ds_read_b64_tr_b16 v[54:55], v5 offset:35328
  s_waitcnt lgkmcnt(6)
  v_mfma_f32_32x32x16_bf16 v[16:31], v[64:67], v[200:203], v[16:31]
  ds_read_b64_tr_b16 v[56:57], v5 offset:36864
  ds_read_b64_tr_b16 v[58:59], v5 offset:37376
  s_waitcnt lgkmcnt(6)
  v_mfma_f32_32x32x16_bf16 v[16:31], v[68:71], v[204:207], v[16:31]
  ds_read_b64_tr_b16 v[60:61], v5 offset:38912
  ds_read_b64_tr_b16 v[62:63], v5 offset:39424
  s_setprio 0
  s_add_u32 m0, s67, 155648
  s_add_u32 s74, s33, 2359296
  buffer_load_dwordx4 v3, s[8:11], s74 offen lds
  s_add_u32 m0, s67, 8192
  s_add_u32 s74, s33, 2949120
  buffer_load_dwordx4 v3, s[8:11], s74 offen lds
  v_mov_b32 v88, v101
  v_mov_b32 v111, 1
  buffer_store_dword v111, v109, s[16:19], s79 offen sc1
  v_fma_f32 v74, v74, s73, s73
  v_fma_f32 v75, v75, s73, s73
  v_rcp_f32 v72, v72
  v_rcp_f32 v73, v73
  v_rcp_f32 v74, v74
  v_rcp_f32 v75, v75
  v_mul_f32 v72, v72, v36
  v_mul_f32 v73, v73, v37
  v_mul_f32 v74, v74, v38
  v_mul_f32 v75, v75, v39
  v_cvt_pk_bf16_f32 v82, v72, v73
  v_cvt_pk_bf16_f32 v83, v74, v75
  v_fma_f32 v72, v40, v40, s72
  v_fma_f32 v73, v41, v41, s72
  v_fma_f32 v74, v42, v42, s72
  v_fma_f32 v75, v43, v43, s72
  v_mul_f32 v72, v72, v40
  v_mul_f32 v73, v73, v41
  v_mul_f32 v74, v74, v42
  v_mul_f32 v75, v75, v43
  v_exp_f32 v72, -v72
  v_exp_f32 v73, -v73
  v_exp_f32 v74, -v74
  v_exp_f32 v75, -v75
  v_fma_f32 v72, v72, s73, s73
  v_fma_f32 v73, v73, s73, s73
  v_fma_f32 v74, v74, s73, s73
  v_fma_f32 v75, v75, s73, s73
  v_rcp_f32 v72, v72
  v_rcp_f32 v73, v73
  v_rcp_f32 v74, v74
  s_add_u32 s74, s35, 49152
  buffer_store_dwordx4 v[80:83], v12, s[16:19], s74 offen sc1
  ds_write_b128 v106, v[80:83] offset:49152
  s_barrier
  s_setprio 1
  s_waitcnt lgkmcnt(7)
  v_mfma_f32_32x32x16_bf16 v[16:31], v[48:51], v[208:211], v[16:31]
  ds_read_b64_tr_b16 v[64:65], v5 offset:40960
  ds_read_b64_tr_b16 v[66:67], v5 offset:41472
  s_waitcnt lgkmcnt(7)
  v_mfma_f32_32x32x16_bf16 v[16:31], v[52:55], v[212:215], v[16:31]
  ds_read_b64_tr_b16 v[68:69], v5 offset:43008
  ds_read_b64_tr_b16 v[70:71], v5 offset:43520
  s_waitcnt lgkmcnt(7)
  v_mfma_f32_32x32x16_bf16 v[16:31], v[56:59], v[216:219], v[16:31]
  ds_read_b64_tr_b16 v[48:49], v5 offset:45056
  ds_read_b64_tr_b16 v[50:51], v5 offset:45568
  s_waitcnt lgkmcnt(7)
  v_mfma_f32_32x32x16_bf16 v[16:31], v[60:63], v[220:223], v[16:31]
  ds_read_b64_tr_b16 v[52:53], v5 offset:47104
  ds_read_b64_tr_b16 v[54:55], v5 offset:47616
  s_waitcnt lgkmcnt(6)
  v_mfma_f32_32x32x16_bf16 v[16:31], v[64:67], v[224:227], v[16:31]
  ds_read_b64_tr_b16 v[56:57], v5 offset:49152
  ds_read_b64_tr_b16 v[58:59], v5 offset:49664
  s_waitcnt lgkmcnt(6)
  v_mfma_f32_32x32x16_bf16 v[16:31], v[68:71], v[228:231], v[16:31]
  ds_read_b64_tr_b16 v[60:61], v5 offset:51200
  ds_read_b64_tr_b16 v[62:63], v5 offset:51712
  s_waitcnt lgkmcnt(6)
  v_mfma_f32_32x32x16_bf16 v[16:31], v[48:51], v[232:235], v[16:31]
  ds_read_b64_tr_b16 v[64:65], v5 offset:53248
  ds_read_b64_tr_b16 v[66:67], v5 offset:53760
  s_waitcnt lgkmcnt(6)
  v_mfma_f32_32x32x16_bf16 v[16:31], v[52:55], v[236:239], v[16:31]
  ds_read_b64_tr_b16 v[68:69], v5 offset:55296
  ds_read_b64_tr_b16 v[70:71], v5 offset:55808
  s_waitcnt lgkmcnt(6)
  v_mfma_f32_32x32x16_bf16 v[16:31], v[56:59], v[240:243], v[16:31]
  ds_read_b64_tr_b16 v[48:49], v5 offset:57344
  ds_read_b64_tr_b16 v[50:51], v5 offset:57856
  s_waitcnt lgkmcnt(6)
  v_mfma_f32_32x32x16_bf16 v[16:31], v[60:63], v[244:247], v[16:31]
  ds_read_b64_tr_b16 v[52:53], v5 offset:59392
  ds_read_b64_tr_b16 v[54:55], v5 offset:59904
  s_waitcnt lgkmcnt(6)
  v_mfma_f32_32x32x16_bf16 v[16:31], v[64:67], v[248:251], v[16:31]
  ds_read_b64_tr_b16 v[56:57], v5 offset:61440
  ds_read_b64_tr_b16 v[58:59], v5 offset:61952
  s_waitcnt lgkmcnt(6)
  v_mfma_f32_32x32x16_bf16 v[16:31], v[68:71], v[252:255], v[16:31]
  ds_read_b64_tr_b16 v[60:61], v5 offset:63488
  ds_read_b64_tr_b16 v[62:63], v5 offset:64000
  s_setprio 0
  s_add_u32 m0, s67, 0
  s_add_u32 s74, s33, 3538944
  buffer_load_dwordx4 v3, s[8:11], s74 offen lds
  s_add_u32 m0, s67, 16384
  s_add_u32 s74, s33, 4128768
  buffer_load_dwordx4 v3, s[8:11], s74 offen lds
  s_add_u32 m0, s67, 24576
  s_add_u32 s74, s33, 4718592
  buffer_load_dwordx4 v3, s[8:11], s74 offen lds
  v_rcp_f32 v75, v75
  v_mul_f32 v72, v72, v40
  v_mul_f32 v73, v73, v41
  v_mul_f32 v74, v74, v42
  v_mul_f32 v75, v75, v43
  v_cvt_pk_bf16_f32 v84, v72, v73
  v_cvt_pk_bf16_f32 v85, v74, v75
  v_fma_f32 v72, v44, v44, s72
  v_fma_f32 v73, v45, v45, s72
  v_fma_f32 v74, v46, v46, s72
  v_fma_f32 v75, v47, v47, s72
  v_mul_f32 v72, v72, v44
  v_mul_f32 v73, v73, v45
  v_mul_f32 v74, v74, v46
  v_mul_f32 v75, v75, v47
  v_exp_f32 v72, -v72
  v_exp_f32 v73, -v73
  v_exp_f32 v74, -v74
  v_exp_f32 v75, -v75
  v_fma_f32 v72, v72, s73, s73
  v_fma_f32 v73, v73, s73, s73
  v_fma_f32 v74, v74, s73, s73
  v_fma_f32 v75, v75, s73, s73
  v_rcp_f32 v72, v72
  v_rcp_f32 v73, v73
  v_rcp_f32 v74, v74
  v_rcp_f32 v75, v75
  v_mul_f32 v72, v72, v44
  v_mul_f32 v73, v73, v45
  v_mul_f32 v74, v74, v46
  v_mul_f32 v75, v75, v47
  v_cvt_pk_bf16_f32 v86, v72, v73
  v_cvt_pk_bf16_f32 v87, v74, v75
  s_add_u32 s74, s35, 53248
  buffer_store_dwordx4 v[84:87], v12, s[16:19], s74 offen sc1
  ds_write_b128 v106, v[84:87] offset:53248
  s_waitcnt vmcnt(8) lgkmcnt(0)
  s_barrier
  s_setprio 1
  v_mfma_f32_32x32x16_bf16 v[32:47], v[88:91], v[92:95], 0
  v_mfma_f32_32x32x16_bf16 v[32:47], v[48:51], v[112:115], v[32:47]
  ds_read_b64_tr_b16 v[64:65], v7 offset:0
  ds_read_b64_tr_b16 v[66:67], v7 offset:512
  v_mfma_f32_32x32x16_bf16 v[32:47], v[52:55], v[116:119], v[32:47]
  ds_read_b64_tr_b16 v[68:69], v7 offset:2048
  ds_read_b64_tr_b16 v[70:71], v7 offset:2560
  v_mfma_f32_32x32x16_bf16 v[32:47], v[56:59], v[120:123], v[32:47]
  ds_read_b64_tr_b16 v[48:49], v7 offset:4096
  ds_read_b64_tr_b16 v[50:51], v7 offset:4608
  v_mfma_f32_32x32x16_bf16 v[32:47], v[60:63], v[124:127], v[32:47]
  ds_read_b64_tr_b16 v[52:53], v7 offset:6144
  ds_read_b64_tr_b16 v[54:55], v7 offset:6656
  s_waitcnt lgkmcnt(6)
  v_mfma_f32_32x32x16_bf16 v[32:47], v[64:67], v[128:131], v[32:47]
  ds_read_b64_tr_b16 v[56:57], v7 offset:8192
  ds_read_b64_tr_b16 v[58:59], v7 offset:8704
  s_waitcnt lgkmcnt(6)
  v_mfma_f32_32x32x16_bf16 v[32:47], v[68:71], v[132:135], v[32:47]
  ds_read_b64_tr_b16 v[60:61], v7 offset:10240
  ds_read_b64_tr_b16 v[62:63], v7 offset:10752
  s_waitcnt lgkmcnt(6)
  v_mfma_f32_32x32x16_bf16 v[32:47], v[48:51], v[136:139], v[32:47]
  ds_read_b64_tr_b16 v[64:65], v7 offset:12288
  ds_read_b64_tr_b16 v[66:67], v7 offset:12800
  s_waitcnt lgkmcnt(6)
  v_mfma_f32_32x32x16_bf16 v[32:47], v[52:55], v[140:143], v[32:47]
  ds_read_b64_tr_b16 v[68:69], v7 offset:14336
  ds_read_b64_tr_b16 v[70:71], v7 offset:14848
  s_waitcnt lgkmcnt(6)
  v_mfma_f32_32x32x16_bf16 v[32:47], v[56:59], v[144:147], v[32:47]
  ds_read_b64_tr_b16 v[48:49], v7 offset:16384
  ds_read_b64_tr_b16 v[50:51], v7 offset:16896
  s_waitcnt lgkmcnt(6)
  v_mfma_f32_32x32x16_bf16 v[32:47], v[60:63], v[148:151], v[32:47]
  ds_read_b64_tr_b16 v[52:53], v7 offset:18432
  ds_read_b64_tr_b16 v[54:55], v7 offset:18944
  s_waitcnt lgkmcnt(6)
  v_mfma_f32_32x32x16_bf16 v[32:47], v[64:67], v[152:155], v[32:47]
  ds_read_b64_tr_b16 v[56:57], v7 offset:20480
  ds_read_b64_tr_b16 v[58:59], v7 offset:20992
  s_waitcnt lgkmcnt(6)
  v_mfma_f32_32x32x16_bf16 v[32:47], v[68:71], v[156:159], v[32:47]
  ds_read_b64_tr_b16 v[60:61], v7 offset:22528
  ds_read_b64_tr_b16 v[62:63], v7 offset:23040
  s_setprio 0
  s_add_u32 m0, s67, 32768
  s_add_u32 s74, s80, s86
  buffer_load_dwordx4 v4, s[12:15], s74 offen lds
  s_add_u32 m0, s67, 40960
  s_add_u32 s74, s80, s87
  buffer_load_dwordx4 v4, s[12:15], s74 offen lds
  s_add_u32 m0, s67, 49152
  s_add_u32 s74, s80, s88
  buffer_load_dwordx4 v4, s[12:15], s74 offen lds
  buffer_load_dword v110, v2, s[16:19], s76 offen sc1
  v_fma_f32 v72, v16, v16, s72
  v_fma_f32 v73, v17, v17, s72
  v_fma_f32 v74, v18, v18, s72
  v_fma_f32 v75, v19, v19, s72
  v_mul_f32 v72, v72, v16
  v_mul_f32 v73, v73, v17
  v_mul_f32 v74, v74, v18
  v_mul_f32 v75, v75, v19
  v_exp_f32 v72, -v72
  v_exp_f32 v73, -v73
  v_exp_f32 v74, -v74
  v_exp_f32 v75, -v75
  v_fma_f32 v72, v72, s73, s73
  v_fma_f32 v73, v73, s73, s73
  v_fma_f32 v74, v74, s73, s73
  v_fma_f32 v75, v75, s73, s73
  v_rcp_f32 v72, v72
  v_rcp_f32 v73, v73
  v_rcp_f32 v74, v74
  v_rcp_f32 v75, v75
  v_mul_f32 v72, v72, v16
  v_mul_f32 v73, v73, v17
  v_mul_f32 v74, v74, v18
  v_mul_f32 v75, v75, v19
  v_cvt_pk_bf16_f32 v80, v72, v73
  v_cvt_pk_bf16_f32 v81, v74, v75
  v_fma_f32 v72, v20, v20, s72
  v_fma_f32 v73, v21, v21, s72
  v_fma_f32 v74, v22, v22, s72
  v_fma_f32 v75, v23, v23, s72
  v_mul_f32 v72, v72, v20
  v_mul_f32 v73, v73, v21
  v_mul_f32 v74, v74, v22
  v_mul_f32 v75, v75, v23
  v_exp_f32 v72, -v72
  v_exp_f32 v73, -v73
  v_exp_f32 v74, -v74
  v_exp_f32 v75, -v75
  v_fma_f32 v72, v72, s73, s73
  v_fma_f32 v73, v73, s73, s73
  s_waitcnt vmcnt(7)
  s_barrier
  s_setprio 1
  s_waitcnt lgkmcnt(6)
  v_mfma_f32_32x32x16_bf16 v[32:47], v[48:51], v[160:163], v[32:47]
  ds_read_b128 v[112:115], v104 offset:0
  ds_read_b64_tr_b16 v[64:65], v7 offset:24576
  ds_read_b64_tr_b16 v[66:67], v7 offset:25088
  s_waitcnt lgkmcnt(7)
  v_mfma_f32_32x32x16_bf16 v[32:47], v[52:55], v[164:167], v[32:47]
  ds_read_b128 v[116:119], v104 offset:4096
  ds_read_b64_tr_b16 v[68:69], v7 offset:26624
  ds_read_b64_tr_b16 v[70:71], v7 offset:27136
  s_waitcnt lgkmcnt(8)
  v_mfma_f32_32x32x16_bf16 v[32:47], v[56:59], v[168:171], v[32:47]
  ds_read_b128 v[120:123], v104 offset:8192
  ds_read_b64_tr_b16 v[48:49], v7 offset:28672
  ds_read_b64_tr_b16 v[50:51], v7 offset:29184
  s_waitcnt lgkmcnt(9)
  v_mfma_f32_32x32x16_bf16 v[32:47], v[60:63], v[172:175], v[32:47]
  ds_read_b128 v[124:127], v104 offset:12288
  ds_read_b64_tr_b16 v[52:53], v7 offset:30720
  ds_read_b64_tr_b16 v[54:55], v7 offset:31232
  s_waitcnt lgkmcnt(9)
  v_mfma_f32_32x32x16_bf16 v[32:47], v[64:67], v[176:179], v[32:47]
  ds_read_b128 v[128:131], v104 offset:16384
  ds_read_b64_tr_b16 v[56:57], v5 offset:8192
  ds_read_b64_tr_b16 v[58:59], v5 offset:8704
  s_waitcnt lgkmcnt(9)
  v_mfma_f32_32x32x16_bf16 v[32:47], v[68:71], v[180:183], v[32:47]
  ds_read_b128 v[132:135], v104 offset:20480
  ds_read_b64_tr_b16 v[60:61], v5 offset:10240
  ds_read_b64_tr_b16 v[62:63], v5 offset:10752
  s_waitcnt lgkmcnt(9)
  v_mfma_f32_32x32x16_bf16 v[32:47], v[48:51], v[184:187], v[32:47]
  ds_read_b128 v[136:139], v104 offset:24576
  ds_read_b64_tr_b16 v[64:65], v5 offset:12288
  ds_read_b64_tr_b16 v[66:67], v5 offset:12800
  s_waitcnt lgkmcnt(9)
  v_mfma_f32_32x32x16_bf16 v[32:47], v[52:55], v[188:191], v[32:47]
  ds_read_b128 v[140:143], v104 offset:28672
  ds_read_b64_tr_b16 v[68:69], v5 offset:14336
  ds_read_b64_tr_b16 v[70:71], v5 offset:14848
  s_waitcnt lgkmcnt(9)
  v_mfma_f32_32x32x16_bf16 v[32:47], v[56:59], v[192:195], v[32:47]
  ds_read_b128 v[144:147], v104 offset:32768
  ds_read_b64_tr_b16 v[48:49], v5 offset:0
  ds_read_b64_tr_b16 v[50:51], v5 offset:512
  s_waitcnt lgkmcnt(9)
  v_mfma_f32_32x32x16_bf16 v[32:47], v[60:63], v[196:199], v[32:47]
  ds_read_b128 v[148:151], v104 offset:36864
  ds_read_b64_tr_b16 v[52:53], v5 offset:2048
  ds_read_b64_tr_b16 v[54:55], v5 offset:2560
  s_waitcnt lgkmcnt(9)
  v_mfma_f32_32x32x16_bf16 v[32:47], v[64:67], v[200:203], v[32:47]
  ds_read_b128 v[152:155], v104 offset:40960
  ds_read_b64_tr_b16 v[56:57], v5 offset:4096
  ds_read_b64_tr_b16 v[58:59], v5 offset:4608
  s_waitcnt lgkmcnt(9)
  v_mfma_f32_32x32x16_bf16 v[32:47], v[68:71], v[204:207], v[32:47]
  ds_read_b128 v[156:159], v104 offset:45056
  ds_read_b64_tr_b16 v[60:61], v5 offset:6144
  ds_read_b64_tr_b16 v[62:63], v5 offset:6656
  s_setprio 0
  s_add_u32 m0, s67, 57344
  s_add_u32 s74, s81, s86
  buffer_load_dwordx4 v4, s[12:15], s74 offen lds
  v_fma_f32 v74, v74, s73, s73
  v_fma_f32 v75, v75, s73, s73
  v_rcp_f32 v72, v72
  v_rcp_f32 v73, v73
  v_rcp_f32 v74, v74
  v_rcp_f32 v75, v75
  v_mul_f32 v72, v72, v20
  v_mul_f32 v73, v73, v21
  v_mul_f32 v74, v74, v22
  v_mul_f32 v75, v75, v23
  v_cvt_pk_bf16_f32 v82, v72, v73
  v_cvt_pk_bf16_f32 v83, v74, v75
  v_fma_f32 v72, v24, v24, s72
  v_fma_f32 v73, v25, v25, s72
  v_fma_f32 v74, v26, v26, s72
  v_fma_f32 v75, v27, v27, s72
  v_mul_f32 v72, v72, v24
  v_mul_f32 v73, v73, v25
  v_mul_f32 v74, v74, v26
  v_mul_f32 v75, v75, v27
  v_exp_f32 v72, -v72
  v_exp_f32 v73, -v73
  v_exp_f32 v74, -v74
  v_exp_f32 v75, -v75
  v_fma_f32 v72, v72, s73, s73
  v_fma_f32 v73, v73, s73, s73
  v_fma_f32 v74, v74, s73, s73
  v_fma_f32 v75, v75, s73, s73
  v_rcp_f32 v72, v72
  v_rcp_f32 v73, v73
  v_rcp_f32 v74, v74
  s_add_u32 s74, s35, 65536
  buffer_store_dwordx4 v[80:83], v12, s[16:19], s74 offen sc1
  ds_write_b128 v107, v[80:83] offset:0
  s_waitcnt vmcnt(2)
  s_cmp_eq_u32 s60, 0
  s_cbranch_scc0 L_hc1_d
  v_cmp_le_u32 vcc, 1, v110
  s_nop 0
  s_cmp_eq_u64 vcc, -1
  s_cbranch_scc1 L_hc1_d
  s_mov_b32 s78, 49414144
  s_mov_b32 s74, 400000
L_hc1:
  buffer_load_dword v14, v2, s[16:19], s78 offen sc1
  s_waitcnt vmcnt(0)
  v_cmp_le_u32 vcc, 1, v14
  s_sub_u32 s74, s74, 1
  s_cmp_eq_u64 vcc, -1
  s_cbranch_scc1 L_hc1_d
  s_cmp_eq_u32 s74, 0
  s_cbranch_scc1 L_hc1_d
  s_sleep 2
  s_branch L_hc1
L_hc1_d:
  s_waitcnt lgkmcnt(3)
  s_barrier
  s_setprio 1
  v_mfma_f32_32x32x16_bf16 v[32:47], v[48:51], v[208:211], v[32:47]
  ds_read_b128 v[160:163], v104 offset:49152
  ds_read_b64_tr_b16 v[64:65], v5 offset:16384
  ds_read_b64_tr_b16 v[66:67], v5 offset:16896
  v_mfma_f32_32x32x16_bf16 v[32:47], v[52:55], v[212:215], v[32:47]
  ds_read_b128 v[164:167], v104 offset:53248
  ds_read_b64_tr_b16 v[68:69], v5 offset:18432
  ds_read_b64_tr_b16 v[70:71], v5 offset:18944
  v_mfma_f32_32x32x16_bf16 v[32:47], v[56:59], v[216:219], v[32:47]
  ds_read_b128 v[168:171], v104 offset:57344
  ds_read_b64_tr_b16 v[48:49], v5 offset:20480
  ds_read_b64_tr_b16 v[50:51], v5 offset:20992
  s_waitcnt lgkmcnt(10)
  v_mfma_f32_32x32x16_bf16 v[32:47], v[60:63], v[220:223], v[32:47]
  ds_read_b128 v[172:175], v104 offset:61440
  ds_read_b64_tr_b16 v[52:53], v5 offset:22528
  ds_read_b64_tr_b16 v[54:55], v5 offset:23040
  s_waitcnt lgkmcnt(9)
  v_mfma_f32_32x32x16_bf16 v[32:47], v[64:67], v[224:227], v[32:47]
  ds_read_b64_tr_b16 v[56:57], v5 offset:24576
  ds_read_b64_tr_b16 v[58:59], v5 offset:25088
  s_waitcnt lgkmcnt(8)
  v_mfma_f32_32x32x16_bf16 v[32:47], v[68:71], v[228:231], v[32:47]
  ds_read_b64_tr_b16 v[60:61], v5 offset:26624
  ds_read_b64_tr_b16 v[62:63], v5 offset:27136
  s_waitcnt lgkmcnt(7)
  v_mfma_f32_32x32x16_bf16 v[32:47], v[48:51], v[232:235], v[32:47]
  ds_read_b64_tr_b16 v[64:65], v5 offset:28672
  ds_read_b64_tr_b16 v[66:67], v5 offset:29184
  s_waitcnt lgkmcnt(6)
  v_mfma_f32_32x32x16_bf16 v[32:47], v[52:55], v[236:239], v[32:47]
  ds_read_b64_tr_b16 v[68:69], v5 offset:30720
  ds_read_b64_tr_b16 v[70:71], v5 offset:31232
  s_waitcnt lgkmcnt(6)
  v_mfma_f32_32x32x16_bf16 v[32:47], v[56:59], v[240:243], v[32:47]
  ds_read_b64_tr_b16 v[48:49], v8 offset:32768
  ds_read_b64_tr_b16 v[50:51], v8 offset:33792
  s_waitcnt lgkmcnt(6)
  v_mfma_f32_32x32x16_bf16 v[32:47], v[60:63], v[244:247], v[32:47]
  ds_read_b64_tr_b16 v[52:53], v8 offset:34816
  ds_read_b64_tr_b16 v[54:55], v8 offset:35840
  s_waitcnt lgkmcnt(6)
  v_mfma_f32_32x32x16_bf16 v[32:47], v[64:67], v[248:251], v[32:47]
  ds_read_b64_tr_b16 v[56:57], v8 offset:36864
  ds_read_b64_tr_b16 v[58:59], v8 offset:37888
  s_waitcnt lgkmcnt(6)
  v_mfma_f32_32x32x16_bf16 v[32:47], v[68:71], v[252:255], v[32:47]
  ds_read_b64_tr_b16 v[60:61], v8 offset:38912
  ds_read_b64_tr_b16 v[62:63], v8 offset:39936
  s_setprio 0
  s_add_u32 m0, s67, 8192
  s_add_u32 s74, s81, s87
  buffer_load_dwordx4 v4, s[12:15], s74 offen lds
  s_add_u32 m0, s67, 65536
  s_add_u32 s74, s81, s88
  buffer_load_dwordx4 v4, s[12:15], s74 offen lds
  s_add_u32 m0, s67, 73728
  s_add_u32 s74, s34, 0
  buffer_load_dwordx4 v12, s[16:19], s74 offen sc1 lds
  s_add_u32 m0, s67, 81920
  s_add_u32 s74, s34, 8192
  buffer_load_dwordx4 v12, s[16:19], s74 offen sc1 lds
  s_add_u32 m0, s67, 90112
  s_add_u32 s74, s80, s89
  buffer_load_dwordx4 v4, s[12:15], s74 offen lds
  v_rcp_f32 v75, v75
  v_mul_f32 v72, v72, v24
  v_mul_f32 v73, v73, v25
  v_mul_f32 v74, v74, v26
  v_mul_f32 v75, v75, v27
  v_cvt_pk_bf16_f32 v84, v72, v73
  v_cvt_pk_bf16_f32 v85, v74, v75
  v_fma_f32 v72, v28, v28, s72
  v_fma_f32 v73, v29, v29, s72
  v_fma_f32 v74, v30, v30, s72
  v_fma_f32 v75, v31, v31, s72
  v_mul_f32 v72, v72, v28
  v_mul_f32 v73, v73, v29
  v_mul_f32 v74, v74, v30
  v_mul_f32 v75, v75, v31
  v_exp_f32 v72, -v72
  v_exp_f32 v73, -v73
  v_exp_f32 v74, -v74
  v_exp_f32 v75, -v75
  v_fma_f32 v72, v72, s73, s73
  v_fma_f32 v73, v73, s73, s73
  v_fma_f32 v74, v74, s73, s73
  v_fma_f32 v75, v75, s73, s73
  v_rcp_f32 v72, v72
  v_rcp_f32 v73, v73
  v_rcp_f32 v74, v74
  v_rcp_f32 v75, v75
  v_mul_f32 v72, v72, v28
  v_mul_f32 v73, v73, v29
  v_mul_f32 v74, v74, v30
  v_mul_f32 v75, v75, v31
  v_cvt_pk_bf16_f32 v86, v72, v73
  v_cvt_pk_bf16_f32 v87, v74, v75
  s_add_u32 s74, s35, 69632
  buffer_store_dwordx4 v[84:87], v12, s[16:19], s74 offen sc1
  ds_write_b128 v107, v[84:87] offset:4096
  s_branch L_pj5
  .p2align 12
L_stub5:
  s_setpc_b64 s[58:59]
  s_nop 0
L_pj5:
  s_waitcnt vmcnt(7) lgkmcnt(0)
  s_barrier
  s_setprio 1
  v_mfma_f32_32x32x16_bf16 v[16:31], v[48:51], v[112:115], 0
  ds_read_b128 v[176:179], v105 offset:0
  ds_read_b64_tr_b16 v[64:65], v8 offset:40960
  ds_read_b64_tr_b16 v[66:67], v8 offset:41984
  v_mfma_f32_32x32x16_bf16 v[16:31], v[52:55], v[116:119], v[16:31]
  ds_read_b128 v[180:183], v105 offset:4096
  ds_read_b64_tr_b16 v[68:69], v8 offset:43008
  ds_read_b64_tr_b16 v[70:71], v8 offset:44032
  v_mfma_f32_32x32x16_bf16 v[16:31], v[56:59], v[120:123], v[16:31]
  ds_read_b128 v[184:187], v105 offset:8192
  ds_read_b64_tr_b16 v[48:49], v8 offset:45056
  ds_read_b64_tr_b16 v[50:51], v8 offset:46080
  v_mfma_f32_32x32x16_bf16 v[16:31], v[60:63], v[124:127], v[16:31]
  ds_read_b128 v[188:191], v105 offset:12288
  ds_read_b64_tr_b16 v[52:53], v8 offset:47104
  ds_read_b64_tr_b16 v[54:55], v8 offset:48128
  s_waitcnt lgkmcnt(9)
  v_mfma_f32_32x32x16_bf16 v[88:103], v[64:67], v[112:115], 0
  ds_read_b64_tr_b16 v[56:57], v8 offset:49152
  ds_read_b64_tr_b16 v[58:59], v8 offset:50176
  s_waitcnt lgkmcnt(8)
  v_mfma_f32_32x32x16_bf16 v[88:103], v[68:71], v[116:119], v[88:103]
  ds_read_b64_tr_b16 v[60:61], v8 offset:51200
  ds_read_b64_tr_b16 v[62:63], v8 offset:52224
  s_waitcnt lgkmcnt(7)
  v_mfma_f32_32x32x16_bf16 v[88:103], v[48:51], v[120:123], v[88:103]
  ds_read_b64_tr_b16 v[64:65], v8 offset:53248
  ds_read_b64_tr_b16 v[66:67], v8 offset:54272
  s_waitcnt lgkmcnt(6)
  v_mfma_f32_32x32x16_bf16 v[88:103], v[52:55], v[124:127], v[88:103]
  ds_read_b64_tr_b16 v[68:69], v8 offset:55296
  ds_read_b64_tr_b16 v[70:71], v8 offset:56320
  s_waitcnt lgkmcnt(6)
  v_mfma_f32_32x32x16_bf16 v[208:223], v[56:59], v[112:115], 0
  ds_read_b64_tr_b16 v[48:49], v8 offset:57344
  ds_read_b64_tr_b16 v[50:51], v8 offset:58368
  s_waitcnt lgkmcnt(6)
  v_mfma_f32_32x32x16_bf16 v[208:223], v[60:63], v[116:119], v[208:223]
  ds_read_b64_tr_b16 v[52:53], v8 offset:59392
  ds_read_b64_tr_b16 v[54:55], v8 offset:60416
  s_waitcnt lgkmcnt(6)
  v_mfma_f32_32x32x16_bf16 v[208:223], v[64:67], v[120:123], v[208:223]
  ds_read_b64_tr_b16 v[56:57], v8 offset:61440
  ds_read_b64_tr_b16 v[58:59], v8 offset:62464
  s_waitcnt lgkmcnt(6)
  v_mfma_f32_32x32x16_bf16 v[208:223], v[68:71], v[124:127], v[208:223]
  ds_read_b64_tr_b16 v[60:61], v8 offset:63488
  ds_read_b64_tr_b16 v[62:63], v8 offset:64512
  s_setprio 0
  s_add_u32 m0, s67, 0
  s_add_u32 s74, s80, s90
  buffer_load_dwordx4 v4, s[12:15], s74 offen lds
  s_add_u32 m0, s67, 16384
  s_add_u32 s74, s80, s91
  buffer_load_dwordx4 v4, s[12:15], s74 offen lds
  s_add_u32 m0, s67, 24576
  s_add_u32 s74, s34, 16384
  buffer_load_dwordx4 v12, s[16:19], s74 offen sc1 lds
  s_add_u32 m0, s67, 98304
  s_add_u32 s74, s34, 24576
  buffer_load_dwordx4 v12, s[16:19], s74 offen sc1 lds
  s_add_u32 m0, s67, 106496
  s_add_u32 s74, s81, s89
  buffer_load_dwordx4 v4, s[12:15], s74 offen lds
  v_fma_f32 v72, v32, v32, s72
  v_fma_f32 v73, v33, v33, s72
  v_fma_f32 v74, v34, v34, s72
  v_fma_f32 v75, v35, v35, s72
  v_mul_f32 v72, v72, v32
  v_mul_f32 v73, v73, v33
  v_mul_f32 v74, v74, v34
  v_mul_f32 v75, v75, v35
  v_exp_f32 v72, -v72
  v_exp_f32 v73, -v73
  v_exp_f32 v74, -v74
  v_exp_f32 v75, -v75
  v_fma_f32 v72, v72, s73, s73
  v_fma_f32 v73, v73, s73, s73
  v_fma_f32 v74, v74, s73, s73
  v_fma_f32 v75, v75, s73, s73
  v_rcp_f32 v72, v72
  v_rcp_f32 v73, v73
  v_rcp_f32 v74, v74
  v_rcp_f32 v75, v75
  v_mul_f32 v72, v72, v32
  v_mul_f32 v73, v73, v33
  v_mul_f32 v74, v74, v34
  v_mul_f32 v75, v75, v35
  v_cvt_pk_bf16_f32 v80, v72, v73
  v_cvt_pk_bf16_f32 v81, v74, v75
  v_fma_f32 v72, v36, v36, s72
  v_fma_f32 v73, v37, v37, s72
  v_fma_f32 v74, v38, v38, s72
  v_fma_f32 v75, v39, v39, s72
  v_mul_f32 v72, v72, v36
  v_mul_f32 v73, v73, v37
  v_mul_f32 v74, v74, v38
  v_mul_f32 v75, v75, v39
  v_exp_f32 v72, -v72
  v_exp_f32 v73, -v73
  v_exp_f32 v74, -v74
  v_exp_f32 v75, -v75
  v_fma_f32 v72, v72, s73, s73
  v_fma_f32 v73, v73, s73, s73
  s_waitcnt vmcnt(5)
  s_barrier
  s_setprio 1
  s_waitcnt lgkmcnt(6)
  v_mfma_f32_32x32x16_bf16 v[16:31], v[48:51], v[128:131], v[16:31]
  ds_read_b128 v[224:227], v104 offset:8192
  ds_read_b64_tr_b16 v[64:65], v8 offset:8192
  ds_read_b64_tr_b16 v[66:67], v8 offset:9216
  s_waitcnt lgkmcnt(7)
  v_mfma_f32_32x32x16_bf16 v[16:31], v[52:55], v[132:135], v[16:31]
  ds_read_b128 v[228:231], v104 offset:12288
  ds_read_b64_tr_b16 v[68:69], v8 offset:10240
  ds_read_b64_tr_b16 v[70:71], v8 offset:11264
  s_waitcnt lgkmcnt(8)
  v_mfma_f32_32x32x16_bf16 v[16:31], v[56:59], v[136:139], v[16:31]
  ds_read_b128 v[232:235], v104 offset:16384
  ds_read_b64_tr_b16 v[48:49], v8 offset:12288
  ds_read_b64_tr_b16 v[50:51], v8 offset:13312
  s_waitcnt lgkmcnt(9)
  v_mfma_f32_32x32x16_bf16 v[16:31], v[60:63], v[140:143], v[16:31]
  ds_read_b128 v[236:239], v104 offset:20480
  ds_read_b64_tr_b16 v[52:53], v8 offset:14336
  ds_read_b64_tr_b16 v[54:55], v8 offset:15360
  s_waitcnt lgkmcnt(9)
  v_mfma_f32_32x32x16_bf16 v[88:103], v[64:67], v[128:131], v[88:103]
  ds_read_b64_tr_b16 v[56:57], v9 offset:0
  ds_read_b64_tr_b16 v[58:59], v9 offset:1024
  s_waitcnt lgkmcnt(8)
  v_mfma_f32_32x32x16_bf16 v[88:103], v[68:71], v[132:135], v[88:103]
  ds_read_b64_tr_b16 v[60:61], v9 offset:2048
  ds_read_b64_tr_b16 v[62:63], v9 offset:3072
  s_waitcnt lgkmcnt(7)
  v_mfma_f32_32x32x16_bf16 v[88:103], v[48:51], v[136:139], v[88:103]
  ds_read_b64_tr_b16 v[64:65], v9 offset:4096
  ds_read_b64_tr_b16 v[66:67], v9 offset:5120
  s_waitcnt lgkmcnt(6)
  v_mfma_f32_32x32x16_bf16 v[88:103], v[52:55], v[140:143], v[88:103]
  ds_read_b64_tr_b16 v[68:69], v9 offset:6144
  ds_read_b64_tr_b16 v[70:71], v9 offset:7168
  s_waitcnt lgkmcnt(6)
  v_mfma_f32_32x32x16_bf16 v[208:223], v[56:59], v[128:131], v[208:223]
  ds_read_b64_tr_b16 v[48:49], v9 offset:24576
  ds_read_b64_tr_b16 v[50:51], v9 offset:25600
  s_waitcnt lgkmcnt(6)
  v_mfma_f32_32x32x16_bf16 v[208:223], v[60:63], v[132:135], v[208:223]
  ds_read_b64_tr_b16 v[52:53], v9 offset:26624
  ds_read_b64_tr_b16 v[54:55], v9 offset:27648
  s_waitcnt lgkmcnt(6)
  v_mfma_f32_32x32x16_bf16 v[208:223], v[64:67], v[136:139], v[208:223]
  ds_read_b64_tr_b16 v[56:57], v9 offset:28672
  ds_read_b64_tr_b16 v[58:59], v9 offset:29696
  s_waitcnt lgkmcnt(6)
  v_mfma_f32_32x32x16_bf16 v[208:223], v[68:71], v[140:143], v[208:223]
  ds_read_b64_tr_b16 v[60:61], v9 offset:30720
  ds_read_b64_tr_b16 v[62:63], v9 offset:31744
  s_setprio 0
  s_add_u32 m0, s67, 32768
  s_add_u32 s74, s81, s90
  buffer_load_dwordx4 v4, s[12:15], s74 offen lds
  s_add_u32 m0, s67, 40960
  s_add_u32 s74, s81, s91
  buffer_load_dwordx4 v4, s[12:15], s74 offen lds
  s_add_u32 m0, s67, 49152
  s_add_u32 s74, s34, 32768
  buffer_load_dwordx4 v12, s[16:19], s74 offen sc1 lds
  s_add_u32 m0, s67, 114688
  s_add_u32 s74, s34, 40960
  buffer_load_dwordx4 v12, s[16:19], s74 offen sc1 lds
  s_add_u32 m0, s67, 122880
  s_add_u32 s74, s82, s89
  buffer_load_dwordx4 v4, s[12:15], s74 offen lds
  v_mov_b32 v111, 2
  buffer_store_dword v111, v109, s[16:19], s79 offen sc1
  v_fma_f32 v74, v74, s73, s73
  v_fma_f32 v75, v75, s73, s73
  v_rcp_f32 v72, v72
  v_rcp_f32 v73, v73
  v_rcp_f32 v74, v74
  v_rcp_f32 v75, v75
  v_mul_f32 v72, v72, v36
  v_mul_f32 v73, v73, v37
  v_mul_f32 v74, v74, v38
  v_mul_f32 v75, v75, v39
  v_cvt_pk_bf16_f32 v82, v72, v73
  v_cvt_pk_bf16_f32 v83, v74, v75
  v_fma_f32 v72, v40, v40, s72
  v_fma_f32 v73, v41, v41, s72
  v_fma_f32 v74, v42, v42, s72
  v_fma_f32 v75, v43, v43, s72
  v_mul_f32 v72, v72, v40
  v_mul_f32 v73, v73, v41
  v_mul_f32 v74, v74, v42
  v_mul_f32 v75, v75, v43
  v_exp_f32 v72, -v72
  v_exp_f32 v73, -v73
  v_exp_f32 v74, -v74
  v_exp_f32 v75, -v75
  v_fma_f32 v72, v72, s73, s73
  v_fma_f32 v73, v73, s73, s73
  v_fma_f32 v74, v74, s73, s73
  v_fma_f32 v75, v75, s73, s73
  v_rcp_f32 v72, v72
  v_rcp_f32 v73, v73
  v_rcp_f32 v74, v74
  s_add_u32 s74, s35, 81920
  buffer_store_dwordx4 v[80:83], v12, s[16:19], s74 offen sc1
  ds_write_b128 v107, v[80:83] offset:16384
  s_waitcnt vmcnt(7)
  s_barrier
  s_setprio 1
  s_waitcnt lgkmcnt(7)
  v_mfma_f32_32x32x16_bf16 v[16:31], v[48:51], v[224:227], v[16:31]
  ds_read_b128 v[240:243], v13 offset:24576
  ds_read_b64_tr_b16 v[64:65], v8 offset:0
  ds_read_b64_tr_b16 v[66:67], v8 offset:1024
  s_waitcnt lgkmcnt(8)
  v_mfma_f32_32x32x16_bf16 v[16:31], v[52:55], v[228:231], v[16:31]
  ds_read_b128 v[244:247], v13 offset:28672
  ds_read_b64_tr_b16 v[68:69], v8 offset:2048
  ds_read_b64_tr_b16 v[70:71], v8 offset:3072
  s_waitcnt lgkmcnt(9)
  v_mfma_f32_32x32x16_bf16 v[16:31], v[56:59], v[232:235], v[16:31]
  ds_read_b128 v[248:251], v104 offset:32768
  ds_read_b64_tr_b16 v[48:49], v8 offset:4096
  ds_read_b64_tr_b16 v[50:51], v8 offset:5120
  s_waitcnt lgkmcnt(10)
  v_mfma_f32_32x32x16_bf16 v[16:31], v[60:63], v[236:239], v[16:31]
  ds_read_b128 v[252:255], v104 offset:36864
  ds_read_b64_tr_b16 v[52:53], v8 offset:6144
  ds_read_b64_tr_b16 v[54:55], v8 offset:7168
  s_waitcnt lgkmcnt(9)
  v_mfma_f32_32x32x16_bf16 v[88:103], v[64:67], v[224:227], v[88:103]
  ds_read_b64_tr_b16 v[56:57], v8 offset:16384
  ds_read_b64_tr_b16 v[58:59], v8 offset:17408
  s_waitcnt lgkmcnt(8)
  v_mfma_f32_32x32x16_bf16 v[88:103], v[68:71], v[228:231], v[88:103]
  ds_read_b64_tr_b16 v[60:61], v8 offset:18432
  ds_read_b64_tr_b16 v[62:63], v8 offset:19456
  s_waitcnt lgkmcnt(7)
  v_mfma_f32_32x32x16_bf16 v[88:103], v[48:51], v[232:235], v[88:103]
  ds_read_b64_tr_b16 v[64:65], v8 offset:20480
  ds_read_b64_tr_b16 v[66:67], v8 offset:21504
  s_waitcnt lgkmcnt(6)
  v_mfma_f32_32x32x16_bf16 v[88:103], v[52:55], v[236:239], v[88:103]
  ds_read_b64_tr_b16 v[68:69], v8 offset:22528
  ds_read_b64_tr_b16 v[70:71], v8 offset:23552
  s_waitcnt lgkmcnt(6)
  v_mfma_f32_32x32x16_bf16 v[208:223], v[56:59], v[224:227], v[208:223]
  ds_read_b64_tr_b16 v[48:49], v9 offset:40960
  ds_read_b64_tr_b16 v[50:51], v9 offset:41984
  s_waitcnt lgkmcnt(6)
  v_mfma_f32_32x32x16_bf16 v[208:223], v[60:63], v[228:231], v[208:223]
  ds_read_b64_tr_b16 v[52:53], v9 offset:43008
  ds_read_b64_tr_b16 v[54:55], v9 offset:44032
  s_waitcnt lgkmcnt(6)
  v_mfma_f32_32x32x16_bf16 v[208:223], v[64:67], v[232:235], v[208:223]
  ds_read_b64_tr_b16 v[56:57], v9 offset:45056
  ds_read_b64_tr_b16 v[58:59], v9 offset:46080
  s_waitcnt lgkmcnt(6)
  v_mfma_f32_32x32x16_bf16 v[208:223], v[68:71], v[236:239], v[208:223]
  ds_read_b64_tr_b16 v[60:61], v9 offset:47104
  ds_read_b64_tr_b16 v[62:63], v9 offset:48128
  s_setprio 0
  s_add_u32 m0, s67, 8192
  s_add_u32 s74, s82, s90
  buffer_load_dwordx4 v4, s[12:15], s74 offen lds
  s_add_u32 m0, s67, 57344
  s_add_u32 s74, s82, s91
  buffer_load_dwordx4 v4, s[12:15], s74 offen lds
  s_add_u32 m0, s67, 65536
  s_add_u32 s74, s3, 0
  buffer_load_dwordx4 v12, s[16:19], s74 offen sc1 lds
  s_add_u32 m0, s67, 73728
  s_add_u32 s74, s3, 8192
  buffer_load_dwordx4 v12, s[16:19], s74 offen sc1 lds
  s_add_u32 m0, s67, 81920
  s_add_u32 s74, s80, s92
  buffer_load_dwordx4 v4, s[12:15], s74 offen lds
  v_rcp_f32 v75, v75
  v_mul_f32 v72, v72, v40
  v_mul_f32 v73, v73, v41
  v_mul_f32 v74, v74, v42
  v_mul_f32 v75, v75, v43
  v_cvt_pk_bf16_f32 v84, v72, v73
  v_cvt_pk_bf16_f32 v85, v74, v75
  v_fma_f32 v72, v44, v44, s72
  v_fma_f32 v73, v45, v45, s72
  v_fma_f32 v74, v46, v46, s72
  v_fma_f32 v75, v47, v47, s72
  v_mul_f32 v72, v72, v44
  v_mul_f32 v73, v73, v45
  v_mul_f32 v74, v74, v46
  v_mul_f32 v75, v75, v47
  v_exp_f32 v72, -v72
  v_exp_f32 v73, -v73
  v_exp_f32 v74, -v74
  v_exp_f32 v75, -v75
  v_fma_f32 v72, v72, s73, s73
  v_fma_f32 v73, v73, s73, s73
  v_fma_f32 v74, v74, s73, s73
  v_fma_f32 v75, v75, s73, s73
  v_rcp_f32 v72, v72
  v_rcp_f32 v73, v73
  v_rcp_f32 v74, v74
  v_rcp_f32 v75, v75
  v_mul_f32 v72, v72, v44
  v_mul_f32 v73, v73, v45
  v_mul_f32 v74, v74, v46
  v_mul_f32 v75, v75, v47
  v_cvt_pk_bf16_f32 v86, v72, v73
  v_cvt_pk_bf16_f32 v87, v74, v75
  s_add_u32 s74, s35, 86016
  buffer_store_dwordx4 v[84:87], v12, s[16:19], s74 offen sc1
  ds_write_b128 v107, v[84:87] offset:20480
  s_waitcnt vmcnt(8) lgkmcnt(0)
  s_barrier
  s_setprio 1
  v_mfma_f32_32x32x16_bf16 v[16:31], v[48:51], v[240:243], v[16:31]
  ds_read_b128 v[192:195], v105 offset:16384
  ds_read_b64_tr_b16 v[64:65], v8 offset:32768
  ds_read_b64_tr_b16 v[66:67], v8 offset:33792
  v_mfma_f32_32x32x16_bf16 v[16:31], v[52:55], v[244:247], v[16:31]
  ds_read_b128 v[196:199], v105 offset:20480
  ds_read_b64_tr_b16 v[68:69], v8 offset:34816
  ds_read_b64_tr_b16 v[70:71], v8 offset:35840
  v_mfma_f32_32x32x16_bf16 v[16:31], v[56:59], v[248:251], v[16:31]
  ds_read_b128 v[200:203], v105 offset:24576
  ds_read_b64_tr_b16 v[48:49], v8 offset:36864
  ds_read_b64_tr_b16 v[50:51], v8 offset:37888
  v_mfma_f32_32x32x16_bf16 v[16:31], v[60:63], v[252:255], v[16:31]
  ds_read_b128 v[204:207], v105 offset:28672
  ds_read_b64_tr_b16 v[52:53], v8 offset:38912
  ds_read_b64_tr_b16 v[54:55], v8 offset:39936
  s_waitcnt lgkmcnt(9)
  v_mfma_f32_32x32x16_bf16 v[88:103], v[64:67], v[240:243], v[88:103]
  ds_read_b128 v[224:227], v13 offset:49152
  ds_read_b64_tr_b16 v[56:57], v8 offset:40960
  ds_read_b64_tr_b16 v[58:59], v8 offset:41984
  s_waitcnt lgkmcnt(9)
  v_mfma_f32_32x32x16_bf16 v[88:103], v[68:71], v[244:247], v[88:103]
  ds_read_b128 v[228:231], v13 offset:53248
  ds_read_b64_tr_b16 v[60:61], v8 offset:43008
  ds_read_b64_tr_b16 v[62:63], v8 offset:44032
  s_waitcnt lgkmcnt(9)
  v_mfma_f32_32x32x16_bf16 v[88:103], v[48:51], v[248:251], v[88:103]
  ds_read_b128 v[232:235], v104 offset:49152
  ds_read_b64_tr_b16 v[64:65], v8 offset:45056
  ds_read_b64_tr_b16 v[66:67], v8 offset:46080
  s_waitcnt lgkmcnt(9)
  v_mfma_f32_32x32x16_bf16 v[88:103], v[52:55], v[252:255], v[88:103]
  ds_read_b128 v[236:239], v104 offset:53248
  ds_read_b64_tr_b16 v[68:69], v8 offset:47104
  ds_read_b64_tr_b16 v[70:71], v8 offset:48128
  s_waitcnt lgkmcnt(9)
  v_mfma_f32_32x32x16_bf16 v[208:223], v[56:59], v[240:243], v[208:223]
  ds_read_b64_tr_b16 v[48:49], v9 offset:57344
  ds_read_b64_tr_b16 v[50:51], v9 offset:58368
  s_waitcnt lgkmcnt(8)
  v_mfma_f32_32x32x16_bf16 v[208:223], v[60:63], v[244:247], v[208:223]
  ds_read_b64_tr_b16 v[52:53], v9 offset:59392
  ds_read_b64_tr_b16 v[54:55], v9 offset:60416
  s_waitcnt lgkmcnt(7)
  v_mfma_f32_32x32x16_bf16 v[208:223], v[64:67], v[248:251], v[208:223]
  ds_read_b64_tr_b16 v[56:57], v9 offset:61440
  ds_read_b64_tr_b16 v[58:59], v9 offset:62464
  s_waitcnt lgkmcnt(6)
  v_mfma_f32_32x32x16_bf16 v[208:223], v[68:71], v[252:255], v[208:223]
  ds_read_b64_tr_b16 v[60:61], v9 offset:63488
  ds_read_b64_tr_b16 v[62:63], v9 offset:64512
  s_setprio 0
  s_add_u32 m0, s67, 0
  s_add_u32 s74, s80, s93
  buffer_load_dwordx4 v4, s[12:15], s74 offen lds
  s_add_u32 m0, s67, 16384
  s_add_u32 s74, s80, s94
  buffer_load_dwordx4 v4, s[12:15], s74 offen lds
  s_add_u32 m0, s67, 24576
  s_add_u32 s74, s3, 16384
  buffer_load_dwordx4 v12, s[16:19], s74 offen sc1 lds
  s_add_u32 m0, s67, 90112
  s_add_u32 s74, s3, 24576
  buffer_load_dwordx4 v12, s[16:19], s74 offen sc1 lds
  s_add_u32 m0, s67, 98304
  s_add_u32 s74, s81, s92
  buffer_load_dwordx4 v4, s[12:15], s74 offen lds
  s_add_u32 m0, s67, 131072
  s_add_u32 s74, s81, s93
  buffer_load_dwordx4 v4, s[12:15], s74 offen lds
  buffer_load_dword v110, v2, s[16:19], s76 offen sc1
  s_waitcnt vmcnt(7)
  s_barrier
  s_setprio 1
  s_waitcnt lgkmcnt(6)
  v_mfma_f32_32x32x16_bf16 v[16:31], v[48:51], v[224:227], v[16:31]
  ds_read_b128 v[240:243], v104 offset:0
  ds_read_b64_tr_b16 v[64:65], v8 offset:8192
  ds_read_b64_tr_b16 v[66:67], v8 offset:9216
  s_waitcnt lgkmcnt(7)
  v_mfma_f32_32x32x16_bf16 v[16:31], v[52:55], v[228:231], v[16:31]
  ds_read_b128 v[244:247], v104 offset:4096
  ds_read_b64_tr_b16 v[68:69], v8 offset:10240
  ds_read_b64_tr_b16 v[70:71], v8 offset:11264
  s_waitcnt lgkmcnt(8)
  v_mfma_f32_32x32x16_bf16 v[16:31], v[56:59], v[232:235], v[16:31]
  ds_read_b128 v[248:251], v104 offset:8192
  ds_read_b64_tr_b16 v[48:49], v8 offset:12288
  ds_read_b64_tr_b16 v[50:51], v8 offset:13312
  s_waitcnt lgkmcnt(9)
  v_mfma_f32_32x32x16_bf16 v[16:31], v[60:63], v[236:239], v[16:31]
  ds_read_b128 v[252:255], v104 offset:12288
  ds_read_b64_tr_b16 v[52:53], v8 offset:14336
  ds_read_b64_tr_b16 v[54:55], v8 offset:15360
  s_waitcnt lgkmcnt(9)
  v_mfma_f32_32x32x16_bf16 v[88:103], v[64:67], v[224:227], v[88:103]
  ds_read_b64_tr_b16 v[56:57], v8 offset:57344
  ds_read_b64_tr_b16 v[58:59], v8 offset:58368
  s_waitcnt lgkmcnt(8)
  v_mfma_f32_32x32x16_bf16 v[88:103], v[68:71], v[228:231], v[88:103]
  ds_read_b64_tr_b16 v[60:61], v8 offset:59392
  ds_read_b64_tr_b16 v[62:63], v8 offset:60416
  s_waitcnt lgkmcnt(7)
  v_mfma_f32_32x32x16_bf16 v[88:103], v[48:51], v[232:235], v[88:103]
  ds_read_b64_tr_b16 v[64:65], v8 offset:61440
  ds_read_b64_tr_b16 v[66:67], v8 offset:62464
  s_waitcnt lgkmcnt(6)
  v_mfma_f32_32x32x16_bf16 v[88:103], v[52:55], v[236:239], v[88:103]
  ds_read_b64_tr_b16 v[68:69], v8 offset:63488
  ds_read_b64_tr_b16 v[70:71], v8 offset:64512
  s_waitcnt lgkmcnt(6)
  v_mfma_f32_32x32x16_bf16 v[208:223], v[56:59], v[224:227], v[208:223]
  ds_read_b64_tr_b16 v[48:49], v9 offset:16384
  ds_read_b64_tr_b16 v[50:51], v9 offset:17408
  s_waitcnt lgkmcnt(6)
  v_mfma_f32_32x32x16_bf16 v[208:223], v[60:63], v[228:231], v[208:223]
  ds_read_b64_tr_b16 v[52:53], v9 offset:18432
  ds_read_b64_tr_b16 v[54:55], v9 offset:19456
  s_waitcnt lgkmcnt(6)
  v_mfma_f32_32x32x16_bf16 v[208:223], v[64:67], v[232:235], v[208:223]
  ds_read_b64_tr_b16 v[56:57], v9 offset:20480
  ds_read_b64_tr_b16 v[58:59], v9 offset:21504
  s_waitcnt lgkmcnt(6)
  v_mfma_f32_32x32x16_bf16 v[208:223], v[68:71], v[236:239], v[208:223]
  ds_read_b64_tr_b16 v[60:61], v9 offset:22528
  ds_read_b64_tr_b16 v[62:63], v9 offset:23552
  s_setprio 0
  s_add_u32 m0, s67, 32768
  s_add_u32 s74, s81, s94
  buffer_load_dwordx4 v4, s[12:15], s74 offen lds
  s_add_u32 m0, s67, 40960
  s_add_u32 s74, s3, 32768
  buffer_load_dwordx4 v12, s[16:19], s74 offen sc1 lds
  s_add_u32 m0, s67, 49152
  s_add_u32 s74, s3, 40960
  buffer_load_dwordx4 v12, s[16:19], s74 offen sc1 lds
  s_add_u32 m0, s67, 106496
  s_add_u32 s74, s82, s92
  buffer_load_dwordx4 v4, s[12:15], s74 offen lds
  s_add_u32 m0, s67, 114688
  s_add_u32 s74, s82, s93
  buffer_load_dwordx4 v4, s[12:15], s74 offen lds
  s_add_u32 m0, s67, 139264
  s_add_u32 s74, s82, s94
  buffer_load_dwordx4 v4, s[12:15], s74 offen lds
  v_mov_b32 v111, 3
  buffer_store_dword v111, v109, s[16:19], s79 offen sc1
  s_waitcnt vmcnt(7)
  s_cmp_eq_u32 s60, 0
  s_cbranch_scc0 L_hc2_d
  v_cmp_le_u32 vcc, 2, v110
  s_nop 0
  s_cmp_eq_u64 vcc, -1
  s_cbranch_scc1 L_hc2_d
  s_mov_b32 s78, 49414144
  s_mov_b32 s74, 400000
L_hc2:
  buffer_load_dword v14, v2, s[16:19], s78 offen sc1
  s_waitcnt vmcnt(0)
  v_cmp_le_u32 vcc, 2, v14
  s_sub_u32 s74, s74, 1
  s_cmp_eq_u64 vcc, -1
  s_cbranch_scc1 L_hc2_d
  s_cmp_eq_u32 s74, 0
  s_cbranch_scc1 L_hc2_d
  s_sleep 2
  s_branch L_hc2
L_hc2_d:
  s_barrier
  s_setprio 1
  s_waitcnt lgkmcnt(6)
  v_mfma_f32_32x32x16_bf16 v[16:31], v[48:51], v[240:243], v[16:31]
  ds_read_b128 v[224:227], v13 offset:24576
  ds_read_b64_tr_b16 v[64:65], v8 offset:0
  ds_read_b64_tr_b16 v[66:67], v8 offset:1024
  s_waitcnt lgkmcnt(7)
  v_mfma_f32_32x32x16_bf16 v[16:31], v[52:55], v[244:247], v[16:31]
  ds_read_b128 v[228:231], v13 offset:28672
  ds_read_b64_tr_b16 v[68:69], v8 offset:2048
  ds_read_b64_tr_b16 v[70:71], v8 offset:3072
  s_waitcnt lgkmcnt(8)
  v_mfma_f32_32x32x16_bf16 v[16:31], v[56:59], v[248:251], v[16:31]
  ds_read_b128 v[232:235], v104 offset:24576
  ds_read_b64_tr_b16 v[48:49], v8 offset:4096
  ds_read_b64_tr_b16 v[50:51], v8 offset:5120
  s_waitcnt lgkmcnt(9)
  v_mfma_f32_32x32x16_bf16 v[16:31], v[60:63], v[252:255], v[16:31]
  ds_read_b128 v[236:239], v104 offset:28672
  ds_read_b64_tr_b16 v[52:53], v8 offset:6144
  ds_read_b64_tr_b16 v[54:55], v8 offset:7168
  s_waitcnt lgkmcnt(9)
  v_mfma_f32_32x32x16_bf16 v[88:103], v[64:67], v[240:243], v[88:103]
  ds_read_b64_tr_b16 v[56:57], v8 offset:16384
  ds_read_b64_tr_b16 v[58:59], v8 offset:17408
  s_waitcnt lgkmcnt(8)
  v_mfma_f32_32x32x16_bf16 v[88:103], v[68:71], v[244:247], v[88:103]
  ds_read_b64_tr_b16 v[60:61], v8 offset:18432
  ds_read_b64_tr_b16 v[62:63], v8 offset:19456
  s_waitcnt lgkmcnt(7)
  v_mfma_f32_32x32x16_bf16 v[88:103], v[48:51], v[248:251], v[88:103]
  ds_read_b64_tr_b16 v[64:65], v8 offset:20480
  ds_read_b64_tr_b16 v[66:67], v8 offset:21504
  s_waitcnt lgkmcnt(6)
  v_mfma_f32_32x32x16_bf16 v[88:103], v[52:55], v[252:255], v[88:103]
  ds_read_b64_tr_b16 v[68:69], v8 offset:22528
  ds_read_b64_tr_b16 v[70:71], v8 offset:23552
  s_waitcnt lgkmcnt(6)
  v_mfma_f32_32x32x16_bf16 v[208:223], v[56:59], v[240:243], v[208:223]
  ds_read_b64_tr_b16 v[48:49], v9 offset:32768
  ds_read_b64_tr_b16 v[50:51], v9 offset:33792
  s_waitcnt lgkmcnt(6)
  v_mfma_f32_32x32x16_bf16 v[208:223], v[60:63], v[244:247], v[208:223]
  ds_read_b64_tr_b16 v[52:53], v9 offset:34816
  ds_read_b64_tr_b16 v[54:55], v9 offset:35840
  s_waitcnt lgkmcnt(6)
  v_mfma_f32_32x32x16_bf16 v[208:223], v[64:67], v[248:251], v[208:223]
  ds_read_b64_tr_b16 v[56:57], v9 offset:36864
  ds_read_b64_tr_b16 v[58:59], v9 offset:37888
  s_waitcnt lgkmcnt(6)
  v_mfma_f32_32x32x16_bf16 v[208:223], v[68:71], v[252:255], v[208:223]
  ds_read_b64_tr_b16 v[60:61], v9 offset:38912
  ds_read_b64_tr_b16 v[62:63], v9 offset:39936
  s_setprio 0
  s_add_u32 m0, s67, 8192
  s_add_u32 s74, s34, 49152
  buffer_load_dwordx4 v12, s[16:19], s74 offen sc1 lds
  s_add_u32 m0, s67, 57344
  s_add_u32 s74, s34, 57344
  buffer_load_dwordx4 v12, s[16:19], s74 offen sc1 lds
  s_add_u32 m0, s67, 65536
  s_add_u32 s74, s83, s89
  buffer_load_dwordx4 v4, s[12:15], s74 offen lds
  s_add_u32 m0, s67, 73728
  s_add_u32 s74, s83, s90
  buffer_load_dwordx4 v4, s[12:15], s74 offen lds
  s_add_u32 m0, s67, 122880
  s_add_u32 s74, s83, s91
  buffer_load_dwordx4 v4, s[12:15], s74 offen lds
  s_add_u32 m0, s67, 147456
  s_add_u32 s74, s3, 49152
  buffer_load_dwordx4 v12, s[16:19], s74 offen sc1 lds
  s_branch L_pj6
  .p2align 12
L_stub6:
  s_setpc_b64 s[58:59]
  s_nop 0
L_pj6:
  s_waitcnt vmcnt(9)
  s_barrier
  s_setprio 1
  s_waitcnt lgkmcnt(6)
  v_mfma_f32_32x32x16_bf16 v[16:31], v[48:51], v[224:227], v[16:31]
  ds_read_b128 v[240:243], v13 offset:40960
  ds_read_b64_tr_b16 v[64:65], v10 offset:0
  ds_read_b64_tr_b16 v[66:67], v10 offset:1024
  s_waitcnt lgkmcnt(7)
  v_mfma_f32_32x32x16_bf16 v[16:31], v[52:55], v[228:231], v[16:31]
  ds_read_b128 v[244:247], v13 offset:45056
  ds_read_b64_tr_b16 v[68:69], v10 offset:2048
  ds_read_b64_tr_b16 v[70:71], v10 offset:3072
  s_waitcnt lgkmcnt(8)
  v_mfma_f32_32x32x16_bf16 v[16:31], v[56:59], v[232:235], v[16:31]
  ds_read_b128 v[248:251], v13 offset:49152
  ds_read_b64_tr_b16 v[48:49], v10 offset:4096
  ds_read_b64_tr_b16 v[50:51], v10 offset:5120
  s_waitcnt lgkmcnt(9)
  v_mfma_f32_32x32x16_bf16 v[16:31], v[60:63], v[236:239], v[16:31]
  ds_read_b128 v[252:255], v13 offset:53248
  ds_read_b64_tr_b16 v[52:53], v10 offset:6144
  ds_read_b64_tr_b16 v[54:55], v10 offset:7168
  s_waitcnt lgkmcnt(9)
  v_mfma_f32_32x32x16_bf16 v[88:103], v[64:67], v[224:227], v[88:103]
  ds_read_b64_tr_b16 v[56:57], v8 offset:32768
  ds_read_b64_tr_b16 v[58:59], v8 offset:33792
  s_waitcnt lgkmcnt(8)
  v_mfma_f32_32x32x16_bf16 v[88:103], v[68:71], v[228:231], v[88:103]
  ds_read_b64_tr_b16 v[60:61], v8 offset:34816
  ds_read_b64_tr_b16 v[62:63], v8 offset:35840
  s_waitcnt lgkmcnt(7)
  v_mfma_f32_32x32x16_bf16 v[88:103], v[48:51], v[232:235], v[88:103]
  ds_read_b64_tr_b16 v[64:65], v8 offset:36864
  ds_read_b64_tr_b16 v[66:67], v8 offset:37888
  s_waitcnt lgkmcnt(6)
  v_mfma_f32_32x32x16_bf16 v[88:103], v[52:55], v[236:239], v[88:103]
  ds_read_b64_tr_b16 v[68:69], v8 offset:38912
  ds_read_b64_tr_b16 v[70:71], v8 offset:39936
  s_waitcnt lgkmcnt(6)
  v_mfma_f32_32x32x16_bf16 v[208:223], v[56:59], v[224:227], v[208:223]
  ds_read_b64_tr_b16 v[48:49], v9 offset:40960
  ds_read_b64_tr_b16 v[50:51], v9 offset:41984
  s_waitcnt lgkmcnt(6)
  v_mfma_f32_32x32x16_bf16 v[208:223], v[60:63], v[228:231], v[208:223]
  ds_read_b64_tr_b16 v[52:53], v9 offset:43008
  ds_read_b64_tr_b16 v[54:55], v9 offset:44032
  s_waitcnt lgkmcnt(6)
  v_mfma_f32_32x32x16_bf16 v[208:223], v[64:67], v[232:235], v[208:223]
  ds_read_b64_tr_b16 v[56:57], v9 offset:45056
  ds_read_b64_tr_b16 v[58:59], v9 offset:46080
  s_waitcnt lgkmcnt(6)
  v_mfma_f32_32x32x16_bf16 v[208:223], v[68:71], v[236:239], v[208:223]
  ds_read_b64_tr_b16 v[60:61], v9 offset:47104
  ds_read_b64_tr_b16 v[62:63], v9 offset:48128
  s_setprio 0
  s_add_u32 m0, s67, 0
  s_add_u32 s74, s3, 57344
  buffer_load_dwordx4 v12, s[16:19], s74 offen sc1 lds
  s_add_u32 m0, s67, 16384
  s_add_u32 s74, s83, s92
  buffer_load_dwordx4 v4, s[12:15], s74 offen lds
  s_add_u32 m0, s67, 24576
  s_add_u32 s74, s83, s93
  buffer_load_dwordx4 v4, s[12:15], s74 offen lds
  s_add_u32 m0, s67, 81920
  s_add_u32 s74, s83, s94
  buffer_load_dwordx4 v4, s[12:15], s74 offen lds
  s_add_u32 m0, s67, 90112
  s_add_u32 s74, s34, 65536
  buffer_load_dwordx4 v12, s[16:19], s74 offen sc1 lds
  s_add_u32 m0, s67, 155648
  s_add_u32 s74, s34, 73728
  buffer_load_dwordx4 v12, s[16:19], s74 offen sc1 lds
  s_mul_hi_u32 s69, s62, 0x55555556
  s_mul_i32 s33, s69, 3
  s_sub_u32 s33, s62, s33
  s_lshl_b32 s69, s69, 2
  s_add_u32 s69, s69, s63
  s_xor_b32 s68, s61, 8
  s_mov_b32 s20, s50
  s_and_b32 s21, s51, 0xffff
  s_mov_b32 s22, 1152
  s_mov_b32 s23, 0x00020000
  s_mov_b32 s8, s52
  s_and_b32 s9, s53, 0xffff
  s_mov_b32 s10, 2359296
  s_mov_b32 s11, 0x00020000
  s_lshl_b32 s31, s68, 2
  s_lshr_b32 s66, s69, 2
  s_add_u32 s31, s31, s66
  s_lshl_b32 s32, s68, 3
  s_lshr_b32 s66, s69, 1
  s_add_u32 s32, s32, s66
  s_lshl_b32 s32, s32, 7
  s_add_u32 s32, s32, 49283072
  s_waitcnt vmcnt(9)
  s_barrier
  s_setprio 1
  s_waitcnt lgkmcnt(6)
  v_mfma_f32_32x32x16_bf16 v[16:31], v[48:51], v[240:243], v[16:31]
  ds_read_b128 v[224:227], v13 offset:8192
  ds_read_b64_tr_b16 v[64:65], v9 offset:49152
  ds_read_b64_tr_b16 v[66:67], v9 offset:50176
  s_waitcnt lgkmcnt(7)
  v_mfma_f32_32x32x16_bf16 v[16:31], v[52:55], v[244:247], v[16:31]
  ds_read_b128 v[228:231], v13 offset:12288
  ds_read_b64_tr_b16 v[68:69], v9 offset:51200
  ds_read_b64_tr_b16 v[70:71], v9 offset:52224
  s_waitcnt lgkmcnt(8)
  v_mfma_f32_32x32x16_bf16 v[16:31], v[56:59], v[248:251], v[16:31]
  ds_read_b128 v[232:235], v13 offset:57344
  ds_read_b64_tr_b16 v[48:49], v9 offset:53248
  ds_read_b64_tr_b16 v[50:51], v9 offset:54272
  s_waitcnt lgkmcnt(9)
  v_mfma_f32_32x32x16_bf16 v[16:31], v[60:63], v[252:255], v[16:31]
  ds_read_b128 v[236:239], v13 offset:61440
  ds_read_b64_tr_b16 v[52:53], v9 offset:55296
  ds_read_b64_tr_b16 v[54:55], v9 offset:56320
  s_waitcnt lgkmcnt(9)
  v_mfma_f32_32x32x16_bf16 v[88:103], v[64:67], v[240:243], v[88:103]
  ds_read_b64_tr_b16 v[56:57], v10 offset:8192
  ds_read_b64_tr_b16 v[58:59], v10 offset:9216
  s_waitcnt lgkmcnt(8)
  v_mfma_f32_32x32x16_bf16 v[88:103], v[68:71], v[244:247], v[88:103]
  ds_read_b64_tr_b16 v[60:61], v10 offset:10240
  ds_read_b64_tr_b16 v[62:63], v10 offset:11264
  s_waitcnt lgkmcnt(7)
  v_mfma_f32_32x32x16_bf16 v[88:103], v[48:51], v[248:251], v[88:103]
  ds_read_b64_tr_b16 v[64:65], v10 offset:12288
  ds_read_b64_tr_b16 v[66:67], v10 offset:13312
  s_waitcnt lgkmcnt(6)
  v_mfma_f32_32x32x16_bf16 v[88:103], v[52:55], v[252:255], v[88:103]
  ds_read_b64_tr_b16 v[68:69], v10 offset:14336
  ds_read_b64_tr_b16 v[70:71], v10 offset:15360
  s_waitcnt lgkmcnt(6)
  v_mfma_f32_32x32x16_bf16 v[208:223], v[56:59], v[240:243], v[208:223]
  ds_read_b64_tr_b16 v[48:49], v9 offset:0
  ds_read_b64_tr_b16 v[50:51], v9 offset:1024
  s_waitcnt lgkmcnt(6)
  v_mfma_f32_32x32x16_bf16 v[208:223], v[60:63], v[244:247], v[208:223]
  ds_read_b64_tr_b16 v[52:53], v9 offset:2048
  ds_read_b64_tr_b16 v[54:55], v9 offset:3072
  s_waitcnt lgkmcnt(6)
  v_mfma_f32_32x32x16_bf16 v[208:223], v[64:67], v[248:251], v[208:223]
  ds_read_b64_tr_b16 v[56:57], v9 offset:4096
  ds_read_b64_tr_b16 v[58:59], v9 offset:5120
  s_waitcnt lgkmcnt(6)
  v_mfma_f32_32x32x16_bf16 v[208:223], v[68:71], v[252:255], v[208:223]
  ds_read_b64_tr_b16 v[60:61], v9 offset:6144
  ds_read_b64_tr_b16 v[62:63], v9 offset:7168
  s_setprio 0
  s_add_u32 m0, s67, 32768
  s_add_u32 s74, s84, s89
  buffer_load_dwordx4 v4, s[12:15], s74 offen lds
  s_add_u32 m0, s67, 40960
  s_add_u32 s74, s84, s90
  buffer_load_dwordx4 v4, s[12:15], s74 offen lds
  s_add_u32 m0, s67, 49152
  s_add_u32 s74, s84, s91
  buffer_load_dwordx4 v4, s[12:15], s74 offen lds
  s_add_u32 m0, s67, 98304
  s_add_u32 s74, s3, 65536
  buffer_load_dwordx4 v12, s[16:19], s74 offen sc1 lds
  s_add_u32 m0, s67, 131072
  s_add_u32 s74, s3, 73728
  buffer_load_dwordx4 v12, s[16:19], s74 offen sc1 lds
  buffer_load_dword v110, v2, s[16:19], s76 offen sc1
  s_and_b32 s70, s69, 1
  s_lshl_b32 s66, s70, 8
  v_and_b32 v32, 15, v1
  v_lshl_add_u32 v32, v32, 4, s66
  v_bfe_u32 v14, v1, 4, 1
  v_lshl_add_u32 v32, v14, 9, v32
  v_lshrrev_b32 v15, 5, v1
  v_lshl_add_u32 v33, v15, 10, v32
  v_mul_u32_u24 v35, 4096, v15
  v_add_u32 v32, v32, v35
  v_lshlrev_b32 v35, 5, v14
  v_lshl_add_u32 v35, v15, 4, v35
  s_and_b32 s65, s31, 7
  s_lshl_b32 s65, s65, 8
  s_lshl_b32 s70, s70, 7
  s_add_u32 s65, s65, s70
  s_lshr_b32 s66, s31, 5
  s_add_u32 s65, s65, s66
  s_and_b32 s66, s31, 16
  s_lshl_b32 s66, s66, 1
  s_add_u32 s65, s65, s66
  s_and_b32 s66, s31, 8
  s_add_u32 s65, s65, s66
  v_lshl_add_u32 v34, v15, 6, s65
  v_lshl_add_u32 v34, v14, 4, v34
  v_bfe_u32 v14, v1, 2, 2
  v_lshl_add_u32 v34, v14, 1, v34
  v_mul_u32_u24 v34, 1152, v34
  v_and_b32 v37, 3, v1
  v_lshl_add_u32 v34, v37, 4, v34
  s_waitcnt vmcnt(10)
  s_barrier
  s_setprio 1
  s_waitcnt lgkmcnt(6)
  v_mfma_f32_32x32x16_bf16 v[16:31], v[48:51], v[224:227], v[16:31]
  ds_read_b128 v[240:243], v105 offset:16384
  ds_read_b64_tr_b16 v[64:65], v9 offset:8192
  ds_read_b64_tr_b16 v[66:67], v9 offset:9216
  s_waitcnt lgkmcnt(7)
  v_mfma_f32_32x32x16_bf16 v[16:31], v[52:55], v[228:231], v[16:31]
  ds_read_b128 v[244:247], v105 offset:20480
  ds_read_b64_tr_b16 v[68:69], v9 offset:10240
  ds_read_b64_tr_b16 v[70:71], v9 offset:11264
  s_waitcnt lgkmcnt(8)
  v_mfma_f32_32x32x16_bf16 v[16:31], v[56:59], v[232:235], v[16:31]
  ds_read_b128 v[248:251], v13 offset:0
  ds_read_b64_tr_b16 v[48:49], v9 offset:12288
  ds_read_b64_tr_b16 v[50:51], v9 offset:13312
  s_waitcnt lgkmcnt(9)
  v_mfma_f32_32x32x16_bf16 v[16:31], v[60:63], v[236:239], v[16:31]
  ds_read_b128 v[252:255], v13 offset:4096
  ds_read_b64_tr_b16 v[52:53], v9 offset:14336
  ds_read_b64_tr_b16 v[54:55], v9 offset:15360
  s_waitcnt lgkmcnt(9)
  v_mfma_f32_32x32x16_bf16 v[88:103], v[64:67], v[224:227], v[88:103]
  ds_read_b64_tr_b16 v[56:57], v9 offset:57344
  ds_read_b64_tr_b16 v[58:59], v9 offset:58368
  s_waitcnt lgkmcnt(8)
  v_mfma_f32_32x32x16_bf16 v[88:103], v[68:71], v[228:231], v[88:103]
  ds_read_b64_tr_b16 v[60:61], v9 offset:59392
  ds_read_b64_tr_b16 v[62:63], v9 offset:60416
  s_waitcnt lgkmcnt(7)
  v_mfma_f32_32x32x16_bf16 v[88:103], v[48:51], v[232:235], v[88:103]
  ds_read_b64_tr_b16 v[64:65], v9 offset:61440
  ds_read_b64_tr_b16 v[66:67], v9 offset:62464
  s_waitcnt lgkmcnt(6)
  v_mfma_f32_32x32x16_bf16 v[88:103], v[52:55], v[236:239], v[88:103]
  ds_read_b64_tr_b16 v[68:69], v9 offset:63488
  ds_read_b64_tr_b16 v[70:71], v9 offset:64512
  s_waitcnt lgkmcnt(6)
  v_mfma_f32_32x32x16_bf16 v[208:223], v[56:59], v[224:227], v[208:223]
  ds_read_b64_tr_b16 v[48:49], v8 offset:16384
  ds_read_b64_tr_b16 v[50:51], v8 offset:17408
  s_waitcnt lgkmcnt(6)
  v_mfma_f32_32x32x16_bf16 v[208:223], v[60:63], v[228:231], v[208:223]
  ds_read_b64_tr_b16 v[52:53], v8 offset:18432
  ds_read_b64_tr_b16 v[54:55], v8 offset:19456
  s_waitcnt lgkmcnt(6)
  v_mfma_f32_32x32x16_bf16 v[208:223], v[64:67], v[232:235], v[208:223]
  ds_read_b64_tr_b16 v[56:57], v8 offset:20480
  ds_read_b64_tr_b16 v[58:59], v8 offset:21504
  s_waitcnt lgkmcnt(6)
  v_mfma_f32_32x32x16_bf16 v[208:223], v[68:71], v[236:239], v[208:223]
  ds_read_b64_tr_b16 v[60:61], v8 offset:22528
  ds_read_b64_tr_b16 v[62:63], v8 offset:23552
  s_setprio 0
  s_add_u32 m0, s67, 8192
  s_add_u32 s74, s84, s92
  buffer_load_dwordx4 v4, s[12:15], s74 offen lds
  s_add_u32 m0, s67, 57344
  s_add_u32 s74, s84, s93
  buffer_load_dwordx4 v4, s[12:15], s74 offen lds
  s_add_u32 m0, s67, 106496
  s_add_u32 s74, s84, s94
  buffer_load_dwordx4 v4, s[12:15], s74 offen lds
  s_waitcnt vmcnt(3)
  s_cmp_eq_u32 s60, 0
  s_cbranch_scc0 L_hc3_d
  v_cmp_le_u32 vcc, 3, v110
  s_nop 0
  s_cmp_eq_u64 vcc, -1
  s_cbranch_scc1 L_hc3_d
  s_mov_b32 s78, 49414144
  s_mov_b32 s74, 400000
L_hc3:
  buffer_load_dword v14, v2, s[16:19], s78 offen sc1
  s_waitcnt vmcnt(0)
  v_cmp_le_u32 vcc, 3, v14
  s_sub_u32 s74, s74, 1
  s_cmp_eq_u64 vcc, -1
  s_cbranch_scc1 L_hc3_d
  s_cmp_eq_u32 s74, 0
  s_cbranch_scc1 L_hc3_d
  s_sleep 2
  s_branch L_hc3
L_hc3_d:
  s_barrier
  s_setprio 1
  s_waitcnt lgkmcnt(6)
  v_mfma_f32_32x32x16_bf16 v[16:31], v[48:51], v[240:243], v[16:31]
  ds_read_b128 v[224:227], v104 offset:24576
  ds_read_b64_tr_b16 v[64:65], v8 offset:24576
  ds_read_b64_tr_b16 v[66:67], v8 offset:25600
  s_waitcnt lgkmcnt(7)
  v_mfma_f32_32x32x16_bf16 v[16:31], v[52:55], v[244:247], v[16:31]
  ds_read_b128 v[228:231], v104 offset:28672
  ds_read_b64_tr_b16 v[68:69], v8 offset:26624
  ds_read_b64_tr_b16 v[70:71], v8 offset:27648
  s_waitcnt lgkmcnt(8)
  v_mfma_f32_32x32x16_bf16 v[16:31], v[56:59], v[248:251], v[16:31]
  ds_read_b128 v[232:235], v105 offset:24576
  ds_read_b64_tr_b16 v[48:49], v8 offset:28672
  ds_read_b64_tr_b16 v[50:51], v8 offset:29696
  s_waitcnt lgkmcnt(9)
  v_mfma_f32_32x32x16_bf16 v[16:31], v[60:63], v[252:255], v[16:31]
  ds_read_b128 v[236:239], v105 offset:28672
  ds_read_b64_tr_b16 v[52:53], v8 offset:30720
  ds_read_b64_tr_b16 v[54:55], v8 offset:31744
  s_waitcnt lgkmcnt(9)
  v_mfma_f32_32x32x16_bf16 v[88:103], v[64:67], v[240:243], v[88:103]
  ds_read_b64_tr_b16 v[56:57], v9 offset:16384
  ds_read_b64_tr_b16 v[58:59], v9 offset:17408
  s_waitcnt lgkmcnt(8)
  v_mfma_f32_32x32x16_bf16 v[88:103], v[68:71], v[244:247], v[88:103]
  ds_read_b64_tr_b16 v[60:61], v9 offset:18432
  ds_read_b64_tr_b16 v[62:63], v9 offset:19456
  s_waitcnt lgkmcnt(7)
  v_mfma_f32_32x32x16_bf16 v[88:103], v[48:51], v[248:251], v[88:103]
  ds_read_b64_tr_b16 v[64:65], v9 offset:20480
  ds_read_b64_tr_b16 v[66:67], v9 offset:21504
  s_waitcnt lgkmcnt(6)
  v_mfma_f32_32x32x16_bf16 v[88:103], v[52:55], v[252:255], v[88:103]
  ds_read_b64_tr_b16 v[68:69], v9 offset:22528
  ds_read_b64_tr_b16 v[70:71], v9 offset:23552
  s_waitcnt lgkmcnt(6)
  v_mfma_f32_32x32x16_bf16 v[208:223], v[56:59], v[240:243], v[208:223]
  ds_read_b64_tr_b16 v[48:49], v8 offset:32768
  ds_read_b64_tr_b16 v[50:51], v8 offset:33792
  s_waitcnt lgkmcnt(6)
  v_mfma_f32_32x32x16_bf16 v[208:223], v[60:63], v[244:247], v[208:223]
  ds_read_b64_tr_b16 v[52:53], v8 offset:34816
  ds_read_b64_tr_b16 v[54:55], v8 offset:35840
  s_waitcnt lgkmcnt(6)
  v_mfma_f32_32x32x16_bf16 v[208:223], v[64:67], v[248:251], v[208:223]
  ds_read_b64_tr_b16 v[56:57], v8 offset:36864
  ds_read_b64_tr_b16 v[58:59], v8 offset:37888
  s_waitcnt lgkmcnt(6)
  v_mfma_f32_32x32x16_bf16 v[208:223], v[68:71], v[252:255], v[208:223]
  ds_read_b64_tr_b16 v[60:61], v8 offset:38912
  ds_read_b64_tr_b16 v[62:63], v8 offset:39936
  s_setprio 0
  s_add_u32 m0, s67, 0
  s_add_u32 s74, s34, 81920
  buffer_load_dwordx4 v12, s[16:19], s74 offen sc1 lds
  s_add_u32 m0, s67, 65536
  s_add_u32 s74, s34, 90112
  buffer_load_dwordx4 v12, s[16:19], s74 offen sc1 lds
  s_add_u32 m0, s67, 73728
  s_add_u32 s74, s85, s89
  buffer_load_dwordx4 v4, s[12:15], s74 offen lds
  s_add_u32 m0, s67, 114688
  s_add_u32 s74, s85, s90
  buffer_load_dwordx4 v4, s[12:15], s74 offen lds
  s_add_u32 m0, s67, 122880
  s_add_u32 s74, s85, s91
  buffer_load_dwordx4 v4, s[12:15], s74 offen lds
  s_add_u32 m0, s67, 139264
  s_add_u32 s74, s3, 81920
  buffer_load_dwordx4 v12, s[16:19], s74 offen sc1 lds
  v_lshrrev_b32 v38, 2, v1
  v_and_b32 v14, 1, v1
  v_lshl_add_u32 v38, v14, 5, v38
  v_bfe_u32 v14, v1, 1, 1
  v_lshl_add_u32 v38, v14, 4, v38
  v_lshlrev_b32 v38, 2, v38
  v_mul_u32_u24 v36, 12, v37
  v_lshlrev_b32 v37, 7, v37
  s_mov_b32 s71, 0xffff0000
  s_mov_b32 s72, 0xbfb8aa3b
  s_add_u32 s66, s68, 2
  s_mul_hi_u32 s65, s66, 0x55555556
  s_mul_i32 s65, s65, 3
  s_sub_u32 s66, s66, s65
  s_mul_i32 s65, s33, 3
  s_add_u32 s66, s66, s65
  s_lshl_b32 s66, s66, 1
  s_bfe_u32 s65, s69, 0x10001
  s_add_u32 s66, s66, s65
  s_lshl_b32 s30, s66, 6
  s_mul_i32 s65, s31, 147584
  s_lshl_b32 s28, s66, 13
  s_add_u32 s28, s28, s65
  s_mul_i32 s65, s31, 36992
  s_lshl_b32 s29, s66, 11
  s_add_u32 s29, s29, s65
  s_add_u32 s29, s29, 33554432
  s_mul_i32 s32, s68, 12
  s_add_u32 s32, s32, s62
  s_lshl_b32 s32, s32, 7
  s_add_u32 s32, s32, 49414176
  v_and_b32 v36, 7, v1
  v_lshlrev_b32 v36, 2, v36
  s_lshl_b32 s77, s68, 9
  s_add_u32 s77, s77, 49807360
  s_and_b32 s77, s61, 7
  s_lshl_b32 s77, s77, 9
  s_add_u32 s77, s77, 49807360
  v_bfe_u32 v14, v1, 2, 1
  v_lshl_add_u32 v37, v14, 12, v37
  s_waitcnt vmcnt(8)
  s_barrier
  s_setprio 1
  s_waitcnt lgkmcnt(6)
  v_mfma_f32_32x32x16_bf16 v[16:31], v[48:51], v[224:227], v[16:31]
  ds_read_b128 v[240:243], v104 offset:32768
  ds_read_b64_tr_b16 v[64:65], v8 offset:40960
  ds_read_b64_tr_b16 v[66:67], v8 offset:41984
  s_waitcnt lgkmcnt(7)
  v_mfma_f32_32x32x16_bf16 v[16:31], v[52:55], v[228:231], v[16:31]
  ds_read_b128 v[244:247], v104 offset:36864
  ds_read_b64_tr_b16 v[68:69], v8 offset:43008
  ds_read_b64_tr_b16 v[70:71], v8 offset:44032
  s_waitcnt lgkmcnt(8)
  v_mfma_f32_32x32x16_bf16 v[16:31], v[56:59], v[232:235], v[16:31]
  ds_read_b128 v[248:251], v105 offset:0
  ds_read_b64_tr_b16 v[48:49], v8 offset:45056
  ds_read_b64_tr_b16 v[50:51], v8 offset:46080
  s_waitcnt lgkmcnt(9)
  v_mfma_f32_32x32x16_bf16 v[16:31], v[60:63], v[236:239], v[16:31]
  ds_read_b128 v[252:255], v105 offset:4096
  ds_read_b64_tr_b16 v[52:53], v8 offset:47104
  ds_read_b64_tr_b16 v[54:55], v8 offset:48128
  s_waitcnt lgkmcnt(9)
  v_mfma_f32_32x32x16_bf16 v[88:103], v[64:67], v[224:227], v[88:103]
  ds_read_b64_tr_b16 v[56:57], v8 offset:49152
  ds_read_b64_tr_b16 v[58:59], v8 offset:50176
  s_waitcnt lgkmcnt(8)
  v_mfma_f32_32x32x16_bf16 v[88:103], v[68:71], v[228:231], v[88:103]
  ds_read_b64_tr_b16 v[60:61], v8 offset:51200
  ds_read_b64_tr_b16 v[62:63], v8 offset:52224
  s_waitcnt lgkmcnt(7)
  v_mfma_f32_32x32x16_bf16 v[88:103], v[48:51], v[232:235], v[88:103]
  ds_read_b64_tr_b16 v[64:65], v8 offset:53248
  ds_read_b64_tr_b16 v[66:67], v8 offset:54272
  s_waitcnt lgkmcnt(6)
  v_mfma_f32_32x32x16_bf16 v[88:103], v[52:55], v[236:239], v[88:103]
  ds_read_b64_tr_b16 v[68:69], v8 offset:55296
  ds_read_b64_tr_b16 v[70:71], v8 offset:56320
  s_waitcnt lgkmcnt(6)
  v_mfma_f32_32x32x16_bf16 v[208:223], v[56:59], v[224:227], v[208:223]
  ds_read_b64_tr_b16 v[48:49], v8 offset:8192
  ds_read_b64_tr_b16 v[50:51], v8 offset:9216
  s_waitcnt lgkmcnt(6)
  v_mfma_f32_32x32x16_bf16 v[208:223], v[60:63], v[228:231], v[208:223]
  ds_read_b64_tr_b16 v[52:53], v8 offset:10240
  ds_read_b64_tr_b16 v[54:55], v8 offset:11264
  s_waitcnt lgkmcnt(6)
  v_mfma_f32_32x32x16_bf16 v[208:223], v[64:67], v[232:235], v[208:223]
  ds_read_b64_tr_b16 v[56:57], v8 offset:12288
  ds_read_b64_tr_b16 v[58:59], v8 offset:13312
  s_waitcnt lgkmcnt(6)
  v_mfma_f32_32x32x16_bf16 v[208:223], v[68:71], v[236:239], v[208:223]
  ds_read_b64_tr_b16 v[60:61], v8 offset:14336
  ds_read_b64_tr_b16 v[62:63], v8 offset:15360
  s_setprio 0
  s_add_u32 m0, s67, 16384
  s_add_u32 s74, s3, 90112
  buffer_load_dwordx4 v12, s[16:19], s74 offen sc1 lds
  s_add_u32 m0, s67, 24576
  s_add_u32 s74, s85, s92
  buffer_load_dwordx4 v4, s[12:15], s74 offen lds
  s_add_u32 m0, s67, 81920
  s_add_u32 s74, s85, s93
  buffer_load_dwordx4 v4, s[12:15], s74 offen lds
  s_add_u32 m0, s67, 90112
  s_add_u32 s74, s85, s94
  buffer_load_dwordx4 v4, s[12:15], s74 offen lds
  s_add_u32 m0, s67, 147456
  s_add_u32 s74, s82, s86
  buffer_load_dwordx4 v4, s[12:15], s74 offen lds
  s_add_u32 m0, s67, 155648
  s_add_u32 s74, s83, s86
  buffer_load_dwordx4 v4, s[12:15], s74 offen lds
  s_waitcnt vmcnt(9)
  s_barrier
  s_setprio 1
  s_waitcnt lgkmcnt(6)
  v_mfma_f32_32x32x16_bf16 v[16:31], v[48:51], v[240:243], v[16:31]
  ds_read_b128 v[224:227], v13 offset:0
  ds_read_b64_tr_b16 v[64:65], v8 offset:57344
  ds_read_b64_tr_b16 v[66:67], v8 offset:58368
  s_waitcnt lgkmcnt(7)
  v_mfma_f32_32x32x16_bf16 v[16:31], v[52:55], v[244:247], v[16:31]
  ds_read_b128 v[228:231], v13 offset:4096
  ds_read_b64_tr_b16 v[68:69], v8 offset:59392
  ds_read_b64_tr_b16 v[70:71], v8 offset:60416
  s_waitcnt lgkmcnt(8)
  v_mfma_f32_32x32x16_bf16 v[16:31], v[56:59], v[248:251], v[16:31]
  ds_read_b128 v[232:235], v104 offset:0
  ds_read_b64_tr_b16 v[48:49], v8 offset:61440
  ds_read_b64_tr_b16 v[50:51], v8 offset:62464
  s_waitcnt lgkmcnt(9)
  v_mfma_f32_32x32x16_bf16 v[16:31], v[60:63], v[252:255], v[16:31]
  ds_read_b128 v[236:239], v104 offset:4096
  ds_read_b64_tr_b16 v[52:53], v8 offset:63488
  ds_read_b64_tr_b16 v[54:55], v8 offset:64512
  s_waitcnt lgkmcnt(9)
  v_mfma_f32_32x32x16_bf16 v[88:103], v[64:67], v[240:243], v[88:103]
  ds_read_b64_tr_b16 v[56:57], v9 offset:40960
  ds_read_b64_tr_b16 v[58:59], v9 offset:41984
  s_waitcnt lgkmcnt(8)
  v_mfma_f32_32x32x16_bf16 v[88:103], v[68:71], v[244:247], v[88:103]
  ds_read_b64_tr_b16 v[60:61], v9 offset:43008
  ds_read_b64_tr_b16 v[62:63], v9 offset:44032
  s_waitcnt lgkmcnt(7)
  v_mfma_f32_32x32x16_bf16 v[88:103], v[48:51], v[248:251], v[88:103]
  ds_read_b64_tr_b16 v[64:65], v9 offset:45056
  ds_read_b64_tr_b16 v[66:67], v9 offset:46080
  s_waitcnt lgkmcnt(6)
  v_mfma_f32_32x32x16_bf16 v[88:103], v[52:55], v[252:255], v[88:103]
  ds_read_b64_tr_b16 v[68:69], v9 offset:47104
  ds_read_b64_tr_b16 v[70:71], v9 offset:48128
  s_waitcnt lgkmcnt(6)
  v_mfma_f32_32x32x16_bf16 v[208:223], v[56:59], v[240:243], v[208:223]
  ds_read_b64_tr_b16 v[48:49], v9 offset:8192
  ds_read_b64_tr_b16 v[50:51], v9 offset:9216
  s_waitcnt lgkmcnt(6)
  v_mfma_f32_32x32x16_bf16 v[208:223], v[60:63], v[244:247], v[208:223]
  ds_read_b64_tr_b16 v[52:53], v9 offset:10240
  ds_read_b64_tr_b16 v[54:55], v9 offset:11264
  s_waitcnt lgkmcnt(6)
  v_mfma_f32_32x32x16_bf16 v[208:223], v[64:67], v[248:251], v[208:223]
  ds_read_b64_tr_b16 v[56:57], v9 offset:12288
  ds_read_b64_tr_b16 v[58:59], v9 offset:13312
  s_waitcnt lgkmcnt(6)
  v_mfma_f32_32x32x16_bf16 v[208:223], v[68:71], v[252:255], v[208:223]
  ds_read_b64_tr_b16 v[60:61], v9 offset:14336
  ds_read_b64_tr_b16 v[62:63], v9 offset:15360
  s_setprio 0
  s_add_u32 m0, s67, 32768
  s_add_u32 s74, s84, s86
  buffer_load_dwordx4 v4, s[12:15], s74 offen lds
  s_add_u32 m0, s67, 40960
  s_add_u32 s74, s85, s86
  buffer_load_dwordx4 v4, s[12:15], s74 offen lds
  s_add_u32 m0, s67, 49152
  s_add_u32 s74, s82, s87
  buffer_load_dwordx4 v4, s[12:15], s74 offen lds
  s_add_u32 m0, s67, 98304
  s_add_u32 s74, s83, s87
  buffer_load_dwordx4 v4, s[12:15], s74 offen lds
  s_add_u32 m0, s67, 131072
  s_add_u32 s74, s84, s87
  buffer_load_dwordx4 v4, s[12:15], s74 offen lds
  s_cmp_eq_u32 s60, 0
  s_cselect_b32 s66, s77, 1879048192
  buffer_load_dword v110, v37, s[16:19], s66 offen sc1
  s_waitcnt vmcnt(10)
  s_barrier
  s_setprio 1
  s_waitcnt lgkmcnt(6)
  v_mfma_f32_32x32x16_bf16 v[16:31], v[48:51], v[224:227], v[16:31]
  ds_read_b128 v[240:243], v105 offset:8192
  ds_read_b64_tr_b16 v[64:65], v9 offset:49152
  ds_read_b64_tr_b16 v[66:67], v9 offset:50176
  s_waitcnt lgkmcnt(7)
  v_mfma_f32_32x32x16_bf16 v[16:31], v[52:55], v[228:231], v[16:31]
  ds_read_b128 v[244:247], v105 offset:12288
  ds_read_b64_tr_b16 v[68:69], v9 offset:51200
  ds_read_b64_tr_b16 v[70:71], v9 offset:52224
  s_waitcnt lgkmcnt(8)
  v_mfma_f32_32x32x16_bf16 v[16:31], v[56:59], v[232:235], v[16:31]
  ds_read_b128 v[248:251], v13 offset:16384
  ds_read_b64_tr_b16 v[48:49], v9 offset:53248
  ds_read_b64_tr_b16 v[50:51], v9 offset:54272
  s_waitcnt lgkmcnt(9)
  v_mfma_f32_32x32x16_bf16 v[16:31], v[60:63], v[236:239], v[16:31]
  ds_read_b128 v[252:255], v13 offset:20480
  ds_read_b64_tr_b16 v[52:53], v9 offset:55296
  ds_read_b64_tr_b16 v[54:55], v9 offset:56320
  s_waitcnt lgkmcnt(9)
  v_mfma_f32_32x32x16_bf16 v[88:103], v[64:67], v[224:227], v[88:103]
  ds_read_b64_tr_b16 v[56:57], v9 offset:57344
  ds_read_b64_tr_b16 v[58:59], v9 offset:58368
  s_waitcnt lgkmcnt(8)
  v_mfma_f32_32x32x16_bf16 v[88:103], v[68:71], v[228:231], v[88:103]
  ds_read_b64_tr_b16 v[60:61], v9 offset:59392
  ds_read_b64_tr_b16 v[62:63], v9 offset:60416
  s_waitcnt lgkmcnt(7)
  v_mfma_f32_32x32x16_bf16 v[88:103], v[48:51], v[232:235], v[88:103]
  ds_read_b64_tr_b16 v[64:65], v9 offset:61440
  ds_read_b64_tr_b16 v[66:67], v9 offset:62464
  s_waitcnt lgkmcnt(6)
  v_mfma_f32_32x32x16_bf16 v[88:103], v[52:55], v[236:239], v[88:103]
  ds_read_b64_tr_b16 v[68:69], v9 offset:63488
  ds_read_b64_tr_b16 v[70:71], v9 offset:64512
  s_waitcnt lgkmcnt(6)
  v_mfma_f32_32x32x16_bf16 v[208:223], v[56:59], v[224:227], v[208:223]
  ds_read_b64_tr_b16 v[48:49], v8 offset:24576
  ds_read_b64_tr_b16 v[50:51], v8 offset:25600
  s_waitcnt lgkmcnt(6)
  v_mfma_f32_32x32x16_bf16 v[208:223], v[60:63], v[228:231], v[208:223]
  ds_read_b64_tr_b16 v[52:53], v8 offset:26624
  ds_read_b64_tr_b16 v[54:55], v8 offset:27648
  s_waitcnt lgkmcnt(6)
  v_mfma_f32_32x32x16_bf16 v[208:223], v[64:67], v[232:235], v[208:223]
  ds_read_b64_tr_b16 v[56:57], v8 offset:28672
  ds_read_b64_tr_b16 v[58:59], v8 offset:29696
  s_waitcnt lgkmcnt(6)
  v_mfma_f32_32x32x16_bf16 v[208:223], v[68:71], v[236:239], v[208:223]
  ds_read_b64_tr_b16 v[60:61], v8 offset:30720
  ds_read_b64_tr_b16 v[62:63], v8 offset:31744
  s_setprio 0
  s_add_u32 m0, s67, 0
  s_add_u32 s74, s85, s87
  buffer_load_dwordx4 v4, s[12:15], s74 offen lds
  s_add_u32 m0, s67, 8192
  s_add_u32 s74, s82, s88
  buffer_load_dwordx4 v4, s[12:15], s74 offen lds
  s_add_u32 m0, s67, 57344
  s_add_u32 s74, s83, s88
  buffer_load_dwordx4 v4, s[12:15], s74 offen lds
  s_branch L_pj7
  .p2align 12
L_stub7:
  s_setpc_b64 s[58:59]
  s_nop 0
L_pj7:
  s_waitcnt vmcnt(10)
  s_barrier
  s_setprio 1
  s_waitcnt lgkmcnt(6)
  v_mfma_f32_32x32x16_bf16 v[16:31], v[48:51], v[240:243], v[16:31]
  ds_read_b64_tr_b16 v[64:65], v9 offset:16384
  ds_read_b64_tr_b16 v[66:67], v9 offset:17408
  s_waitcnt lgkmcnt(6)
  v_mfma_f32_32x32x16_bf16 v[16:31], v[52:55], v[244:247], v[16:31]
  ds_read_b64_tr_b16 v[68:69], v9 offset:18432
  ds_read_b64_tr_b16 v[70:71], v9 offset:19456
  s_waitcnt lgkmcnt(6)
  v_mfma_f32_32x32x16_bf16 v[16:31], v[56:59], v[248:251], v[16:31]
  ds_read_b64_tr_b16 v[48:49], v9 offset:20480
  ds_read_b64_tr_b16 v[50:51], v9 offset:21504
  s_waitcnt lgkmcnt(6)
  v_mfma_f32_32x32x16_bf16 v[16:31], v[60:63], v[252:255], v[16:31]
  ds_read_b64_tr_b16 v[52:53], v9 offset:22528
  ds_read_b64_tr_b16 v[54:55], v9 offset:23552
  s_waitcnt lgkmcnt(6)
  v_mfma_f32_32x32x16_bf16 v[88:103], v[64:67], v[240:243], v[88:103]
  ds_read_b64_tr_b16 v[56:57], v9 offset:24576
  ds_read_b64_tr_b16 v[58:59], v9 offset:25600
  s_waitcnt lgkmcnt(6)
  v_mfma_f32_32x32x16_bf16 v[88:103], v[68:71], v[244:247], v[88:103]
  ds_read_b64_tr_b16 v[60:61], v9 offset:26624
  ds_read_b64_tr_b16 v[62:63], v9 offset:27648
  s_waitcnt lgkmcnt(6)
  v_mfma_f32_32x32x16_bf16 v[88:103], v[48:51], v[248:251], v[88:103]
  ds_read_b64_tr_b16 v[64:65], v9 offset:28672
  ds_read_b64_tr_b16 v[66:67], v9 offset:29696
  s_waitcnt lgkmcnt(6)
  v_mfma_f32_32x32x16_bf16 v[88:103], v[52:55], v[252:255], v[88:103]
  ds_read_b64_tr_b16 v[68:69], v9 offset:30720
  ds_read_b64_tr_b16 v[70:71], v9 offset:31744
  s_waitcnt lgkmcnt(6)
  v_mfma_f32_32x32x16_bf16 v[208:223], v[56:59], v[240:243], v[208:223]
  ds_read_b64_tr_b16 v[48:49], v10 offset:16384
  ds_read_b64_tr_b16 v[50:51], v10 offset:17408
  s_waitcnt lgkmcnt(6)
  v_mfma_f32_32x32x16_bf16 v[208:223], v[60:63], v[244:247], v[208:223]
  ds_read_b64_tr_b16 v[52:53], v10 offset:18432
  ds_read_b64_tr_b16 v[54:55], v10 offset:19456
  s_waitcnt lgkmcnt(6)
  v_mfma_f32_32x32x16_bf16 v[208:223], v[64:67], v[248:251], v[208:223]
  ds_read_b64_tr_b16 v[56:57], v10 offset:20480
  ds_read_b64_tr_b16 v[58:59], v10 offset:21504
  s_waitcnt lgkmcnt(6)
  v_mfma_f32_32x32x16_bf16 v[208:223], v[68:71], v[252:255], v[208:223]
  ds_read_b64_tr_b16 v[60:61], v10 offset:22528
  ds_read_b64_tr_b16 v[62:63], v10 offset:23552
  s_setprio 0
  s_add_u32 m0, s67, 16384
  s_add_u32 s74, s84, s88
  buffer_load_dwordx4 v4, s[12:15], s74 offen lds
  s_add_u32 m0, s67, 65536
  s_add_u32 s74, s85, s88
  buffer_load_dwordx4 v4, s[12:15], s74 offen lds
  s_waitcnt vmcnt(5)
  s_cmp_eq_u32 s60, 0
  s_cbranch_scc0 L_ms_d
  v_cmp_le_u32 vcc, 3, v110
  s_nop 0
  s_cmp_eq_u64 vcc, -1
  s_cbranch_scc1 L_ms_d
  s_mov_b32 s76, 400000
L_ms:
  buffer_load_dword v14, v37, s[16:19], s77 offen sc1
  s_waitcnt vmcnt(0)
  v_cmp_le_u32 vcc, 3, v14
  s_sub_u32 s76, s76, 1
  s_cmp_eq_u64 vcc, -1
  s_cbranch_scc1 L_ms_d
  s_cmp_eq_u32 s76, 0
  s_cbranch_scc1 L_ms_d
  s_sleep 8
  s_branch L_ms
L_ms_d:
  s_barrier
  s_setprio 1
  s_waitcnt lgkmcnt(6)
  v_mfma_f32_32x32x16_bf16 v[16:31], v[48:51], v[144:147], v[16:31]
  ds_read_b64_tr_b16 v[64:65], v10 offset:24576
  ds_read_b64_tr_b16 v[66:67], v10 offset:25600
  s_waitcnt lgkmcnt(6)
  v_mfma_f32_32x32x16_bf16 v[16:31], v[52:55], v[148:151], v[16:31]
  ds_read_b64_tr_b16 v[68:69], v10 offset:26624
  ds_read_b64_tr_b16 v[70:71], v10 offset:27648
  s_waitcnt lgkmcnt(6)
  v_mfma_f32_32x32x16_bf16 v[16:31], v[56:59], v[152:155], v[16:31]
  ds_read_b64_tr_b16 v[48:49], v10 offset:28672
  ds_read_b64_tr_b16 v[50:51], v10 offset:29696
  s_waitcnt lgkmcnt(6)
  v_mfma_f32_32x32x16_bf16 v[16:31], v[60:63], v[156:159], v[16:31]
  ds_read_b64_tr_b16 v[52:53], v10 offset:30720
  ds_read_b64_tr_b16 v[54:55], v10 offset:31744
  s_waitcnt lgkmcnt(6)
  v_mfma_f32_32x32x16_bf16 v[16:31], v[64:67], v[160:163], v[16:31]
  ds_read_b64_tr_b16 v[56:57], v8 offset:32768
  ds_read_b64_tr_b16 v[58:59], v8 offset:33792
  s_waitcnt lgkmcnt(6)
  v_mfma_f32_32x32x16_bf16 v[16:31], v[68:71], v[164:167], v[16:31]
  ds_read_b64_tr_b16 v[60:61], v8 offset:34816
  ds_read_b64_tr_b16 v[62:63], v8 offset:35840
  s_waitcnt lgkmcnt(6)
  v_mfma_f32_32x32x16_bf16 v[16:31], v[48:51], v[168:171], v[16:31]
  ds_read_b64_tr_b16 v[64:65], v8 offset:36864
  ds_read_b64_tr_b16 v[66:67], v8 offset:37888
  s_waitcnt lgkmcnt(6)
  v_mfma_f32_32x32x16_bf16 v[16:31], v[52:55], v[172:175], v[16:31]
  ds_read_b64_tr_b16 v[68:69], v8 offset:38912
  ds_read_b64_tr_b16 v[70:71], v8 offset:39936
  s_waitcnt lgkmcnt(6)
  v_mfma_f32_32x32x16_bf16 v[16:31], v[56:59], v[176:179], v[16:31]
  ds_read_b64_tr_b16 v[48:49], v8 offset:40960
  ds_read_b64_tr_b16 v[50:51], v8 offset:41984
  s_waitcnt lgkmcnt(6)
  v_mfma_f32_32x32x16_bf16 v[16:31], v[60:63], v[180:183], v[16:31]
  ds_read_b64_tr_b16 v[52:53], v8 offset:43008
  ds_read_b64_tr_b16 v[54:55], v8 offset:44032
  s_waitcnt lgkmcnt(6)
  v_mfma_f32_32x32x16_bf16 v[16:31], v[64:67], v[184:187], v[16:31]
  ds_read_b64_tr_b16 v[56:57], v8 offset:45056
  ds_read_b64_tr_b16 v[58:59], v8 offset:46080
  s_waitcnt lgkmcnt(6)
  v_mfma_f32_32x32x16_bf16 v[16:31], v[68:71], v[188:191], v[16:31]
  ds_read_b64_tr_b16 v[60:61], v8 offset:47104
  ds_read_b64_tr_b16 v[62:63], v8 offset:48128
  s_setprio 0
  buffer_load_dwordx4 v[116:119], v34, s[4:7], s30 offen
  buffer_load_dwordx4 v[120:123], v35, s[20:23], s30 offen
  s_barrier
  s_setprio 1
  s_waitcnt lgkmcnt(6)
  v_mfma_f32_32x32x16_bf16 v[16:31], v[48:51], v[192:195], v[16:31]
  ds_read_b64_tr_b16 v[64:65], v8 offset:49152
  ds_read_b64_tr_b16 v[66:67], v8 offset:50176
  s_waitcnt lgkmcnt(6)
  v_mfma_f32_32x32x16_bf16 v[16:31], v[52:55], v[196:199], v[16:31]
  ds_read_b64_tr_b16 v[68:69], v8 offset:51200
  ds_read_b64_tr_b16 v[70:71], v8 offset:52224
  s_waitcnt lgkmcnt(6)
  v_mfma_f32_32x32x16_bf16 v[16:31], v[56:59], v[200:203], v[16:31]
  ds_read_b64_tr_b16 v[48:49], v8 offset:53248
  ds_read_b64_tr_b16 v[50:51], v8 offset:54272
  s_waitcnt lgkmcnt(6)
  v_mfma_f32_32x32x16_bf16 v[16:31], v[60:63], v[204:207], v[16:31]
  ds_read_b64_tr_b16 v[52:53], v8 offset:55296
  ds_read_b64_tr_b16 v[54:55], v8 offset:56320
  s_waitcnt lgkmcnt(6)
  v_mfma_f32_32x32x16_bf16 v[88:103], v[64:67], v[144:147], v[88:103]
  ds_read_b64_tr_b16 v[56:57], v9 offset:32768
  ds_read_b64_tr_b16 v[58:59], v9 offset:33792
  s_waitcnt lgkmcnt(6)
  v_mfma_f32_32x32x16_bf16 v[88:103], v[68:71], v[148:151], v[88:103]
  ds_read_b64_tr_b16 v[60:61], v9 offset:34816
  ds_read_b64_tr_b16 v[62:63], v9 offset:35840
  s_waitcnt lgkmcnt(6)
  v_mfma_f32_32x32x16_bf16 v[88:103], v[48:51], v[152:155], v[88:103]
  ds_read_b64_tr_b16 v[64:65], v9 offset:36864
  ds_read_b64_tr_b16 v[66:67], v9 offset:37888
  s_waitcnt lgkmcnt(6)
  v_mfma_f32_32x32x16_bf16 v[88:103], v[52:55], v[156:159], v[88:103]
  ds_read_b64_tr_b16 v[68:69], v9 offset:38912
  ds_read_b64_tr_b16 v[70:71], v9 offset:39936
  s_waitcnt lgkmcnt(6)
  v_mfma_f32_32x32x16_bf16 v[88:103], v[56:59], v[160:163], v[88:103]
  ds_read_b64_tr_b16 v[48:49], v10 offset:0
  ds_read_b64_tr_b16 v[50:51], v10 offset:1024
  s_waitcnt lgkmcnt(6)
  v_mfma_f32_32x32x16_bf16 v[88:103], v[60:63], v[164:167], v[88:103]
  ds_read_b64_tr_b16 v[52:53], v10 offset:2048
  ds_read_b64_tr_b16 v[54:55], v10 offset:3072
  s_waitcnt lgkmcnt(6)
  v_mfma_f32_32x32x16_bf16 v[88:103], v[64:67], v[168:171], v[88:103]
  ds_read_b64_tr_b16 v[56:57], v10 offset:4096
  ds_read_b64_tr_b16 v[58:59], v10 offset:5120
  s_waitcnt lgkmcnt(6)
  v_mfma_f32_32x32x16_bf16 v[88:103], v[68:71], v[172:175], v[88:103]
  ds_read_b64_tr_b16 v[60:61], v10 offset:6144
  ds_read_b64_tr_b16 v[62:63], v10 offset:7168
  s_setprio 0
  v_cvt_pk_bf16_f32 v80, v16, v17
  v_cvt_pk_bf16_f32 v81, v18, v19
  v_cvt_pk_bf16_f32 v82, v20, v21
  v_cvt_pk_bf16_f32 v83, v22, v23
  v_cvt_pk_bf16_f32 v84, v24, v25
  v_cvt_pk_bf16_f32 v85, v26, v27
  v_cvt_pk_bf16_f32 v86, v28, v29
  v_cvt_pk_bf16_f32 v87, v30, v31
  v_min_u32 v80, -2, v80
  v_min_u32 v81, -2, v81
  v_min_u32 v82, -2, v82
  v_min_u32 v83, -2, v83
  v_min_u32 v84, -2, v84
  v_min_u32 v85, -2, v85
  v_min_u32 v86, -2, v86
  v_min_u32 v87, -2, v87
  s_lshl_b32 s74, s86, 7
  s_add_u32 s74, s74, s75
  s_add_u32 s78, s74, 4096
  buffer_store_dwordx4 v[80:83], v12, s[16:19], s74 offen sc1
  buffer_store_dwordx4 v[84:87], v12, s[16:19], s78 offen sc1
  s_waitcnt vmcnt(6)
  s_barrier
  s_setprio 1
  s_waitcnt lgkmcnt(6)
  v_mfma_f32_32x32x16_bf16 v[88:103], v[48:51], v[176:179], v[88:103]
  ds_read_b64_tr_b16 v[64:65], v8 offset:0
  ds_read_b64_tr_b16 v[66:67], v8 offset:1024
  s_waitcnt lgkmcnt(6)
  v_mfma_f32_32x32x16_bf16 v[88:103], v[52:55], v[180:183], v[88:103]
  ds_read_b64_tr_b16 v[68:69], v8 offset:2048
  ds_read_b64_tr_b16 v[70:71], v8 offset:3072
  s_waitcnt lgkmcnt(6)
  v_mfma_f32_32x32x16_bf16 v[88:103], v[56:59], v[184:187], v[88:103]
  ds_read_b64_tr_b16 v[48:49], v8 offset:4096
  ds_read_b64_tr_b16 v[50:51], v8 offset:5120
  s_waitcnt lgkmcnt(6)
  v_mfma_f32_32x32x16_bf16 v[88:103], v[60:63], v[188:191], v[88:103]
  ds_read_b64_tr_b16 v[52:53], v8 offset:6144
  ds_read_b64_tr_b16 v[54:55], v8 offset:7168
  s_waitcnt lgkmcnt(6)
  v_mfma_f32_32x32x16_bf16 v[88:103], v[64:67], v[192:195], v[88:103]
  ds_read_b64_tr_b16 v[56:57], v8 offset:8192
  ds_read_b64_tr_b16 v[58:59], v8 offset:9216
  s_waitcnt lgkmcnt(6)
  v_mfma_f32_32x32x16_bf16 v[88:103], v[68:71], v[196:199], v[88:103]
  ds_read_b64_tr_b16 v[60:61], v8 offset:10240
  ds_read_b64_tr_b16 v[62:63], v8 offset:11264
  s_waitcnt lgkmcnt(6)
  v_mfma_f32_32x32x16_bf16 v[88:103], v[48:51], v[200:203], v[88:103]
  ds_read_b64_tr_b16 v[64:65], v8 offset:12288
  ds_read_b64_tr_b16 v[66:67], v8 offset:13312
  s_waitcnt lgkmcnt(6)
  v_mfma_f32_32x32x16_bf16 v[88:103], v[52:55], v[204:207], v[88:103]
  ds_read_b64_tr_b16 v[68:69], v8 offset:14336
  ds_read_b64_tr_b16 v[70:71], v8 offset:15360
  s_waitcnt lgkmcnt(6)
  v_mfma_f32_32x32x16_bf16 v[208:223], v[56:59], v[144:147], v[208:223]
  ds_read_b64_tr_b16 v[48:49], v8 offset:57344
  ds_read_b64_tr_b16 v[50:51], v8 offset:58368
  s_waitcnt lgkmcnt(6)
  v_mfma_f32_32x32x16_bf16 v[208:223], v[60:63], v[148:151], v[208:223]
  ds_read_b64_tr_b16 v[52:53], v8 offset:59392
  ds_read_b64_tr_b16 v[54:55], v8 offset:60416
  s_waitcnt lgkmcnt(6)
  v_mfma_f32_32x32x16_bf16 v[208:223], v[64:67], v[152:155], v[208:223]
  ds_read_b64_tr_b16 v[56:57], v8 offset:61440
  ds_read_b64_tr_b16 v[58:59], v8 offset:62464
  s_waitcnt lgkmcnt(6)
  v_mfma_f32_32x32x16_bf16 v[208:223], v[68:71], v[156:159], v[208:223]
  ds_read_b64_tr_b16 v[60:61], v8 offset:63488
  ds_read_b64_tr_b16 v[62:63], v8 offset:64512
  s_setprio 0
  v_cvt_pk_bf16_f32 v80, v88, v89
  v_cvt_pk_bf16_f32 v81, v90, v91
  v_cvt_pk_bf16_f32 v82, v92, v93
  v_cvt_pk_bf16_f32 v83, v94, v95
  v_cvt_pk_bf16_f32 v84, v96, v97
  v_cvt_pk_bf16_f32 v85, v98, v99
  v_cvt_pk_bf16_f32 v86, v100, v101
  v_cvt_pk_bf16_f32 v87, v102, v103
  v_min_u32 v80, -2, v80
  v_min_u32 v81, -2, v81
  v_min_u32 v82, -2, v82
  v_min_u32 v83, -2, v83
  v_min_u32 v84, -2, v84
  v_min_u32 v85, -2, v85
  v_min_u32 v86, -2, v86
  v_min_u32 v87, -2, v87
  s_lshl_b32 s74, s87, 7
  s_add_u32 s74, s74, s75
  s_add_u32 s78, s74, 4096
  buffer_store_dwordx4 v[80:83], v12, s[16:19], s74 offen sc1
  buffer_store_dwordx4 v[84:87], v12, s[16:19], s78 offen sc1
  s_waitcnt vmcnt(6)
  s_barrier
  s_setprio 1
  s_waitcnt lgkmcnt(6)
  v_mfma_f32_32x32x16_bf16 v[208:223], v[48:51], v[160:163], v[208:223]
  ds_read_b64_tr_b16 v[64:65], v8 offset:16384
  ds_read_b64_tr_b16 v[66:67], v8 offset:17408
  s_waitcnt lgkmcnt(6)
  v_mfma_f32_32x32x16_bf16 v[208:223], v[52:55], v[164:167], v[208:223]
  ds_read_b64_tr_b16 v[68:69], v8 offset:18432
  ds_read_b64_tr_b16 v[70:71], v8 offset:19456
  s_waitcnt lgkmcnt(6)
  v_mfma_f32_32x32x16_bf16 v[208:223], v[56:59], v[168:171], v[208:223]
  ds_read_b64_tr_b16 v[48:49], v8 offset:20480
  ds_read_b64_tr_b16 v[50:51], v8 offset:21504
  s_waitcnt lgkmcnt(6)
  v_mfma_f32_32x32x16_bf16 v[208:223], v[60:63], v[172:175], v[208:223]
  ds_read_b64_tr_b16 v[52:53], v8 offset:22528
  ds_read_b64_tr_b16 v[54:55], v8 offset:23552
  s_waitcnt lgkmcnt(6)
  v_mfma_f32_32x32x16_bf16 v[208:223], v[64:67], v[176:179], v[208:223]
  ds_read_b64_tr_b16 v[56:57], v9 offset:0
  ds_read_b64_tr_b16 v[58:59], v9 offset:1024
  s_waitcnt lgkmcnt(6)
  v_mfma_f32_32x32x16_bf16 v[208:223], v[68:71], v[180:183], v[208:223]
  ds_read_b64_tr_b16 v[60:61], v9 offset:2048
  ds_read_b64_tr_b16 v[62:63], v9 offset:3072
  s_waitcnt lgkmcnt(6)
  v_mfma_f32_32x32x16_bf16 v[208:223], v[48:51], v[184:187], v[208:223]
  ds_read_b64_tr_b16 v[64:65], v9 offset:4096
  ds_read_b64_tr_b16 v[66:67], v9 offset:5120
  s_waitcnt lgkmcnt(6)
  v_mfma_f32_32x32x16_bf16 v[208:223], v[52:55], v[188:191], v[208:223]
  ds_read_b64_tr_b16 v[68:69], v9 offset:6144
  ds_read_b64_tr_b16 v[70:71], v9 offset:7168
  s_waitcnt lgkmcnt(6)
  v_mfma_f32_32x32x16_bf16 v[208:223], v[56:59], v[192:195], v[208:223]
  s_waitcnt lgkmcnt(4)
  v_mfma_f32_32x32x16_bf16 v[208:223], v[60:63], v[196:199], v[208:223]
  s_waitcnt lgkmcnt(2)
  v_mfma_f32_32x32x16_bf16 v[208:223], v[64:67], v[200:203], v[208:223]
  s_waitcnt lgkmcnt(0)
  v_mfma_f32_32x32x16_bf16 v[208:223], v[68:71], v[204:207], v[208:223]
  s_setprio 0
  s_cmp_eq_u32 s60, 0
  s_cselect_b32 s66, s77, 1879048192
  buffer_load_dword v110, v37, s[16:19], s66 offen sc1
  s_nop 7
  v_cvt_pk_bf16_f32 v80, v208, v209
  v_cvt_pk_bf16_f32 v81, v210, v211
  v_cvt_pk_bf16_f32 v82, v212, v213
  v_cvt_pk_bf16_f32 v83, v214, v215
  v_cvt_pk_bf16_f32 v84, v216, v217
  v_cvt_pk_bf16_f32 v85, v218, v219
  v_cvt_pk_bf16_f32 v86, v220, v221
  v_cvt_pk_bf16_f32 v87, v222, v223
  v_min_u32 v80, -2, v80
  v_min_u32 v81, -2, v81
  v_min_u32 v82, -2, v82
  v_min_u32 v83, -2, v83
  v_min_u32 v84, -2, v84
  v_min_u32 v85, -2, v85
  v_min_u32 v86, -2, v86
  v_min_u32 v87, -2, v87
  s_lshl_b32 s74, s88, 7
  s_add_u32 s74, s74, s75
  s_add_u32 s78, s74, 4096
  buffer_store_dwordx4 v[80:83], v12, s[16:19], s74 offen sc1
  buffer_store_dwordx4 v[84:87], v12, s[16:19], s78 offen sc1
  s_branch L_mtail
  .p2align 12
L_stub8:
  s_setpc_b64 s[58:59]
  s_nop 0
L_roleB:
  s_nop 7
  s_cmp_eq_u32 s77, 0
  s_cbranch_scc1 L_early1
  s_setprio 1
  ds_read_b128 v[112:115], v110 offset:0
  ds_read_b128 v[116:119], v110 offset:2208
  ds_read_b128 v[120:123], v110 offset:4416
  ds_read_b128 v[124:127], v110 offset:6624
  v_mfma_f32_32x32x16_bf16 v[16:31], v[88:91], v[92:95], 0
  s_waitcnt lgkmcnt(3)
  v_mfma_f32_32x32x16_bf16 v[16:31], v[48:51], v[112:115], v[16:31]
  ds_read_b128 v[128:131], v110 offset:8832
  ds_read_b128 v[132:135], v110 offset:11040
  ds_read_b128 v[136:139], v110 offset:13248
  ds_read_b128 v[140:143], v110 offset:15456
  ds_read_b64_tr_b16 v[64:65], v6 offset:8192
  ds_read_b64_tr_b16 v[66:67], v6 offset:8704
  s_waitcnt lgkmcnt(8)
  v_mfma_f32_32x32x16_bf16 v[16:31], v[52:55], v[116:119], v[16:31]
  ds_read_b128 v[144:147], v110 offset:17664
  ds_read_b128 v[148:151], v110 offset:19872
  ds_read_b128 v[152:155], v110 offset:22080
  ds_read_b128 v[156:159], v110 offset:24288
  ds_read_b64_tr_b16 v[68:69], v6 offset:10240
  ds_read_b64_tr_b16 v[70:71], v6 offset:10752
  s_waitcnt lgkmcnt(13)
  v_mfma_f32_32x32x16_bf16 v[16:31], v[56:59], v[120:123], v[16:31]
  ds_read_b128 v[160:163], v110 offset:26496
  ds_read_b128 v[164:167], v110 offset:28704
  ds_read_b128 v[168:171], v110 offset:30912
  ds_read_b128 v[172:175], v110 offset:33120
  ds_read_b64_tr_b16 v[48:49], v6 offset:12288
  ds_read_b64_tr_b16 v[50:51], v6 offset:12800
  s_waitcnt lgkmcnt(15)
  v_mfma_f32_32x32x16_bf16 v[16:31], v[60:63], v[124:127], v[16:31]
  ds_read_b128 v[176:179], v110 offset:35328
  ds_read_b128 v[180:183], v110 offset:37536
  ds_read_b128 v[184:187], v111 offset:0
  ds_read_b128 v[188:191], v111 offset:2208
  ds_read_b64_tr_b16 v[52:53], v6 offset:14336
  ds_read_b64_tr_b16 v[54:55], v6 offset:14848
  s_waitcnt lgkmcnt(15)
  v_mfma_f32_32x32x16_bf16 v[16:31], v[64:67], v[128:131], v[16:31]
  ds_read_b128 v[192:195], v111 offset:4416
  ds_read_b128 v[196:199], v111 offset:6624
  ds_read_b128 v[200:203], v111 offset:8832
  ds_read_b128 v[204:207], v111 offset:11040
  ds_read_b64_tr_b16 v[56:57], v5 offset:0
  ds_read_b64_tr_b16 v[58:59], v5 offset:512
  s_waitcnt lgkmcnt(15)
  v_mfma_f32_32x32x16_bf16 v[16:31], v[68:71], v[132:135], v[16:31]
  ds_read_b128 v[208:211], v111 offset:13248
  ds_read_b128 v[212:215], v111 offset:15456
  ds_read_b128 v[216:219], v111 offset:17664
  ds_read_b128 v[220:223], v111 offset:19872
  ds_read_b64_tr_b16 v[60:61], v5 offset:2048
  ds_read_b64_tr_b16 v[62:63], v5 offset:2560
  s_waitcnt lgkmcnt(15)
  v_mfma_f32_32x32x16_bf16 v[16:31], v[48:51], v[136:139], v[16:31]
  ds_read_b128 v[224:227], v111 offset:22080
  ds_read_b128 v[228:231], v111 offset:24288
  ds_read_b128 v[232:235], v111 offset:26496
  ds_read_b128 v[236:239], v111 offset:28704
  ds_read_b64_tr_b16 v[64:65], v5 offset:4096
  ds_read_b64_tr_b16 v[66:67], v5 offset:4608
  s_waitcnt lgkmcnt(15)
  v_mfma_f32_32x32x16_bf16 v[16:31], v[52:55], v[140:143], v[16:31]
  ds_read_b128 v[240:243], v111 offset:30912
  ds_read_b128 v[244:247], v111 offset:33120
  ds_read_b128 v[248:251], v111 offset:35328
  ds_read_b128 v[252:255], v111 offset:37536
  ds_read_b64_tr_b16 v[68:69], v5 offset:6144
  ds_read_b64_tr_b16 v[70:71], v5 offset:6656
  s_waitcnt lgkmcnt(15)
  v_mfma_f32_32x32x16_bf16 v[16:31], v[56:59], v[144:147], v[16:31]
  ds_read_b64_tr_b16 v[48:49], v5 offset:8192
  ds_read_b64_tr_b16 v[50:51], v5 offset:8704
  s_waitcnt lgkmcnt(14)
  v_mfma_f32_32x32x16_bf16 v[16:31], v[60:63], v[148:151], v[16:31]
  ds_read_b64_tr_b16 v[52:53], v5 offset:10240
  ds_read_b64_tr_b16 v[54:55], v5 offset:10752
  s_waitcnt lgkmcnt(10)
  v_mfma_f32_32x32x16_bf16 v[16:31], v[64:67], v[152:155], v[16:31]
  ds_read_b64_tr_b16 v[56:57], v5 offset:12288
  ds_read_b64_tr_b16 v[58:59], v5 offset:12800
  s_waitcnt lgkmcnt(6)
  v_mfma_f32_32x32x16_bf16 v[16:31], v[68:71], v[156:159], v[16:31]
  ds_read_b64_tr_b16 v[60:61], v5 offset:14336
  ds_read_b64_tr_b16 v[62:63], v5 offset:14848
  s_setprio 0
  s_waitcnt vmcnt(3)
  s_barrier
  s_branch L_join1
L_early1:
  s_setprio 1
  v_mfma_f32_32x32x16_bf16 v[16:31], v[88:91], v[92:95], 0
  s_waitcnt lgkmcnt(6)
  v_mfma_f32_32x32x16_bf16 v[16:31], v[48:51], v[112:115], v[16:31]
  ds_read_b64_tr_b16 v[64:65], v6 offset:8192
  ds_read_b64_tr_b16 v[66:67], v6 offset:8704
  s_waitcnt lgkmcnt(6)
  v_mfma_f32_32x32x16_bf16 v[16:31], v[52:55], v[116:119], v[16:31]
  ds_read_b64_tr_b16 v[68:69], v6 offset:10240
  ds_read_b64_tr_b16 v[70:71], v6 offset:10752
  s_waitcnt lgkmcnt(6)
  v_mfma_f32_32x32x16_bf16 v[16:31], v[56:59], v[120:123], v[16:31]
  ds_read_b64_tr_b16 v[48:49], v6 offset:12288
  ds_read_b64_tr_b16 v[50:51], v6 offset:12800
  s_waitcnt lgkmcnt(6)
  v_mfma_f32_32x32x16_bf16 v[16:31], v[60:63], v[124:127], v[16:31]
  ds_read_b64_tr_b16 v[52:53], v6 offset:14336
  ds_read_b64_tr_b16 v[54:55], v6 offset:14848
  s_waitcnt lgkmcnt(6)
  v_mfma_f32_32x32x16_bf16 v[16:31], v[64:67], v[128:131], v[16:31]
  ds_read_b64_tr_b16 v[56:57], v5 offset:0
  ds_read_b64_tr_b16 v[58:59], v5 offset:512
  s_waitcnt lgkmcnt(6)
  v_mfma_f32_32x32x16_bf16 v[16:31], v[68:71], v[132:135], v[16:31]
  ds_read_b64_tr_b16 v[60:61], v5 offset:2048
  ds_read_b64_tr_b16 v[62:63], v5 offset:2560
  s_waitcnt lgkmcnt(6)
  v_mfma_f32_32x32x16_bf16 v[16:31], v[48:51], v[136:139], v[16:31]
  ds_read_b64_tr_b16 v[64:65], v5 offset:4096
  ds_read_b64_tr_b16 v[66:67], v5 offset:4608
  s_waitcnt lgkmcnt(6)
  v_mfma_f32_32x32x16_bf16 v[16:31], v[52:55], v[140:143], v[16:31]
  ds_read_b64_tr_b16 v[68:69], v5 offset:6144
  ds_read_b64_tr_b16 v[70:71], v5 offset:6656
  s_waitcnt lgkmcnt(6)
  v_mfma_f32_32x32x16_bf16 v[16:31], v[56:59], v[144:147], v[16:31]
  ds_read_b64_tr_b16 v[48:49], v5 offset:8192
  ds_read_b64_tr_b16 v[50:51], v5 offset:8704
  s_waitcnt lgkmcnt(6)
  v_mfma_f32_32x32x16_bf16 v[16:31], v[60:63], v[148:151], v[16:31]
  ds_read_b64_tr_b16 v[52:53], v5 offset:10240
  ds_read_b64_tr_b16 v[54:55], v5 offset:10752
  s_waitcnt lgkmcnt(6)
  v_mfma_f32_32x32x16_bf16 v[16:31], v[64:67], v[152:155], v[16:31]
  ds_read_b64_tr_b16 v[56:57], v5 offset:12288
  ds_read_b64_tr_b16 v[58:59], v5 offset:12800
  s_waitcnt lgkmcnt(6)
  v_mfma_f32_32x32x16_bf16 v[16:31], v[68:71], v[156:159], v[16:31]
  ds_read_b64_tr_b16 v[60:61], v5 offset:14336
  ds_read_b64_tr_b16 v[62:63], v5 offset:14848
  s_setprio 0
  s_waitcnt vmcnt(3)
  s_barrier
L_join1:
  s_add_u32 m0, s67, 65536
  s_add_u32 s74, s29, 589824
  buffer_load_dwordx4 v3, s[8:11], s74 offen lds
  s_add_u32 m0, s67, 73728
  s_add_u32 s74, s29, 1179648
  buffer_load_dwordx4 v3, s[8:11], s74 offen lds
  s_add_u32 m0, s67, 81920
  s_add_u32 s74, s29, 1769472
  buffer_load_dwordx4 v3, s[8:11], s74 offen lds
  s_add_u32 m0, s67, 90112
  s_add_u32 s74, s29, 2359296
  buffer_load_dwordx4 v3, s[8:11], s74 offen lds
  s_add_u32 m0, s67, 98304
  s_add_u32 s74, s29, 2949120
  buffer_load_dwordx4 v3, s[8:11], s74 offen lds
  v_mov_b32 v88, v97
  s_mov_b32 s24, s54
  s_and_b32 s25, s55, 0xffff
  s_mov_b32 s26, 256
  s_mov_b32 s27, 0x00020000
  v_cmp_eq_u32 vcc, 0, v1
  v_mov_b32 v108, 0
  v_mov_b32 v109, 0x40000000
  v_cndmask_b32 v109, v109, v108, vcc
  s_setprio 1
  s_waitcnt lgkmcnt(6)
  v_mfma_f32_32x32x16_bf16 v[16:31], v[48:51], v[160:163], v[16:31]
  ds_read_b64_tr_b16 v[64:65], v5 offset:16384
  ds_read_b64_tr_b16 v[66:67], v5 offset:16896
  s_waitcnt lgkmcnt(6)
  v_mfma_f32_32x32x16_bf16 v[16:31], v[52:55], v[164:167], v[16:31]
  ds_read_b64_tr_b16 v[68:69], v5 offset:18432
  ds_read_b64_tr_b16 v[70:71], v5 offset:18944
  s_waitcnt lgkmcnt(6)
  v_mfma_f32_32x32x16_bf16 v[16:31], v[56:59], v[168:171], v[16:31]
  ds_read_b64_tr_b16 v[48:49], v5 offset:20480
  ds_read_b64_tr_b16 v[50:51], v5 offset:20992
  s_waitcnt lgkmcnt(6)
  v_mfma_f32_32x32x16_bf16 v[16:31], v[60:63], v[172:175], v[16:31]
  ds_read_b64_tr_b16 v[52:53], v5 offset:22528
  ds_read_b64_tr_b16 v[54:55], v5 offset:23040
  s_waitcnt lgkmcnt(6)
  v_mfma_f32_32x32x16_bf16 v[16:31], v[64:67], v[176:179], v[16:31]
  ds_read_b64_tr_b16 v[56:57], v5 offset:24576
  ds_read_b64_tr_b16 v[58:59], v5 offset:25088
  s_waitcnt lgkmcnt(6)
  v_mfma_f32_32x32x16_bf16 v[16:31], v[68:71], v[180:183], v[16:31]
  ds_read_b64_tr_b16 v[60:61], v5 offset:26624
  ds_read_b64_tr_b16 v[62:63], v5 offset:27136
  s_waitcnt lgkmcnt(6)
  v_mfma_f32_32x32x16_bf16 v[16:31], v[48:51], v[184:187], v[16:31]
  ds_read_b64_tr_b16 v[64:65], v5 offset:28672
  ds_read_b64_tr_b16 v[66:67], v5 offset:29184
  s_waitcnt lgkmcnt(6)
  v_mfma_f32_32x32x16_bf16 v[16:31], v[52:55], v[188:191], v[16:31]
  ds_read_b64_tr_b16 v[68:69], v5 offset:30720
  ds_read_b64_tr_b16 v[70:71], v5 offset:31232
  s_waitcnt lgkmcnt(6)
  v_mfma_f32_32x32x16_bf16 v[16:31], v[56:59], v[192:195], v[16:31]
  ds_read_b64_tr_b16 v[48:49], v5 offset:32768
  ds_read_b64_tr_b16 v[50:51], v5 offset:33280
  s_waitcnt lgkmcnt(6)
  v_mfma_f32_32x32x16_bf16 v[16:31], v[60:63], v[196:199], v[16:31]
  ds_read_b64_tr_b16 v[52:53], v5 offset:34816
  ds_read_b64_tr_b16 v[54:55], v5 offset:35328
  s_waitcnt lgkmcnt(6)
  v_mfma_f32_32x32x16_bf16 v[16:31], v[64:67], v[200:203], v[16:31]
  ds_read_b64_tr_b16 v[56:57], v5 offset:36864
  ds_read_b64_tr_b16 v[58:59], v5 offset:37376
  s_waitcnt lgkmcnt(6)
  v_mfma_f32_32x32x16_bf16 v[16:31], v[68:71], v[204:207], v[16:31]
  ds_read_b64_tr_b16 v[60:61], v5 offset:38912
  ds_read_b64_tr_b16 v[62:63], v5 offset:39424
  s_setprio 0
  s_waitcnt vmcnt(5)
  s_barrier
  s_add_u32 m0, s67, 106496
  s_add_u32 s74, s29, 3538944
  buffer_load_dwordx4 v3, s[8:11], s74 offen lds
  s_add_u32 m0, s67, 114688
  s_add_u32 s74, s29, 4128768
  buffer_load_dwordx4 v3, s[8:11], s74 offen lds
  s_add_u32 m0, s67, 122880
  s_add_u32 s74, s29, 4718592
  buffer_load_dwordx4 v3, s[8:11], s74 offen lds
  s_add_u32 m0, s67, 131072
  s_add_u32 s74, s30, 0
  buffer_load_dwordx4 v3, s[8:11], s74 offen lds
  s_add_u32 m0, s67, 139264
  s_add_u32 s74, s30, 589824
  buffer_load_dwordx4 v3, s[8:11], s74 offen lds
  s_lshl_b32 s79, s35, 7
  s_add_u32 s79, s79, 49414144
  s_cmp_eq_u32 s60, 0
  s_cselect_b32 s79, s79, 1879048192
  s_mov_b32 s76, 49414144
  s_cselect_b32 s76, s76, 1879048192
  v_mov_b32 v14, s34
  v_mov_b32 v15, s3
  v_cmp_gt_u32 vcc, 32, v1
  s_nop 1
  v_cndmask_b32 v2, v15, v14, vcc
  v_lshlrev_b32 v2, 7, v2
  s_mul_i32 s34, s34, 98304
  s_add_u32 s34, s34, 10485760
  s_add_u32 s34, s34, s67
  s_mul_i32 s3, s3, 98304
  s_add_u32 s3, s3, 10485760
  s_add_u32 s3, s3, s67
  s_mul_i32 s35, s35, 98304
  s_add_u32 s35, s35, 10485760
  s_add_u32 s59, s35, s67
  s_lshl_b32 s66, s64, 13
  s_add_u32 s35, s35, s66
  s_lshl_b32 s66, s63, 10
  s_add_u32 s35, s35, s66
  v_add_u32 v13, 0xffff0000, v104
  s_setprio 1
  s_waitcnt lgkmcnt(6)
  v_mfma_f32_32x32x16_bf16 v[16:31], v[48:51], v[208:211], v[16:31]
  ds_read_b64_tr_b16 v[64:65], v5 offset:40960
  ds_read_b64_tr_b16 v[66:67], v5 offset:41472
  s_waitcnt lgkmcnt(6)
  v_mfma_f32_32x32x16_bf16 v[16:31], v[52:55], v[212:215], v[16:31]
  ds_read_b64_tr_b16 v[68:69], v5 offset:43008
  ds_read_b64_tr_b16 v[70:71], v5 offset:43520
  s_waitcnt lgkmcnt(6)
  v_mfma_f32_32x32x16_bf16 v[16:31], v[56:59], v[216:219], v[16:31]
  ds_read_b64_tr_b16 v[48:49], v5 offset:45056
  ds_read_b64_tr_b16 v[50:51], v5 offset:45568
  s_waitcnt lgkmcnt(6)
  v_mfma_f32_32x32x16_bf16 v[16:31], v[60:63], v[220:223], v[16:31]
  ds_read_b64_tr_b16 v[52:53], v5 offset:47104
  ds_read_b64_tr_b16 v[54:55], v5 offset:47616
  s_waitcnt lgkmcnt(6)
  v_mfma_f32_32x32x16_bf16 v[16:31], v[64:67], v[224:227], v[16:31]
  ds_read_b64_tr_b16 v[56:57], v5 offset:49152
  ds_read_b64_tr_b16 v[58:59], v5 offset:49664
  s_waitcnt lgkmcnt(6)
  v_mfma_f32_32x32x16_bf16 v[16:31], v[68:71], v[228:231], v[16:31]
  ds_read_b64_tr_b16 v[60:61], v5 offset:51200
  ds_read_b64_tr_b16 v[62:63], v5 offset:51712
  s_waitcnt lgkmcnt(6)
  v_mfma_f32_32x32x16_bf16 v[16:31], v[48:51], v[232:235], v[16:31]
  ds_read_b64_tr_b16 v[64:65], v5 offset:53248
  ds_read_b64_tr_b16 v[66:67], v5 offset:53760
  s_waitcnt lgkmcnt(6)
  v_mfma_f32_32x32x16_bf16 v[16:31], v[52:55], v[236:239], v[16:31]
  ds_read_b64_tr_b16 v[68:69], v5 offset:55296
  ds_read_b64_tr_b16 v[70:71], v5 offset:55808
  s_waitcnt lgkmcnt(6)
  v_mfma_f32_32x32x16_bf16 v[16:31], v[56:59], v[240:243], v[16:31]
  ds_read_b64_tr_b16 v[48:49], v5 offset:57344
  ds_read_b64_tr_b16 v[50:51], v5 offset:57856
  s_waitcnt lgkmcnt(6)
  v_mfma_f32_32x32x16_bf16 v[16:31], v[60:63], v[244:247], v[16:31]
  ds_read_b64_tr_b16 v[52:53], v5 offset:59392
  ds_read_b64_tr_b16 v[54:55], v5 offset:59904
  s_waitcnt lgkmcnt(6)
  v_mfma_f32_32x32x16_bf16 v[16:31], v[64:67], v[248:251], v[16:31]
  ds_read_b64_tr_b16 v[56:57], v5 offset:61440
  ds_read_b64_tr_b16 v[58:59], v5 offset:61952
  s_waitcnt lgkmcnt(6)
  v_mfma_f32_32x32x16_bf16 v[16:31], v[68:71], v[252:255], v[16:31]
  ds_read_b64_tr_b16 v[60:61], v5 offset:63488
  ds_read_b64_tr_b16 v[62:63], v5 offset:64000
  s_setprio 0
  s_waitcnt vmcnt(7)
  s_barrier
  s_add_u32 m0, s67, 147456
  s_add_u32 s74, s30, 1179648
  buffer_load_dwordx4 v3, s[8:11], s74 offen lds
  s_add_u32 m0, s67, 155648
  s_add_u32 s74, s30, 1769472
  buffer_load_dwordx4 v3, s[8:11], s74 offen lds
  s_add_u32 m0, s67, 0
  s_add_u32 s74, s30, 2359296
  buffer_load_dwordx4 v3, s[8:11], s74 offen lds
  s_add_u32 m0, s67, 8192
  s_add_u32 s74, s30, 2949120
  buffer_load_dwordx4 v3, s[8:11], s74 offen lds
  s_add_u32 m0, s67, 16384
  s_add_u32 s74, s30, 3538944
  buffer_load_dwordx4 v3, s[8:11], s74 offen lds
  v_fma_f32 v72, v16, v16, s72
  v_fma_f32 v73, v17, v17, s72
  v_fma_f32 v74, v18, v18, s72
  v_fma_f32 v75, v19, v19, s72
  v_mul_f32 v72, v72, v16
  v_mul_f32 v73, v73, v17
  v_mul_f32 v74, v74, v18
  v_mul_f32 v75, v75, v19
  v_exp_f32 v72, -v72
  v_exp_f32 v73, -v73
  v_exp_f32 v74, -v74
  v_exp_f32 v75, -v75
  v_fma_f32 v72, v72, s73, s73
  v_fma_f32 v73, v73, s73, s73
  v_fma_f32 v74, v74, s73, s73
  v_fma_f32 v75, v75, s73, s73
  v_rcp_f32 v72, v72
  v_rcp_f32 v73, v73
  v_rcp_f32 v74, v74
  v_rcp_f32 v75, v75
  v_mul_f32 v72, v72, v16
  v_mul_f32 v73, v73, v17
  v_mul_f32 v74, v74, v18
  v_mul_f32 v75, v75, v19
  v_cvt_pk_bf16_f32 v80, v72, v73
  v_cvt_pk_bf16_f32 v81, v74, v75
  v_fma_f32 v72, v20, v20, s72
  v_fma_f32 v73, v21, v21, s72
  v_fma_f32 v74, v22, v22, s72
  v_fma_f32 v75, v23, v23, s72
  v_mul_f32 v72, v72, v20
  v_mul_f32 v73, v73, v21
  v_mul_f32 v74, v74, v22
  v_mul_f32 v75, v75, v23
  v_exp_f32 v72, -v72
  v_exp_f32 v73, -v73
  v_exp_f32 v74, -v74
  v_exp_f32 v75, -v75
  v_fma_f32 v72, v72, s73, s73
  v_fma_f32 v73, v73, s73, s73
  s_setprio 1
  v_mfma_f32_32x32x16_bf16 v[32:47], v[88:91], v[92:95], 0
  s_waitcnt lgkmcnt(6)
  v_mfma_f32_32x32x16_bf16 v[32:47], v[48:51], v[112:115], v[32:47]
  ds_read_b64_tr_b16 v[64:65], v6 offset:0
  ds_read_b64_tr_b16 v[66:67], v6 offset:512
  s_waitcnt lgkmcnt(6)
  v_mfma_f32_32x32x16_bf16 v[32:47], v[52:55], v[116:119], v[32:47]
  ds_read_b64_tr_b16 v[68:69], v6 offset:2048
  ds_read_b64_tr_b16 v[70:71], v6 offset:2560
  s_waitcnt lgkmcnt(6)
  v_mfma_f32_32x32x16_bf16 v[32:47], v[56:59], v[120:123], v[32:47]
  ds_read_b64_tr_b16 v[48:49], v6 offset:4096
  ds_read_b64_tr_b16 v[50:51], v6 offset:4608
  s_waitcnt lgkmcnt(6)
  v_mfma_f32_32x32x16_bf16 v[32:47], v[60:63], v[124:127], v[32:47]
  ds_read_b64_tr_b16 v[52:53], v6 offset:6144
  ds_read_b64_tr_b16 v[54:55], v6 offset:6656
  s_waitcnt lgkmcnt(6)
  v_mfma_f32_32x32x16_bf16 v[32:47], v[64:67], v[128:131], v[32:47]
  ds_read_b64_tr_b16 v[56:57], v6 offset:8192
  ds_read_b64_tr_b16 v[58:59], v6 offset:8704
  s_waitcnt lgkmcnt(6)
  v_mfma_f32_32x32x16_bf16 v[32:47], v[68:71], v[132:135], v[32:47]
  ds_read_b64_tr_b16 v[60:61], v6 offset:10240
  ds_read_b64_tr_b16 v[62:63], v6 offset:10752
  s_waitcnt lgkmcnt(6)
  v_mfma_f32_32x32x16_bf16 v[32:47], v[48:51], v[136:139], v[32:47]
  ds_read_b64_tr_b16 v[64:65], v6 offset:12288
  ds_read_b64_tr_b16 v[66:67], v6 offset:12800
  s_waitcnt lgkmcnt(6)
  v_mfma_f32_32x32x16_bf16 v[32:47], v[52:55], v[140:143], v[32:47]
  ds_read_b64_tr_b16 v[68:69], v6 offset:14336
  ds_read_b64_tr_b16 v[70:71], v6 offset:14848
  s_waitcnt lgkmcnt(6)
  v_mfma_f32_32x32x16_bf16 v[32:47], v[56:59], v[144:147], v[32:47]
  ds_read_b64_tr_b16 v[48:49], v6 offset:16384
  ds_read_b64_tr_b16 v[50:51], v6 offset:16896
  s_waitcnt lgkmcnt(6)
  v_mfma_f32_32x32x16_bf16 v[32:47], v[60:63], v[148:151], v[32:47]
  ds_read_b64_tr_b16 v[52:53], v6 offset:18432
  ds_read_b64_tr_b16 v[54:55], v6 offset:18944
  s_waitcnt lgkmcnt(6)
  v_mfma_f32_32x32x16_bf16 v[32:47], v[64:67], v[152:155], v[32:47]
  ds_read_b64_tr_b16 v[56:57], v6 offset:20480
  ds_read_b64_tr_b16 v[58:59], v6 offset:20992
  s_waitcnt lgkmcnt(6)
  v_mfma_f32_32x32x16_bf16 v[32:47], v[68:71], v[156:159], v[32:47]
  ds_read_b64_tr_b16 v[60:61], v6 offset:22528
  ds_read_b64_tr_b16 v[62:63], v6 offset:23040
  s_setprio 0
  s_waitcnt vmcnt(9)
  s_barrier
  s_add_u32 m0, s67, 24576
  s_add_u32 s74, s30, 4128768
  buffer_load_dwordx4 v3, s[8:11], s74 offen lds
  v_mov_b32 v88, v98
  v_fma_f32 v74, v74, s73, s73
  v_fma_f32 v75, v75, s73, s73
  v_rcp_f32 v72, v72
  v_rcp_f32 v73, v73
  v_rcp_f32 v74, v74
  v_rcp_f32 v75, v75
  v_mul_f32 v72, v72, v20
  v_mul_f32 v73, v73, v21
  v_mul_f32 v74, v74, v22
  v_mul_f32 v75, v75, v23
  v_cvt_pk_bf16_f32 v82, v72, v73
  v_cvt_pk_bf16_f32 v83, v74, v75
  v_fma_f32 v72, v24, v24, s72
  v_fma_f32 v73, v25, v25, s72
  v_fma_f32 v74, v26, v26, s72
  v_fma_f32 v75, v27, v27, s72
  v_mul_f32 v72, v72, v24
  v_mul_f32 v73, v73, v25
  v_mul_f32 v74, v74, v26
  v_mul_f32 v75, v75, v27
  v_exp_f32 v72, -v72
  v_exp_f32 v73, -v73
  v_exp_f32 v74, -v74
  v_exp_f32 v75, -v75
  v_fma_f32 v72, v72, s73, s73
  v_fma_f32 v73, v73, s73, s73
  v_fma_f32 v74, v74, s73, s73
  v_fma_f32 v75, v75, s73, s73
  v_rcp_f32 v72, v72
  v_rcp_f32 v73, v73
  v_rcp_f32 v74, v74
  s_add_u32 s74, s35, 0
  buffer_store_dwordx4 v[80:83], v12, s[16:19], s74 offen sc1
  ds_write_b128 v106, v[80:83] offset:0
  s_setprio 1
  s_waitcnt lgkmcnt(7)
  v_mfma_f32_32x32x16_bf16 v[32:47], v[48:51], v[160:163], v[32:47]
  ds_read_b64_tr_b16 v[64:65], v6 offset:24576
  ds_read_b64_tr_b16 v[66:67], v6 offset:25088
  s_waitcnt lgkmcnt(7)
  v_mfma_f32_32x32x16_bf16 v[32:47], v[52:55], v[164:167], v[32:47]
  ds_read_b64_tr_b16 v[68:69], v6 offset:26624
  ds_read_b64_tr_b16 v[70:71], v6 offset:27136
  s_waitcnt lgkmcnt(7)
  v_mfma_f32_32x32x16_bf16 v[32:47], v[56:59], v[168:171], v[32:47]
  ds_read_b64_tr_b16 v[48:49], v6 offset:28672
  ds_read_b64_tr_b16 v[50:51], v6 offset:29184
  s_waitcnt lgkmcnt(7)
  v_mfma_f32_32x32x16_bf16 v[32:47], v[60:63], v[172:175], v[32:47]
  ds_read_b64_tr_b16 v[52:53], v6 offset:30720
  ds_read_b64_tr_b16 v[54:55], v6 offset:31232
  s_waitcnt lgkmcnt(6)
  v_mfma_f32_32x32x16_bf16 v[32:47], v[64:67], v[176:179], v[32:47]
  ds_read_b64_tr_b16 v[56:57], v6 offset:32768
  ds_read_b64_tr_b16 v[58:59], v6 offset:33280
  s_waitcnt lgkmcnt(6)
  v_mfma_f32_32x32x16_bf16 v[32:47], v[68:71], v[180:183], v[32:47]
  ds_read_b64_tr_b16 v[60:61], v6 offset:34816
  ds_read_b64_tr_b16 v[62:63], v6 offset:35328
  s_waitcnt lgkmcnt(6)
  v_mfma_f32_32x32x16_bf16 v[32:47], v[48:51], v[184:187], v[32:47]
  ds_read_b64_tr_b16 v[64:65], v6 offset:36864
  ds_read_b64_tr_b16 v[66:67], v6 offset:37376
  s_waitcnt lgkmcnt(6)
  v_mfma_f32_32x32x16_bf16 v[32:47], v[52:55], v[188:191], v[32:47]
  ds_read_b64_tr_b16 v[68:69], v6 offset:38912
  ds_read_b64_tr_b16 v[70:71], v6 offset:39424
  s_waitcnt lgkmcnt(6)
  v_mfma_f32_32x32x16_bf16 v[32:47], v[56:59], v[192:195], v[32:47]
  ds_read_b64_tr_b16 v[48:49], v6 offset:40960
  ds_read_b64_tr_b16 v[50:51], v6 offset:41472
  s_waitcnt lgkmcnt(6)
  v_mfma_f32_32x32x16_bf16 v[32:47], v[60:63], v[196:199], v[32:47]
  ds_read_b64_tr_b16 v[52:53], v6 offset:43008
  ds_read_b64_tr_b16 v[54:55], v6 offset:43520
  s_waitcnt lgkmcnt(6)
  v_mfma_f32_32x32x16_bf16 v[32:47], v[64:67], v[200:203], v[32:47]
  ds_read_b64_tr_b16 v[56:57], v6 offset:45056
  ds_read_b64_tr_b16 v[58:59], v6 offset:45568
  s_waitcnt lgkmcnt(6)
  v_mfma_f32_32x32x16_bf16 v[32:47], v[68:71], v[204:207], v[32:47]
  ds_read_b64_tr_b16 v[60:61], v6 offset:47104
  ds_read_b64_tr_b16 v[62:63], v6 offset:47616
  s_setprio 0
  s_waitcnt vmcnt(8)
  s_barrier
  s_add_u32 m0, s67, 32768
  s_add_u32 s74, s30, 4718592
  buffer_load_dwordx4 v3, s[8:11], s74 offen lds
  s_add_u32 m0, s67, 98304
  s_add_u32 s74, s31, 0
  buffer_load_dwordx4 v3, s[8:11], s74 offen lds
  s_add_u32 m0, s67, 40960
  s_add_u32 s74, s31, 589824
  buffer_load_dwordx4 v3, s[8:11], s74 offen lds
  v_rcp_f32 v75, v75
  v_mul_f32 v72, v72, v24
  v_mul_f32 v73, v73, v25
  v_mul_f32 v74, v74, v26
  v_mul_f32 v75, v75, v27
  v_cvt_pk_bf16_f32 v84, v72, v73
  v_cvt_pk_bf16_f32 v85, v74, v75
  v_fma_f32 v72, v28, v28, s72
  v_fma_f32 v73, v29, v29, s72
  v_fma_f32 v74, v30, v30, s72
  v_fma_f32 v75, v31, v31, s72
  v_mul_f32 v72, v72, v28
  v_mul_f32 v73, v73, v29
  v_mul_f32 v74, v74, v30
  v_mul_f32 v75, v75, v31
  v_exp_f32 v72, -v72
  v_exp_f32 v73, -v73
  v_exp_f32 v74, -v74
  v_exp_f32 v75, -v75
  v_fma_f32 v72, v72, s73, s73
  v_fma_f32 v73, v73, s73, s73
  v_fma_f32 v74, v74, s73, s73
  v_fma_f32 v75, v75, s73, s73
  v_rcp_f32 v72, v72
  v_rcp_f32 v73, v73
  v_rcp_f32 v74, v74
  v_rcp_f32 v75, v75
  v_mul_f32 v72, v72, v28
  v_mul_f32 v73, v73, v29
  v_mul_f32 v74, v74, v30
  v_mul_f32 v75, v75, v31
  v_cvt_pk_bf16_f32 v86, v72, v73
  v_cvt_pk_bf16_f32 v87, v74, v75
  s_add_u32 s74, s35, 4096
  buffer_store_dwordx4 v[84:87], v12, s[16:19], s74 offen sc1
  ds_write_b128 v106, v[84:87] offset:4096
  s_branch L_pj9
  .p2align 12
L_stub9:
  s_setpc_b64 s[58:59]
  s_nop 0
L_pj9:
  s_setprio 1
  s_waitcnt lgkmcnt(7)
  v_mfma_f32_32x32x16_bf16 v[32:47], v[48:51], v[208:211], v[32:47]
  ds_read_b64_tr_b16 v[64:65], v6 offset:49152
  ds_read_b64_tr_b16 v[66:67], v6 offset:49664
  s_waitcnt lgkmcnt(7)
  v_mfma_f32_32x32x16_bf16 v[32:47], v[52:55], v[212:215], v[32:47]
  ds_read_b64_tr_b16 v[68:69], v6 offset:51200
  ds_read_b64_tr_b16 v[70:71], v6 offset:51712
  s_waitcnt lgkmcnt(7)
  v_mfma_f32_32x32x16_bf16 v[32:47], v[56:59], v[216:219], v[32:47]
  ds_read_b64_tr_b16 v[48:49], v6 offset:53248
  ds_read_b64_tr_b16 v[50:51], v6 offset:53760
  s_waitcnt lgkmcnt(7)
  v_mfma_f32_32x32x16_bf16 v[32:47], v[60:63], v[220:223], v[32:47]
  ds_read_b64_tr_b16 v[52:53], v6 offset:55296
  ds_read_b64_tr_b16 v[54:55], v6 offset:55808
  s_waitcnt lgkmcnt(6)
  v_mfma_f32_32x32x16_bf16 v[32:47], v[64:67], v[224:227], v[32:47]
  ds_read_b64_tr_b16 v[56:57], v6 offset:57344
  ds_read_b64_tr_b16 v[58:59], v6 offset:57856
  s_waitcnt lgkmcnt(6)
  v_mfma_f32_32x32x16_bf16 v[32:47], v[68:71], v[228:231], v[32:47]
  ds_read_b64_tr_b16 v[60:61], v6 offset:59392
  ds_read_b64_tr_b16 v[62:63], v6 offset:59904
  s_waitcnt lgkmcnt(6)
  v_mfma_f32_32x32x16_bf16 v[32:47], v[48:51], v[232:235], v[32:47]
  ds_read_b64_tr_b16 v[64:65], v6 offset:61440
  ds_read_b64_tr_b16 v[66:67], v6 offset:61952
  s_waitcnt lgkmcnt(6)
  v_mfma_f32_32x32x16_bf16 v[32:47], v[52:55], v[236:239], v[32:47]
  ds_read_b64_tr_b16 v[68:69], v6 offset:63488
  ds_read_b64_tr_b16 v[70:71], v6 offset:64000
  s_waitcnt lgkmcnt(6)
  v_mfma_f32_32x32x16_bf16 v[32:47], v[56:59], v[240:243], v[32:47]
  ds_read_b64_tr_b16 v[48:49], v7 offset:0
  ds_read_b64_tr_b16 v[50:51], v7 offset:512
  s_waitcnt lgkmcnt(6)
  v_mfma_f32_32x32x16_bf16 v[32:47], v[60:63], v[244:247], v[32:47]
  ds_read_b64_tr_b16 v[52:53], v7 offset:2048
  ds_read_b64_tr_b16 v[54:55], v7 offset:2560
  s_waitcnt lgkmcnt(6)
  v_mfma_f32_32x32x16_bf16 v[32:47], v[64:67], v[248:251], v[32:47]
  ds_read_b64_tr_b16 v[56:57], v7 offset:4096
  ds_read_b64_tr_b16 v[58:59], v7 offset:4608
  s_waitcnt lgkmcnt(6)
  v_mfma_f32_32x32x16_bf16 v[32:47], v[68:71], v[252:255], v[32:47]
  ds_read_b64_tr_b16 v[60:61], v7 offset:6144
  ds_read_b64_tr_b16 v[62:63], v7 offset:6656
  s_setprio 0
  s_waitcnt vmcnt(9)
  s_barrier
  s_add_u32 m0, s67, 106496
  s_add_u32 s74, s31, 1179648
  buffer_load_dwordx4 v3, s[8:11], s74 offen lds
  s_add_u32 m0, s67, 57344
  s_add_u32 s74, s31, 1769472
  buffer_load_dwordx4 v3, s[8:11], s74 offen lds
  s_add_u32 m0, s67, 49152
  s_add_u32 s74, s31, 2359296
  buffer_load_dwordx4 v3, s[8:11], s74 offen lds
  s_add_u32 m0, s67, 114688
  s_add_u32 s74, s31, 2949120
  buffer_load_dwordx4 v3, s[8:11], s74 offen lds
  v_fma_f32 v72, v32, v32, s72
  v_fma_f32 v73, v33, v33, s72
  v_fma_f32 v74, v34, v34, s72
  v_fma_f32 v75, v35, v35, s72
  v_mul_f32 v72, v72, v32
  v_mul_f32 v73, v73, v33
  v_mul_f32 v74, v74, v34
  v_mul_f32 v75, v75, v35
  v_exp_f32 v72, -v72
  v_exp_f32 v73, -v73
  v_exp_f32 v74, -v74
  v_exp_f32 v75, -v75
  v_fma_f32 v72, v72, s73, s73
  v_fma_f32 v73, v73, s73, s73
  v_fma_f32 v74, v74, s73, s73
  v_fma_f32 v75, v75, s73, s73
  v_rcp_f32 v72, v72
  v_rcp_f32 v73, v73
  v_rcp_f32 v74, v74
  v_rcp_f32 v75, v75
  v_mul_f32 v72, v72, v32
  v_mul_f32 v73, v73, v33
  v_mul_f32 v74, v74, v34
  v_mul_f32 v75, v75, v35
  v_cvt_pk_bf16_f32 v80, v72, v73
  v_cvt_pk_bf16_f32 v81, v74, v75
  v_fma_f32 v72, v36, v36, s72
  v_fma_f32 v73, v37, v37, s72
  v_fma_f32 v74, v38, v38, s72
  v_fma_f32 v75, v39, v39, s72
  v_mul_f32 v72, v72, v36
  v_mul_f32 v73, v73, v37
  v_mul_f32 v74, v74, v38
  v_mul_f32 v75, v75, v39
  v_exp_f32 v72, -v72
  v_exp_f32 v73, -v73
  v_exp_f32 v74, -v74
  v_exp_f32 v75, -v75
  v_fma_f32 v72, v72, s73, s73
  v_fma_f32 v73, v73, s73, s73
  s_setprio 1
  v_mfma_f32_32x32x16_bf16 v[16:31], v[88:91], v[92:95], 0
  s_waitcnt lgkmcnt(6)
  v_mfma_f32_32x32x16_bf16 v[16:31], v[48:51], v[112:115], v[16:31]
  ds_read_b64_tr_b16 v[64:65], v7 offset:8192
  ds_read_b64_tr_b16 v[66:67], v7 offset:8704
  s_waitcnt lgkmcnt(6)
  v_mfma_f32_32x32x16_bf16 v[16:31], v[52:55], v[116:119], v[16:31]
  ds_read_b64_tr_b16 v[68:69], v7 offset:10240
  ds_read_b64_tr_b16 v[70:71], v7 offset:10752
  s_waitcnt lgkmcnt(6)
  v_mfma_f32_32x32x16_bf16 v[16:31], v[56:59], v[120:123], v[16:31]
  ds_read_b64_tr_b16 v[48:49], v7 offset:12288
  ds_read_b64_tr_b16 v[50:51], v7 offset:12800
  s_waitcnt lgkmcnt(6)
  v_mfma_f32_32x32x16_bf16 v[16:31], v[60:63], v[124:127], v[16:31]
  ds_read_b64_tr_b16 v[52:53], v7 offset:14336
  ds_read_b64_tr_b16 v[54:55], v7 offset:14848
  s_waitcnt lgkmcnt(6)
  v_mfma_f32_32x32x16_bf16 v[16:31], v[64:67], v[128:131], v[16:31]
  ds_read_b64_tr_b16 v[56:57], v7 offset:16384
  ds_read_b64_tr_b16 v[58:59], v7 offset:16896
  s_waitcnt lgkmcnt(6)
  v_mfma_f32_32x32x16_bf16 v[16:31], v[68:71], v[132:135], v[16:31]
  ds_read_b64_tr_b16 v[60:61], v7 offset:18432
  ds_read_b64_tr_b16 v[62:63], v7 offset:18944
  s_waitcnt lgkmcnt(6)
  v_mfma_f32_32x32x16_bf16 v[16:31], v[48:51], v[136:139], v[16:31]
  ds_read_b64_tr_b16 v[64:65], v7 offset:20480
  ds_read_b64_tr_b16 v[66:67], v7 offset:20992
  s_waitcnt lgkmcnt(6)
  v_mfma_f32_32x32x16_bf16 v[16:31], v[52:55], v[140:143], v[16:31]
  ds_read_b64_tr_b16 v[68:69], v7 offset:22528
  ds_read_b64_tr_b16 v[70:71], v7 offset:23040
  s_waitcnt lgkmcnt(6)
  v_mfma_f32_32x32x16_bf16 v[16:31], v[56:59], v[144:147], v[16:31]
  ds_read_b64_tr_b16 v[48:49], v7 offset:24576
  ds_read_b64_tr_b16 v[50:51], v7 offset:25088
  s_waitcnt lgkmcnt(6)
  v_mfma_f32_32x32x16_bf16 v[16:31], v[60:63], v[148:151], v[16:31]
  ds_read_b64_tr_b16 v[52:53], v7 offset:26624
  ds_read_b64_tr_b16 v[54:55], v7 offset:27136
  s_waitcnt lgkmcnt(6)
  v_mfma_f32_32x32x16_bf16 v[16:31], v[64:67], v[152:155], v[16:31]
  ds_read_b64_tr_b16 v[56:57], v7 offset:28672
  ds_read_b64_tr_b16 v[58:59], v7 offset:29184
  s_waitcnt lgkmcnt(6)
  v_mfma_f32_32x32x16_bf16 v[16:31], v[68:71], v[156:159], v[16:31]
  ds_read_b64_tr_b16 v[60:61], v7 offset:30720
  ds_read_b64_tr_b16 v[62:63], v7 offset:31232
  s_setprio 0
  s_waitcnt vmcnt(10)
  s_barrier
  s_add_u32 m0, s67, 147456
  s_add_u32 s74, s31, 3538944
  buffer_load_dwordx4 v3, s[8:11], s74 offen lds
  s_add_u32 m0, s67, 139264
  s_add_u32 s74, s31, 4128768
  buffer_load_dwordx4 v3, s[8:11], s74 offen lds
  s_add_u32 m0, s67, 131072
  s_add_u32 s74, s31, 4718592
  buffer_load_dwordx4 v3, s[8:11], s74 offen lds
  s_add_u32 m0, s67, 122880
  s_add_u32 s74, s32, 0
  buffer_load_dwordx4 v3, s[8:11], s74 offen lds
  v_mov_b32 v88, v99
  v_fma_f32 v74, v74, s73, s73
  v_fma_f32 v75, v75, s73, s73
  v_rcp_f32 v72, v72
  v_rcp_f32 v73, v73
  v_rcp_f32 v74, v74
  v_rcp_f32 v75, v75
  v_mul_f32 v72, v72, v36
  v_mul_f32 v73, v73, v37
  v_mul_f32 v74, v74, v38
  v_mul_f32 v75, v75, v39
  v_cvt_pk_bf16_f32 v82, v72, v73
  v_cvt_pk_bf16_f32 v83, v74, v75
  v_fma_f32 v72, v40, v40, s72
  v_fma_f32 v73, v41, v41, s72
  v_fma_f32 v74, v42, v42, s72
  v_fma_f32 v75, v43, v43, s72
  v_mul_f32 v72, v72, v40
  v_mul_f32 v73, v73, v41
  v_mul_f32 v74, v74, v42
  v_mul_f32 v75, v75, v43
  v_exp_f32 v72, -v72
  v_exp_f32 v73, -v73
  v_exp_f32 v74, -v74
  v_exp_f32 v75, -v75
  v_fma_f32 v72, v72, s73, s73
  v_fma_f32 v73, v73, s73, s73
  v_fma_f32 v74, v74, s73, s73
  v_fma_f32 v75, v75, s73, s73
  v_rcp_f32 v72, v72
  v_rcp_f32 v73, v73
  v_rcp_f32 v74, v74
  s_add_u32 s74, s35, 16384
  buffer_store_dwordx4 v[80:83], v12, s[16:19], s74 offen sc1
  ds_write_b128 v106, v[80:83] offset:16384
  s_setprio 1
  s_waitcnt lgkmcnt(7)
  v_mfma_f32_32x32x16_bf16 v[16:31], v[48:51], v[160:163], v[16:31]
  ds_read_b64_tr_b16 v[64:65], v5 offset:0
  ds_read_b64_tr_b16 v[66:67], v5 offset:512
  s_waitcnt lgkmcnt(7)
  v_mfma_f32_32x32x16_bf16 v[16:31], v[52:55], v[164:167], v[16:31]
  ds_read_b64_tr_b16 v[68:69], v5 offset:2048
  ds_read_b64_tr_b16 v[70:71], v5 offset:2560
  s_waitcnt lgkmcnt(7)
  v_mfma_f32_32x32x16_bf16 v[16:31], v[56:59], v[168:171], v[16:31]
  ds_read_b64_tr_b16 v[48:49], v5 offset:4096
  ds_read_b64_tr_b16 v[50:51], v5 offset:4608
  s_waitcnt lgkmcnt(7)
  v_mfma_f32_32x32x16_bf16 v[16:31], v[60:63], v[172:175], v[16:31]
  ds_read_b64_tr_b16 v[52:53], v5 offset:6144
  ds_read_b64_tr_b16 v[54:55], v5 offset:6656
  s_waitcnt lgkmcnt(6)
  v_mfma_f32_32x32x16_bf16 v[16:31], v[64:67], v[176:179], v[16:31]
  ds_read_b64_tr_b16 v[56:57], v5 offset:8192
  ds_read_b64_tr_b16 v[58:59], v5 offset:8704
  s_waitcnt lgkmcnt(6)
  v_mfma_f32_32x32x16_bf16 v[16:31], v[68:71], v[180:183], v[16:31]
  ds_read_b64_tr_b16 v[60:61], v5 offset:10240
  ds_read_b64_tr_b16 v[62:63], v5 offset:10752
  s_waitcnt lgkmcnt(6)
  v_mfma_f32_32x32x16_bf16 v[16:31], v[48:51], v[184:187], v[16:31]
  ds_read_b64_tr_b16 v[64:65], v5 offset:12288
  ds_read_b64_tr_b16 v[66:67], v5 offset:12800
  s_waitcnt lgkmcnt(6)
  v_mfma_f32_32x32x16_bf16 v[16:31], v[52:55], v[188:191], v[16:31]
  ds_read_b64_tr_b16 v[68:69], v5 offset:14336
  ds_read_b64_tr_b16 v[70:71], v5 offset:14848
  s_waitcnt lgkmcnt(6)
  v_mfma_f32_32x32x16_bf16 v[16:31], v[56:59], v[192:195], v[16:31]
  ds_read_b64_tr_b16 v[48:49], v5 offset:16384
  ds_read_b64_tr_b16 v[50:51], v5 offset:16896
  s_waitcnt lgkmcnt(6)
  v_mfma_f32_32x32x16_bf16 v[16:31], v[60:63], v[196:199], v[16:31]
  ds_read_b64_tr_b16 v[52:53], v5 offset:18432
  ds_read_b64_tr_b16 v[54:55], v5 offset:18944
  s_waitcnt lgkmcnt(6)
  v_mfma_f32_32x32x16_bf16 v[16:31], v[64:67], v[200:203], v[16:31]
  ds_read_b64_tr_b16 v[56:57], v5 offset:20480
  ds_read_b64_tr_b16 v[58:59], v5 offset:20992
  s_waitcnt lgkmcnt(6)
  v_mfma_f32_32x32x16_bf16 v[16:31], v[68:71], v[204:207], v[16:31]
  ds_read_b64_tr_b16 v[60:61], v5 offset:22528
  ds_read_b64_tr_b16 v[62:63], v5 offset:23040
  s_setprio 0
  s_waitcnt vmcnt(11)
  s_barrier
  s_add_u32 m0, s67, 155648
  s_add_u32 s74, s32, 589824
  buffer_load_dwordx4 v3, s[8:11], s74 offen lds
  s_add_u32 m0, s67, 8192
  s_add_u32 s74, s32, 1179648
  buffer_load_dwordx4 v3, s[8:11], s74 offen lds
  v_rcp_f32 v75, v75
  v_mul_f32 v72, v72, v40
  v_mul_f32 v73, v73, v41
  v_mul_f32 v74, v74, v42
  v_mul_f32 v75, v75, v43
  v_cvt_pk_bf16_f32 v84, v72, v73
  v_cvt_pk_bf16_f32 v85, v74, v75
  v_fma_f32 v72, v44, v44, s72
  v_fma_f32 v73, v45, v45, s72
  v_fma_f32 v74, v46, v46, s72
  v_fma_f32 v75, v47, v47, s72
  v_mul_f32 v72, v72, v44
  v_mul_f32 v73, v73, v45
  v_mul_f32 v74, v74, v46
  v_mul_f32 v75, v75, v47
  v_exp_f32 v72, -v72
  v_exp_f32 v73, -v73
  v_exp_f32 v74, -v74
  v_exp_f32 v75, -v75
  v_fma_f32 v72, v72, s73, s73
  v_fma_f32 v73, v73, s73, s73
  v_fma_f32 v74, v74, s73, s73
  v_fma_f32 v75, v75, s73, s73
  v_rcp_f32 v72, v72
  v_rcp_f32 v73, v73
  v_rcp_f32 v74, v74
  v_rcp_f32 v75, v75
  v_mul_f32 v72, v72, v44
  v_mul_f32 v73, v73, v45
  v_mul_f32 v74, v74, v46
  v_mul_f32 v75, v75, v47
  v_cvt_pk_bf16_f32 v86, v72, v73
  v_cvt_pk_bf16_f32 v87, v74, v75
  s_add_u32 s74, s35, 20480
  buffer_store_dwordx4 v[84:87], v12, s[16:19], s74 offen sc1
  ds_write_b128 v106, v[84:87] offset:20480
  s_setprio 1
  s_waitcnt lgkmcnt(7)
  v_mfma_f32_32x32x16_bf16 v[16:31], v[48:51], v[208:211], v[16:31]
  ds_read_b64_tr_b16 v[64:65], v5 offset:24576
  ds_read_b64_tr_b16 v[66:67], v5 offset:25088
  s_waitcnt lgkmcnt(7)
  v_mfma_f32_32x32x16_bf16 v[16:31], v[52:55], v[212:215], v[16:31]
  ds_read_b64_tr_b16 v[68:69], v5 offset:26624
  ds_read_b64_tr_b16 v[70:71], v5 offset:27136
  s_waitcnt lgkmcnt(7)
  v_mfma_f32_32x32x16_bf16 v[16:31], v[56:59], v[216:219], v[16:31]
  ds_read_b64_tr_b16 v[48:49], v5 offset:28672
  ds_read_b64_tr_b16 v[50:51], v5 offset:29184
  s_waitcnt lgkmcnt(7)
  v_mfma_f32_32x32x16_bf16 v[16:31], v[60:63], v[220:223], v[16:31]
  ds_read_b64_tr_b16 v[52:53], v5 offset:30720
  ds_read_b64_tr_b16 v[54:55], v5 offset:31232
  s_waitcnt lgkmcnt(6)
  v_mfma_f32_32x32x16_bf16 v[16:31], v[64:67], v[224:227], v[16:31]
  ds_read_b64_tr_b16 v[56:57], v5 offset:32768
  ds_read_b64_tr_b16 v[58:59], v5 offset:33280
  s_waitcnt lgkmcnt(6)
  v_mfma_f32_32x32x16_bf16 v[16:31], v[68:71], v[228:231], v[16:31]
  ds_read_b64_tr_b16 v[60:61], v5 offset:34816
  ds_read_b64_tr_b16 v[62:63], v5 offset:35328
  s_waitcnt lgkmcnt(6)
  v_mfma_f32_32x32x16_bf16 v[16:31], v[48:51], v[232:235], v[16:31]
  ds_read_b64_tr_b16 v[64:65], v5 offset:36864
  ds_read_b64_tr_b16 v[66:67], v5 offset:37376
  s_waitcnt lgkmcnt(6)
  v_mfma_f32_32x32x16_bf16 v[16:31], v[52:55], v[236:239], v[16:31]
  ds_read_b64_tr_b16 v[68:69], v5 offset:38912
  ds_read_b64_tr_b16 v[70:71], v5 offset:39424
  s_waitcnt lgkmcnt(6)
  v_mfma_f32_32x32x16_bf16 v[16:31], v[56:59], v[240:243], v[16:31]
  ds_read_b64_tr_b16 v[48:49], v6 offset:32768
  ds_read_b64_tr_b16 v[50:51], v6 offset:33280
  s_waitcnt lgkmcnt(6)
  v_mfma_f32_32x32x16_bf16 v[16:31], v[60:63], v[244:247], v[16:31]
  ds_read_b64_tr_b16 v[52:53], v6 offset:34816
  ds_read_b64_tr_b16 v[54:55], v6 offset:35328
  s_waitcnt lgkmcnt(6)
  v_mfma_f32_32x32x16_bf16 v[16:31], v[64:67], v[248:251], v[16:31]
  ds_read_b64_tr_b16 v[56:57], v6 offset:36864
  ds_read_b64_tr_b16 v[58:59], v6 offset:37376
  s_waitcnt lgkmcnt(6)
  v_mfma_f32_32x32x16_bf16 v[16:31], v[68:71], v[252:255], v[16:31]
  ds_read_b64_tr_b16 v[60:61], v6 offset:38912
  ds_read_b64_tr_b16 v[62:63], v6 offset:39424
  s_setprio 0
  s_waitcnt vmcnt(10)
  s_barrier
  s_add_u32 m0, s67, 0
  s_add_u32 s74, s32, 1769472
  buffer_load_dwordx4 v3, s[8:11], s74 offen lds
  s_add_u32 m0, s67, 16384
  s_add_u32 s74, s32, 2359296
  buffer_load_dwordx4 v3, s[8:11], s74 offen lds
  s_add_u32 m0, s67, 24576
  s_add_u32 s74, s32, 2949120
  buffer_load_dwordx4 v3, s[8:11], s74 offen lds
  s_add_u32 m0, s67, 32768
  s_add_u32 s74, s32, 3538944
  buffer_load_dwordx4 v3, s[8:11], s74 offen lds
  v_fma_f32 v72, v16, v16, s72
  v_fma_f32 v73, v17, v17, s72
  v_fma_f32 v74, v18, v18, s72
  v_fma_f32 v75, v19, v19, s72
  v_mul_f32 v72, v72, v16
  v_mul_f32 v73, v73, v17
  v_mul_f32 v74, v74, v18
  v_mul_f32 v75, v75, v19
  v_exp_f32 v72, -v72
  v_exp_f32 v73, -v73
  v_exp_f32 v74, -v74
  v_exp_f32 v75, -v75
  v_fma_f32 v72, v72, s73, s73
  v_fma_f32 v73, v73, s73, s73
  v_fma_f32 v74, v74, s73, s73
  v_fma_f32 v75, v75, s73, s73
  v_rcp_f32 v72, v72
  v_rcp_f32 v73, v73
  v_rcp_f32 v74, v74
  v_rcp_f32 v75, v75
  v_mul_f32 v72, v72, v16
  v_mul_f32 v73, v73, v17
  v_mul_f32 v74, v74, v18
  v_mul_f32 v75, v75, v19
  v_cvt_pk_bf16_f32 v80, v72, v73
  v_cvt_pk_bf16_f32 v81, v74, v75
  v_fma_f32 v72, v20, v20, s72
  v_fma_f32 v73, v21, v21, s72
  v_fma_f32 v74, v22, v22, s72
  v_fma_f32 v75, v23, v23, s72
  v_mul_f32 v72, v72, v20
  v_mul_f32 v73, v73, v21
  v_mul_f32 v74, v74, v22
  v_mul_f32 v75, v75, v23
  v_exp_f32 v72, -v72
  v_exp_f32 v73, -v73
  v_exp_f32 v74, -v74
  v_exp_f32 v75, -v75
  v_fma_f32 v72, v72, s73, s73
  v_fma_f32 v73, v73, s73, s73
  s_setprio 1
  v_mfma_f32_32x32x16_bf16 v[32:47], v[88:91], v[92:95], 0
  s_waitcnt lgkmcnt(6)
  v_mfma_f32_32x32x16_bf16 v[32:47], v[48:51], v[112:115], v[32:47]
  ds_read_b64_tr_b16 v[64:65], v5 offset:40960
  ds_read_b64_tr_b16 v[66:67], v5 offset:41472
  s_waitcnt lgkmcnt(6)
  v_mfma_f32_32x32x16_bf16 v[32:47], v[52:55], v[116:119], v[32:47]
  ds_read_b64_tr_b16 v[68:69], v5 offset:43008
  ds_read_b64_tr_b16 v[70:71], v5 offset:43520
  s_waitcnt lgkmcnt(6)
  v_mfma_f32_32x32x16_bf16 v[32:47], v[56:59], v[120:123], v[32:47]
  ds_read_b64_tr_b16 v[48:49], v5 offset:45056
  ds_read_b64_tr_b16 v[50:51], v5 offset:45568
  s_waitcnt lgkmcnt(6)
  v_mfma_f32_32x32x16_bf16 v[32:47], v[60:63], v[124:127], v[32:47]
  ds_read_b64_tr_b16 v[52:53], v5 offset:47104
  ds_read_b64_tr_b16 v[54:55], v5 offset:47616
  s_waitcnt lgkmcnt(6)
  v_mfma_f32_32x32x16_bf16 v[32:47], v[64:67], v[128:131], v[32:47]
  ds_read_b64_tr_b16 v[56:57], v6 offset:40960
  ds_read_b64_tr_b16 v[58:59], v6 offset:41472
  s_waitcnt lgkmcnt(6)
  v_mfma_f32_32x32x16_bf16 v[32:47], v[68:71], v[132:135], v[32:47]
  ds_read_b64_tr_b16 v[60:61], v6 offset:43008
  ds_read_b64_tr_b16 v[62:63], v6 offset:43520
  s_waitcnt lgkmcnt(6)
  v_mfma_f32_32x32x16_bf16 v[32:47], v[48:51], v[136:139], v[32:47]
  ds_read_b64_tr_b16 v[64:65], v6 offset:45056
  ds_read_b64_tr_b16 v[66:67], v6 offset:45568
  s_waitcnt lgkmcnt(6)
  v_mfma_f32_32x32x16_bf16 v[32:47], v[52:55], v[140:143], v[32:47]
  ds_read_b64_tr_b16 v[68:69], v6 offset:47104
  ds_read_b64_tr_b16 v[70:71], v6 offset:47616
  s_waitcnt lgkmcnt(6)
  v_mfma_f32_32x32x16_bf16 v[32:47], v[56:59], v[144:147], v[32:47]
  ds_read_b64_tr_b16 v[48:49], v5 offset:57344
  ds_read_b64_tr_b16 v[50:51], v5 offset:57856
  s_waitcnt lgkmcnt(6)
  v_mfma_f32_32x32x16_bf16 v[32:47], v[60:63], v[148:151], v[32:47]
  ds_read_b64_tr_b16 v[52:53], v5 offset:59392
  ds_read_b64_tr_b16 v[54:55], v5 offset:59904
  s_waitcnt lgkmcnt(6)
  v_mfma_f32_32x32x16_bf16 v[32:47], v[64:67], v[152:155], v[32:47]
  ds_read_b64_tr_b16 v[56:57], v5 offset:61440
  ds_read_b64_tr_b16 v[58:59], v5 offset:61952
  s_waitcnt lgkmcnt(6)
  v_mfma_f32_32x32x16_bf16 v[32:47], v[68:71], v[156:159], v[32:47]
  ds_read_b64_tr_b16 v[60:61], v5 offset:63488
  ds_read_b64_tr_b16 v[62:63], v5 offset:64000
  s_setprio 0
  s_waitcnt vmcnt(11)
  s_barrier
  s_add_u32 m0, s67, 40960
  s_add_u32 s74, s32, 4128768
  buffer_load_dwordx4 v3, s[8:11], s74 offen lds
  v_mov_b32 v88, v100
  v_fma_f32 v74, v74, s73, s73
  v_fma_f32 v75, v75, s73, s73
  v_rcp_f32 v72, v72
  v_rcp_f32 v73, v73
  v_rcp_f32 v74, v74
  v_rcp_f32 v75, v75
  v_mul_f32 v72, v72, v20
  v_mul_f32 v73, v73, v21
  v_mul_f32 v74, v74, v22
  v_mul_f32 v75, v75, v23
  v_cvt_pk_bf16_f32 v82, v72, v73
  v_cvt_pk_bf16_f32 v83, v74, v75
  v_fma_f32 v72, v24, v24, s72
  v_fma_f32 v73, v25, v25, s72
  v_fma_f32 v74, v26, v26, s72
  v_fma_f32 v75, v27, v27, s72
  v_mul_f32 v72, v72, v24
  v_mul_f32 v73, v73, v25
  v_mul_f32 v74, v74, v26
  v_mul_f32 v75, v75, v27
  v_exp_f32 v72, -v72
  v_exp_f32 v73, -v73
  v_exp_f32 v74, -v74
  v_exp_f32 v75, -v75
  v_fma_f32 v72, v72, s73, s73
  v_fma_f32 v73, v73, s73, s73
  v_fma_f32 v74, v74, s73, s73
  v_fma_f32 v75, v75, s73, s73
  v_rcp_f32 v72, v72
  v_rcp_f32 v73, v73
  v_rcp_f32 v74, v74
  s_add_u32 s74, s35, 32768
  buffer_store_dwordx4 v[80:83], v12, s[16:19], s74 offen sc1
  ds_write_b128 v106, v[80:83] offset:32768
  s_setprio 1
  s_waitcnt lgkmcnt(7)
  v_mfma_f32_32x32x16_bf16 v[32:47], v[48:51], v[160:163], v[32:47]
  ds_read_b64_tr_b16 v[64:65], v5 offset:49152
  ds_read_b64_tr_b16 v[66:67], v5 offset:49664
  s_waitcnt lgkmcnt(7)
  v_mfma_f32_32x32x16_bf16 v[32:47], v[52:55], v[164:167], v[32:47]
  ds_read_b64_tr_b16 v[68:69], v5 offset:51200
  ds_read_b64_tr_b16 v[70:71], v5 offset:51712
  s_waitcnt lgkmcnt(7)
  v_mfma_f32_32x32x16_bf16 v[32:47], v[56:59], v[168:171], v[32:47]
  ds_read_b64_tr_b16 v[48:49], v5 offset:53248
  ds_read_b64_tr_b16 v[50:51], v5 offset:53760
  s_waitcnt lgkmcnt(7)
  v_mfma_f32_32x32x16_bf16 v[32:47], v[60:63], v[172:175], v[32:47]
  ds_read_b64_tr_b16 v[52:53], v5 offset:55296
  ds_read_b64_tr_b16 v[54:55], v5 offset:55808
  s_waitcnt lgkmcnt(6)
  v_mfma_f32_32x32x16_bf16 v[32:47], v[64:67], v[176:179], v[32:47]
  ds_read_b64_tr_b16 v[56:57], v6 offset:49152
  ds_read_b64_tr_b16 v[58:59], v6 offset:49664
  s_waitcnt lgkmcnt(6)
  v_mfma_f32_32x32x16_bf16 v[32:47], v[68:71], v[180:183], v[32:47]
  ds_read_b64_tr_b16 v[60:61], v6 offset:51200
  ds_read_b64_tr_b16 v[62:63], v6 offset:51712
  s_waitcnt lgkmcnt(6)
  v_mfma_f32_32x32x16_bf16 v[32:47], v[48:51], v[184:187], v[32:47]
  ds_read_b64_tr_b16 v[64:65], v6 offset:53248
  ds_read_b64_tr_b16 v[66:67], v6 offset:53760
  s_waitcnt lgkmcnt(6)
  v_mfma_f32_32x32x16_bf16 v[32:47], v[52:55], v[188:191], v[32:47]
  ds_read_b64_tr_b16 v[68:69], v6 offset:55296
  ds_read_b64_tr_b16 v[70:71], v6 offset:55808
  s_waitcnt lgkmcnt(6)
  v_mfma_f32_32x32x16_bf16 v[32:47], v[56:59], v[192:195], v[32:47]
  ds_read_b64_tr_b16 v[48:49], v7 offset:16384
  ds_read_b64_tr_b16 v[50:51], v7 offset:16896
  s_waitcnt lgkmcnt(6)
  v_mfma_f32_32x32x16_bf16 v[32:47], v[60:63], v[196:199], v[32:47]
  ds_read_b64_tr_b16 v[52:53], v7 offset:18432
  ds_read_b64_tr_b16 v[54:55], v7 offset:18944
  s_waitcnt lgkmcnt(6)
  v_mfma_f32_32x32x16_bf16 v[32:47], v[64:67], v[200:203], v[32:47]
  ds_read_b64_tr_b16 v[56:57], v7 offset:20480
  ds_read_b64_tr_b16 v[58:59], v7 offset:20992
  s_waitcnt lgkmcnt(6)
  v_mfma_f32_32x32x16_bf16 v[32:47], v[68:71], v[204:207], v[32:47]
  ds_read_b64_tr_b16 v[60:61], v7 offset:22528
  ds_read_b64_tr_b16 v[62:63], v7 offset:23040
  s_setprio 0
  s_waitcnt vmcnt(10)
  s_barrier
  s_add_u32 m0, s67, 49152
  s_add_u32 s74, s32, 4718592
  buffer_load_dwordx4 v3, s[8:11], s74 offen lds
  s_add_u32 m0, s67, 57344
  s_add_u32 s74, s33, 0
  buffer_load_dwordx4 v3, s[8:11], s74 offen lds
  v_rcp_f32 v75, v75
  v_mul_f32 v72, v72, v24
  v_mul_f32 v73, v73, v25
  v_mul_f32 v74, v74, v26
  v_mul_f32 v75, v75, v27
  v_cvt_pk_bf16_f32 v84, v72, v73
  v_cvt_pk_bf16_f32 v85, v74, v75
  v_fma_f32 v72, v28, v28, s72
  v_fma_f32 v73, v29, v29, s72
  v_fma_f32 v74, v30, v30, s72
  v_fma_f32 v75, v31, v31, s72
  v_mul_f32 v72, v72, v28
  v_mul_f32 v73, v73, v29
  v_mul_f32 v74, v74, v30
  v_mul_f32 v75, v75, v31
  v_exp_f32 v72, -v72
  v_exp_f32 v73, -v73
  v_exp_f32 v74, -v74
  v_exp_f32 v75, -v75
  v_fma_f32 v72, v72, s73, s73
  v_fma_f32 v73, v73, s73, s73
  v_fma_f32 v74, v74, s73, s73
  v_fma_f32 v75, v75, s73, s73
  v_rcp_f32 v72, v72
  v_rcp_f32 v73, v73
  v_rcp_f32 v74, v74
  v_rcp_f32 v75, v75
  v_mul_f32 v72, v72, v28
  v_mul_f32 v73, v73, v29
  v_mul_f32 v74, v74, v30
  v_mul_f32 v75, v75, v31
  v_cvt_pk_bf16_f32 v86, v72, v73
  v_cvt_pk_bf16_f32 v87, v74, v75
  s_add_u32 s74, s35, 36864
  buffer_store_dwordx4 v[84:87], v12, s[16:19], s74 offen sc1
  ds_write_b128 v106, v[84:87] offset:36864
  s_branch L_pj10
  .p2align 12
L_stub10:
  s_setpc_b64 s[58:59]
  s_nop 0
L_pj10:
  s_setprio 1
  s_waitcnt lgkmcnt(7)
  v_mfma_f32_32x32x16_bf16 v[32:47], v[48:51], v[208:211], v[32:47]
  ds_read_b64_tr_b16 v[64:65], v7 offset:8192
  ds_read_b64_tr_b16 v[66:67], v7 offset:8704
  s_waitcnt lgkmcnt(7)
  v_mfma_f32_32x32x16_bf16 v[32:47], v[52:55], v[212:215], v[32:47]
  ds_read_b64_tr_b16 v[68:69], v7 offset:10240
  ds_read_b64_tr_b16 v[70:71], v7 offset:10752
  s_waitcnt lgkmcnt(7)
  v_mfma_f32_32x32x16_bf16 v[32:47], v[56:59], v[216:219], v[32:47]
  ds_read_b64_tr_b16 v[48:49], v7 offset:12288
  ds_read_b64_tr_b16 v[50:51], v7 offset:12800
  s_waitcnt lgkmcnt(7)
  v_mfma_f32_32x32x16_bf16 v[32:47], v[60:63], v[220:223], v[32:47]
  ds_read_b64_tr_b16 v[52:53], v7 offset:14336
  ds_read_b64_tr_b16 v[54:55], v7 offset:14848
  s_waitcnt lgkmcnt(6)
  v_mfma_f32_32x32x16_bf16 v[32:47], v[64:67], v[224:227], v[32:47]
  ds_read_b64_tr_b16 v[56:57], v7 offset:0
  ds_read_b64_tr_b16 v[58:59], v7 offset:512
  s_waitcnt lgkmcnt(6)
  v_mfma_f32_32x32x16_bf16 v[32:47], v[68:71], v[228:231], v[32:47]
  ds_read_b64_tr_b16 v[60:61], v7 offset:2048
  ds_read_b64_tr_b16 v[62:63], v7 offset:2560
  s_waitcnt lgkmcnt(6)
  v_mfma_f32_32x32x16_bf16 v[32:47], v[48:51], v[232:235], v[32:47]
  ds_read_b64_tr_b16 v[64:65], v7 offset:4096
  ds_read_b64_tr_b16 v[66:67], v7 offset:4608
  s_waitcnt lgkmcnt(6)
  v_mfma_f32_32x32x16_bf16 v[32:47], v[52:55], v[236:239], v[32:47]
  ds_read_b64_tr_b16 v[68:69], v7 offset:6144
  ds_read_b64_tr_b16 v[70:71], v7 offset:6656
  s_waitcnt lgkmcnt(6)
  v_mfma_f32_32x32x16_bf16 v[32:47], v[56:59], v[240:243], v[32:47]
  ds_read_b64_tr_b16 v[48:49], v6 offset:57344
  ds_read_b64_tr_b16 v[50:51], v6 offset:57856
  s_waitcnt lgkmcnt(6)
  v_mfma_f32_32x32x16_bf16 v[32:47], v[60:63], v[244:247], v[32:47]
  ds_read_b64_tr_b16 v[52:53], v6 offset:59392
  ds_read_b64_tr_b16 v[54:55], v6 offset:59904
  s_waitcnt lgkmcnt(6)
  v_mfma_f32_32x32x16_bf16 v[32:47], v[64:67], v[248:251], v[32:47]
  ds_read_b64_tr_b16 v[56:57], v6 offset:61440
  ds_read_b64_tr_b16 v[58:59], v6 offset:61952
  s_waitcnt lgkmcnt(6)
  v_mfma_f32_32x32x16_bf16 v[32:47], v[68:71], v[252:255], v[32:47]
  ds_read_b64_tr_b16 v[60:61], v6 offset:63488
  ds_read_b64_tr_b16 v[62:63], v6 offset:64000
  s_setprio 0
  s_waitcnt vmcnt(8)
  s_barrier
  s_add_u32 m0, s67, 131072
  s_add_u32 s74, s33, 589824
  buffer_load_dwordx4 v3, s[8:11], s74 offen lds
  s_add_u32 m0, s67, 139264
  s_add_u32 s74, s33, 1179648
  buffer_load_dwordx4 v3, s[8:11], s74 offen lds
  s_add_u32 m0, s67, 147456
  s_add_u32 s74, s33, 1769472
  buffer_load_dwordx4 v3, s[8:11], s74 offen lds
  v_fma_f32 v72, v32, v32, s72
  v_fma_f32 v73, v33, v33, s72
  v_fma_f32 v74, v34, v34, s72
  v_fma_f32 v75, v35, v35, s72
  v_mul_f32 v72, v72, v32
  v_mul_f32 v73, v73, v33
  v_mul_f32 v74, v74, v34
  v_mul_f32 v75, v75, v35
  v_exp_f32 v72, -v72
  v_exp_f32 v73, -v73
  v_exp_f32 v74, -v74
  v_exp_f32 v75, -v75
  v_fma_f32 v72, v72, s73, s73
  v_fma_f32 v73, v73, s73, s73
  v_fma_f32 v74, v74, s73, s73
  v_fma_f32 v75, v75, s73, s73
  v_rcp_f32 v72, v72
  v_rcp_f32 v73, v73
  v_rcp_f32 v74, v74
  v_rcp_f32 v75, v75
  v_mul_f32 v72, v72, v32
  v_mul_f32 v73, v73, v33
  v_mul_f32 v74, v74, v34
  v_mul_f32 v75, v75, v35
  v_cvt_pk_bf16_f32 v80, v72, v73
  v_cvt_pk_bf16_f32 v81, v74, v75
  v_fma_f32 v72, v36, v36, s72
  v_fma_f32 v73, v37, v37, s72
  v_fma_f32 v74, v38, v38, s72
  v_fma_f32 v75, v39, v39, s72
  v_mul_f32 v72, v72, v36
  v_mul_f32 v73, v73, v37
  v_mul_f32 v74, v74, v38
  v_mul_f32 v75, v75, v39
  v_exp_f32 v72, -v72
  v_exp_f32 v73, -v73
  v_exp_f32 v74, -v74
  v_exp_f32 v75, -v75
  v_fma_f32 v72, v72, s73, s73
  v_fma_f32 v73, v73, s73, s73
  s_setprio 1
  v_mfma_f32_32x32x16_bf16 v[16:31], v[88:91], v[92:95], 0
  s_waitcnt lgkmcnt(6)
  v_mfma_f32_32x32x16_bf16 v[16:31], v[48:51], v[112:115], v[16:31]
  ds_read_b64_tr_b16 v[64:65], v7 offset:24576
  ds_read_b64_tr_b16 v[66:67], v7 offset:25088
  s_waitcnt lgkmcnt(6)
  v_mfma_f32_32x32x16_bf16 v[16:31], v[52:55], v[116:119], v[16:31]
  ds_read_b64_tr_b16 v[68:69], v7 offset:26624
  ds_read_b64_tr_b16 v[70:71], v7 offset:27136
  s_waitcnt lgkmcnt(6)
  v_mfma_f32_32x32x16_bf16 v[16:31], v[56:59], v[120:123], v[16:31]
  ds_read_b64_tr_b16 v[48:49], v7 offset:28672
  ds_read_b64_tr_b16 v[50:51], v7 offset:29184
  s_waitcnt lgkmcnt(6)
  v_mfma_f32_32x32x16_bf16 v[16:31], v[60:63], v[124:127], v[16:31]
  ds_read_b64_tr_b16 v[52:53], v7 offset:30720
  ds_read_b64_tr_b16 v[54:55], v7 offset:31232
  s_waitcnt lgkmcnt(6)
  v_mfma_f32_32x32x16_bf16 v[16:31], v[64:67], v[128:131], v[16:31]
  ds_read_b64_tr_b16 v[56:57], v5 offset:8192
  ds_read_b64_tr_b16 v[58:59], v5 offset:8704
  s_waitcnt lgkmcnt(6)
  v_mfma_f32_32x32x16_bf16 v[16:31], v[68:71], v[132:135], v[16:31]
  ds_read_b64_tr_b16 v[60:61], v5 offset:10240
  ds_read_b64_tr_b16 v[62:63], v5 offset:10752
  s_waitcnt lgkmcnt(6)
  v_mfma_f32_32x32x16_bf16 v[16:31], v[48:51], v[136:139], v[16:31]
  ds_read_b64_tr_b16 v[64:65], v5 offset:12288
  ds_read_b64_tr_b16 v[66:67], v5 offset:12800
  s_waitcnt lgkmcnt(6)
  v_mfma_f32_32x32x16_bf16 v[16:31], v[52:55], v[140:143], v[16:31]
  ds_read_b64_tr_b16 v[68:69], v5 offset:14336
  ds_read_b64_tr_b16 v[70:71], v5 offset:14848
  s_waitcnt lgkmcnt(6)
  v_mfma_f32_32x32x16_bf16 v[16:31], v[56:59], v[144:147], v[16:31]
  ds_read_b64_tr_b16 v[48:49], v5 offset:0
  ds_read_b64_tr_b16 v[50:51], v5 offset:512
  s_waitcnt lgkmcnt(6)
  v_mfma_f32_32x32x16_bf16 v[16:31], v[60:63], v[148:151], v[16:31]
  ds_read_b64_tr_b16 v[52:53], v5 offset:2048
  ds_read_b64_tr_b16 v[54:55], v5 offset:2560
  s_waitcnt lgkmcnt(6)
  v_mfma_f32_32x32x16_bf16 v[16:31], v[64:67], v[152:155], v[16:31]
  ds_read_b64_tr_b16 v[56:57], v5 offset:4096
  ds_read_b64_tr_b16 v[58:59], v5 offset:4608
  s_waitcnt lgkmcnt(6)
  v_mfma_f32_32x32x16_bf16 v[16:31], v[68:71], v[156:159], v[16:31]
  ds_read_b64_tr_b16 v[60:61], v5 offset:6144
  ds_read_b64_tr_b16 v[62:63], v5 offset:6656
  s_setprio 0
  s_waitcnt vmcnt(3)
  s_barrier
  s_add_u32 m0, s67, 155648
  s_add_u32 s74, s33, 2359296
  buffer_load_dwordx4 v3, s[8:11], s74 offen lds
  s_add_u32 m0, s67, 8192
  s_add_u32 s74, s33, 2949120
  buffer_load_dwordx4 v3, s[8:11], s74 offen lds
  v_mov_b32 v88, v101
  v_fma_f32 v74, v74, s73, s73
  v_fma_f32 v75, v75, s73, s73
  v_rcp_f32 v72, v72
  v_rcp_f32 v73, v73
  v_rcp_f32 v74, v74
  v_rcp_f32 v75, v75
  v_mul_f32 v72, v72, v36
  v_mul_f32 v73, v73, v37
  v_mul_f32 v74, v74, v38
  v_mul_f32 v75, v75, v39
  v_cvt_pk_bf16_f32 v82, v72, v73
  v_cvt_pk_bf16_f32 v83, v74, v75
  v_fma_f32 v72, v40, v40, s72
  v_fma_f32 v73, v41, v41, s72
  v_fma_f32 v74, v42, v42, s72
  v_fma_f32 v75, v43, v43, s72
  v_mul_f32 v72, v72, v40
  v_mul_f32 v73, v73, v41
  v_mul_f32 v74, v74, v42
  v_mul_f32 v75, v75, v43
  v_exp_f32 v72, -v72
  v_exp_f32 v73, -v73
  v_exp_f32 v74, -v74
  v_exp_f32 v75, -v75
  v_fma_f32 v72, v72, s73, s73
  v_fma_f32 v73, v73, s73, s73
  v_fma_f32 v74, v74, s73, s73
  v_fma_f32 v75, v75, s73, s73
  v_rcp_f32 v72, v72
  v_rcp_f32 v73, v73
  v_rcp_f32 v74, v74
  s_add_u32 s74, s35, 49152
  buffer_store_dwordx4 v[80:83], v12, s[16:19], s74 offen sc1
  ds_write_b128 v106, v[80:83] offset:49152
  s_setprio 1
  s_waitcnt lgkmcnt(7)
  v_mfma_f32_32x32x16_bf16 v[16:31], v[48:51], v[160:163], v[16:31]
  ds_read_b64_tr_b16 v[64:65], v5 offset:16384
  ds_read_b64_tr_b16 v[66:67], v5 offset:16896
  s_waitcnt lgkmcnt(7)
  v_mfma_f32_32x32x16_bf16 v[16:31], v[52:55], v[164:167], v[16:31]
  ds_read_b64_tr_b16 v[68:69], v5 offset:18432
  ds_read_b64_tr_b16 v[70:71], v5 offset:18944
  s_waitcnt lgkmcnt(7)
  v_mfma_f32_32x32x16_bf16 v[16:31], v[56:59], v[168:171], v[16:31]
  ds_read_b64_tr_b16 v[48:49], v5 offset:20480
  ds_read_b64_tr_b16 v[50:51], v5 offset:20992
  s_waitcnt lgkmcnt(7)
  v_mfma_f32_32x32x16_bf16 v[16:31], v[60:63], v[172:175], v[16:31]
  ds_read_b64_tr_b16 v[52:53], v5 offset:22528
  ds_read_b64_tr_b16 v[54:55], v5 offset:23040
  s_waitcnt lgkmcnt(6)
  v_mfma_f32_32x32x16_bf16 v[16:31], v[64:67], v[176:179], v[16:31]
  ds_read_b64_tr_b16 v[56:57], v5 offset:24576
  ds_read_b64_tr_b16 v[58:59], v5 offset:25088
  s_waitcnt lgkmcnt(6)
  v_mfma_f32_32x32x16_bf16 v[16:31], v[68:71], v[180:183], v[16:31]
  ds_read_b64_tr_b16 v[60:61], v5 offset:26624
  ds_read_b64_tr_b16 v[62:63], v5 offset:27136
  s_waitcnt lgkmcnt(6)
  v_mfma_f32_32x32x16_bf16 v[16:31], v[48:51], v[184:187], v[16:31]
  ds_read_b64_tr_b16 v[64:65], v5 offset:28672
  ds_read_b64_tr_b16 v[66:67], v5 offset:29184
  s_waitcnt lgkmcnt(6)
  v_mfma_f32_32x32x16_bf16 v[16:31], v[52:55], v[188:191], v[16:31]
  ds_read_b64_tr_b16 v[68:69], v5 offset:30720
  ds_read_b64_tr_b16 v[70:71], v5 offset:31232
  s_waitcnt lgkmcnt(6)
  v_mfma_f32_32x32x16_bf16 v[16:31], v[56:59], v[192:195], v[16:31]
  ds_read_b64_tr_b16 v[48:49], v5 offset:32768
  ds_read_b64_tr_b16 v[50:51], v5 offset:33280
  s_waitcnt lgkmcnt(6)
  v_mfma_f32_32x32x16_bf16 v[16:31], v[60:63], v[196:199], v[16:31]
  ds_read_b64_tr_b16 v[52:53], v5 offset:34816
  ds_read_b64_tr_b16 v[54:55], v5 offset:35328
  s_waitcnt lgkmcnt(6)
  v_mfma_f32_32x32x16_bf16 v[16:31], v[64:67], v[200:203], v[16:31]
  ds_read_b64_tr_b16 v[56:57], v5 offset:36864
  ds_read_b64_tr_b16 v[58:59], v5 offset:37376
  s_waitcnt lgkmcnt(6)
  v_mfma_f32_32x32x16_bf16 v[16:31], v[68:71], v[204:207], v[16:31]
  ds_read_b64_tr_b16 v[60:61], v5 offset:38912
  ds_read_b64_tr_b16 v[62:63], v5 offset:39424
  s_setprio 0
  s_barrier
  s_add_u32 m0, s67, 0
  s_add_u32 s74, s33, 3538944
  buffer_load_dwordx4 v3, s[8:11], s74 offen lds
  s_add_u32 m0, s67, 16384
  s_add_u32 s74, s33, 4128768
  buffer_load_dwordx4 v3, s[8:11], s74 offen lds
  s_add_u32 m0, s67, 24576
  s_add_u32 s74, s33, 4718592
  buffer_load_dwordx4 v3, s[8:11], s74 offen lds
  v_rcp_f32 v75, v75
  v_mul_f32 v72, v72, v40
  v_mul_f32 v73, v73, v41
  v_mul_f32 v74, v74, v42
  v_mul_f32 v75, v75, v43
  v_cvt_pk_bf16_f32 v84, v72, v73
  v_cvt_pk_bf16_f32 v85, v74, v75
  v_fma_f32 v72, v44, v44, s72
  v_fma_f32 v73, v45, v45, s72
  v_fma_f32 v74, v46, v46, s72
  v_fma_f32 v75, v47, v47, s72
  v_mul_f32 v72, v72, v44
  v_mul_f32 v73, v73, v45
  v_mul_f32 v74, v74, v46
  v_mul_f32 v75, v75, v47
  v_exp_f32 v72, -v72
  v_exp_f32 v73, -v73
  v_exp_f32 v74, -v74
  v_exp_f32 v75, -v75
  v_fma_f32 v72, v72, s73, s73
  v_fma_f32 v73, v73, s73, s73
  v_fma_f32 v74, v74, s73, s73
  v_fma_f32 v75, v75, s73, s73
  v_rcp_f32 v72, v72
  v_rcp_f32 v73, v73
  v_rcp_f32 v74, v74
  v_rcp_f32 v75, v75
  v_mul_f32 v72, v72, v44
  v_mul_f32 v73, v73, v45
  v_mul_f32 v74, v74, v46
  v_mul_f32 v75, v75, v47
  v_cvt_pk_bf16_f32 v86, v72, v73
  v_cvt_pk_bf16_f32 v87, v74, v75
  s_add_u32 s74, s35, 53248
  buffer_store_dwordx4 v[84:87], v12, s[16:19], s74 offen sc1
  ds_write_b128 v106, v[84:87] offset:53248
  s_setprio 1
  s_waitcnt lgkmcnt(7)
  v_mfma_f32_32x32x16_bf16 v[16:31], v[48:51], v[208:211], v[16:31]
  ds_read_b64_tr_b16 v[64:65], v5 offset:40960
  ds_read_b64_tr_b16 v[66:67], v5 offset:41472
  s_waitcnt lgkmcnt(7)
  v_mfma_f32_32x32x16_bf16 v[16:31], v[52:55], v[212:215], v[16:31]
  ds_read_b64_tr_b16 v[68:69], v5 offset:43008
  ds_read_b64_tr_b16 v[70:71], v5 offset:43520
  s_waitcnt lgkmcnt(7)
  v_mfma_f32_32x32x16_bf16 v[16:31], v[56:59], v[216:219], v[16:31]
  ds_read_b64_tr_b16 v[48:49], v5 offset:45056
  ds_read_b64_tr_b16 v[50:51], v5 offset:45568
  s_waitcnt lgkmcnt(7)
  v_mfma_f32_32x32x16_bf16 v[16:31], v[60:63], v[220:223], v[16:31]
  ds_read_b64_tr_b16 v[52:53], v5 offset:47104
  ds_read_b64_tr_b16 v[54:55], v5 offset:47616
  s_waitcnt lgkmcnt(6)
  v_mfma_f32_32x32x16_bf16 v[16:31], v[64:67], v[224:227], v[16:31]
  ds_read_b64_tr_b16 v[56:57], v5 offset:49152
  ds_read_b64_tr_b16 v[58:59], v5 offset:49664
  s_waitcnt lgkmcnt(6)
  v_mfma_f32_32x32x16_bf16 v[16:31], v[68:71], v[228:231], v[16:31]
  ds_read_b64_tr_b16 v[60:61], v5 offset:51200
  ds_read_b64_tr_b16 v[62:63], v5 offset:51712
  s_waitcnt lgkmcnt(6)
  v_mfma_f32_32x32x16_bf16 v[16:31], v[48:51], v[232:235], v[16:31]
  ds_read_b64_tr_b16 v[64:65], v5 offset:53248
  ds_read_b64_tr_b16 v[66:67], v5 offset:53760
  s_waitcnt lgkmcnt(6)
  v_mfma_f32_32x32x16_bf16 v[16:31], v[52:55], v[236:239], v[16:31]
  ds_read_b64_tr_b16 v[68:69], v5 offset:55296
  ds_read_b64_tr_b16 v[70:71], v5 offset:55808
  s_waitcnt lgkmcnt(6)
  v_mfma_f32_32x32x16_bf16 v[16:31], v[56:59], v[240:243], v[16:31]
  ds_read_b64_tr_b16 v[48:49], v5 offset:57344
  ds_read_b64_tr_b16 v[50:51], v5 offset:57856
  s_waitcnt lgkmcnt(6)
  v_mfma_f32_32x32x16_bf16 v[16:31], v[60:63], v[244:247], v[16:31]
  ds_read_b64_tr_b16 v[52:53], v5 offset:59392
  ds_read_b64_tr_b16 v[54:55], v5 offset:59904
  s_waitcnt lgkmcnt(6)
  v_mfma_f32_32x32x16_bf16 v[16:31], v[64:67], v[248:251], v[16:31]
  ds_read_b64_tr_b16 v[56:57], v5 offset:61440
  ds_read_b64_tr_b16 v[58:59], v5 offset:61952
  s_waitcnt lgkmcnt(6)
  v_mfma_f32_32x32x16_bf16 v[16:31], v[68:71], v[252:255], v[16:31]
  ds_read_b64_tr_b16 v[60:61], v5 offset:63488
  ds_read_b64_tr_b16 v[62:63], v5 offset:64000
  s_setprio 0
  s_waitcnt vmcnt(7)
  s_barrier
  s_add_u32 m0, s67, 32768
  s_add_u32 s74, s80, s86
  buffer_load_dwordx4 v4, s[12:15], s74 offen lds
  s_add_u32 m0, s67, 40960
  s_add_u32 s74, s80, s87
  buffer_load_dwordx4 v4, s[12:15], s74 offen lds
  s_add_u32 m0, s67, 49152
  s_add_u32 s74, s80, s88
  buffer_load_dwordx4 v4, s[12:15], s74 offen lds
  v_fma_f32 v72, v16, v16, s72
  v_fma_f32 v73, v17, v17, s72
  v_fma_f32 v74, v18, v18, s72
  v_fma_f32 v75, v19, v19, s72
  v_mul_f32 v72, v72, v16
  v_mul_f32 v73, v73, v17
  v_mul_f32 v74, v74, v18
  v_mul_f32 v75, v75, v19
  v_exp_f32 v72, -v72
  v_exp_f32 v73, -v73
  v_exp_f32 v74, -v74
  v_exp_f32 v75, -v75
  v_fma_f32 v72, v72, s73, s73
  v_fma_f32 v73, v73, s73, s73
  v_fma_f32 v74, v74, s73, s73
  v_fma_f32 v75, v75, s73, s73
  v_rcp_f32 v72, v72
  v_rcp_f32 v73, v73
  v_rcp_f32 v74, v74
  v_rcp_f32 v75, v75
  v_mul_f32 v72, v72, v16
  v_mul_f32 v73, v73, v17
  v_mul_f32 v74, v74, v18
  v_mul_f32 v75, v75, v19
  v_cvt_pk_bf16_f32 v80, v72, v73
  v_cvt_pk_bf16_f32 v81, v74, v75
  v_fma_f32 v72, v20, v20, s72
  v_fma_f32 v73, v21, v21, s72
  v_fma_f32 v74, v22, v22, s72
  v_fma_f32 v75, v23, v23, s72
  v_mul_f32 v72, v72, v20
  v_mul_f32 v73, v73, v21
  v_mul_f32 v74, v74, v22
  v_mul_f32 v75, v75, v23
  v_exp_f32 v72, -v72
  v_exp_f32 v73, -v73
  v_exp_f32 v74, -v74
  v_exp_f32 v75, -v75
  v_fma_f32 v72, v72, s73, s73
  v_fma_f32 v73, v73, s73, s73
  s_setprio 1
  v_mfma_f32_32x32x16_bf16 v[32:47], v[88:91], v[92:95], 0
  s_waitcnt lgkmcnt(6)
  v_mfma_f32_32x32x16_bf16 v[32:47], v[48:51], v[112:115], v[32:47]
  ds_read_b64_tr_b16 v[64:65], v7 offset:0
  ds_read_b64_tr_b16 v[66:67], v7 offset:512
  s_waitcnt lgkmcnt(6)
  v_mfma_f32_32x32x16_bf16 v[32:47], v[52:55], v[116:119], v[32:47]
  ds_read_b64_tr_b16 v[68:69], v7 offset:2048
  ds_read_b64_tr_b16 v[70:71], v7 offset:2560
  s_waitcnt lgkmcnt(6)
  v_mfma_f32_32x32x16_bf16 v[32:47], v[56:59], v[120:123], v[32:47]
  ds_read_b64_tr_b16 v[48:49], v7 offset:4096
  ds_read_b64_tr_b16 v[50:51], v7 offset:4608
  s_waitcnt lgkmcnt(6)
  v_mfma_f32_32x32x16_bf16 v[32:47], v[60:63], v[124:127], v[32:47]
  ds_read_b64_tr_b16 v[52:53], v7 offset:6144
  ds_read_b64_tr_b16 v[54:55], v7 offset:6656
  s_waitcnt lgkmcnt(6)
  v_mfma_f32_32x32x16_bf16 v[32:47], v[64:67], v[128:131], v[32:47]
  ds_read_b64_tr_b16 v[56:57], v7 offset:8192
  ds_read_b64_tr_b16 v[58:59], v7 offset:8704
  s_waitcnt lgkmcnt(6)
  v_mfma_f32_32x32x16_bf16 v[32:47], v[68:71], v[132:135], v[32:47]
  ds_read_b64_tr_b16 v[60:61], v7 offset:10240
  ds_read_b64_tr_b16 v[62:63], v7 offset:10752
  s_waitcnt lgkmcnt(6)
  v_mfma_f32_32x32x16_bf16 v[32:47], v[48:51], v[136:139], v[32:47]
  ds_read_b64_tr_b16 v[64:65], v7 offset:12288
  ds_read_b64_tr_b16 v[66:67], v7 offset:12800
  s_waitcnt lgkmcnt(6)
  v_mfma_f32_32x32x16_bf16 v[32:47], v[52:55], v[140:143], v[32:47]
  ds_read_b64_tr_b16 v[68:69], v7 offset:14336
  ds_read_b64_tr_b16 v[70:71], v7 offset:14848
  s_waitcnt lgkmcnt(6)
  v_mfma_f32_32x32x16_bf16 v[32:47], v[56:59], v[144:147], v[32:47]
  ds_read_b64_tr_b16 v[48:49], v7 offset:16384
  ds_read_b64_tr_b16 v[50:51], v7 offset:16896
  s_waitcnt lgkmcnt(6)
  v_mfma_f32_32x32x16_bf16 v[32:47], v[60:63], v[148:151], v[32:47]
  ds_read_b64_tr_b16 v[52:53], v7 offset:18432
  ds_read_b64_tr_b16 v[54:55], v7 offset:18944
  s_waitcnt lgkmcnt(6)
  v_mfma_f32_32x32x16_bf16 v[32:47], v[64:67], v[152:155], v[32:47]
  ds_read_b64_tr_b16 v[56:57], v7 offset:20480
  ds_read_b64_tr_b16 v[58:59], v7 offset:20992
  s_waitcnt lgkmcnt(6)
  v_mfma_f32_32x32x16_bf16 v[32:47], v[68:71], v[156:159], v[32:47]
  ds_read_b64_tr_b16 v[60:61], v7 offset:22528
  ds_read_b64_tr_b16 v[62:63], v7 offset:23040
  s_setprio 0
  s_waitcnt vmcnt(6)
  s_barrier
  s_add_u32 m0, s67, 57344
  s_add_u32 s74, s81, s86
  buffer_load_dwordx4 v4, s[12:15], s74 offen lds
  v_fma_f32 v74, v74, s73, s73
  v_fma_f32 v75, v75, s73, s73
  v_rcp_f32 v72, v72
  v_rcp_f32 v73, v73
  v_rcp_f32 v74, v74
  v_rcp_f32 v75, v75
  v_mul_f32 v72, v72, v20
  v_mul_f32 v73, v73, v21
  v_mul_f32 v74, v74, v22
  v_mul_f32 v75, v75, v23
  v_cvt_pk_bf16_f32 v82, v72, v73
  v_cvt_pk_bf16_f32 v83, v74, v75
  v_fma_f32 v72, v24, v24, s72
  v_fma_f32 v73, v25, v25, s72
  v_fma_f32 v74, v26, v26, s72
  v_fma_f32 v75, v27, v27, s72
  v_mul_f32 v72, v72, v24
  v_mul_f32 v73, v73, v25
  v_mul_f32 v74, v74, v26
  v_mul_f32 v75, v75, v27
  v_exp_f32 v72, -v72
  v_exp_f32 v73, -v73
  v_exp_f32 v74, -v74
  v_exp_f32 v75, -v75
  v_fma_f32 v72, v72, s73, s73
  v_fma_f32 v73, v73, s73, s73
  v_fma_f32 v74, v74, s73, s73
  v_fma_f32 v75, v75, s73, s73
  v_rcp_f32 v72, v72
  v_rcp_f32 v73, v73
  v_rcp_f32 v74, v74
  s_add_u32 s74, s35, 65536
  buffer_store_dwordx4 v[80:83], v12, s[16:19], s74 offen sc1
  ds_write_b128 v107, v[80:83] offset:0
  s_setprio 1
  s_waitcnt lgkmcnt(7)
  v_mfma_f32_32x32x16_bf16 v[32:47], v[48:51], v[160:163], v[32:47]
  ds_read_b128 v[112:115], v104 offset:0
  ds_read_b64_tr_b16 v[64:65], v7 offset:24576
  ds_read_b64_tr_b16 v[66:67], v7 offset:25088
  s_waitcnt lgkmcnt(8)
  v_mfma_f32_32x32x16_bf16 v[32:47], v[52:55], v[164:167], v[32:47]
  ds_read_b128 v[116:119], v104 offset:4096
  ds_read_b64_tr_b16 v[68:69], v7 offset:26624
  ds_read_b64_tr_b16 v[70:71], v7 offset:27136
  s_waitcnt lgkmcnt(9)
  v_mfma_f32_32x32x16_bf16 v[32:47], v[56:59], v[168:171], v[32:47]
  ds_read_b128 v[120:123], v104 offset:8192
  ds_read_b64_tr_b16 v[48:49], v7 offset:28672
  ds_read_b64_tr_b16 v[50:51], v7 offset:29184
  s_waitcnt lgkmcnt(10)
  v_mfma_f32_32x32x16_bf16 v[32:47], v[60:63], v[172:175], v[32:47]
  ds_read_b128 v[124:127], v104 offset:12288
  ds_read_b64_tr_b16 v[52:53], v7 offset:30720
  ds_read_b64_tr_b16 v[54:55], v7 offset:31232
  s_waitcnt lgkmcnt(9)
  v_mfma_f32_32x32x16_bf16 v[32:47], v[64:67], v[176:179], v[32:47]
  ds_read_b128 v[128:131], v104 offset:16384
  ds_read_b64_tr_b16 v[56:57], v5 offset:8192
  ds_read_b64_tr_b16 v[58:59], v5 offset:8704
  s_waitcnt lgkmcnt(9)
  v_mfma_f32_32x32x16_bf16 v[32:47], v[68:71], v[180:183], v[32:47]
  ds_read_b128 v[132:135], v104 offset:20480
  ds_read_b64_tr_b16 v[60:61], v5 offset:10240
  ds_read_b64_tr_b16 v[62:63], v5 offset:10752
  s_waitcnt lgkmcnt(9)
  v_mfma_f32_32x32x16_bf16 v[32:47], v[48:51], v[184:187], v[32:47]
  ds_read_b128 v[136:139], v104 offset:24576
  ds_read_b64_tr_b16 v[64:65], v5 offset:12288
  ds_read_b64_tr_b16 v[66:67], v5 offset:12800
  s_waitcnt lgkmcnt(9)
  v_mfma_f32_32x32x16_bf16 v[32:47], v[52:55], v[188:191], v[32:47]
  ds_read_b128 v[140:143], v104 offset:28672
  ds_read_b64_tr_b16 v[68:69], v5 offset:14336
  ds_read_b64_tr_b16 v[70:71], v5 offset:14848
  s_waitcnt lgkmcnt(9)
  v_mfma_f32_32x32x16_bf16 v[32:47], v[56:59], v[192:195], v[32:47]
  ds_read_b128 v[144:147], v104 offset:32768
  ds_read_b64_tr_b16 v[48:49], v5 offset:0
  ds_read_b64_tr_b16 v[50:51], v5 offset:512
  s_waitcnt lgkmcnt(9)
  v_mfma_f32_32x32x16_bf16 v[32:47], v[60:63], v[196:199], v[32:47]
  ds_read_b128 v[148:151], v104 offset:36864
  ds_read_b64_tr_b16 v[52:53], v5 offset:2048
  ds_read_b64_tr_b16 v[54:55], v5 offset:2560
  s_waitcnt lgkmcnt(9)
  v_mfma_f32_32x32x16_bf16 v[32:47], v[64:67], v[200:203], v[32:47]
  ds_read_b128 v[152:155], v104 offset:40960
  ds_read_b64_tr_b16 v[56:57], v5 offset:4096
  ds_read_b64_tr_b16 v[58:59], v5 offset:4608
  s_waitcnt lgkmcnt(9)
  v_mfma_f32_32x32x16_bf16 v[32:47], v[68:71], v[204:207], v[32:47]
  ds_read_b128 v[156:159], v104 offset:45056
  ds_read_b64_tr_b16 v[60:61], v5 offset:6144
  ds_read_b64_tr_b16 v[62:63], v5 offset:6656
  s_setprio 0
  s_waitcnt vmcnt(4) lgkmcnt(2)
  s_barrier
  s_add_u32 m0, s67, 8192
  s_add_u32 s74, s81, s87
  buffer_load_dwordx4 v4, s[12:15], s74 offen lds
  s_add_u32 m0, s67, 65536
  s_add_u32 s74, s81, s88
  buffer_load_dwordx4 v4, s[12:15], s74 offen lds
  s_add_u32 m0, s67, 73728
  s_add_u32 s74, s34, 0
  buffer_load_dwordx4 v12, s[16:19], s74 offen sc1 lds
  s_add_u32 m0, s67, 81920
  s_add_u32 s74, s34, 8192
  buffer_load_dwordx4 v12, s[16:19], s74 offen sc1 lds
  s_add_u32 m0, s67, 90112
  s_add_u32 s74, s80, s89
  buffer_load_dwordx4 v4, s[12:15], s74 offen lds
  v_rcp_f32 v75, v75
  v_mul_f32 v72, v72, v24
  v_mul_f32 v73, v73, v25
  v_mul_f32 v74, v74, v26
  v_mul_f32 v75, v75, v27
  v_cvt_pk_bf16_f32 v84, v72, v73
  v_cvt_pk_bf16_f32 v85, v74, v75
  v_fma_f32 v72, v28, v28, s72
  v_fma_f32 v73, v29, v29, s72
  v_fma_f32 v74, v30, v30, s72
  v_fma_f32 v75, v31, v31, s72
  v_mul_f32 v72, v72, v28
  v_mul_f32 v73, v73, v29
  v_mul_f32 v74, v74, v30
  v_mul_f32 v75, v75, v31
  v_exp_f32 v72, -v72
  v_exp_f32 v73, -v73
  v_exp_f32 v74, -v74
  v_exp_f32 v75, -v75
  v_fma_f32 v72, v72, s73, s73
  v_fma_f32 v73, v73, s73, s73
  v_fma_f32 v74, v74, s73, s73
  v_fma_f32 v75, v75, s73, s73
  v_rcp_f32 v72, v72
  v_rcp_f32 v73, v73
  v_rcp_f32 v74, v74
  v_rcp_f32 v75, v75
  v_mul_f32 v72, v72, v28
  v_mul_f32 v73, v73, v29
  v_mul_f32 v74, v74, v30
  v_mul_f32 v75, v75, v31
  v_cvt_pk_bf16_f32 v86, v72, v73
  v_cvt_pk_bf16_f32 v87, v74, v75
  s_add_u32 s74, s35, 69632
  buffer_store_dwordx4 v[84:87], v12, s[16:19], s74 offen sc1
  ds_write_b128 v107, v[84:87] offset:4096
  s_branch L_pj11
  .p2align 12
L_stub11:
  s_setpc_b64 s[58:59]
  s_nop 0
L_pj11:
  s_setprio 1
  v_mfma_f32_32x32x16_bf16 v[32:47], v[48:51], v[208:211], v[32:47]
  ds_read_b128 v[160:163], v104 offset:49152
  ds_read_b64_tr_b16 v[64:65], v5 offset:16384
  ds_read_b64_tr_b16 v[66:67], v5 offset:16896
  v_mfma_f32_32x32x16_bf16 v[32:47], v[52:55], v[212:215], v[32:47]
  ds_read_b128 v[164:167], v104 offset:53248
  ds_read_b64_tr_b16 v[68:69], v5 offset:18432
  ds_read_b64_tr_b16 v[70:71], v5 offset:18944
  v_mfma_f32_32x32x16_bf16 v[32:47], v[56:59], v[216:219], v[32:47]
  ds_read_b128 v[168:171], v104 offset:57344
  ds_read_b64_tr_b16 v[48:49], v5 offset:20480
  ds_read_b64_tr_b16 v[50:51], v5 offset:20992
  s_waitcnt lgkmcnt(10)
  v_mfma_f32_32x32x16_bf16 v[32:47], v[60:63], v[220:223], v[32:47]
  ds_read_b128 v[172:175], v104 offset:61440
  ds_read_b64_tr_b16 v[52:53], v5 offset:22528
  ds_read_b64_tr_b16 v[54:55], v5 offset:23040
  s_waitcnt lgkmcnt(9)
  v_mfma_f32_32x32x16_bf16 v[32:47], v[64:67], v[224:227], v[32:47]
  ds_read_b64_tr_b16 v[56:57], v5 offset:24576
  ds_read_b64_tr_b16 v[58:59], v5 offset:25088
  s_waitcnt lgkmcnt(8)
  v_mfma_f32_32x32x16_bf16 v[32:47], v[68:71], v[228:231], v[32:47]
  ds_read_b64_tr_b16 v[60:61], v5 offset:26624
  ds_read_b64_tr_b16 v[62:63], v5 offset:27136
  s_waitcnt lgkmcnt(7)
  v_mfma_f32_32x32x16_bf16 v[32:47], v[48:51], v[232:235], v[32:47]
  ds_read_b64_tr_b16 v[64:65], v5 offset:28672
  ds_read_b64_tr_b16 v[66:67], v5 offset:29184
  s_waitcnt lgkmcnt(6)
  v_mfma_f32_32x32x16_bf16 v[32:47], v[52:55], v[236:239], v[32:47]
  ds_read_b64_tr_b16 v[68:69], v5 offset:30720
  ds_read_b64_tr_b16 v[70:71], v5 offset:31232
  s_waitcnt lgkmcnt(6)
  v_mfma_f32_32x32x16_bf16 v[32:47], v[56:59], v[240:243], v[32:47]
  ds_read_b64_tr_b16 v[48:49], v8 offset:32768
  ds_read_b64_tr_b16 v[50:51], v8 offset:33792
  s_waitcnt lgkmcnt(6)
  v_mfma_f32_32x32x16_bf16 v[32:47], v[60:63], v[244:247], v[32:47]
  ds_read_b64_tr_b16 v[52:53], v8 offset:34816
  ds_read_b64_tr_b16 v[54:55], v8 offset:35840
  s_waitcnt lgkmcnt(6)
  v_mfma_f32_32x32x16_bf16 v[32:47], v[64:67], v[248:251], v[32:47]
  ds_read_b64_tr_b16 v[56:57], v8 offset:36864
  ds_read_b64_tr_b16 v[58:59], v8 offset:37888
  s_waitcnt lgkmcnt(6)
  v_mfma_f32_32x32x16_bf16 v[32:47], v[68:71], v[252:255], v[32:47]
  ds_read_b64_tr_b16 v[60:61], v8 offset:38912
  ds_read_b64_tr_b16 v[62:63], v8 offset:39936
  s_setprio 0
  s_waitcnt vmcnt(7)
  s_barrier
  s_add_u32 m0, s67, 0
  s_add_u32 s74, s80, s90
  buffer_load_dwordx4 v4, s[12:15], s74 offen lds
  s_add_u32 m0, s67, 16384
  s_add_u32 s74, s80, s91
  buffer_load_dwordx4 v4, s[12:15], s74 offen lds
  s_add_u32 m0, s67, 24576
  s_add_u32 s74, s34, 16384
  buffer_load_dwordx4 v12, s[16:19], s74 offen sc1 lds
  s_add_u32 m0, s67, 98304
  s_add_u32 s74, s34, 24576
  buffer_load_dwordx4 v12, s[16:19], s74 offen sc1 lds
  s_add_u32 m0, s67, 106496
  s_add_u32 s74, s81, s89
  buffer_load_dwordx4 v4, s[12:15], s74 offen lds
  v_fma_f32 v72, v32, v32, s72
  v_fma_f32 v73, v33, v33, s72
  v_fma_f32 v74, v34, v34, s72
  v_fma_f32 v75, v35, v35, s72
  v_mul_f32 v72, v72, v32
  v_mul_f32 v73, v73, v33
  v_mul_f32 v74, v74, v34
  v_mul_f32 v75, v75, v35
  v_exp_f32 v72, -v72
  v_exp_f32 v73, -v73
  v_exp_f32 v74, -v74
  v_exp_f32 v75, -v75
  v_fma_f32 v72, v72, s73, s73
  v_fma_f32 v73, v73, s73, s73
  v_fma_f32 v74, v74, s73, s73
  v_fma_f32 v75, v75, s73, s73
  v_rcp_f32 v72, v72
  v_rcp_f32 v73, v73
  v_rcp_f32 v74, v74
  v_rcp_f32 v75, v75
  v_mul_f32 v72, v72, v32
  v_mul_f32 v73, v73, v33
  v_mul_f32 v74, v74, v34
  v_mul_f32 v75, v75, v35
  v_cvt_pk_bf16_f32 v80, v72, v73
  v_cvt_pk_bf16_f32 v81, v74, v75
  v_fma_f32 v72, v36, v36, s72
  v_fma_f32 v73, v37, v37, s72
  v_fma_f32 v74, v38, v38, s72
  v_fma_f32 v75, v39, v39, s72
  v_mul_f32 v72, v72, v36
  v_mul_f32 v73, v73, v37
  v_mul_f32 v74, v74, v38
  v_mul_f32 v75, v75, v39
  v_exp_f32 v72, -v72
  v_exp_f32 v73, -v73
  v_exp_f32 v74, -v74
  v_exp_f32 v75, -v75
  v_fma_f32 v72, v72, s73, s73
  v_fma_f32 v73, v73, s73, s73
  s_setprio 1
  s_waitcnt lgkmcnt(6)
  v_mfma_f32_32x32x16_bf16 v[16:31], v[48:51], v[112:115], 0
  ds_read_b128 v[176:179], v105 offset:0
  ds_read_b64_tr_b16 v[64:65], v8 offset:40960
  ds_read_b64_tr_b16 v[66:67], v8 offset:41984
  s_waitcnt lgkmcnt(7)
  v_mfma_f32_32x32x16_bf16 v[16:31], v[52:55], v[116:119], v[16:31]
  ds_read_b128 v[180:183], v105 offset:4096
  ds_read_b64_tr_b16 v[68:69], v8 offset:43008
  ds_read_b64_tr_b16 v[70:71], v8 offset:44032
  s_waitcnt lgkmcnt(8)
  v_mfma_f32_32x32x16_bf16 v[16:31], v[56:59], v[120:123], v[16:31]
  ds_read_b128 v[184:187], v105 offset:8192
  ds_read_b64_tr_b16 v[48:49], v8 offset:45056
  ds_read_b64_tr_b16 v[50:51], v8 offset:46080
  s_waitcnt lgkmcnt(9)
  v_mfma_f32_32x32x16_bf16 v[16:31], v[60:63], v[124:127], v[16:31]
  ds_read_b128 v[188:191], v105 offset:12288
  ds_read_b64_tr_b16 v[52:53], v8 offset:47104
  ds_read_b64_tr_b16 v[54:55], v8 offset:48128
  s_waitcnt lgkmcnt(9)
  v_mfma_f32_32x32x16_bf16 v[88:103], v[64:67], v[112:115], 0
  ds_read_b64_tr_b16 v[56:57], v8 offset:49152
  ds_read_b64_tr_b16 v[58:59], v8 offset:50176
  s_waitcnt lgkmcnt(8)
  v_mfma_f32_32x32x16_bf16 v[88:103], v[68:71], v[116:119], v[88:103]
  ds_read_b64_tr_b16 v[60:61], v8 offset:51200
  ds_read_b64_tr_b16 v[62:63], v8 offset:52224
  s_waitcnt lgkmcnt(7)
  v_mfma_f32_32x32x16_bf16 v[88:103], v[48:51], v[120:123], v[88:103]
  ds_read_b64_tr_b16 v[64:65], v8 offset:53248
  ds_read_b64_tr_b16 v[66:67], v8 offset:54272
  s_waitcnt lgkmcnt(6)
  v_mfma_f32_32x32x16_bf16 v[88:103], v[52:55], v[124:127], v[88:103]
  ds_read_b64_tr_b16 v[68:69], v8 offset:55296
  ds_read_b64_tr_b16 v[70:71], v8 offset:56320
  s_waitcnt lgkmcnt(6)
  v_mfma_f32_32x32x16_bf16 v[208:223], v[56:59], v[112:115], 0
  ds_read_b64_tr_b16 v[48:49], v8 offset:57344
  ds_read_b64_tr_b16 v[50:51], v8 offset:58368
  s_waitcnt lgkmcnt(6)
  v_mfma_f32_32x32x16_bf16 v[208:223], v[60:63], v[116:119], v[208:223]
  ds_read_b64_tr_b16 v[52:53], v8 offset:59392
  ds_read_b64_tr_b16 v[54:55], v8 offset:60416
  s_waitcnt lgkmcnt(6)
  v_mfma_f32_32x32x16_bf16 v[208:223], v[64:67], v[120:123], v[208:223]
  ds_read_b64_tr_b16 v[56:57], v8 offset:61440
  ds_read_b64_tr_b16 v[58:59], v8 offset:62464
  s_waitcnt lgkmcnt(6)
  v_mfma_f32_32x32x16_bf16 v[208:223], v[68:71], v[124:127], v[208:223]
  ds_read_b64_tr_b16 v[60:61], v8 offset:63488
  ds_read_b64_tr_b16 v[62:63], v8 offset:64512
  s_setprio 0
  s_waitcnt vmcnt(5)
  s_barrier
  s_add_u32 m0, s67, 32768
  s_add_u32 s74, s81, s90
  buffer_load_dwordx4 v4, s[12:15], s74 offen lds
  s_add_u32 m0, s67, 40960
  s_add_u32 s74, s81, s91
  buffer_load_dwordx4 v4, s[12:15], s74 offen lds
  s_add_u32 m0, s67, 49152
  s_add_u32 s74, s34, 32768
  buffer_load_dwordx4 v12, s[16:19], s74 offen sc1 lds
  s_add_u32 m0, s67, 114688
  s_add_u32 s74, s34, 40960
  buffer_load_dwordx4 v12, s[16:19], s74 offen sc1 lds
  s_add_u32 m0, s67, 122880
  s_add_u32 s74, s82, s89
  buffer_load_dwordx4 v4, s[12:15], s74 offen lds
  v_fma_f32 v74, v74, s73, s73
  v_fma_f32 v75, v75, s73, s73
  v_rcp_f32 v72, v72
  v_rcp_f32 v73, v73
  v_rcp_f32 v74, v74
  v_rcp_f32 v75, v75
  v_mul_f32 v72, v72, v36
  v_mul_f32 v73, v73, v37
  v_mul_f32 v74, v74, v38
  v_mul_f32 v75, v75, v39
  v_cvt_pk_bf16_f32 v82, v72, v73
  v_cvt_pk_bf16_f32 v83, v74, v75
  v_fma_f32 v72, v40, v40, s72
  v_fma_f32 v73, v41, v41, s72
  v_fma_f32 v74, v42, v42, s72
  v_fma_f32 v75, v43, v43, s72
  v_mul_f32 v72, v72, v40
  v_mul_f32 v73, v73, v41
  v_mul_f32 v74, v74, v42
  v_mul_f32 v75, v75, v43
  v_exp_f32 v72, -v72
  v_exp_f32 v73, -v73
  v_exp_f32 v74, -v74
  v_exp_f32 v75, -v75
  v_fma_f32 v72, v72, s73, s73
  v_fma_f32 v73, v73, s73, s73
  v_fma_f32 v74, v74, s73, s73
  v_fma_f32 v75, v75, s73, s73
  v_rcp_f32 v72, v72
  v_rcp_f32 v73, v73
  v_rcp_f32 v74, v74
  s_add_u32 s74, s35, 81920
  buffer_store_dwordx4 v[80:83], v12, s[16:19], s74 offen sc1
  ds_write_b128 v107, v[80:83] offset:16384
  s_setprio 1
  s_waitcnt lgkmcnt(7)
  v_mfma_f32_32x32x16_bf16 v[16:31], v[48:51], v[128:131], v[16:31]
  ds_read_b128 v[224:227], v104 offset:8192
  ds_read_b64_tr_b16 v[64:65], v8 offset:8192
  ds_read_b64_tr_b16 v[66:67], v8 offset:9216
  s_waitcnt lgkmcnt(8)
  v_mfma_f32_32x32x16_bf16 v[16:31], v[52:55], v[132:135], v[16:31]
  ds_read_b128 v[228:231], v104 offset:12288
  ds_read_b64_tr_b16 v[68:69], v8 offset:10240
  ds_read_b64_tr_b16 v[70:71], v8 offset:11264
  s_waitcnt lgkmcnt(9)
  v_mfma_f32_32x32x16_bf16 v[16:31], v[56:59], v[136:139], v[16:31]
  ds_read_b128 v[232:235], v104 offset:16384
  ds_read_b64_tr_b16 v[48:49], v8 offset:12288
  ds_read_b64_tr_b16 v[50:51], v8 offset:13312
  s_waitcnt lgkmcnt(10)
  v_mfma_f32_32x32x16_bf16 v[16:31], v[60:63], v[140:143], v[16:31]
  ds_read_b128 v[236:239], v104 offset:20480
  ds_read_b64_tr_b16 v[52:53], v8 offset:14336
  ds_read_b64_tr_b16 v[54:55], v8 offset:15360
  s_waitcnt lgkmcnt(9)
  v_mfma_f32_32x32x16_bf16 v[88:103], v[64:67], v[128:131], v[88:103]
  ds_read_b64_tr_b16 v[56:57], v9 offset:0
  ds_read_b64_tr_b16 v[58:59], v9 offset:1024
  s_waitcnt lgkmcnt(8)
  v_mfma_f32_32x32x16_bf16 v[88:103], v[68:71], v[132:135], v[88:103]
  ds_read_b64_tr_b16 v[60:61], v9 offset:2048
  ds_read_b64_tr_b16 v[62:63], v9 offset:3072
  s_waitcnt lgkmcnt(7)
  v_mfma_f32_32x32x16_bf16 v[88:103], v[48:51], v[136:139], v[88:103]
  ds_read_b64_tr_b16 v[64:65], v9 offset:4096
  ds_read_b64_tr_b16 v[66:67], v9 offset:5120
  s_waitcnt lgkmcnt(6)
  v_mfma_f32_32x32x16_bf16 v[88:103], v[52:55], v[140:143], v[88:103]
  ds_read_b64_tr_b16 v[68:69], v9 offset:6144
  ds_read_b64_tr_b16 v[70:71], v9 offset:7168
  s_waitcnt lgkmcnt(6)
  v_mfma_f32_32x32x16_bf16 v[208:223], v[56:59], v[128:131], v[208:223]
  ds_read_b64_tr_b16 v[48:49], v9 offset:24576
  ds_read_b64_tr_b16 v[50:51], v9 offset:25600
  s_waitcnt lgkmcnt(6)
  v_mfma_f32_32x32x16_bf16 v[208:223], v[60:63], v[132:135], v[208:223]
  ds_read_b64_tr_b16 v[52:53], v9 offset:26624
  ds_read_b64_tr_b16 v[54:55], v9 offset:27648
  s_waitcnt lgkmcnt(6)
  v_mfma_f32_32x32x16_bf16 v[208:223], v[64:67], v[136:139], v[208:223]
  ds_read_b64_tr_b16 v[56:57], v9 offset:28672
  ds_read_b64_tr_b16 v[58:59], v9 offset:29696
  s_waitcnt lgkmcnt(6)
  v_mfma_f32_32x32x16_bf16 v[208:223], v[68:71], v[140:143], v[208:223]
  ds_read_b64_tr_b16 v[60:61], v9 offset:30720
  ds_read_b64_tr_b16 v[62:63], v9 offset:31744
  s_setprio 0
  s_waitcnt vmcnt(6)
  s_barrier
  s_add_u32 m0, s67, 8192
  s_add_u32 s74, s82, s90
  buffer_load_dwordx4 v4, s[12:15], s74 offen lds
  s_add_u32 m0, s67, 57344
  s_add_u32 s74, s82, s91
  buffer_load_dwordx4 v4, s[12:15], s74 offen lds
  s_add_u32 m0, s67, 65536
  s_add_u32 s74, s3, 0
  buffer_load_dwordx4 v12, s[16:19], s74 offen sc1 lds
  s_add_u32 m0, s67, 73728
  s_add_u32 s74, s3, 8192
  buffer_load_dwordx4 v12, s[16:19], s74 offen sc1 lds
  s_add_u32 m0, s67, 81920
  s_add_u32 s74, s80, s92
  buffer_load_dwordx4 v4, s[12:15], s74 offen lds
  v_rcp_f32 v75, v75
  v_mul_f32 v72, v72, v40
  v_mul_f32 v73, v73, v41
  v_mul_f32 v74, v74, v42
  v_mul_f32 v75, v75, v43
  v_cvt_pk_bf16_f32 v84, v72, v73
  v_cvt_pk_bf16_f32 v85, v74, v75
  v_fma_f32 v72, v44, v44, s72
  v_fma_f32 v73, v45, v45, s72
  v_fma_f32 v74, v46, v46, s72
  v_fma_f32 v75, v47, v47, s72
  v_mul_f32 v72, v72, v44
  v_mul_f32 v73, v73, v45
  v_mul_f32 v74, v74, v46
  v_mul_f32 v75, v75, v47
  v_exp_f32 v72, -v72
  v_exp_f32 v73, -v73
  v_exp_f32 v74, -v74
  v_exp_f32 v75, -v75
  v_fma_f32 v72, v72, s73, s73
  v_fma_f32 v73, v73, s73, s73
  v_fma_f32 v74, v74, s73, s73
  v_fma_f32 v75, v75, s73, s73
  v_rcp_f32 v72, v72
  v_rcp_f32 v73, v73
  v_rcp_f32 v74, v74
  v_rcp_f32 v75, v75
  v_mul_f32 v72, v72, v44
  v_mul_f32 v73, v73, v45
  v_mul_f32 v74, v74, v46
  v_mul_f32 v75, v75, v47
  v_cvt_pk_bf16_f32 v86, v72, v73
  v_cvt_pk_bf16_f32 v87, v74, v75
  s_add_u32 s74, s35, 86016
  buffer_store_dwordx4 v[84:87], v12, s[16:19], s74 offen sc1
  ds_write_b128 v107, v[84:87] offset:20480
  s_setprio 1
  s_waitcnt lgkmcnt(7)
  v_mfma_f32_32x32x16_bf16 v[16:31], v[48:51], v[224:227], v[16:31]
  ds_read_b128 v[240:243], v13 offset:24576
  ds_read_b64_tr_b16 v[64:65], v8 offset:0
  ds_read_b64_tr_b16 v[66:67], v8 offset:1024
  s_waitcnt lgkmcnt(8)
  v_mfma_f32_32x32x16_bf16 v[16:31], v[52:55], v[228:231], v[16:31]
  ds_read_b128 v[244:247], v13 offset:28672
  ds_read_b64_tr_b16 v[68:69], v8 offset:2048
  ds_read_b64_tr_b16 v[70:71], v8 offset:3072
  s_waitcnt lgkmcnt(9)
  v_mfma_f32_32x32x16_bf16 v[16:31], v[56:59], v[232:235], v[16:31]
  ds_read_b128 v[248:251], v104 offset:32768
  ds_read_b64_tr_b16 v[48:49], v8 offset:4096
  ds_read_b64_tr_b16 v[50:51], v8 offset:5120
  s_waitcnt lgkmcnt(10)
  v_mfma_f32_32x32x16_bf16 v[16:31], v[60:63], v[236:239], v[16:31]
  ds_read_b128 v[252:255], v104 offset:36864
  ds_read_b64_tr_b16 v[52:53], v8 offset:6144
  ds_read_b64_tr_b16 v[54:55], v8 offset:7168
  s_waitcnt lgkmcnt(9)
  v_mfma_f32_32x32x16_bf16 v[88:103], v[64:67], v[224:227], v[88:103]
  ds_read_b64_tr_b16 v[56:57], v8 offset:16384
  ds_read_b64_tr_b16 v[58:59], v8 offset:17408
  s_waitcnt lgkmcnt(8)
  v_mfma_f32_32x32x16_bf16 v[88:103], v[68:71], v[228:231], v[88:103]
  ds_read_b64_tr_b16 v[60:61], v8 offset:18432
  ds_read_b64_tr_b16 v[62:63], v8 offset:19456
  s_waitcnt lgkmcnt(7)
  v_mfma_f32_32x32x16_bf16 v[88:103], v[48:51], v[232:235], v[88:103]
  ds_read_b64_tr_b16 v[64:65], v8 offset:20480
  ds_read_b64_tr_b16 v[66:67], v8 offset:21504
  s_waitcnt lgkmcnt(6)
  v_mfma_f32_32x32x16_bf16 v[88:103], v[52:55], v[236:239], v[88:103]
  ds_read_b64_tr_b16 v[68:69], v8 offset:22528
  ds_read_b64_tr_b16 v[70:71], v8 offset:23552
  s_waitcnt lgkmcnt(6)
  v_mfma_f32_32x32x16_bf16 v[208:223], v[56:59], v[224:227], v[208:223]
  ds_read_b64_tr_b16 v[48:49], v9 offset:40960
  ds_read_b64_tr_b16 v[50:51], v9 offset:41984
  s_waitcnt lgkmcnt(6)
  v_mfma_f32_32x32x16_bf16 v[208:223], v[60:63], v[228:231], v[208:223]
  ds_read_b64_tr_b16 v[52:53], v9 offset:43008
  ds_read_b64_tr_b16 v[54:55], v9 offset:44032
  s_waitcnt lgkmcnt(6)
  v_mfma_f32_32x32x16_bf16 v[208:223], v[64:67], v[232:235], v[208:223]
  ds_read_b64_tr_b16 v[56:57], v9 offset:45056
  ds_read_b64_tr_b16 v[58:59], v9 offset:46080
  s_waitcnt lgkmcnt(6)
  v_mfma_f32_32x32x16_bf16 v[208:223], v[68:71], v[236:239], v[208:223]
  ds_read_b64_tr_b16 v[60:61], v9 offset:47104
  ds_read_b64_tr_b16 v[62:63], v9 offset:48128
  s_setprio 0
  s_waitcnt vmcnt(7)
  s_barrier
  s_add_u32 m0, s67, 0
  s_add_u32 s74, s80, s93
  buffer_load_dwordx4 v4, s[12:15], s74 offen lds
  s_add_u32 m0, s67, 16384
  s_add_u32 s74, s80, s94
  buffer_load_dwordx4 v4, s[12:15], s74 offen lds
  s_add_u32 m0, s67, 24576
  s_add_u32 s74, s3, 16384
  buffer_load_dwordx4 v12, s[16:19], s74 offen sc1 lds
  s_add_u32 m0, s67, 90112
  s_add_u32 s74, s3, 24576
  buffer_load_dwordx4 v12, s[16:19], s74 offen sc1 lds
  s_add_u32 m0, s67, 98304
  s_add_u32 s74, s81, s92
  buffer_load_dwordx4 v4, s[12:15], s74 offen lds
  s_add_u32 m0, s67, 131072
  s_add_u32 s74, s81, s93
  buffer_load_dwordx4 v4, s[12:15], s74 offen lds
  s_setprio 1
  s_waitcnt lgkmcnt(6)
  v_mfma_f32_32x32x16_bf16 v[16:31], v[48:51], v[240:243], v[16:31]
  ds_read_b128 v[192:195], v105 offset:16384
  ds_read_b64_tr_b16 v[64:65], v8 offset:32768
  ds_read_b64_tr_b16 v[66:67], v8 offset:33792
  s_waitcnt lgkmcnt(7)
  v_mfma_f32_32x32x16_bf16 v[16:31], v[52:55], v[244:247], v[16:31]
  ds_read_b128 v[196:199], v105 offset:20480
  ds_read_b64_tr_b16 v[68:69], v8 offset:34816
  ds_read_b64_tr_b16 v[70:71], v8 offset:35840
  s_waitcnt lgkmcnt(8)
  v_mfma_f32_32x32x16_bf16 v[16:31], v[56:59], v[248:251], v[16:31]
  ds_read_b128 v[200:203], v105 offset:24576
  ds_read_b64_tr_b16 v[48:49], v8 offset:36864
  ds_read_b64_tr_b16 v[50:51], v8 offset:37888
  s_waitcnt lgkmcnt(9)
  v_mfma_f32_32x32x16_bf16 v[16:31], v[60:63], v[252:255], v[16:31]
  ds_read_b128 v[204:207], v105 offset:28672
  ds_read_b64_tr_b16 v[52:53], v8 offset:38912
  ds_read_b64_tr_b16 v[54:55], v8 offset:39936
  s_waitcnt lgkmcnt(9)
  v_mfma_f32_32x32x16_bf16 v[88:103], v[64:67], v[240:243], v[88:103]
  ds_read_b128 v[224:227], v13 offset:49152
  ds_read_b64_tr_b16 v[56:57], v8 offset:40960
  ds_read_b64_tr_b16 v[58:59], v8 offset:41984
  s_waitcnt lgkmcnt(9)
  v_mfma_f32_32x32x16_bf16 v[88:103], v[68:71], v[244:247], v[88:103]
  ds_read_b128 v[228:231], v13 offset:53248
  ds_read_b64_tr_b16 v[60:61], v8 offset:43008
  ds_read_b64_tr_b16 v[62:63], v8 offset:44032
  s_waitcnt lgkmcnt(9)
  v_mfma_f32_32x32x16_bf16 v[88:103], v[48:51], v[248:251], v[88:103]
  ds_read_b128 v[232:235], v104 offset:49152
  ds_read_b64_tr_b16 v[64:65], v8 offset:45056
  ds_read_b64_tr_b16 v[66:67], v8 offset:46080
  s_waitcnt lgkmcnt(9)
  v_mfma_f32_32x32x16_bf16 v[88:103], v[52:55], v[252:255], v[88:103]
  ds_read_b128 v[236:239], v104 offset:53248
  ds_read_b64_tr_b16 v[68:69], v8 offset:47104
  ds_read_b64_tr_b16 v[70:71], v8 offset:48128
  s_waitcnt lgkmcnt(9)
  v_mfma_f32_32x32x16_bf16 v[208:223], v[56:59], v[240:243], v[208:223]
  ds_read_b64_tr_b16 v[48:49], v9 offset:57344
  ds_read_b64_tr_b16 v[50:51], v9 offset:58368
  s_waitcnt lgkmcnt(8)
  v_mfma_f32_32x32x16_bf16 v[208:223], v[60:63], v[244:247], v[208:223]
  ds_read_b64_tr_b16 v[52:53], v9 offset:59392
  ds_read_b64_tr_b16 v[54:55], v9 offset:60416
  s_waitcnt lgkmcnt(7)
  v_mfma_f32_32x32x16_bf16 v[208:223], v[64:67], v[248:251], v[208:223]
  ds_read_b64_tr_b16 v[56:57], v9 offset:61440
  ds_read_b64_tr_b16 v[58:59], v9 offset:62464
  s_waitcnt lgkmcnt(6)
  v_mfma_f32_32x32x16_bf16 v[208:223], v[68:71], v[252:255], v[208:223]
  ds_read_b64_tr_b16 v[60:61], v9 offset:63488
  ds_read_b64_tr_b16 v[62:63], v9 offset:64512
  s_setprio 0
  s_waitcnt vmcnt(6)
  s_barrier
  s_add_u32 m0, s67, 32768
  s_add_u32 s74, s81, s94
  buffer_load_dwordx4 v4, s[12:15], s74 offen lds
  s_add_u32 m0, s67, 40960
  s_add_u32 s74, s3, 32768
  buffer_load_dwordx4 v12, s[16:19], s74 offen sc1 lds
  s_add_u32 m0, s67, 49152
  s_add_u32 s74, s3, 40960
  buffer_load_dwordx4 v12, s[16:19], s74 offen sc1 lds
  s_add_u32 m0, s67, 106496
  s_add_u32 s74, s82, s92
  buffer_load_dwordx4 v4, s[12:15], s74 offen lds
  s_add_u32 m0, s67, 114688
  s_add_u32 s74, s82, s93
  buffer_load_dwordx4 v4, s[12:15], s74 offen lds
  s_add_u32 m0, s67, 139264
  s_add_u32 s74, s82, s94
  buffer_load_dwordx4 v4, s[12:15], s74 offen lds
  s_setprio 1
  s_waitcnt lgkmcnt(6)
  v_mfma_f32_32x32x16_bf16 v[16:31], v[48:51], v[224:227], v[16:31]
  ds_read_b128 v[240:243], v104 offset:0
  ds_read_b64_tr_b16 v[64:65], v8 offset:8192
  ds_read_b64_tr_b16 v[66:67], v8 offset:9216
  s_waitcnt lgkmcnt(7)
  v_mfma_f32_32x32x16_bf16 v[16:31], v[52:55], v[228:231], v[16:31]
  ds_read_b128 v[244:247], v104 offset:4096
  ds_read_b64_tr_b16 v[68:69], v8 offset:10240
  ds_read_b64_tr_b16 v[70:71], v8 offset:11264
  s_waitcnt lgkmcnt(8)
  v_mfma_f32_32x32x16_bf16 v[16:31], v[56:59], v[232:235], v[16:31]
  ds_read_b128 v[248:251], v104 offset:8192
  ds_read_b64_tr_b16 v[48:49], v8 offset:12288
  ds_read_b64_tr_b16 v[50:51], v8 offset:13312
  s_waitcnt lgkmcnt(9)
  v_mfma_f32_32x32x16_bf16 v[16:31], v[60:63], v[236:239], v[16:31]
  ds_read_b128 v[252:255], v104 offset:12288
  ds_read_b64_tr_b16 v[52:53], v8 offset:14336
  ds_read_b64_tr_b16 v[54:55], v8 offset:15360
  s_waitcnt lgkmcnt(9)
  v_mfma_f32_32x32x16_bf16 v[88:103], v[64:67], v[224:227], v[88:103]
  ds_read_b64_tr_b16 v[56:57], v8 offset:57344
  ds_read_b64_tr_b16 v[58:59], v8 offset:58368
  s_waitcnt lgkmcnt(8)
  v_mfma_f32_32x32x16_bf16 v[88:103], v[68:71], v[228:231], v[88:103]
  ds_read_b64_tr_b16 v[60:61], v8 offset:59392
  ds_read_b64_tr_b16 v[62:63], v8 offset:60416
  s_waitcnt lgkmcnt(7)
  v_mfma_f32_32x32x16_bf16 v[88:103], v[48:51], v[232:235], v[88:103]
  ds_read_b64_tr_b16 v[64:65], v8 offset:61440
  ds_read_b64_tr_b16 v[66:67], v8 offset:62464
  s_waitcnt lgkmcnt(6)
  v_mfma_f32_32x32x16_bf16 v[88:103], v[52:55], v[236:239], v[88:103]
  ds_read_b64_tr_b16 v[68:69], v8 offset:63488
  ds_read_b64_tr_b16 v[70:71], v8 offset:64512
  s_waitcnt lgkmcnt(6)
  v_mfma_f32_32x32x16_bf16 v[208:223], v[56:59], v[224:227], v[208:223]
  ds_read_b64_tr_b16 v[48:49], v9 offset:16384
  ds_read_b64_tr_b16 v[50:51], v9 offset:17408
  s_waitcnt lgkmcnt(6)
  v_mfma_f32_32x32x16_bf16 v[208:223], v[60:63], v[228:231], v[208:223]
  ds_read_b64_tr_b16 v[52:53], v9 offset:18432
  ds_read_b64_tr_b16 v[54:55], v9 offset:19456
  s_waitcnt lgkmcnt(6)
  v_mfma_f32_32x32x16_bf16 v[208:223], v[64:67], v[232:235], v[208:223]
  ds_read_b64_tr_b16 v[56:57], v9 offset:20480
  ds_read_b64_tr_b16 v[58:59], v9 offset:21504
  s_waitcnt lgkmcnt(6)
  v_mfma_f32_32x32x16_bf16 v[208:223], v[68:71], v[236:239], v[208:223]
  ds_read_b64_tr_b16 v[60:61], v9 offset:22528
  ds_read_b64_tr_b16 v[62:63], v9 offset:23552
  s_setprio 0
  s_waitcnt vmcnt(7)
  s_barrier
  s_add_u32 m0, s67, 8192
  s_add_u32 s74, s34, 49152
  buffer_load_dwordx4 v12, s[16:19], s74 offen sc1 lds
  s_add_u32 m0, s67, 57344
  s_add_u32 s74, s34, 57344
  buffer_load_dwordx4 v12, s[16:19], s74 offen sc1 lds
  s_add_u32 m0, s67, 65536
  s_add_u32 s74, s83, s89
  buffer_load_dwordx4 v4, s[12:15], s74 offen lds
  s_add_u32 m0, s67, 73728
  s_add_u32 s74, s83, s90
  buffer_load_dwordx4 v4, s[12:15], s74 offen lds
  s_add_u32 m0, s67, 122880
  s_add_u32 s74, s83, s91
  buffer_load_dwordx4 v4, s[12:15], s74 offen lds
  s_add_u32 m0, s67, 147456
  s_add_u32 s74, s3, 49152
  buffer_load_dwordx4 v12, s[16:19], s74 offen sc1 lds
  s_branch L_pj12
  .p2align 12
L_stub12:
  s_setpc_b64 s[58:59]
  s_nop 0
L_pj12:
  s_setprio 1
  s_waitcnt lgkmcnt(6)
  v_mfma_f32_32x32x16_bf16 v[16:31], v[48:51], v[240:243], v[16:31]
  ds_read_b128 v[224:227], v13 offset:24576
  ds_read_b64_tr_b16 v[64:65], v8 offset:0
  ds_read_b64_tr_b16 v[66:67], v8 offset:1024
  s_waitcnt lgkmcnt(7)
  v_mfma_f32_32x32x16_bf16 v[16:31], v[52:55], v[244:247], v[16:31]
  ds_read_b128 v[228:231], v13 offset:28672
  ds_read_b64_tr_b16 v[68:69], v8 offset:2048
  ds_read_b64_tr_b16 v[70:71], v8 offset:3072
  s_waitcnt lgkmcnt(8)
  v_mfma_f32_32x32x16_bf16 v[16:31], v[56:59], v[248:251], v[16:31]
  ds_read_b128 v[232:235], v104 offset:24576
  ds_read_b64_tr_b16 v[48:49], v8 offset:4096
  ds_read_b64_tr_b16 v[50:51], v8 offset:5120
  s_waitcnt lgkmcnt(9)
  v_mfma_f32_32x32x16_bf16 v[16:31], v[60:63], v[252:255], v[16:31]
  ds_read_b128 v[236:239], v104 offset:28672
  ds_read_b64_tr_b16 v[52:53], v8 offset:6144
  ds_read_b64_tr_b16 v[54:55], v8 offset:7168
  s_waitcnt lgkmcnt(9)
  v_mfma_f32_32x32x16_bf16 v[88:103], v[64:67], v[240:243], v[88:103]
  ds_read_b64_tr_b16 v[56:57], v8 offset:16384
  ds_read_b64_tr_b16 v[58:59], v8 offset:17408
  s_waitcnt lgkmcnt(8)
  v_mfma_f32_32x32x16_bf16 v[88:103], v[68:71], v[244:247], v[88:103]
  ds_read_b64_tr_b16 v[60:61], v8 offset:18432
  ds_read_b64_tr_b16 v[62:63], v8 offset:19456
  s_waitcnt lgkmcnt(7)
  v_mfma_f32_32x32x16_bf16 v[88:103], v[48:51], v[248:251], v[88:103]
  ds_read_b64_tr_b16 v[64:65], v8 offset:20480
  ds_read_b64_tr_b16 v[66:67], v8 offset:21504
  s_waitcnt lgkmcnt(6)
  v_mfma_f32_32x32x16_bf16 v[88:103], v[52:55], v[252:255], v[88:103]
  ds_read_b64_tr_b16 v[68:69], v8 offset:22528
  ds_read_b64_tr_b16 v[70:71], v8 offset:23552
  s_waitcnt lgkmcnt(6)
  v_mfma_f32_32x32x16_bf16 v[208:223], v[56:59], v[240:243], v[208:223]
  ds_read_b64_tr_b16 v[48:49], v9 offset:32768
  ds_read_b64_tr_b16 v[50:51], v9 offset:33792
  s_waitcnt lgkmcnt(6)
  v_mfma_f32_32x32x16_bf16 v[208:223], v[60:63], v[244:247], v[208:223]
  ds_read_b64_tr_b16 v[52:53], v9 offset:34816
  ds_read_b64_tr_b16 v[54:55], v9 offset:35840
  s_waitcnt lgkmcnt(6)
  v_mfma_f32_32x32x16_bf16 v[208:223], v[64:67], v[248:251], v[208:223]
  ds_read_b64_tr_b16 v[56:57], v9 offset:36864
  ds_read_b64_tr_b16 v[58:59], v9 offset:37888
  s_waitcnt lgkmcnt(6)
  v_mfma_f32_32x32x16_bf16 v[208:223], v[68:71], v[252:255], v[208:223]
  ds_read_b64_tr_b16 v[60:61], v9 offset:38912
  ds_read_b64_tr_b16 v[62:63], v9 offset:39936
  s_setprio 0
  s_waitcnt vmcnt(8)
  s_barrier
  s_add_u32 m0, s67, 0
  s_add_u32 s74, s3, 57344
  buffer_load_dwordx4 v12, s[16:19], s74 offen sc1 lds
  s_add_u32 m0, s67, 16384
  s_add_u32 s74, s83, s92
  buffer_load_dwordx4 v4, s[12:15], s74 offen lds
  s_add_u32 m0, s67, 24576
  s_add_u32 s74, s83, s93
  buffer_load_dwordx4 v4, s[12:15], s74 offen lds
  s_add_u32 m0, s67, 81920
  s_add_u32 s74, s83, s94
  buffer_load_dwordx4 v4, s[12:15], s74 offen lds
  s_add_u32 m0, s67, 90112
  s_add_u32 s74, s34, 65536
  buffer_load_dwordx4 v12, s[16:19], s74 offen sc1 lds
  s_add_u32 m0, s67, 155648
  s_add_u32 s74, s34, 73728
  buffer_load_dwordx4 v12, s[16:19], s74 offen sc1 lds
  s_mul_hi_u32 s69, s62, 0x55555556
  s_mul_i32 s33, s69, 3
  s_sub_u32 s33, s62, s33
  s_lshl_b32 s69, s69, 2
  s_add_u32 s69, s69, s63
  s_xor_b32 s68, s61, 8
  s_mov_b32 s20, s50
  s_and_b32 s21, s51, 0xffff
  s_mov_b32 s22, 1152
  s_mov_b32 s23, 0x00020000
  s_mov_b32 s8, s52
  s_and_b32 s9, s53, 0xffff
  s_mov_b32 s10, 2359296
  s_mov_b32 s11, 0x00020000
  s_lshl_b32 s31, s68, 2
  s_lshr_b32 s66, s69, 2
  s_add_u32 s31, s31, s66
  s_lshl_b32 s32, s68, 3
  s_lshr_b32 s66, s69, 1
  s_add_u32 s32, s32, s66
  s_lshl_b32 s32, s32, 7
  s_add_u32 s32, s32, 49283072
  s_setprio 1
  s_waitcnt lgkmcnt(6)
  v_mfma_f32_32x32x16_bf16 v[16:31], v[48:51], v[224:227], v[16:31]
  ds_read_b128 v[240:243], v13 offset:40960
  ds_read_b64_tr_b16 v[64:65], v10 offset:0
  ds_read_b64_tr_b16 v[66:67], v10 offset:1024
  s_waitcnt lgkmcnt(7)
  v_mfma_f32_32x32x16_bf16 v[16:31], v[52:55], v[228:231], v[16:31]
  ds_read_b128 v[244:247], v13 offset:45056
  ds_read_b64_tr_b16 v[68:69], v10 offset:2048
  ds_read_b64_tr_b16 v[70:71], v10 offset:3072
  s_waitcnt lgkmcnt(8)
  v_mfma_f32_32x32x16_bf16 v[16:31], v[56:59], v[232:235], v[16:31]
  ds_read_b128 v[248:251], v13 offset:49152
  ds_read_b64_tr_b16 v[48:49], v10 offset:4096
  ds_read_b64_tr_b16 v[50:51], v10 offset:5120
  s_waitcnt lgkmcnt(9)
  v_mfma_f32_32x32x16_bf16 v[16:31], v[60:63], v[236:239], v[16:31]
  ds_read_b128 v[252:255], v13 offset:53248
  ds_read_b64_tr_b16 v[52:53], v10 offset:6144
  ds_read_b64_tr_b16 v[54:55], v10 offset:7168
  s_waitcnt lgkmcnt(9)
  v_mfma_f32_32x32x16_bf16 v[88:103], v[64:67], v[224:227], v[88:103]
  ds_read_b64_tr_b16 v[56:57], v8 offset:32768
  ds_read_b64_tr_b16 v[58:59], v8 offset:33792
  s_waitcnt lgkmcnt(8)
  v_mfma_f32_32x32x16_bf16 v[88:103], v[68:71], v[228:231], v[88:103]
  ds_read_b64_tr_b16 v[60:61], v8 offset:34816
  ds_read_b64_tr_b16 v[62:63], v8 offset:35840
  s_waitcnt lgkmcnt(7)
  v_mfma_f32_32x32x16_bf16 v[88:103], v[48:51], v[232:235], v[88:103]
  ds_read_b64_tr_b16 v[64:65], v8 offset:36864
  ds_read_b64_tr_b16 v[66:67], v8 offset:37888
  s_waitcnt lgkmcnt(6)
  v_mfma_f32_32x32x16_bf16 v[88:103], v[52:55], v[236:239], v[88:103]
  ds_read_b64_tr_b16 v[68:69], v8 offset:38912
  ds_read_b64_tr_b16 v[70:71], v8 offset:39936
  s_waitcnt lgkmcnt(6)
  v_mfma_f32_32x32x16_bf16 v[208:223], v[56:59], v[224:227], v[208:223]
  ds_read_b64_tr_b16 v[48:49], v9 offset:40960
  ds_read_b64_tr_b16 v[50:51], v9 offset:41984
  s_waitcnt lgkmcnt(6)
  v_mfma_f32_32x32x16_bf16 v[208:223], v[60:63], v[228:231], v[208:223]
  ds_read_b64_tr_b16 v[52:53], v9 offset:43008
  ds_read_b64_tr_b16 v[54:55], v9 offset:44032
  s_waitcnt lgkmcnt(6)
  v_mfma_f32_32x32x16_bf16 v[208:223], v[64:67], v[232:235], v[208:223]
  ds_read_b64_tr_b16 v[56:57], v9 offset:45056
  ds_read_b64_tr_b16 v[58:59], v9 offset:46080
  s_waitcnt lgkmcnt(6)
  v_mfma_f32_32x32x16_bf16 v[208:223], v[68:71], v[236:239], v[208:223]
  ds_read_b64_tr_b16 v[60:61], v9 offset:47104
  ds_read_b64_tr_b16 v[62:63], v9 offset:48128
  s_setprio 0
  s_waitcnt vmcnt(9)
  s_barrier
  s_add_u32 m0, s67, 32768
  s_add_u32 s74, s84, s89
  buffer_load_dwordx4 v4, s[12:15], s74 offen lds
  s_add_u32 m0, s67, 40960
  s_add_u32 s74, s84, s90
  buffer_load_dwordx4 v4, s[12:15], s74 offen lds
  s_add_u32 m0, s67, 49152
  s_add_u32 s74, s84, s91
  buffer_load_dwordx4 v4, s[12:15], s74 offen lds
  s_add_u32 m0, s67, 98304
  s_add_u32 s74, s3, 65536
  buffer_load_dwordx4 v12, s[16:19], s74 offen sc1 lds
  s_add_u32 m0, s67, 131072
  s_add_u32 s74, s3, 73728
  buffer_load_dwordx4 v12, s[16:19], s74 offen sc1 lds
  s_and_b32 s70, s69, 1
  s_lshl_b32 s66, s70, 8
  v_and_b32 v32, 15, v1
  v_lshl_add_u32 v32, v32, 4, s66
  v_bfe_u32 v14, v1, 4, 1
  v_lshl_add_u32 v32, v14, 9, v32
  v_lshrrev_b32 v15, 5, v1
  v_lshl_add_u32 v33, v15, 10, v32
  v_mul_u32_u24 v35, 4096, v15
  v_add_u32 v32, v32, v35
  v_lshlrev_b32 v35, 5, v14
  v_lshl_add_u32 v35, v15, 4, v35
  s_and_b32 s65, s31, 7
  s_lshl_b32 s65, s65, 8
  s_lshl_b32 s70, s70, 7
  s_add_u32 s65, s65, s70
  s_lshr_b32 s66, s31, 5
  s_add_u32 s65, s65, s66
  s_and_b32 s66, s31, 16
  s_lshl_b32 s66, s66, 1
  s_add_u32 s65, s65, s66
  s_and_b32 s66, s31, 8
  s_add_u32 s65, s65, s66
  v_lshl_add_u32 v34, v15, 6, s65
  v_lshl_add_u32 v34, v14, 4, v34
  v_bfe_u32 v14, v1, 2, 2
  v_lshl_add_u32 v34, v14, 1, v34
  v_mul_u32_u24 v34, 1152, v34
  v_and_b32 v37, 3, v1
  v_lshl_add_u32 v34, v37, 4, v34
  s_setprio 1
  s_waitcnt lgkmcnt(6)
  v_mfma_f32_32x32x16_bf16 v[16:31], v[48:51], v[240:243], v[16:31]
  ds_read_b128 v[224:227], v13 offset:8192
  ds_read_b64_tr_b16 v[64:65], v9 offset:49152
  ds_read_b64_tr_b16 v[66:67], v9 offset:50176
  s_waitcnt lgkmcnt(7)
  v_mfma_f32_32x32x16_bf16 v[16:31], v[52:55], v[244:247], v[16:31]
  ds_read_b128 v[228:231], v13 offset:12288
  ds_read_b64_tr_b16 v[68:69], v9 offset:51200
  ds_read_b64_tr_b16 v[70:71], v9 offset:52224
  s_waitcnt lgkmcnt(8)
  v_mfma_f32_32x32x16_bf16 v[16:31], v[56:59], v[248:251], v[16:31]
  ds_read_b128 v[232:235], v13 offset:57344
  ds_read_b64_tr_b16 v[48:49], v9 offset:53248
  ds_read_b64_tr_b16 v[50:51], v9 offset:54272
  s_waitcnt lgkmcnt(9)
  v_mfma_f32_32x32x16_bf16 v[16:31], v[60:63], v[252:255], v[16:31]
  ds_read_b128 v[236:239], v13 offset:61440
  ds_read_b64_tr_b16 v[52:53], v9 offset:55296
  ds_read_b64_tr_b16 v[54:55], v9 offset:56320
  s_waitcnt lgkmcnt(9)
  v_mfma_f32_32x32x16_bf16 v[88:103], v[64:67], v[240:243], v[88:103]
  ds_read_b64_tr_b16 v[56:57], v10 offset:8192
  ds_read_b64_tr_b16 v[58:59], v10 offset:9216
  s_waitcnt lgkmcnt(8)
  v_mfma_f32_32x32x16_bf16 v[88:103], v[68:71], v[244:247], v[88:103]
  ds_read_b64_tr_b16 v[60:61], v10 offset:10240
  ds_read_b64_tr_b16 v[62:63], v10 offset:11264
  s_waitcnt lgkmcnt(7)
  v_mfma_f32_32x32x16_bf16 v[88:103], v[48:51], v[248:251], v[88:103]
  ds_read_b64_tr_b16 v[64:65], v10 offset:12288
  ds_read_b64_tr_b16 v[66:67], v10 offset:13312
  s_waitcnt lgkmcnt(6)
  v_mfma_f32_32x32x16_bf16 v[88:103], v[52:55], v[252:255], v[88:103]
  ds_read_b64_tr_b16 v[68:69], v10 offset:14336
  ds_read_b64_tr_b16 v[70:71], v10 offset:15360
  s_waitcnt lgkmcnt(6)
  v_mfma_f32_32x32x16_bf16 v[208:223], v[56:59], v[240:243], v[208:223]
  ds_read_b64_tr_b16 v[48:49], v9 offset:0
  ds_read_b64_tr_b16 v[50:51], v9 offset:1024
  s_waitcnt lgkmcnt(6)
  v_mfma_f32_32x32x16_bf16 v[208:223], v[60:63], v[244:247], v[208:223]
  ds_read_b64_tr_b16 v[52:53], v9 offset:2048
  ds_read_b64_tr_b16 v[54:55], v9 offset:3072
  s_waitcnt lgkmcnt(6)
  v_mfma_f32_32x32x16_bf16 v[208:223], v[64:67], v[248:251], v[208:223]
  ds_read_b64_tr_b16 v[56:57], v9 offset:4096
  ds_read_b64_tr_b16 v[58:59], v9 offset:5120
  s_waitcnt lgkmcnt(6)
  v_mfma_f32_32x32x16_bf16 v[208:223], v[68:71], v[252:255], v[208:223]
  ds_read_b64_tr_b16 v[60:61], v9 offset:6144
  ds_read_b64_tr_b16 v[62:63], v9 offset:7168
  s_setprio 0
  s_waitcnt vmcnt(9)
  s_barrier
  s_add_u32 m0, s67, 8192
  s_add_u32 s74, s84, s92
  buffer_load_dwordx4 v4, s[12:15], s74 offen lds
  s_add_u32 m0, s67, 57344
  s_add_u32 s74, s84, s93
  buffer_load_dwordx4 v4, s[12:15], s74 offen lds
  s_add_u32 m0, s67, 106496
  s_add_u32 s74, s84, s94
  buffer_load_dwordx4 v4, s[12:15], s74 offen lds
  s_setprio 1
  s_waitcnt lgkmcnt(6)
  v_mfma_f32_32x32x16_bf16 v[16:31], v[48:51], v[224:227], v[16:31]
  ds_read_b128 v[240:243], v105 offset:16384
  ds_read_b64_tr_b16 v[64:65], v9 offset:8192
  ds_read_b64_tr_b16 v[66:67], v9 offset:9216
  s_waitcnt lgkmcnt(7)
  v_mfma_f32_32x32x16_bf16 v[16:31], v[52:55], v[228:231], v[16:31]
  ds_read_b128 v[244:247], v105 offset:20480
  ds_read_b64_tr_b16 v[68:69], v9 offset:10240
  ds_read_b64_tr_b16 v[70:71], v9 offset:11264
  s_waitcnt lgkmcnt(8)
  v_mfma_f32_32x32x16_bf16 v[16:31], v[56:59], v[232:235], v[16:31]
  ds_read_b128 v[248:251], v13 offset:0
  ds_read_b64_tr_b16 v[48:49], v9 offset:12288
  ds_read_b64_tr_b16 v[50:51], v9 offset:13312
  s_waitcnt lgkmcnt(9)
  v_mfma_f32_32x32x16_bf16 v[16:31], v[60:63], v[236:239], v[16:31]
  ds_read_b128 v[252:255], v13 offset:4096
  ds_read_b64_tr_b16 v[52:53], v9 offset:14336
  ds_read_b64_tr_b16 v[54:55], v9 offset:15360
  s_waitcnt lgkmcnt(9)
  v_mfma_f32_32x32x16_bf16 v[88:103], v[64:67], v[224:227], v[88:103]
  ds_read_b64_tr_b16 v[56:57], v9 offset:57344
  ds_read_b64_tr_b16 v[58:59], v9 offset:58368
  s_waitcnt lgkmcnt(8)
  v_mfma_f32_32x32x16_bf16 v[88:103], v[68:71], v[228:231], v[88:103]
  ds_read_b64_tr_b16 v[60:61], v9 offset:59392
  ds_read_b64_tr_b16 v[62:63], v9 offset:60416
  s_waitcnt lgkmcnt(7)
  v_mfma_f32_32x32x16_bf16 v[88:103], v[48:51], v[232:235], v[88:103]
  ds_read_b64_tr_b16 v[64:65], v9 offset:61440
  ds_read_b64_tr_b16 v[66:67], v9 offset:62464
  s_waitcnt lgkmcnt(6)
  v_mfma_f32_32x32x16_bf16 v[88:103], v[52:55], v[236:239], v[88:103]
  ds_read_b64_tr_b16 v[68:69], v9 offset:63488
  ds_read_b64_tr_b16 v[70:71], v9 offset:64512
  s_waitcnt lgkmcnt(6)
  v_mfma_f32_32x32x16_bf16 v[208:223], v[56:59], v[224:227], v[208:223]
  ds_read_b64_tr_b16 v[48:49], v8 offset:16384
  ds_read_b64_tr_b16 v[50:51], v8 offset:17408
  s_waitcnt lgkmcnt(6)
  v_mfma_f32_32x32x16_bf16 v[208:223], v[60:63], v[228:231], v[208:223]
  ds_read_b64_tr_b16 v[52:53], v8 offset:18432
  ds_read_b64_tr_b16 v[54:55], v8 offset:19456
  s_waitcnt lgkmcnt(6)
  v_mfma_f32_32x32x16_bf16 v[208:223], v[64:67], v[232:235], v[208:223]
  ds_read_b64_tr_b16 v[56:57], v8 offset:20480
  ds_read_b64_tr_b16 v[58:59], v8 offset:21504
  s_waitcnt lgkmcnt(6)
  v_mfma_f32_32x32x16_bf16 v[208:223], v[68:71], v[236:239], v[208:223]
  ds_read_b64_tr_b16 v[60:61], v8 offset:22528
  ds_read_b64_tr_b16 v[62:63], v8 offset:23552
  s_setprio 0
  s_waitcnt vmcnt(7)
  s_barrier
  s_add_u32 m0, s67, 0
  s_add_u32 s74, s34, 81920
  buffer_load_dwordx4 v12, s[16:19], s74 offen sc1 lds
  s_add_u32 m0, s67, 65536
  s_add_u32 s74, s34, 90112
  buffer_load_dwordx4 v12, s[16:19], s74 offen sc1 lds
  s_add_u32 m0, s67, 73728
  s_add_u32 s74, s85, s89
  buffer_load_dwordx4 v4, s[12:15], s74 offen lds
  s_add_u32 m0, s67, 114688
  s_add_u32 s74, s85, s90
  buffer_load_dwordx4 v4, s[12:15], s74 offen lds
  s_add_u32 m0, s67, 122880
  s_add_u32 s74, s85, s91
  buffer_load_dwordx4 v4, s[12:15], s74 offen lds
  s_add_u32 m0, s67, 139264
  s_add_u32 s74, s3, 81920
  buffer_load_dwordx4 v12, s[16:19], s74 offen sc1 lds
  v_lshrrev_b32 v38, 2, v1
  v_and_b32 v14, 1, v1
  v_lshl_add_u32 v38, v14, 5, v38
  v_bfe_u32 v14, v1, 1, 1
  v_lshl_add_u32 v38, v14, 4, v38
  v_lshlrev_b32 v38, 2, v38
  v_mul_u32_u24 v36, 12, v37
  v_lshlrev_b32 v37, 7, v37
  s_mov_b32 s71, 0xffff0000
  s_mov_b32 s72, 0xbfb8aa3b
  s_add_u32 s66, s68, 1
  s_mul_hi_u32 s65, s66, 0x55555556
  s_mul_i32 s65, s65, 3
  s_sub_u32 s66, s66, s65
  s_mul_i32 s65, s33, 3
  s_add_u32 s66, s66, s65
  s_lshl_b32 s66, s66, 1
  s_bfe_u32 s65, s69, 0x10001
  s_add_u32 s66, s66, s65
  s_lshl_b32 s30, s66, 6
  s_mul_i32 s65, s31, 147584
  s_lshl_b32 s28, s66, 13
  s_add_u32 s28, s28, s65
  s_mul_i32 s65, s31, 36992
  s_lshl_b32 s29, s66, 11
  s_add_u32 s29, s29, s65
  s_add_u32 s29, s29, 33554432
  s_mul_i32 s32, s68, 12
  s_add_u32 s32, s32, s62
  s_lshl_b32 s32, s32, 7
  s_add_u32 s32, s32, 49414176
  v_and_b32 v36, 7, v1
  v_lshlrev_b32 v36, 2, v36
  s_lshl_b32 s77, s68, 9
  s_add_u32 s77, s77, 49807360
  s_and_b32 s77, s61, 7
  s_lshl_b32 s77, s77, 9
  s_add_u32 s77, s77, 49807360
  v_bfe_u32 v14, v1, 2, 1
  v_lshl_add_u32 v37, v14, 12, v37
  s_setprio 1
  s_waitcnt lgkmcnt(6)
  v_mfma_f32_32x32x16_bf16 v[16:31], v[48:51], v[240:243], v[16:31]
  ds_read_b128 v[224:227], v104 offset:24576
  ds_read_b64_tr_b16 v[64:65], v8 offset:24576
  ds_read_b64_tr_b16 v[66:67], v8 offset:25600
  s_waitcnt lgkmcnt(7)
  v_mfma_f32_32x32x16_bf16 v[16:31], v[52:55], v[244:247], v[16:31]
  ds_read_b128 v[228:231], v104 offset:28672
  ds_read_b64_tr_b16 v[68:69], v8 offset:26624
  ds_read_b64_tr_b16 v[70:71], v8 offset:27648
  s_waitcnt lgkmcnt(8)
  v_mfma_f32_32x32x16_bf16 v[16:31], v[56:59], v[248:251], v[16:31]
  ds_read_b128 v[232:235], v105 offset:24576
  ds_read_b64_tr_b16 v[48:49], v8 offset:28672
  ds_read_b64_tr_b16 v[50:51], v8 offset:29696
  s_waitcnt lgkmcnt(9)
  v_mfma_f32_32x32x16_bf16 v[16:31], v[60:63], v[252:255], v[16:31]
  ds_read_b128 v[236:239], v105 offset:28672
  ds_read_b64_tr_b16 v[52:53], v8 offset:30720
  ds_read_b64_tr_b16 v[54:55], v8 offset:31744
  s_waitcnt lgkmcnt(9)
  v_mfma_f32_32x32x16_bf16 v[88:103], v[64:67], v[240:243], v[88:103]
  ds_read_b64_tr_b16 v[56:57], v9 offset:16384
  ds_read_b64_tr_b16 v[58:59], v9 offset:17408
  s_waitcnt lgkmcnt(8)
  v_mfma_f32_32x32x16_bf16 v[88:103], v[68:71], v[244:247], v[88:103]
  ds_read_b64_tr_b16 v[60:61], v9 offset:18432
  ds_read_b64_tr_b16 v[62:63], v9 offset:19456
  s_waitcnt lgkmcnt(7)
  v_mfma_f32_32x32x16_bf16 v[88:103], v[48:51], v[248:251], v[88:103]
  ds_read_b64_tr_b16 v[64:65], v9 offset:20480
  ds_read_b64_tr_b16 v[66:67], v9 offset:21504
  s_waitcnt lgkmcnt(6)
  v_mfma_f32_32x32x16_bf16 v[88:103], v[52:55], v[252:255], v[88:103]
  ds_read_b64_tr_b16 v[68:69], v9 offset:22528
  ds_read_b64_tr_b16 v[70:71], v9 offset:23552
  s_waitcnt lgkmcnt(6)
  v_mfma_f32_32x32x16_bf16 v[208:223], v[56:59], v[240:243], v[208:223]
  ds_read_b64_tr_b16 v[48:49], v8 offset:32768
  ds_read_b64_tr_b16 v[50:51], v8 offset:33792
  s_waitcnt lgkmcnt(6)
  v_mfma_f32_32x32x16_bf16 v[208:223], v[60:63], v[244:247], v[208:223]
  ds_read_b64_tr_b16 v[52:53], v8 offset:34816
  ds_read_b64_tr_b16 v[54:55], v8 offset:35840
  s_waitcnt lgkmcnt(6)
  v_mfma_f32_32x32x16_bf16 v[208:223], v[64:67], v[248:251], v[208:223]
  ds_read_b64_tr_b16 v[56:57], v8 offset:36864
  ds_read_b64_tr_b16 v[58:59], v8 offset:37888
  s_waitcnt lgkmcnt(6)
  v_mfma_f32_32x32x16_bf16 v[208:223], v[68:71], v[252:255], v[208:223]
  ds_read_b64_tr_b16 v[60:61], v8 offset:38912
  ds_read_b64_tr_b16 v[62:63], v8 offset:39936
  s_setprio 0
  s_waitcnt vmcnt(8)
  s_barrier
  s_add_u32 m0, s67, 16384
  s_add_u32 s74, s3, 90112
  buffer_load_dwordx4 v12, s[16:19], s74 offen sc1 lds
  s_add_u32 m0, s67, 24576
  s_add_u32 s74, s85, s92
  buffer_load_dwordx4 v4, s[12:15], s74 offen lds
  s_add_u32 m0, s67, 81920
  s_add_u32 s74, s85, s93
  buffer_load_dwordx4 v4, s[12:15], s74 offen lds
  s_add_u32 m0, s67, 90112
  s_add_u32 s74, s85, s94
  buffer_load_dwordx4 v4, s[12:15], s74 offen lds
  s_add_u32 m0, s67, 147456
  s_add_u32 s74, s82, s86
  buffer_load_dwordx4 v4, s[12:15], s74 offen lds
  s_add_u32 m0, s67, 155648
  s_add_u32 s74, s83, s86
  buffer_load_dwordx4 v4, s[12:15], s74 offen lds
  s_setprio 1
  s_waitcnt lgkmcnt(6)
  v_mfma_f32_32x32x16_bf16 v[16:31], v[48:51], v[224:227], v[16:31]
  ds_read_b128 v[240:243], v104 offset:32768
  ds_read_b64_tr_b16 v[64:65], v8 offset:40960
  ds_read_b64_tr_b16 v[66:67], v8 offset:41984
  s_waitcnt lgkmcnt(7)
  v_mfma_f32_32x32x16_bf16 v[16:31], v[52:55], v[228:231], v[16:31]
  ds_read_b128 v[244:247], v104 offset:36864
  ds_read_b64_tr_b16 v[68:69], v8 offset:43008
  ds_read_b64_tr_b16 v[70:71], v8 offset:44032
  s_waitcnt lgkmcnt(8)
  v_mfma_f32_32x32x16_bf16 v[16:31], v[56:59], v[232:235], v[16:31]
  ds_read_b128 v[248:251], v105 offset:0
  ds_read_b64_tr_b16 v[48:49], v8 offset:45056
  ds_read_b64_tr_b16 v[50:51], v8 offset:46080
  s_waitcnt lgkmcnt(9)
  v_mfma_f32_32x32x16_bf16 v[16:31], v[60:63], v[236:239], v[16:31]
  ds_read_b128 v[252:255], v105 offset:4096
  ds_read_b64_tr_b16 v[52:53], v8 offset:47104
  ds_read_b64_tr_b16 v[54:55], v8 offset:48128
  s_waitcnt lgkmcnt(9)
  v_mfma_f32_32x32x16_bf16 v[88:103], v[64:67], v[224:227], v[88:103]
  ds_read_b64_tr_b16 v[56:57], v8 offset:49152
  ds_read_b64_tr_b16 v[58:59], v8 offset:50176
  s_waitcnt lgkmcnt(8)
  v_mfma_f32_32x32x16_bf16 v[88:103], v[68:71], v[228:231], v[88:103]
  ds_read_b64_tr_b16 v[60:61], v8 offset:51200
  ds_read_b64_tr_b16 v[62:63], v8 offset:52224
  s_waitcnt lgkmcnt(7)
  v_mfma_f32_32x32x16_bf16 v[88:103], v[48:51], v[232:235], v[88:103]
  ds_read_b64_tr_b16 v[64:65], v8 offset:53248
  ds_read_b64_tr_b16 v[66:67], v8 offset:54272
  s_waitcnt lgkmcnt(6)
  v_mfma_f32_32x32x16_bf16 v[88:103], v[52:55], v[236:239], v[88:103]
  ds_read_b64_tr_b16 v[68:69], v8 offset:55296
  ds_read_b64_tr_b16 v[70:71], v8 offset:56320
  s_waitcnt lgkmcnt(6)
  v_mfma_f32_32x32x16_bf16 v[208:223], v[56:59], v[224:227], v[208:223]
  ds_read_b64_tr_b16 v[48:49], v8 offset:8192
  ds_read_b64_tr_b16 v[50:51], v8 offset:9216
  s_waitcnt lgkmcnt(6)
  v_mfma_f32_32x32x16_bf16 v[208:223], v[60:63], v[228:231], v[208:223]
  ds_read_b64_tr_b16 v[52:53], v8 offset:10240
  ds_read_b64_tr_b16 v[54:55], v8 offset:11264
  s_waitcnt lgkmcnt(6)
  v_mfma_f32_32x32x16_bf16 v[208:223], v[64:67], v[232:235], v[208:223]
  ds_read_b64_tr_b16 v[56:57], v8 offset:12288
  ds_read_b64_tr_b16 v[58:59], v8 offset:13312
  s_waitcnt lgkmcnt(6)
  v_mfma_f32_32x32x16_bf16 v[208:223], v[68:71], v[236:239], v[208:223]
  ds_read_b64_tr_b16 v[60:61], v8 offset:14336
  ds_read_b64_tr_b16 v[62:63], v8 offset:15360
  s_setprio 0
  s_waitcnt vmcnt(9)
  s_barrier
  s_add_u32 m0, s67, 32768
  s_add_u32 s74, s84, s86
  buffer_load_dwordx4 v4, s[12:15], s74 offen lds
  s_add_u32 m0, s67, 40960
  s_add_u32 s74, s85, s86
  buffer_load_dwordx4 v4, s[12:15], s74 offen lds
  s_add_u32 m0, s67, 49152
  s_add_u32 s74, s82, s87
  buffer_load_dwordx4 v4, s[12:15], s74 offen lds
  s_add_u32 m0, s67, 98304
  s_add_u32 s74, s83, s87
  buffer_load_dwordx4 v4, s[12:15], s74 offen lds
  s_add_u32 m0, s67, 131072
  s_add_u32 s74, s84, s87
  buffer_load_dwordx4 v4, s[12:15], s74 offen lds
  s_setprio 1
  s_waitcnt lgkmcnt(6)
  v_mfma_f32_32x32x16_bf16 v[16:31], v[48:51], v[240:243], v[16:31]
  ds_read_b128 v[224:227], v13 offset:0
  ds_read_b64_tr_b16 v[64:65], v8 offset:57344
  ds_read_b64_tr_b16 v[66:67], v8 offset:58368
  s_waitcnt lgkmcnt(7)
  v_mfma_f32_32x32x16_bf16 v[16:31], v[52:55], v[244:247], v[16:31]
  ds_read_b128 v[228:231], v13 offset:4096
  ds_read_b64_tr_b16 v[68:69], v8 offset:59392
  ds_read_b64_tr_b16 v[70:71], v8 offset:60416
  s_waitcnt lgkmcnt(8)
  v_mfma_f32_32x32x16_bf16 v[16:31], v[56:59], v[248:251], v[16:31]
  ds_read_b128 v[232:235], v104 offset:0
  ds_read_b64_tr_b16 v[48:49], v8 offset:61440
  ds_read_b64_tr_b16 v[50:51], v8 offset:62464
  s_waitcnt lgkmcnt(9)
  v_mfma_f32_32x32x16_bf16 v[16:31], v[60:63], v[252:255], v[16:31]
  ds_read_b128 v[236:239], v104 offset:4096
  ds_read_b64_tr_b16 v[52:53], v8 offset:63488
  ds_read_b64_tr_b16 v[54:55], v8 offset:64512
  s_waitcnt lgkmcnt(9)
  v_mfma_f32_32x32x16_bf16 v[88:103], v[64:67], v[240:243], v[88:103]
  ds_read_b64_tr_b16 v[56:57], v9 offset:40960
  ds_read_b64_tr_b16 v[58:59], v9 offset:41984
  s_waitcnt lgkmcnt(8)
  v_mfma_f32_32x32x16_bf16 v[88:103], v[68:71], v[244:247], v[88:103]
  ds_read_b64_tr_b16 v[60:61], v9 offset:43008
  ds_read_b64_tr_b16 v[62:63], v9 offset:44032
  s_waitcnt lgkmcnt(7)
  v_mfma_f32_32x32x16_bf16 v[88:103], v[48:51], v[248:251], v[88:103]
  ds_read_b64_tr_b16 v[64:65], v9 offset:45056
  ds_read_b64_tr_b16 v[66:67], v9 offset:46080
  s_waitcnt lgkmcnt(6)
  v_mfma_f32_32x32x16_bf16 v[88:103], v[52:55], v[252:255], v[88:103]
  ds_read_b64_tr_b16 v[68:69], v9 offset:47104
  ds_read_b64_tr_b16 v[70:71], v9 offset:48128
  s_waitcnt lgkmcnt(6)
  v_mfma_f32_32x32x16_bf16 v[208:223], v[56:59], v[240:243], v[208:223]
  ds_read_b64_tr_b16 v[48:49], v9 offset:8192
  ds_read_b64_tr_b16 v[50:51], v9 offset:9216
  s_waitcnt lgkmcnt(6)
  v_mfma_f32_32x32x16_bf16 v[208:223], v[60:63], v[244:247], v[208:223]
  ds_read_b64_tr_b16 v[52:53], v9 offset:10240
  ds_read_b64_tr_b16 v[54:55], v9 offset:11264
  s_waitcnt lgkmcnt(6)
  v_mfma_f32_32x32x16_bf16 v[208:223], v[64:67], v[248:251], v[208:223]
  ds_read_b64_tr_b16 v[56:57], v9 offset:12288
  ds_read_b64_tr_b16 v[58:59], v9 offset:13312
  s_waitcnt lgkmcnt(6)
  v_mfma_f32_32x32x16_bf16 v[208:223], v[68:71], v[252:255], v[208:223]
  ds_read_b64_tr_b16 v[60:61], v9 offset:14336
  ds_read_b64_tr_b16 v[62:63], v9 offset:15360
  s_setprio 0
  s_waitcnt vmcnt(9)
  s_barrier
  s_add_u32 m0, s67, 0
  s_add_u32 s74, s85, s87
  buffer_load_dwordx4 v4, s[12:15], s74 offen lds
  s_add_u32 m0, s67, 8192
  s_add_u32 s74, s82, s88
  buffer_load_dwordx4 v4, s[12:15], s74 offen lds
  s_add_u32 m0, s67, 57344
  s_add_u32 s74, s83, s88
  buffer_load_dwordx4 v4, s[12:15], s74 offen lds
  s_branch L_pj13
  .p2align 12
L_stub13:
  s_setpc_b64 s[58:59]
  s_nop 0
L_pj13:
  s_setprio 1
  s_waitcnt lgkmcnt(6)
  v_mfma_f32_32x32x16_bf16 v[16:31], v[48:51], v[224:227], v[16:31]
  ds_read_b128 v[240:243], v105 offset:8192
  ds_read_b64_tr_b16 v[64:65], v9 offset:49152
  ds_read_b64_tr_b16 v[66:67], v9 offset:50176
  s_waitcnt lgkmcnt(7)
  v_mfma_f32_32x32x16_bf16 v[16:31], v[52:55], v[228:231], v[16:31]
  ds_read_b128 v[244:247], v105 offset:12288
  ds_read_b64_tr_b16 v[68:69], v9 offset:51200
  ds_read_b64_tr_b16 v[70:71], v9 offset:52224
  s_waitcnt lgkmcnt(8)
  v_mfma_f32_32x32x16_bf16 v[16:31], v[56:59], v[232:235], v[16:31]
  ds_read_b128 v[248:251], v13 offset:16384
  ds_read_b64_tr_b16 v[48:49], v9 offset:53248
  ds_read_b64_tr_b16 v[50:51], v9 offset:54272
  s_waitcnt lgkmcnt(9)
  v_mfma_f32_32x32x16_bf16 v[16:31], v[60:63], v[236:239], v[16:31]
  ds_read_b128 v[252:255], v13 offset:20480
  ds_read_b64_tr_b16 v[52:53], v9 offset:55296
  ds_read_b64_tr_b16 v[54:55], v9 offset:56320
  s_waitcnt lgkmcnt(9)
  v_mfma_f32_32x32x16_bf16 v[88:103], v[64:67], v[224:227], v[88:103]
  ds_read_b64_tr_b16 v[56:57], v9 offset:57344
  ds_read_b64_tr_b16 v[58:59], v9 offset:58368
  s_waitcnt lgkmcnt(8)
  v_mfma_f32_32x32x16_bf16 v[88:103], v[68:71], v[228:231], v[88:103]
  ds_read_b64_tr_b16 v[60:61], v9 offset:59392
  ds_read_b64_tr_b16 v[62:63], v9 offset:60416
  s_waitcnt lgkmcnt(7)
  v_mfma_f32_32x32x16_bf16 v[88:103], v[48:51], v[232:235], v[88:103]
  ds_read_b64_tr_b16 v[64:65], v9 offset:61440
  ds_read_b64_tr_b16 v[66:67], v9 offset:62464
  s_waitcnt lgkmcnt(6)
  v_mfma_f32_32x32x16_bf16 v[88:103], v[52:55], v[236:239], v[88:103]
  ds_read_b64_tr_b16 v[68:69], v9 offset:63488
  ds_read_b64_tr_b16 v[70:71], v9 offset:64512
  s_waitcnt lgkmcnt(6)
  v_mfma_f32_32x32x16_bf16 v[208:223], v[56:59], v[224:227], v[208:223]
  ds_read_b64_tr_b16 v[48:49], v8 offset:24576
  ds_read_b64_tr_b16 v[50:51], v8 offset:25600
  s_waitcnt lgkmcnt(6)
  v_mfma_f32_32x32x16_bf16 v[208:223], v[60:63], v[228:231], v[208:223]
  ds_read_b64_tr_b16 v[52:53], v8 offset:26624
  ds_read_b64_tr_b16 v[54:55], v8 offset:27648
  s_waitcnt lgkmcnt(6)
  v_mfma_f32_32x32x16_bf16 v[208:223], v[64:67], v[232:235], v[208:223]
  ds_read_b64_tr_b16 v[56:57], v8 offset:28672
  ds_read_b64_tr_b16 v[58:59], v8 offset:29696
  s_waitcnt lgkmcnt(6)
  v_mfma_f32_32x32x16_bf16 v[208:223], v[68:71], v[236:239], v[208:223]
  ds_read_b64_tr_b16 v[60:61], v8 offset:30720
  ds_read_b64_tr_b16 v[62:63], v8 offset:31744
  s_setprio 0
  s_waitcnt vmcnt(9)
  s_barrier
  s_add_u32 m0, s67, 16384
  s_add_u32 s74, s84, s88
  buffer_load_dwordx4 v4, s[12:15], s74 offen lds
  s_add_u32 m0, s67, 65536
  s_add_u32 s74, s85, s88
  buffer_load_dwordx4 v4, s[12:15], s74 offen lds
  s_setprio 1
  s_waitcnt lgkmcnt(6)
  v_mfma_f32_32x32x16_bf16 v[16:31], v[48:51], v[240:243], v[16:31]
  ds_read_b64_tr_b16 v[64:65], v9 offset:16384
  ds_read_b64_tr_b16 v[66:67], v9 offset:17408
  s_waitcnt lgkmcnt(6)
  v_mfma_f32_32x32x16_bf16 v[16:31], v[52:55], v[244:247], v[16:31]
  ds_read_b64_tr_b16 v[68:69], v9 offset:18432
  ds_read_b64_tr_b16 v[70:71], v9 offset:19456
  s_waitcnt lgkmcnt(6)
  v_mfma_f32_32x32x16_bf16 v[16:31], v[56:59], v[248:251], v[16:31]
  ds_read_b64_tr_b16 v[48:49], v9 offset:20480
  ds_read_b64_tr_b16 v[50:51], v9 offset:21504
  s_waitcnt lgkmcnt(6)
  v_mfma_f32_32x32x16_bf16 v[16:31], v[60:63], v[252:255], v[16:31]
  ds_read_b64_tr_b16 v[52:53], v9 offset:22528
  ds_read_b64_tr_b16 v[54:55], v9 offset:23552
  s_waitcnt lgkmcnt(6)
  v_mfma_f32_32x32x16_bf16 v[88:103], v[64:67], v[240:243], v[88:103]
  ds_read_b64_tr_b16 v[56:57], v9 offset:24576
  ds_read_b64_tr_b16 v[58:59], v9 offset:25600
  s_waitcnt lgkmcnt(6)
  v_mfma_f32_32x32x16_bf16 v[88:103], v[68:71], v[244:247], v[88:103]
  ds_read_b64_tr_b16 v[60:61], v9 offset:26624
  ds_read_b64_tr_b16 v[62:63], v9 offset:27648
  s_waitcnt lgkmcnt(6)
  v_mfma_f32_32x32x16_bf16 v[88:103], v[48:51], v[248:251], v[88:103]
  ds_read_b64_tr_b16 v[64:65], v9 offset:28672
  ds_read_b64_tr_b16 v[66:67], v9 offset:29696
  s_waitcnt lgkmcnt(6)
  v_mfma_f32_32x32x16_bf16 v[88:103], v[52:55], v[252:255], v[88:103]
  ds_read_b64_tr_b16 v[68:69], v9 offset:30720
  ds_read_b64_tr_b16 v[70:71], v9 offset:31744
  s_waitcnt lgkmcnt(6)
  v_mfma_f32_32x32x16_bf16 v[208:223], v[56:59], v[240:243], v[208:223]
  ds_read_b64_tr_b16 v[48:49], v10 offset:16384
  ds_read_b64_tr_b16 v[50:51], v10 offset:17408
  s_waitcnt lgkmcnt(6)
  v_mfma_f32_32x32x16_bf16 v[208:223], v[60:63], v[244:247], v[208:223]
  ds_read_b64_tr_b16 v[52:53], v10 offset:18432
  ds_read_b64_tr_b16 v[54:55], v10 offset:19456
  s_waitcnt lgkmcnt(6)
  v_mfma_f32_32x32x16_bf16 v[208:223], v[64:67], v[248:251], v[208:223]
  ds_read_b64_tr_b16 v[56:57], v10 offset:20480
  ds_read_b64_tr_b16 v[58:59], v10 offset:21504
  s_waitcnt lgkmcnt(6)
  v_mfma_f32_32x32x16_bf16 v[208:223], v[68:71], v[252:255], v[208:223]
  ds_read_b64_tr_b16 v[60:61], v10 offset:22528
  ds_read_b64_tr_b16 v[62:63], v10 offset:23552
  s_setprio 0
  s_waitcnt vmcnt(8)
  s_barrier
  buffer_load_dwordx4 v[116:119], v34, s[4:7], s30 offen
  buffer_load_dwordx4 v[120:123], v35, s[20:23], s30 offen
  s_setprio 1
  s_waitcnt lgkmcnt(6)
  v_mfma_f32_32x32x16_bf16 v[16:31], v[48:51], v[144:147], v[16:31]
  ds_read_b64_tr_b16 v[64:65], v10 offset:24576
  ds_read_b64_tr_b16 v[66:67], v10 offset:25600
  s_waitcnt lgkmcnt(6)
  v_mfma_f32_32x32x16_bf16 v[16:31], v[52:55], v[148:151], v[16:31]
  ds_read_b64_tr_b16 v[68:69], v10 offset:26624
  ds_read_b64_tr_b16 v[70:71], v10 offset:27648
  s_waitcnt lgkmcnt(6)
  v_mfma_f32_32x32x16_bf16 v[16:31], v[56:59], v[152:155], v[16:31]
  ds_read_b64_tr_b16 v[48:49], v10 offset:28672
  ds_read_b64_tr_b16 v[50:51], v10 offset:29696
  s_waitcnt lgkmcnt(6)
  v_mfma_f32_32x32x16_bf16 v[16:31], v[60:63], v[156:159], v[16:31]
  ds_read_b64_tr_b16 v[52:53], v10 offset:30720
  ds_read_b64_tr_b16 v[54:55], v10 offset:31744
  s_waitcnt lgkmcnt(6)
  v_mfma_f32_32x32x16_bf16 v[16:31], v[64:67], v[160:163], v[16:31]
  ds_read_b64_tr_b16 v[56:57], v8 offset:32768
  ds_read_b64_tr_b16 v[58:59], v8 offset:33792
  s_waitcnt lgkmcnt(6)
  v_mfma_f32_32x32x16_bf16 v[16:31], v[68:71], v[164:167], v[16:31]
  ds_read_b64_tr_b16 v[60:61], v8 offset:34816
  ds_read_b64_tr_b16 v[62:63], v8 offset:35840
  s_waitcnt lgkmcnt(6)
  v_mfma_f32_32x32x16_bf16 v[16:31], v[48:51], v[168:171], v[16:31]
  ds_read_b64_tr_b16 v[64:65], v8 offset:36864
  ds_read_b64_tr_b16 v[66:67], v8 offset:37888
  s_waitcnt lgkmcnt(6)
  v_mfma_f32_32x32x16_bf16 v[16:31], v[52:55], v[172:175], v[16:31]
  ds_read_b64_tr_b16 v[68:69], v8 offset:38912
  ds_read_b64_tr_b16 v[70:71], v8 offset:39936
  s_waitcnt lgkmcnt(6)
  v_mfma_f32_32x32x16_bf16 v[16:31], v[56:59], v[176:179], v[16:31]
  ds_read_b64_tr_b16 v[48:49], v8 offset:40960
  ds_read_b64_tr_b16 v[50:51], v8 offset:41984
  s_waitcnt lgkmcnt(6)
  v_mfma_f32_32x32x16_bf16 v[16:31], v[60:63], v[180:183], v[16:31]
  ds_read_b64_tr_b16 v[52:53], v8 offset:43008
  ds_read_b64_tr_b16 v[54:55], v8 offset:44032
  s_waitcnt lgkmcnt(6)
  v_mfma_f32_32x32x16_bf16 v[16:31], v[64:67], v[184:187], v[16:31]
  ds_read_b64_tr_b16 v[56:57], v8 offset:45056
  ds_read_b64_tr_b16 v[58:59], v8 offset:46080
  s_waitcnt lgkmcnt(6)
  v_mfma_f32_32x32x16_bf16 v[16:31], v[68:71], v[188:191], v[16:31]
  ds_read_b64_tr_b16 v[60:61], v8 offset:47104
  ds_read_b64_tr_b16 v[62:63], v8 offset:48128
  s_setprio 0
  s_waitcnt vmcnt(7)
  s_barrier
  s_setprio 1
  s_waitcnt lgkmcnt(6)
  v_mfma_f32_32x32x16_bf16 v[16:31], v[48:51], v[192:195], v[16:31]
  ds_read_b64_tr_b16 v[64:65], v8 offset:49152
  ds_read_b64_tr_b16 v[66:67], v8 offset:50176
  s_waitcnt lgkmcnt(6)
  v_mfma_f32_32x32x16_bf16 v[16:31], v[52:55], v[196:199], v[16:31]
  ds_read_b64_tr_b16 v[68:69], v8 offset:51200
  ds_read_b64_tr_b16 v[70:71], v8 offset:52224
  s_waitcnt lgkmcnt(6)
  v_mfma_f32_32x32x16_bf16 v[16:31], v[56:59], v[200:203], v[16:31]
  ds_read_b64_tr_b16 v[48:49], v8 offset:53248
  ds_read_b64_tr_b16 v[50:51], v8 offset:54272
  s_waitcnt lgkmcnt(6)
  v_mfma_f32_32x32x16_bf16 v[16:31], v[60:63], v[204:207], v[16:31]
  ds_read_b64_tr_b16 v[52:53], v8 offset:55296
  ds_read_b64_tr_b16 v[54:55], v8 offset:56320
  s_waitcnt lgkmcnt(6)
  v_mfma_f32_32x32x16_bf16 v[88:103], v[64:67], v[144:147], v[88:103]
  ds_read_b64_tr_b16 v[56:57], v9 offset:32768
  ds_read_b64_tr_b16 v[58:59], v9 offset:33792
  s_waitcnt lgkmcnt(6)
  v_mfma_f32_32x32x16_bf16 v[88:103], v[68:71], v[148:151], v[88:103]
  ds_read_b64_tr_b16 v[60:61], v9 offset:34816
  ds_read_b64_tr_b16 v[62:63], v9 offset:35840
  s_waitcnt lgkmcnt(6)
  v_mfma_f32_32x32x16_bf16 v[88:103], v[48:51], v[152:155], v[88:103]
  ds_read_b64_tr_b16 v[64:65], v9 offset:36864
  ds_read_b64_tr_b16 v[66:67], v9 offset:37888
  s_waitcnt lgkmcnt(6)
  v_mfma_f32_32x32x16_bf16 v[88:103], v[52:55], v[156:159], v[88:103]
  ds_read_b64_tr_b16 v[68:69], v9 offset:38912
  ds_read_b64_tr_b16 v[70:71], v9 offset:39936
  s_waitcnt lgkmcnt(6)
  v_mfma_f32_32x32x16_bf16 v[88:103], v[56:59], v[160:163], v[88:103]
  ds_read_b64_tr_b16 v[48:49], v10 offset:0
  ds_read_b64_tr_b16 v[50:51], v10 offset:1024
  s_waitcnt lgkmcnt(6)
  v_mfma_f32_32x32x16_bf16 v[88:103], v[60:63], v[164:167], v[88:103]
  ds_read_b64_tr_b16 v[52:53], v10 offset:2048
  ds_read_b64_tr_b16 v[54:55], v10 offset:3072
  s_waitcnt lgkmcnt(6)
  v_mfma_f32_32x32x16_bf16 v[88:103], v[64:67], v[168:171], v[88:103]
  ds_read_b64_tr_b16 v[56:57], v10 offset:4096
  ds_read_b64_tr_b16 v[58:59], v10 offset:5120
  s_waitcnt lgkmcnt(6)
  v_mfma_f32_32x32x16_bf16 v[88:103], v[68:71], v[172:175], v[88:103]
  ds_read_b64_tr_b16 v[60:61], v10 offset:6144
  ds_read_b64_tr_b16 v[62:63], v10 offset:7168
  s_setprio 0
  s_waitcnt vmcnt(4)
  s_barrier
  v_cvt_pk_bf16_f32 v80, v16, v17
  v_cvt_pk_bf16_f32 v81, v18, v19
  v_cvt_pk_bf16_f32 v82, v20, v21
  v_cvt_pk_bf16_f32 v83, v22, v23
  v_cvt_pk_bf16_f32 v84, v24, v25
  v_cvt_pk_bf16_f32 v85, v26, v27
  v_cvt_pk_bf16_f32 v86, v28, v29
  v_cvt_pk_bf16_f32 v87, v30, v31
  v_min_u32 v80, -2, v80
  v_min_u32 v81, -2, v81
  v_min_u32 v82, -2, v82
  v_min_u32 v83, -2, v83
  v_min_u32 v84, -2, v84
  v_min_u32 v85, -2, v85
  v_min_u32 v86, -2, v86
  v_min_u32 v87, -2, v87
  s_lshl_b32 s74, s86, 7
  s_add_u32 s74, s74, s75
  s_add_u32 s78, s74, 4096
  buffer_store_dwordx4 v[80:83], v12, s[16:19], s74 offen sc1
  buffer_store_dwordx4 v[84:87], v12, s[16:19], s78 offen sc1
  s_setprio 1
  s_waitcnt lgkmcnt(6)
  v_mfma_f32_32x32x16_bf16 v[88:103], v[48:51], v[176:179], v[88:103]
  ds_read_b64_tr_b16 v[64:65], v8 offset:0
  ds_read_b64_tr_b16 v[66:67], v8 offset:1024
  s_waitcnt lgkmcnt(6)
  v_mfma_f32_32x32x16_bf16 v[88:103], v[52:55], v[180:183], v[88:103]
  ds_read_b64_tr_b16 v[68:69], v8 offset:2048
  ds_read_b64_tr_b16 v[70:71], v8 offset:3072
  s_waitcnt lgkmcnt(6)
  v_mfma_f32_32x32x16_bf16 v[88:103], v[56:59], v[184:187], v[88:103]
  ds_read_b64_tr_b16 v[48:49], v8 offset:4096
  ds_read_b64_tr_b16 v[50:51], v8 offset:5120
  s_waitcnt lgkmcnt(6)
  v_mfma_f32_32x32x16_bf16 v[88:103], v[60:63], v[188:191], v[88:103]
  ds_read_b64_tr_b16 v[52:53], v8 offset:6144
  ds_read_b64_tr_b16 v[54:55], v8 offset:7168
  s_waitcnt lgkmcnt(6)
  v_mfma_f32_32x32x16_bf16 v[88:103], v[64:67], v[192:195], v[88:103]
  ds_read_b64_tr_b16 v[56:57], v8 offset:8192
  ds_read_b64_tr_b16 v[58:59], v8 offset:9216
  s_waitcnt lgkmcnt(6)
  v_mfma_f32_32x32x16_bf16 v[88:103], v[68:71], v[196:199], v[88:103]
  ds_read_b64_tr_b16 v[60:61], v8 offset:10240
  ds_read_b64_tr_b16 v[62:63], v8 offset:11264
  s_waitcnt lgkmcnt(6)
  v_mfma_f32_32x32x16_bf16 v[88:103], v[48:51], v[200:203], v[88:103]
  ds_read_b64_tr_b16 v[64:65], v8 offset:12288
  ds_read_b64_tr_b16 v[66:67], v8 offset:13312
  s_waitcnt lgkmcnt(6)
  v_mfma_f32_32x32x16_bf16 v[88:103], v[52:55], v[204:207], v[88:103]
  ds_read_b64_tr_b16 v[68:69], v8 offset:14336
  ds_read_b64_tr_b16 v[70:71], v8 offset:15360
  s_waitcnt lgkmcnt(6)
  v_mfma_f32_32x32x16_bf16 v[208:223], v[56:59], v[144:147], v[208:223]
  ds_read_b64_tr_b16 v[48:49], v8 offset:57344
  ds_read_b64_tr_b16 v[50:51], v8 offset:58368
  s_waitcnt lgkmcnt(6)
  v_mfma_f32_32x32x16_bf16 v[208:223], v[60:63], v[148:151], v[208:223]
  ds_read_b64_tr_b16 v[52:53], v8 offset:59392
  ds_read_b64_tr_b16 v[54:55], v8 offset:60416
  s_waitcnt lgkmcnt(6)
  v_mfma_f32_32x32x16_bf16 v[208:223], v[64:67], v[152:155], v[208:223]
  ds_read_b64_tr_b16 v[56:57], v8 offset:61440
  ds_read_b64_tr_b16 v[58:59], v8 offset:62464
  s_waitcnt lgkmcnt(6)
  v_mfma_f32_32x32x16_bf16 v[208:223], v[68:71], v[156:159], v[208:223]
  ds_read_b64_tr_b16 v[60:61], v8 offset:63488
  ds_read_b64_tr_b16 v[62:63], v8 offset:64512
  s_setprio 0
  s_waitcnt vmcnt(4)
  s_barrier
  v_cvt_pk_bf16_f32 v80, v88, v89
  v_cvt_pk_bf16_f32 v81, v90, v91
  v_cvt_pk_bf16_f32 v82, v92, v93
  v_cvt_pk_bf16_f32 v83, v94, v95
  v_cvt_pk_bf16_f32 v84, v96, v97
  v_cvt_pk_bf16_f32 v85, v98, v99
  v_cvt_pk_bf16_f32 v86, v100, v101
  v_cvt_pk_bf16_f32 v87, v102, v103
  v_min_u32 v80, -2, v80
  v_min_u32 v81, -2, v81
  v_min_u32 v82, -2, v82
  v_min_u32 v83, -2, v83
  v_min_u32 v84, -2, v84
  v_min_u32 v85, -2, v85
  v_min_u32 v86, -2, v86
  v_min_u32 v87, -2, v87
  s_lshl_b32 s74, s87, 7
  s_add_u32 s74, s74, s75
  s_add_u32 s78, s74, 4096
  buffer_store_dwordx4 v[80:83], v12, s[16:19], s74 offen sc1
  buffer_store_dwordx4 v[84:87], v12, s[16:19], s78 offen sc1
  s_setprio 1
  s_waitcnt lgkmcnt(6)
  v_mfma_f32_32x32x16_bf16 v[208:223], v[48:51], v[160:163], v[208:223]
  ds_read_b64_tr_b16 v[64:65], v8 offset:16384
  ds_read_b64_tr_b16 v[66:67], v8 offset:17408
  s_waitcnt lgkmcnt(6)
  v_mfma_f32_32x32x16_bf16 v[208:223], v[52:55], v[164:167], v[208:223]
  ds_read_b64_tr_b16 v[68:69], v8 offset:18432
  ds_read_b64_tr_b16 v[70:71], v8 offset:19456
  s_waitcnt lgkmcnt(6)
  v_mfma_f32_32x32x16_bf16 v[208:223], v[56:59], v[168:171], v[208:223]
  ds_read_b64_tr_b16 v[48:49], v8 offset:20480
  ds_read_b64_tr_b16 v[50:51], v8 offset:21504
  s_waitcnt lgkmcnt(6)
  v_mfma_f32_32x32x16_bf16 v[208:223], v[60:63], v[172:175], v[208:223]
  ds_read_b64_tr_b16 v[52:53], v8 offset:22528
  ds_read_b64_tr_b16 v[54:55], v8 offset:23552
  s_waitcnt lgkmcnt(6)
  v_mfma_f32_32x32x16_bf16 v[208:223], v[64:67], v[176:179], v[208:223]
  ds_read_b64_tr_b16 v[56:57], v9 offset:0
  ds_read_b64_tr_b16 v[58:59], v9 offset:1024
  s_waitcnt lgkmcnt(6)
  v_mfma_f32_32x32x16_bf16 v[208:223], v[68:71], v[180:183], v[208:223]
  ds_read_b64_tr_b16 v[60:61], v9 offset:2048
  ds_read_b64_tr_b16 v[62:63], v9 offset:3072
  s_waitcnt lgkmcnt(6)
  v_mfma_f32_32x32x16_bf16 v[208:223], v[48:51], v[184:187], v[208:223]
  ds_read_b64_tr_b16 v[64:65], v9 offset:4096
  ds_read_b64_tr_b16 v[66:67], v9 offset:5120
  s_waitcnt lgkmcnt(6)
  v_mfma_f32_32x32x16_bf16 v[208:223], v[52:55], v[188:191], v[208:223]
  ds_read_b64_tr_b16 v[68:69], v9 offset:6144
  ds_read_b64_tr_b16 v[70:71], v9 offset:7168
  s_waitcnt lgkmcnt(6)
  v_mfma_f32_32x32x16_bf16 v[208:223], v[56:59], v[192:195], v[208:223]
  s_waitcnt lgkmcnt(4)
  v_mfma_f32_32x32x16_bf16 v[208:223], v[60:63], v[196:199], v[208:223]
  s_waitcnt lgkmcnt(2)
  v_mfma_f32_32x32x16_bf16 v[208:223], v[64:67], v[200:203], v[208:223]
  s_waitcnt lgkmcnt(0)
  v_mfma_f32_32x32x16_bf16 v[208:223], v[68:71], v[204:207], v[208:223]
  s_setprio 0
  s_nop 10
  v_cvt_pk_bf16_f32 v80, v208, v209
  v_cvt_pk_bf16_f32 v81, v210, v211
  v_cvt_pk_bf16_f32 v82, v212, v213
  v_cvt_pk_bf16_f32 v83, v214, v215
  v_cvt_pk_bf16_f32 v84, v216, v217
  v_cvt_pk_bf16_f32 v85, v218, v219
  v_cvt_pk_bf16_f32 v86, v220, v221
  v_cvt_pk_bf16_f32 v87, v222, v223
  v_min_u32 v80, -2, v80
  v_min_u32 v81, -2, v81
  v_min_u32 v82, -2, v82
  v_min_u32 v83, -2, v83
  v_min_u32 v84, -2, v84
  v_min_u32 v85, -2, v85
  v_min_u32 v86, -2, v86
  v_min_u32 v87, -2, v87
  s_lshl_b32 s74, s88, 7
  s_add_u32 s74, s74, s75
  s_add_u32 s78, s74, 4096
  buffer_store_dwordx4 v[80:83], v12, s[16:19], s74 offen sc1
  buffer_store_dwordx4 v[84:87], v12, s[16:19], s78 offen sc1
  s_branch L_mtail
  .p2align 12
L_stub14:
  s_setpc_b64 s[58:59]
  s_nop 0
L_mtail:
  s_cmp_eq_u32 s60, 0
  s_cbranch_scc0 L_mz_d
  s_waitcnt vmcnt(2)
  v_cmp_le_u32 vcc, 4, v110
  s_nop 0
  s_cmp_eq_u64 vcc, -1
  s_cbranch_scc1 L_mz_d
  s_mov_b32 s76, 400000
L_mz:
  buffer_load_dword v14, v37, s[16:19], s77 offen sc1
  s_waitcnt vmcnt(0)
  v_cmp_le_u32 vcc, 4, v14
  s_sub_u32 s76, s76, 1
  s_cmp_eq_u64 vcc, -1
  s_cbranch_scc1 L_mz_d
  s_cmp_eq_u32 s76, 0
  s_cbranch_scc1 L_mz_d
  s_sleep 2
  s_branch L_mz
L_mz_d:
  s_barrier
  buffer_load_dwordx4 v[112:115], v33, s[16:19], s29 offen sc1
  s_mov_b32 s76, 400000
  v_readlane_b32 s66, v32, 63
  v_and_b32 v15, 3, v1
  v_lshlrev_b32 v15, 10, v15
  v_add_u32 v15, s66, v15
L_mwp:
  buffer_load_dword v14, v15, s[16:19], s28 offen sc1
  s_waitcnt vmcnt(0)
  v_cmp_eq_u32 vcc, -1, v14
  s_sub_u32 s76, s76, 1
  s_cmp_eq_u64 vcc, 0
  s_cbranch_scc1 L_mwp_d
  s_cmp_lt_i32 s76, 1
  s_cbranch_scc1 L_mwp_d
  s_sleep 1
  s_branch L_mwp
L_mwp_d:
  s_add_u32 s66, s28, 0
  buffer_load_dwordx4 v[240:243], v32, s[16:19], s66 offen offset:0 sc1
  buffer_load_dwordx4 v[244:247], v32, s[16:19], s66 offen offset:1024 sc1
  buffer_load_dwordx4 v[248:251], v32, s[16:19], s66 offen offset:2048 sc1
  buffer_load_dwordx4 v[252:255], v32, s[16:19], s66 offen offset:3072 sc1
L_mw:
  s_waitcnt vmcnt(0)
  s_mov_b32 s73, 0
  v_max3_u32 v15, v240, v241, v242
  v_max_u32 v15, v15, v243
  v_cmp_eq_u32 vcc, -1, v15
  s_nop 0
  s_cmp_eq_u64 vcc, 0
  s_cbranch_scc1 L_mw_00
  buffer_load_dwordx4 v[240:243], v32, s[16:19], s28 offen offset:0 sc1
  s_mov_b32 s73, 1
L_mw_00:
  v_max3_u32 v15, v244, v245, v246
  v_max_u32 v15, v15, v247
  v_cmp_eq_u32 vcc, -1, v15
  s_nop 0
  s_cmp_eq_u64 vcc, 0
  s_cbranch_scc1 L_mw_01
  buffer_load_dwordx4 v[244:247], v32, s[16:19], s28 offen offset:1024 sc1
  s_mov_b32 s73, 1
L_mw_01:
  v_max3_u32 v15, v248, v249, v250
  v_max_u32 v15, v15, v251
  v_cmp_eq_u32 vcc, -1, v15
  s_nop 0
  s_cmp_eq_u64 vcc, 0
  s_cbranch_scc1 L_mw_02
  buffer_load_dwordx4 v[248:251], v32, s[16:19], s28 offen offset:2048 sc1
  s_mov_b32 s73, 1
L_mw_02:
  v_max3_u32 v15, v252, v253, v254
  v_max_u32 v15, v15, v255
  v_cmp_eq_u32 vcc, -1, v15
  s_nop 0
  s_cmp_eq_u64 vcc, 0
  s_cbranch_scc1 L_mw_03
  buffer_load_dwordx4 v[252:255], v32, s[16:19], s28 offen offset:3072 sc1
  s_mov_b32 s73, 1
L_mw_03:
  s_sub_u32 s76, s76, 1
  s_cmp_eq_u32 s73, 0
  s_cbranch_scc1 L_mw_d
  s_cmp_lt_i32 s76, 1
  s_cbranch_scc0 L_mw
  s_waitcnt vmcnt(0)
L_mw_d:
  v_lshlrev_b32 v48, 16, v120
  v_and_b32 v49, s71, v120
  v_lshlrev_b32 v50, 16, v121
  v_and_b32 v51, s71, v121
  v_lshlrev_b32 v52, 16, v122
  v_and_b32 v53, s71, v122
  v_lshlrev_b32 v54, 16, v123
  v_and_b32 v55, s71, v123
  v_lshlrev_b32 v56, 16, v240
  v_and_b32 v57, s71, v240
  v_lshlrev_b32 v58, 16, v241
  v_and_b32 v59, s71, v241
  v_lshlrev_b32 v60, 16, v242
  v_and_b32 v61, s71, v242
  v_lshlrev_b32 v62, 16, v243
  v_and_b32 v63, s71, v243
  v_pk_add_f32 v[48:49], v[48:49], v[56:57]
  v_pk_add_f32 v[50:51], v[50:51], v[58:59]
  v_pk_add_f32 v[52:53], v[52:53], v[60:61]
  v_pk_add_f32 v[54:55], v[54:55], v[62:63]
  v_lshlrev_b32 v64, 16, v244
  v_and_b32 v65, s71, v244
  v_lshlrev_b32 v66, 16, v245
  v_and_b32 v67, s71, v245
  v_lshlrev_b32 v68, 16, v246
  v_and_b32 v69, s71, v246
  v_lshlrev_b32 v70, 16, v247
  v_and_b32 v71, s71, v247
  v_pk_add_f32 v[48:49], v[48:49], v[64:65]
  v_pk_add_f32 v[50:51], v[50:51], v[66:67]
  v_pk_add_f32 v[52:53], v[52:53], v[68:69]
  v_pk_add_f32 v[54:55], v[54:55], v[70:71]
  v_lshlrev_b32 v56, 16, v248
  v_and_b32 v57, s71, v248
  v_lshlrev_b32 v58, 16, v249
  v_and_b32 v59, s71, v249
  v_lshlrev_b32 v60, 16, v250
  v_and_b32 v61, s71, v250
  v_lshlrev_b32 v62, 16, v251
  v_and_b32 v63, s71, v251
  v_pk_add_f32 v[48:49], v[48:49], v[56:57]
  v_pk_add_f32 v[50:51], v[50:51], v[58:59]
  v_pk_add_f32 v[52:53], v[52:53], v[60:61]
  v_pk_add_f32 v[54:55], v[54:55], v[62:63]
  v_lshlrev_b32 v64, 16, v252
  v_and_b32 v65, s71, v252
  v_lshlrev_b32 v66, 16, v253
  v_and_b32 v67, s71, v253
  v_lshlrev_b32 v68, 16, v254
  v_and_b32 v69, s71, v254
  v_lshlrev_b32 v70, 16, v255
  v_and_b32 v71, s71, v255
  v_pk_add_f32 v[48:49], v[48:49], v[64:65]
  v_pk_add_f32 v[50:51], v[50:51], v[66:67]
  v_pk_add_f32 v[52:53], v[52:53], v[68:69]
  v_pk_add_f32 v[54:55], v[54:55], v[70:71]
  v_mul_f32 v56, s72, v48
  v_mul_f32 v57, s72, v49
  v_mul_f32 v58, s72, v50
  v_mul_f32 v59, s72, v51
  v_mul_f32 v60, s72, v52
  v_mul_f32 v61, s72, v53
  v_mul_f32 v62, s72, v54
  v_mul_f32 v63, s72, v55
  v_exp_f32 v56, v56
  v_exp_f32 v57, v57
  v_exp_f32 v58, v58
  v_exp_f32 v59, v59
  v_exp_f32 v60, v60
  v_exp_f32 v61, v61
  v_exp_f32 v62, v62
  v_exp_f32 v63, v63
  v_lshlrev_b32 v64, 16, v112
  v_and_b32 v65, s71, v112
  v_lshlrev_b32 v66, 16, v113
  v_and_b32 v67, s71, v113
  v_lshlrev_b32 v68, 16, v114
  v_and_b32 v69, s71, v114
  v_lshlrev_b32 v70, 16, v115
  v_and_b32 v71, s71, v115
  v_add_f32 v56, 1.0, v56
  v_add_f32 v57, 1.0, v57
  v_add_f32 v58, 1.0, v58
  v_add_f32 v59, 1.0, v59
  v_add_f32 v60, 1.0, v60
  v_add_f32 v61, 1.0, v61
  v_add_f32 v62, 1.0, v62
  v_add_f32 v63, 1.0, v63
  v_rcp_f32 v56, v56
  v_rcp_f32 v57, v57
  v_rcp_f32 v58, v58
  v_rcp_f32 v59, v59
  v_rcp_f32 v60, v60
  v_rcp_f32 v61, v61
  v_rcp_f32 v62, v62
  v_rcp_f32 v63, v63
  v_pk_mul_f32 v[48:49], v[48:49], v[64:65]
  v_pk_mul_f32 v[50:51], v[50:51], v[66:67]
  v_pk_mul_f32 v[52:53], v[52:53], v[68:69]
  v_pk_mul_f32 v[54:55], v[54:55], v[70:71]
  v_pk_mul_f32 v[48:49], v[48:49], v[56:57]
  v_pk_mul_f32 v[50:51], v[50:51], v[58:59]
  v_pk_mul_f32 v[52:53], v[52:53], v[60:61]
  v_pk_mul_f32 v[54:55], v[54:55], v[62:63]
  v_cvt_pk_bf16_f32 v56, v48, v49
  v_cvt_pk_bf16_f32 v57, v50, v51
  v_cvt_pk_bf16_f32 v58, v52, v53
  v_cvt_pk_bf16_f32 v59, v54, v55
  ds_bpermute_b32 v60, v38, v56
  ds_bpermute_b32 v61, v38, v57
  ds_bpermute_b32 v62, v38, v58
  ds_bpermute_b32 v63, v38, v59
  v_lshlrev_b32 v48, 16, v116
  v_and_b32 v49, s71, v116
  v_lshlrev_b32 v50, 16, v117
  v_and_b32 v51, s71, v117
  v_lshlrev_b32 v52, 16, v118
  v_and_b32 v53, s71, v118
  v_lshlrev_b32 v54, 16, v119
  v_and_b32 v55, s71, v119
  s_waitcnt lgkmcnt(0)
  v_lshlrev_b32 v64, 16, v60
  v_and_b32 v65, s71, v60
  v_lshlrev_b32 v66, 16, v61
  v_and_b32 v67, s71, v61
  v_lshlrev_b32 v68, 16, v62
  v_and_b32 v69, s71, v62
  v_lshlrev_b32 v70, 16, v63
  v_and_b32 v71, s71, v63
  v_pk_add_f32 v[48:49], v[48:49], v[64:65]
  v_pk_add_f32 v[50:51], v[50:51], v[66:67]
  v_pk_add_f32 v[52:53], v[52:53], v[68:69]
  v_pk_add_f32 v[54:55], v[54:55], v[70:71]
  v_cvt_pk_bf16_f32 v124, v48, v49
  v_cvt_pk_bf16_f32 v125, v50, v51
  v_cvt_pk_bf16_f32 v126, v52, v53
  v_cvt_pk_bf16_f32 v127, v54, v55
  buffer_store_dwordx4 v[124:127], v34, s[8:11], s30 offen sc1
  s_endpgm
  .p2align 12
L_stub15:
  s_setpc_b64 s[58:59]
  s_nop 0
L_fft:
  s_cmp_lt_u32 s2, 256
  s_cbranch_scc1 L_fgo
  s_endpgm
L_fgo:
  s_and_b32 s62, s2, 1
  s_lshl_b32 s62, s62, 2
  s_bfe_u32 s63, s2, 0x20001
  s_add_u32 s62, s62, s63
  s_lshl_b32 s62, s62, 3
  s_and_b32 s61, s64, 7
  s_add_u32 s61, s61, s62
  v_and_b32 v1, 63, v0
  s_lshr_b32 s62, s61, 1
  s_and_b32 s63, s61, 1
  s_lshr_b32 s64, s60, 2
  s_and_b32 s65, s60, 3
  s_lshl_b32 s66, s65, 9
  s_lshl_b32 s67, s62, 1
  s_add_u32 s66, s66, s67
  s_add_u32 s66, s66, s64
  v_lshrrev_b32 v4, 3, v1
  v_lshl_add_u32 v4, v4, 6, s66
  v_mul_u32_u24 v4, 1152, v4
  v_and_b32 v5, 7, v1
  v_lshl_add_u32 v4, v5, 4, v4
  v_cmp_gt_u32 vcc, 4, v5
  v_mov_b32 v6, 0x40000000
  s_nop 0
  v_cndmask_b32 v6, v6, v4, vcc
  s_waitcnt lgkmcnt(0)
  s_mov_b32 s4, s36
  s_and_b32 s5, s37, 0xffff
  s_mov_b32 s6, 2359296
  s_mov_b32 s7, 0x00020000
  s_mov_b32 s16, s56
  s_and_b32 s17, s57, 0xffff
  s_mov_b32 s18, 67108864
  s_mov_b32 s19, 0x00020000
  s_cmp_eq_u32 s60, 7
  s_cbranch_scc0 L_nin
  v_lshlrev_b32 v14, 2, v1
  v_add_u32 v8, 130048, v14
  v_mov_b32 v15, 0
  ds_write_b32 v8, v15
  s_and_b32 s66, s61, 7
  s_cmp_eq_u32 s66, 0
  s_cbranch_scc0 L_nin
  v_mov_b32 v56, 0
  v_mov_b32 v60, -1
  v_mov_b32 v57, 0
  v_mov_b32 v61, -1
  v_mov_b32 v58, 0
  v_mov_b32 v62, -1
  v_mov_b32 v59, 0
  v_mov_b32 v63, -1
  v_lshlrev_b32 v14, 4, v1
  v_mul_u32_u24 v15, 12, v1
  s_lshl_b32 s66, s61, 8
  s_add_u32 s67, s66, 49283072
  s_add_u32 s66, s66, 49807360
  buffer_store_dwordx4 v[56:59], v14, s[16:19], s67 offen offset:0 sc1
  buffer_store_dwordx4 v[56:59], v14, s[16:19], s67 offen offset:1024 sc1
  buffer_store_dwordx4 v[56:59], v14, s[16:19], s66 offen offset:0 sc1
  buffer_store_dwordx4 v[56:59], v14, s[16:19], s66 offen offset:1024 sc1
  s_mul_i32 s66, s61, 384
  s_add_u32 s66, s66, 49414144
  buffer_store_dwordx4 v[56:59], v14, s[16:19], s66 offen offset:0 sc1
  buffer_store_dwordx4 v[56:59], v14, s[16:19], s66 offen offset:1024 sc1
  buffer_store_dwordx4 v[56:59], v14, s[16:19], s66 offen offset:2048 sc1
L_nin:
  s_mov_b32 s8, s38
  s_and_b32 s9, s39, 0xffff
  s_mov_b32 s10, 1183744
  s_mov_b32 s11, 0x00020000
  s_mov_b32 s12, s40
  s_and_b32 s13, s41, 0xffff
  s_mov_b32 s14, 1183744
  s_mov_b32 s15, 0x00020000
  s_mov_b32 s24, s54
  s_and_b32 s25, s55, 0xffff
  s_mov_b32 s26, 256
  s_mov_b32 s27, 0x00020000
  v_lshlrev_b32 v7, 4, v1
  v_and_b32 v8, 31, v1
  v_cvt_f32_u32 v2, v8
  v_lshrrev_b32 v8, 5, v1
  v_cvt_f32_u32 v3, v8
  s_cmp_eq_u32 s60, 7
  s_cbranch_scc0 L_nin2
  s_and_b32 s66, s61, 7
  s_cmp_eq_u32 s66, 0
  s_cbranch_scc0 L_nin2
  s_waitcnt vmcnt(0)
  v_mov_b32 v14, 1
  v_mov_b32 v15, 0
  s_lshl_b32 s66, s61, 2
  s_mov_b64 exec, 1
  buffer_store_dword v14, v15, s[24:27], s66 offen sc1
  s_mov_b64 exec, -1
L_nin2:
  s_cmp_eq_u32 s60, 0
  s_cbranch_scc0 L_pt1_0
  s_call_b64 s[58:59], L_stub16
L_pt1_0:
  s_cmp_eq_u32 s60, 1
  s_cbranch_scc0 L_pt1_1
  s_call_b64 s[58:59], L_stub17
L_pt1_1:
  s_cmp_eq_u32 s60, 2
  s_cbranch_scc0 L_pt1_2
  s_call_b64 s[58:59], L_stub18
L_pt1_2:
  s_cmp_eq_u32 s60, 3
  s_cbranch_scc0 L_pt1_3
  s_call_b64 s[58:59], L_stub19
L_pt1_3:
  s_cmp_eq_u32 s60, 4
  s_cbranch_scc0 L_pt1_4
  s_call_b64 s[58:59], L_stub20
L_pt1_4:
  s_cmp_eq_u32 s60, 5
  s_cbranch_scc0 L_pt1_5
  s_call_b64 s[58:59], L_stub21
L_pt1_5:
  s_lshl_b32 s66, s60, 5
  v_and_b32 v9, 31, v1
  v_add_u32 v9, s66, v9
  v_cmp_le_u32 vcc, 144, v9
  v_subrev_u32 v10, 144, v9
  s_nop 0
  v_cndmask_b32 v9, v9, v10, vcc
  v_mov_b32 v10, 0
  v_mov_b32 v12, 0x3e800000
  v_cndmask_b32 v10, v10, v12, vcc
  s_sub_u32 s66, 2, s63
  v_lshl_add_u32 v9, v9, 1, s66
  v_cmp_eq_u32 vcc, 288, v9
  v_mov_b32 v13, 1.0
  v_mov_b32 v12, 0.5
  v_cndmask_b32 v13, v13, v12, vcc
  v_cvt_f32_u32 v9, v9
  v_mul_f32 v9, 0x3ae38e39, v9
  v_mul_f32 v12, 0x41000000, v3
  v_fma_f32 v10, v9, v12, v10
  v_fmamk_f32 v56, v9, 0x00000000, v10
  v_fmamk_f32 v57, v9, 0x3f800000, v10
  v_fmamk_f32 v58, v9, 0x40000000, v10
  v_fmamk_f32 v59, v9, 0x40400000, v10
  v_fmamk_f32 v60, v9, 0x40800000, v10
  v_fmamk_f32 v61, v9, 0x40a00000, v10
  v_fmamk_f32 v62, v9, 0x40c00000, v10
  v_fmamk_f32 v63, v9, 0x40e00000, v10
  v_fmamk_f32 v64, v9, 0x41800000, v10
  v_fmamk_f32 v65, v9, 0x41880000, v10
  v_fmamk_f32 v66, v9, 0x41900000, v10
  v_fmamk_f32 v67, v9, 0x41980000, v10
  v_fmamk_f32 v68, v9, 0x41a00000, v10
  v_fmamk_f32 v69, v9, 0x41a80000, v10
  v_fmamk_f32 v70, v9, 0x41b00000, v10
  v_fmamk_f32 v71, v9, 0x41b80000, v10
  v_cos_f32 v56, v56
  v_cos_f32 v57, v57
  v_cos_f32 v58, v58
  v_cos_f32 v59, v59
  v_cos_f32 v60, v60
  v_cos_f32 v61, v61
  v_cos_f32 v62, v62
  v_cos_f32 v63, v63
  v_cos_f32 v64, v64
  v_cos_f32 v65, v65
  v_cos_f32 v66, v66
  v_cos_f32 v67, v67
  v_cos_f32 v68, v68
  v_cos_f32 v69, v69
  v_cos_f32 v70, v70
  v_cos_f32 v71, v71
  v_mul_f32 v12, 0x41800000, v9
  v_cos_f32 v12, v12
  v_mul_f32 v56, v13, v56
  v_mul_f32 v57, v13, v57
  v_mul_f32 v58, v13, v58
  v_mul_f32 v59, v13, v59
  v_mul_f32 v60, v13, v60
  v_mul_f32 v61, v13, v61
  v_mul_f32 v62, v13, v62
  v_mul_f32 v63, v13, v63
  v_mul_f32 v64, v13, v64
  v_mul_f32 v65, v13, v65
  v_mul_f32 v66, v13, v66
  v_mul_f32 v67, v13, v67
  v_mul_f32 v68, v13, v68
  v_mul_f32 v69, v13, v69
  v_mul_f32 v70, v13, v70
  v_mul_f32 v71, v13, v71
  v_add_f32 v12, v12, v12
  v_cvt_pk_bf16_f32 v96, v56, v57
  v_cvt_pk_bf16_f32 v97, v58, v59
  v_cvt_pk_bf16_f32 v98, v60, v61
  v_cvt_pk_bf16_f32 v99, v62, v63
  v_cvt_pk_bf16_f32 v100, v64, v65
  v_cvt_pk_bf16_f32 v101, v66, v67
  v_cvt_pk_bf16_f32 v102, v68, v69
  v_cvt_pk_bf16_f32 v103, v70, v71
  v_pk_fma_f32 v[56:57], v[64:65], v[12:13], v[56:57] op_sel_hi:[1,0,1] neg_lo:[0,0,1] neg_hi:[0,0,1]
  v_pk_fma_f32 v[58:59], v[66:67], v[12:13], v[58:59] op_sel_hi:[1,0,1] neg_lo:[0,0,1] neg_hi:[0,0,1]
  v_pk_fma_f32 v[60:61], v[68:69], v[12:13], v[60:61] op_sel_hi:[1,0,1] neg_lo:[0,0,1] neg_hi:[0,0,1]
  v_pk_fma_f32 v[62:63], v[70:71], v[12:13], v[62:63] op_sel_hi:[1,0,1] neg_lo:[0,0,1] neg_hi:[0,0,1]
  v_cvt_pk_bf16_f32 v104, v56, v57
  v_cvt_pk_bf16_f32 v105, v58, v59
  v_cvt_pk_bf16_f32 v106, v60, v61
  v_cvt_pk_bf16_f32 v107, v62, v63
  v_pk_fma_f32 v[64:65], v[56:57], v[12:13], v[64:65] op_sel_hi:[1,0,1] neg_lo:[0,0,1] neg_hi:[0,0,1]
  v_pk_fma_f32 v[66:67], v[58:59], v[12:13], v[66:67] op_sel_hi:[1,0,1] neg_lo:[0,0,1] neg_hi:[0,0,1]
  v_pk_fma_f32 v[68:69], v[60:61], v[12:13], v[68:69] op_sel_hi:[1,0,1] neg_lo:[0,0,1] neg_hi:[0,0,1]
  v_pk_fma_f32 v[70:71], v[62:63], v[12:13], v[70:71] op_sel_hi:[1,0,1] neg_lo:[0,0,1] neg_hi:[0,0,1]
  v_cvt_pk_bf16_f32 v108, v64, v65
  v_cvt_pk_bf16_f32 v109, v66, v67
  v_cvt_pk_bf16_f32 v110, v68, v69
  v_cvt_pk_bf16_f32 v111, v70, v71
  v_pk_fma_f32 v[56:57], v[64:65], v[12:13], v[56:57] op_sel_hi:[1,0,1] neg_lo:[0,0,1] neg_hi:[0,0,1]
  v_pk_fma_f32 v[58:59], v[66:67], v[12:13], v[58:59] op_sel_hi:[1,0,1] neg_lo:[0,0,1] neg_hi:[0,0,1]
  v_pk_fma_f32 v[60:61], v[68:69], v[12:13], v[60:61] op_sel_hi:[1,0,1] neg_lo:[0,0,1] neg_hi:[0,0,1]
  v_pk_fma_f32 v[62:63], v[70:71], v[12:13], v[62:63] op_sel_hi:[1,0,1] neg_lo:[0,0,1] neg_hi:[0,0,1]
  v_cvt_pk_bf16_f32 v112, v56, v57
  v_cvt_pk_bf16_f32 v113, v58, v59
  v_cvt_pk_bf16_f32 v114, v60, v61
  v_cvt_pk_bf16_f32 v115, v62, v63
  v_pk_fma_f32 v[64:65], v[56:57], v[12:13], v[64:65] op_sel_hi:[1,0,1] neg_lo:[0,0,1] neg_hi:[0,0,1]
  v_pk_fma_f32 v[66:67], v[58:59], v[12:13], v[66:67] op_sel_hi:[1,0,1] neg_lo:[0,0,1] neg_hi:[0,0,1]
  v_pk_fma_f32 v[68:69], v[60:61], v[12:13], v[68:69] op_sel_hi:[1,0,1] neg_lo:[0,0,1] neg_hi:[0,0,1]
  v_pk_fma_f32 v[70:71], v[62:63], v[12:13], v[70:71] op_sel_hi:[1,0,1] neg_lo:[0,0,1] neg_hi:[0,0,1]
  v_cvt_pk_bf16_f32 v116, v64, v65
  v_cvt_pk_bf16_f32 v117, v66, v67
  v_cvt_pk_bf16_f32 v118, v68, v69
  v_cvt_pk_bf16_f32 v119, v70, v71
  v_pk_fma_f32 v[56:57], v[64:65], v[12:13], v[56:57] op_sel_hi:[1,0,1] neg_lo:[0,0,1] neg_hi:[0,0,1]
  v_pk_fma_f32 v[58:59], v[66:67], v[12:13], v[58:59] op_sel_hi:[1,0,1] neg_lo:[0,0,1] neg_hi:[0,0,1]
  v_pk_fma_f32 v[60:61], v[68:69], v[12:13], v[60:61] op_sel_hi:[1,0,1] neg_lo:[0,0,1] neg_hi:[0,0,1]
  v_pk_fma_f32 v[62:63], v[70:71], v[12:13], v[62:63] op_sel_hi:[1,0,1] neg_lo:[0,0,1] neg_hi:[0,0,1]
  v_cvt_pk_bf16_f32 v120, v56, v57
  v_cvt_pk_bf16_f32 v121, v58, v59
  v_cvt_pk_bf16_f32 v122, v60, v61
  v_cvt_pk_bf16_f32 v123, v62, v63
  v_pk_fma_f32 v[64:65], v[56:57], v[12:13], v[64:65] op_sel_hi:[1,0,1] neg_lo:[0,0,1] neg_hi:[0,0,1]
  v_pk_fma_f32 v[66:67], v[58:59], v[12:13], v[66:67] op_sel_hi:[1,0,1] neg_lo:[0,0,1] neg_hi:[0,0,1]
  v_pk_fma_f32 v[68:69], v[60:61], v[12:13], v[68:69] op_sel_hi:[1,0,1] neg_lo:[0,0,1] neg_hi:[0,0,1]
  v_pk_fma_f32 v[70:71], v[62:63], v[12:13], v[70:71] op_sel_hi:[1,0,1] neg_lo:[0,0,1] neg_hi:[0,0,1]
  v_cvt_pk_bf16_f32 v124, v64, v65
  v_cvt_pk_bf16_f32 v125, v66, v67
  v_cvt_pk_bf16_f32 v126, v68, v69
  v_cvt_pk_bf16_f32 v127, v70, v71
  v_pk_fma_f32 v[56:57], v[64:65], v[12:13], v[56:57] op_sel_hi:[1,0,1] neg_lo:[0,0,1] neg_hi:[0,0,1]
  v_pk_fma_f32 v[58:59], v[66:67], v[12:13], v[58:59] op_sel_hi:[1,0,1] neg_lo:[0,0,1] neg_hi:[0,0,1]
  v_pk_fma_f32 v[60:61], v[68:69], v[12:13], v[60:61] op_sel_hi:[1,0,1] neg_lo:[0,0,1] neg_hi:[0,0,1]
  v_pk_fma_f32 v[62:63], v[70:71], v[12:13], v[62:63] op_sel_hi:[1,0,1] neg_lo:[0,0,1] neg_hi:[0,0,1]
  v_cvt_pk_bf16_f32 v128, v56, v57
  v_cvt_pk_bf16_f32 v129, v58, v59
  v_cvt_pk_bf16_f32 v130, v60, v61
  v_cvt_pk_bf16_f32 v131, v62, v63
  v_pk_fma_f32 v[64:65], v[56:57], v[12:13], v[64:65] op_sel_hi:[1,0,1] neg_lo:[0,0,1] neg_hi:[0,0,1]
  v_pk_fma_f32 v[66:67], v[58:59], v[12:13], v[66:67] op_sel_hi:[1,0,1] neg_lo:[0,0,1] neg_hi:[0,0,1]
  v_pk_fma_f32 v[68:69], v[60:61], v[12:13], v[68:69] op_sel_hi:[1,0,1] neg_lo:[0,0,1] neg_hi:[0,0,1]
  v_pk_fma_f32 v[70:71], v[62:63], v[12:13], v[70:71] op_sel_hi:[1,0,1] neg_lo:[0,0,1] neg_hi:[0,0,1]
  v_cvt_pk_bf16_f32 v132, v64, v65
  v_cvt_pk_bf16_f32 v133, v66, v67
  v_cvt_pk_bf16_f32 v134, v68, v69
  v_cvt_pk_bf16_f32 v135, v70, v71
  v_pk_fma_f32 v[56:57], v[64:65], v[12:13], v[56:57] op_sel_hi:[1,0,1] neg_lo:[0,0,1] neg_hi:[0,0,1]
  v_pk_fma_f32 v[58:59], v[66:67], v[12:13], v[58:59] op_sel_hi:[1,0,1] neg_lo:[0,0,1] neg_hi:[0,0,1]
  v_pk_fma_f32 v[60:61], v[68:69], v[12:13], v[60:61] op_sel_hi:[1,0,1] neg_lo:[0,0,1] neg_hi:[0,0,1]
  v_pk_fma_f32 v[62:63], v[70:71], v[12:13], v[62:63] op_sel_hi:[1,0,1] neg_lo:[0,0,1] neg_hi:[0,0,1]
  v_cvt_pk_bf16_f32 v136, v56, v57
  v_cvt_pk_bf16_f32 v137, v58, v59
  v_cvt_pk_bf16_f32 v138, v60, v61
  v_cvt_pk_bf16_f32 v139, v62, v63
  v_pk_fma_f32 v[64:65], v[56:57], v[12:13], v[64:65] op_sel_hi:[1,0,1] neg_lo:[0,0,1] neg_hi:[0,0,1]
  v_pk_fma_f32 v[66:67], v[58:59], v[12:13], v[66:67] op_sel_hi:[1,0,1] neg_lo:[0,0,1] neg_hi:[0,0,1]
  v_pk_fma_f32 v[68:69], v[60:61], v[12:13], v[68:69] op_sel_hi:[1,0,1] neg_lo:[0,0,1] neg_hi:[0,0,1]
  v_pk_fma_f32 v[70:71], v[62:63], v[12:13], v[70:71] op_sel_hi:[1,0,1] neg_lo:[0,0,1] neg_hi:[0,0,1]
  v_cvt_pk_bf16_f32 v140, v64, v65
  v_cvt_pk_bf16_f32 v141, v66, v67
  v_cvt_pk_bf16_f32 v142, v68, v69
  v_cvt_pk_bf16_f32 v143, v70, v71
  v_pk_fma_f32 v[56:57], v[64:65], v[12:13], v[56:57] op_sel_hi:[1,0,1] neg_lo:[0,0,1] neg_hi:[0,0,1]
  v_pk_fma_f32 v[58:59], v[66:67], v[12:13], v[58:59] op_sel_hi:[1,0,1] neg_lo:[0,0,1] neg_hi:[0,0,1]
  v_pk_fma_f32 v[60:61], v[68:69], v[12:13], v[60:61] op_sel_hi:[1,0,1] neg_lo:[0,0,1] neg_hi:[0,0,1]
  v_pk_fma_f32 v[62:63], v[70:71], v[12:13], v[62:63] op_sel_hi:[1,0,1] neg_lo:[0,0,1] neg_hi:[0,0,1]
  v_cvt_pk_bf16_f32 v144, v56, v57
  v_cvt_pk_bf16_f32 v145, v58, v59
  v_cvt_pk_bf16_f32 v146, v60, v61
  v_cvt_pk_bf16_f32 v147, v62, v63
  v_pk_fma_f32 v[64:65], v[56:57], v[12:13], v[64:65] op_sel_hi:[1,0,1] neg_lo:[0,0,1] neg_hi:[0,0,1]
  v_pk_fma_f32 v[66:67], v[58:59], v[12:13], v[66:67] op_sel_hi:[1,0,1] neg_lo:[0,0,1] neg_hi:[0,0,1]
  v_pk_fma_f32 v[68:69], v[60:61], v[12:13], v[68:69] op_sel_hi:[1,0,1] neg_lo:[0,0,1] neg_hi:[0,0,1]
  v_pk_fma_f32 v[70:71], v[62:63], v[12:13], v[70:71] op_sel_hi:[1,0,1] neg_lo:[0,0,1] neg_hi:[0,0,1]
  v_cvt_pk_bf16_f32 v148, v64, v65
  v_cvt_pk_bf16_f32 v149, v66, v67
  v_cvt_pk_bf16_f32 v150, v68, v69
  v_cvt_pk_bf16_f32 v151, v70, v71
  v_pk_fma_f32 v[56:57], v[64:65], v[12:13], v[56:57] op_sel_hi:[1,0,1] neg_lo:[0,0,1] neg_hi:[0,0,1]
  v_pk_fma_f32 v[58:59], v[66:67], v[12:13], v[58:59] op_sel_hi:[1,0,1] neg_lo:[0,0,1] neg_hi:[0,0,1]
  v_pk_fma_f32 v[60:61], v[68:69], v[12:13], v[60:61] op_sel_hi:[1,0,1] neg_lo:[0,0,1] neg_hi:[0,0,1]
  v_pk_fma_f32 v[62:63], v[70:71], v[12:13], v[62:63] op_sel_hi:[1,0,1] neg_lo:[0,0,1] neg_hi:[0,0,1]
  v_cvt_pk_bf16_f32 v152, v56, v57
  v_cvt_pk_bf16_f32 v153, v58, v59
  v_cvt_pk_bf16_f32 v154, v60, v61
  v_cvt_pk_bf16_f32 v155, v62, v63
  v_pk_fma_f32 v[64:65], v[56:57], v[12:13], v[64:65] op_sel_hi:[1,0,1] neg_lo:[0,0,1] neg_hi:[0,0,1]
  v_pk_fma_f32 v[66:67], v[58:59], v[12:13], v[66:67] op_sel_hi:[1,0,1] neg_lo:[0,0,1] neg_hi:[0,0,1]
  v_pk_fma_f32 v[68:69], v[60:61], v[12:13], v[68:69] op_sel_hi:[1,0,1] neg_lo:[0,0,1] neg_hi:[0,0,1]
  v_pk_fma_f32 v[70:71], v[62:63], v[12:13], v[70:71] op_sel_hi:[1,0,1] neg_lo:[0,0,1] neg_hi:[0,0,1]
  v_cvt_pk_bf16_f32 v156, v64, v65
  v_cvt_pk_bf16_f32 v157, v66, v67
  v_cvt_pk_bf16_f32 v158, v68, v69
  v_cvt_pk_bf16_f32 v159, v70, v71
  v_pk_fma_f32 v[56:57], v[64:65], v[12:13], v[56:57] op_sel_hi:[1,0,1] neg_lo:[0,0,1] neg_hi:[0,0,1]
  v_pk_fma_f32 v[58:59], v[66:67], v[12:13], v[58:59] op_sel_hi:[1,0,1] neg_lo:[0,0,1] neg_hi:[0,0,1]
  v_pk_fma_f32 v[60:61], v[68:69], v[12:13], v[60:61] op_sel_hi:[1,0,1] neg_lo:[0,0,1] neg_hi:[0,0,1]
  v_pk_fma_f32 v[62:63], v[70:71], v[12:13], v[62:63] op_sel_hi:[1,0,1] neg_lo:[0,0,1] neg_hi:[0,0,1]
  v_cvt_pk_bf16_f32 v160, v56, v57
  v_cvt_pk_bf16_f32 v161, v58, v59
  v_cvt_pk_bf16_f32 v162, v60, v61
  v_cvt_pk_bf16_f32 v163, v62, v63
  v_pk_fma_f32 v[64:65], v[56:57], v[12:13], v[64:65] op_sel_hi:[1,0,1] neg_lo:[0,0,1] neg_hi:[0,0,1]
  v_pk_fma_f32 v[66:67], v[58:59], v[12:13], v[66:67] op_sel_hi:[1,0,1] neg_lo:[0,0,1] neg_hi:[0,0,1]
  v_pk_fma_f32 v[68:69], v[60:61], v[12:13], v[68:69] op_sel_hi:[1,0,1] neg_lo:[0,0,1] neg_hi:[0,0,1]
  v_pk_fma_f32 v[70:71], v[62:63], v[12:13], v[70:71] op_sel_hi:[1,0,1] neg_lo:[0,0,1] neg_hi:[0,0,1]
  v_cvt_pk_bf16_f32 v164, v64, v65
  v_cvt_pk_bf16_f32 v165, v66, v67
  v_cvt_pk_bf16_f32 v166, v68, v69
  v_cvt_pk_bf16_f32 v167, v70, v71
  s_sub_u32 s77, s60, 5
  s_cmp_lt_u32 s77, 2
  s_cbranch_scc0 L_nf2
  s_mov_b32 s76, 8
  s_lshl_b32 s66, s76, 5
  v_and_b32 v9, 31, v1
  v_add_u32 v9, s66, v9
  v_cmp_le_u32 vcc, 144, v9
  v_subrev_u32 v10, 144, v9
  s_nop 0
  v_cndmask_b32 v9, v9, v10, vcc
  v_mov_b32 v10, 0
  v_mov_b32 v12, 0x3e800000
  v_cndmask_b32 v10, v10, v12, vcc
  s_sub_u32 s66, 2, s63
  v_lshl_add_u32 v9, v9, 1, s66
  v_cmp_eq_u32 vcc, 288, v9
  v_mov_b32 v13, 1.0
  v_mov_b32 v12, 0.5
  v_cndmask_b32 v13, v13, v12, vcc
  v_cvt_f32_u32 v9, v9
  v_mul_f32 v9, 0x3ae38e39, v9
  v_mul_f32 v12, 0x41000000, v3
  v_fma_f32 v10, v9, v12, v10
  v_fmamk_f32 v56, v9, 0x00000000, v10
  v_fmamk_f32 v57, v9, 0x3f800000, v10
  v_fmamk_f32 v58, v9, 0x40000000, v10
  v_fmamk_f32 v59, v9, 0x40400000, v10
  v_fmamk_f32 v60, v9, 0x40800000, v10
  v_fmamk_f32 v61, v9, 0x40a00000, v10
  v_fmamk_f32 v62, v9, 0x40c00000, v10
  v_fmamk_f32 v63, v9, 0x40e00000, v10
  v_fmamk_f32 v64, v9, 0x41800000, v10
  v_fmamk_f32 v65, v9, 0x41880000, v10
  v_fmamk_f32 v66, v9, 0x41900000, v10
  v_fmamk_f32 v67, v9, 0x41980000, v10
  v_fmamk_f32 v68, v9, 0x41a00000, v10
  v_fmamk_f32 v69, v9, 0x41a80000, v10
  v_fmamk_f32 v70, v9, 0x41b00000, v10
  v_fmamk_f32 v71, v9, 0x41b80000, v10
  v_cos_f32 v56, v56
  v_cos_f32 v57, v57
  v_cos_f32 v58, v58
  v_cos_f32 v59, v59
  v_cos_f32 v60, v60
  v_cos_f32 v61, v61
  v_cos_f32 v62, v62
  v_cos_f32 v63, v63
  v_cos_f32 v64, v64
  v_cos_f32 v65, v65
  v_cos_f32 v66, v66
  v_cos_f32 v67, v67
  v_cos_f32 v68, v68
  v_cos_f32 v69, v69
  v_cos_f32 v70, v70
  v_cos_f32 v71, v71
  v_mul_f32 v12, 0x41800000, v9
  v_cos_f32 v12, v12
  v_mul_f32 v56, v13, v56
  v_mul_f32 v57, v13, v57
  v_mul_f32 v58, v13, v58
  v_mul_f32 v59, v13, v59
  v_mul_f32 v60, v13, v60
  v_mul_f32 v61, v13, v61
  v_mul_f32 v62, v13, v62
  v_mul_f32 v63, v13, v63
  v_mul_f32 v64, v13, v64
  v_mul_f32 v65, v13, v65
  v_mul_f32 v66, v13, v66
  v_mul_f32 v67, v13, v67
  v_mul_f32 v68, v13, v68
  v_mul_f32 v69, v13, v69
  v_mul_f32 v70, v13, v70
  v_mul_f32 v71, v13, v71
  v_add_f32 v12, v12, v12
  v_cvt_pk_bf16_f32 v168, v56, v57
  v_cvt_pk_bf16_f32 v169, v58, v59
  v_cvt_pk_bf16_f32 v170, v60, v61
  v_cvt_pk_bf16_f32 v171, v62, v63
  v_cvt_pk_bf16_f32 v172, v64, v65
  v_cvt_pk_bf16_f32 v173, v66, v67
  v_cvt_pk_bf16_f32 v174, v68, v69
  v_cvt_pk_bf16_f32 v175, v70, v71
  v_pk_fma_f32 v[56:57], v[64:65], v[12:13], v[56:57] op_sel_hi:[1,0,1] neg_lo:[0,0,1] neg_hi:[0,0,1]
  v_pk_fma_f32 v[58:59], v[66:67], v[12:13], v[58:59] op_sel_hi:[1,0,1] neg_lo:[0,0,1] neg_hi:[0,0,1]
  v_pk_fma_f32 v[60:61], v[68:69], v[12:13], v[60:61] op_sel_hi:[1,0,1] neg_lo:[0,0,1] neg_hi:[0,0,1]
  v_pk_fma_f32 v[62:63], v[70:71], v[12:13], v[62:63] op_sel_hi:[1,0,1] neg_lo:[0,0,1] neg_hi:[0,0,1]
  v_cvt_pk_bf16_f32 v176, v56, v57
  v_cvt_pk_bf16_f32 v177, v58, v59
  v_cvt_pk_bf16_f32 v178, v60, v61
  v_cvt_pk_bf16_f32 v179, v62, v63
  v_pk_fma_f32 v[64:65], v[56:57], v[12:13], v[64:65] op_sel_hi:[1,0,1] neg_lo:[0,0,1] neg_hi:[0,0,1]
  v_pk_fma_f32 v[66:67], v[58:59], v[12:13], v[66:67] op_sel_hi:[1,0,1] neg_lo:[0,0,1] neg_hi:[0,0,1]
  v_pk_fma_f32 v[68:69], v[60:61], v[12:13], v[68:69] op_sel_hi:[1,0,1] neg_lo:[0,0,1] neg_hi:[0,0,1]
  v_pk_fma_f32 v[70:71], v[62:63], v[12:13], v[70:71] op_sel_hi:[1,0,1] neg_lo:[0,0,1] neg_hi:[0,0,1]
  v_cvt_pk_bf16_f32 v180, v64, v65
  v_cvt_pk_bf16_f32 v181, v66, v67
  v_cvt_pk_bf16_f32 v182, v68, v69
  v_cvt_pk_bf16_f32 v183, v70, v71
  v_pk_fma_f32 v[56:57], v[64:65], v[12:13], v[56:57] op_sel_hi:[1,0,1] neg_lo:[0,0,1] neg_hi:[0,0,1]
  v_pk_fma_f32 v[58:59], v[66:67], v[12:13], v[58:59] op_sel_hi:[1,0,1] neg_lo:[0,0,1] neg_hi:[0,0,1]
  v_pk_fma_f32 v[60:61], v[68:69], v[12:13], v[60:61] op_sel_hi:[1,0,1] neg_lo:[0,0,1] neg_hi:[0,0,1]
  v_pk_fma_f32 v[62:63], v[70:71], v[12:13], v[62:63] op_sel_hi:[1,0,1] neg_lo:[0,0,1] neg_hi:[0,0,1]
  v_cvt_pk_bf16_f32 v184, v56, v57
  v_cvt_pk_bf16_f32 v185, v58, v59
  v_cvt_pk_bf16_f32 v186, v60, v61
  v_cvt_pk_bf16_f32 v187, v62, v63
  v_pk_fma_f32 v[64:65], v[56:57], v[12:13], v[64:65] op_sel_hi:[1,0,1] neg_lo:[0,0,1] neg_hi:[0,0,1]
  v_pk_fma_f32 v[66:67], v[58:59], v[12:13], v[66:67] op_sel_hi:[1,0,1] neg_lo:[0,0,1] neg_hi:[0,0,1]
  v_pk_fma_f32 v[68:69], v[60:61], v[12:13], v[68:69] op_sel_hi:[1,0,1] neg_lo:[0,0,1] neg_hi:[0,0,1]
  v_pk_fma_f32 v[70:71], v[62:63], v[12:13], v[70:71] op_sel_hi:[1,0,1] neg_lo:[0,0,1] neg_hi:[0,0,1]
  v_cvt_pk_bf16_f32 v188, v64, v65
  v_cvt_pk_bf16_f32 v189, v66, v67
  v_cvt_pk_bf16_f32 v190, v68, v69
  v_cvt_pk_bf16_f32 v191, v70, v71
  v_pk_fma_f32 v[56:57], v[64:65], v[12:13], v[56:57] op_sel_hi:[1,0,1] neg_lo:[0,0,1] neg_hi:[0,0,1]
  v_pk_fma_f32 v[58:59], v[66:67], v[12:13], v[58:59] op_sel_hi:[1,0,1] neg_lo:[0,0,1] neg_hi:[0,0,1]
  v_pk_fma_f32 v[60:61], v[68:69], v[12:13], v[60:61] op_sel_hi:[1,0,1] neg_lo:[0,0,1] neg_hi:[0,0,1]
  v_pk_fma_f32 v[62:63], v[70:71], v[12:13], v[62:63] op_sel_hi:[1,0,1] neg_lo:[0,0,1] neg_hi:[0,0,1]
  v_cvt_pk_bf16_f32 v192, v56, v57
  v_cvt_pk_bf16_f32 v193, v58, v59
  v_cvt_pk_bf16_f32 v194, v60, v61
  v_cvt_pk_bf16_f32 v195, v62, v63
  v_pk_fma_f32 v[64:65], v[56:57], v[12:13], v[64:65] op_sel_hi:[1,0,1] neg_lo:[0,0,1] neg_hi:[0,0,1]
  v_pk_fma_f32 v[66:67], v[58:59], v[12:13], v[66:67] op_sel_hi:[1,0,1] neg_lo:[0,0,1] neg_hi:[0,0,1]
  v_pk_fma_f32 v[68:69], v[60:61], v[12:13], v[68:69] op_sel_hi:[1,0,1] neg_lo:[0,0,1] neg_hi:[0,0,1]
  v_pk_fma_f32 v[70:71], v[62:63], v[12:13], v[70:71] op_sel_hi:[1,0,1] neg_lo:[0,0,1] neg_hi:[0,0,1]
  v_cvt_pk_bf16_f32 v196, v64, v65
  v_cvt_pk_bf16_f32 v197, v66, v67
  v_cvt_pk_bf16_f32 v198, v68, v69
  v_cvt_pk_bf16_f32 v199, v70, v71
  v_pk_fma_f32 v[56:57], v[64:65], v[12:13], v[56:57] op_sel_hi:[1,0,1] neg_lo:[0,0,1] neg_hi:[0,0,1]
  v_pk_fma_f32 v[58:59], v[66:67], v[12:13], v[58:59] op_sel_hi:[1,0,1] neg_lo:[0,0,1] neg_hi:[0,0,1]
  v_pk_fma_f32 v[60:61], v[68:69], v[12:13], v[60:61] op_sel_hi:[1,0,1] neg_lo:[0,0,1] neg_hi:[0,0,1]
  v_pk_fma_f32 v[62:63], v[70:71], v[12:13], v[62:63] op_sel_hi:[1,0,1] neg_lo:[0,0,1] neg_hi:[0,0,1]
  v_cvt_pk_bf16_f32 v200, v56, v57
  v_cvt_pk_bf16_f32 v201, v58, v59
  v_cvt_pk_bf16_f32 v202, v60, v61
  v_cvt_pk_bf16_f32 v203, v62, v63
  v_pk_fma_f32 v[64:65], v[56:57], v[12:13], v[64:65] op_sel_hi:[1,0,1] neg_lo:[0,0,1] neg_hi:[0,0,1]
  v_pk_fma_f32 v[66:67], v[58:59], v[12:13], v[66:67] op_sel_hi:[1,0,1] neg_lo:[0,0,1] neg_hi:[0,0,1]
  v_pk_fma_f32 v[68:69], v[60:61], v[12:13], v[68:69] op_sel_hi:[1,0,1] neg_lo:[0,0,1] neg_hi:[0,0,1]
  v_pk_fma_f32 v[70:71], v[62:63], v[12:13], v[70:71] op_sel_hi:[1,0,1] neg_lo:[0,0,1] neg_hi:[0,0,1]
  v_cvt_pk_bf16_f32 v204, v64, v65
  v_cvt_pk_bf16_f32 v205, v66, v67
  v_cvt_pk_bf16_f32 v206, v68, v69
  v_cvt_pk_bf16_f32 v207, v70, v71
  v_pk_fma_f32 v[56:57], v[64:65], v[12:13], v[56:57] op_sel_hi:[1,0,1] neg_lo:[0,0,1] neg_hi:[0,0,1]
  v_pk_fma_f32 v[58:59], v[66:67], v[12:13], v[58:59] op_sel_hi:[1,0,1] neg_lo:[0,0,1] neg_hi:[0,0,1]
  v_pk_fma_f32 v[60:61], v[68:69], v[12:13], v[60:61] op_sel_hi:[1,0,1] neg_lo:[0,0,1] neg_hi:[0,0,1]
  v_pk_fma_f32 v[62:63], v[70:71], v[12:13], v[62:63] op_sel_hi:[1,0,1] neg_lo:[0,0,1] neg_hi:[0,0,1]
  v_cvt_pk_bf16_f32 v208, v56, v57
  v_cvt_pk_bf16_f32 v209, v58, v59
  v_cvt_pk_bf16_f32 v210, v60, v61
  v_cvt_pk_bf16_f32 v211, v62, v63
  v_pk_fma_f32 v[64:65], v[56:57], v[12:13], v[64:65] op_sel_hi:[1,0,1] neg_lo:[0,0,1] neg_hi:[0,0,1]
  v_pk_fma_f32 v[66:67], v[58:59], v[12:13], v[66:67] op_sel_hi:[1,0,1] neg_lo:[0,0,1] neg_hi:[0,0,1]
  v_pk_fma_f32 v[68:69], v[60:61], v[12:13], v[68:69] op_sel_hi:[1,0,1] neg_lo:[0,0,1] neg_hi:[0,0,1]
  v_pk_fma_f32 v[70:71], v[62:63], v[12:13], v[70:71] op_sel_hi:[1,0,1] neg_lo:[0,0,1] neg_hi:[0,0,1]
  v_cvt_pk_bf16_f32 v212, v64, v65
  v_cvt_pk_bf16_f32 v213, v66, v67
  v_cvt_pk_bf16_f32 v214, v68, v69
  v_cvt_pk_bf16_f32 v215, v70, v71
  v_pk_fma_f32 v[56:57], v[64:65], v[12:13], v[56:57] op_sel_hi:[1,0,1] neg_lo:[0,0,1] neg_hi:[0,0,1]
  v_pk_fma_f32 v[58:59], v[66:67], v[12:13], v[58:59] op_sel_hi:[1,0,1] neg_lo:[0,0,1] neg_hi:[0,0,1]
  v_pk_fma_f32 v[60:61], v[68:69], v[12:13], v[60:61] op_sel_hi:[1,0,1] neg_lo:[0,0,1] neg_hi:[0,0,1]
  v_pk_fma_f32 v[62:63], v[70:71], v[12:13], v[62:63] op_sel_hi:[1,0,1] neg_lo:[0,0,1] neg_hi:[0,0,1]
  v_cvt_pk_bf16_f32 v216, v56, v57
  v_cvt_pk_bf16_f32 v217, v58, v59
  v_cvt_pk_bf16_f32 v218, v60, v61
  v_cvt_pk_bf16_f32 v219, v62, v63
  v_pk_fma_f32 v[64:65], v[56:57], v[12:13], v[64:65] op_sel_hi:[1,0,1] neg_lo:[0,0,1] neg_hi:[0,0,1]
  v_pk_fma_f32 v[66:67], v[58:59], v[12:13], v[66:67] op_sel_hi:[1,0,1] neg_lo:[0,0,1] neg_hi:[0,0,1]
  v_pk_fma_f32 v[68:69], v[60:61], v[12:13], v[68:69] op_sel_hi:[1,0,1] neg_lo:[0,0,1] neg_hi:[0,0,1]
  v_pk_fma_f32 v[70:71], v[62:63], v[12:13], v[70:71] op_sel_hi:[1,0,1] neg_lo:[0,0,1] neg_hi:[0,0,1]
  v_cvt_pk_bf16_f32 v220, v64, v65
  v_cvt_pk_bf16_f32 v221, v66, v67
  v_cvt_pk_bf16_f32 v222, v68, v69
  v_cvt_pk_bf16_f32 v223, v70, v71
  v_pk_fma_f32 v[56:57], v[64:65], v[12:13], v[56:57] op_sel_hi:[1,0,1] neg_lo:[0,0,1] neg_hi:[0,0,1]
  v_pk_fma_f32 v[58:59], v[66:67], v[12:13], v[58:59] op_sel_hi:[1,0,1] neg_lo:[0,0,1] neg_hi:[0,0,1]
  v_pk_fma_f32 v[60:61], v[68:69], v[12:13], v[60:61] op_sel_hi:[1,0,1] neg_lo:[0,0,1] neg_hi:[0,0,1]
  v_pk_fma_f32 v[62:63], v[70:71], v[12:13], v[62:63] op_sel_hi:[1,0,1] neg_lo:[0,0,1] neg_hi:[0,0,1]
  v_cvt_pk_bf16_f32 v224, v56, v57
  v_cvt_pk_bf16_f32 v225, v58, v59
  v_cvt_pk_bf16_f32 v226, v60, v61
  v_cvt_pk_bf16_f32 v227, v62, v63
  v_pk_fma_f32 v[64:65], v[56:57], v[12:13], v[64:65] op_sel_hi:[1,0,1] neg_lo:[0,0,1] neg_hi:[0,0,1]
  v_pk_fma_f32 v[66:67], v[58:59], v[12:13], v[66:67] op_sel_hi:[1,0,1] neg_lo:[0,0,1] neg_hi:[0,0,1]
  v_pk_fma_f32 v[68:69], v[60:61], v[12:13], v[68:69] op_sel_hi:[1,0,1] neg_lo:[0,0,1] neg_hi:[0,0,1]
  v_pk_fma_f32 v[70:71], v[62:63], v[12:13], v[70:71] op_sel_hi:[1,0,1] neg_lo:[0,0,1] neg_hi:[0,0,1]
  v_cvt_pk_bf16_f32 v228, v64, v65
  v_cvt_pk_bf16_f32 v229, v66, v67
  v_cvt_pk_bf16_f32 v230, v68, v69
  v_cvt_pk_bf16_f32 v231, v70, v71
  v_pk_fma_f32 v[56:57], v[64:65], v[12:13], v[56:57] op_sel_hi:[1,0,1] neg_lo:[0,0,1] neg_hi:[0,0,1]
  v_pk_fma_f32 v[58:59], v[66:67], v[12:13], v[58:59] op_sel_hi:[1,0,1] neg_lo:[0,0,1] neg_hi:[0,0,1]
  v_pk_fma_f32 v[60:61], v[68:69], v[12:13], v[60:61] op_sel_hi:[1,0,1] neg_lo:[0,0,1] neg_hi:[0,0,1]
  v_pk_fma_f32 v[62:63], v[70:71], v[12:13], v[62:63] op_sel_hi:[1,0,1] neg_lo:[0,0,1] neg_hi:[0,0,1]
  v_cvt_pk_bf16_f32 v232, v56, v57
  v_cvt_pk_bf16_f32 v233, v58, v59
  v_cvt_pk_bf16_f32 v234, v60, v61
  v_cvt_pk_bf16_f32 v235, v62, v63
  v_pk_fma_f32 v[64:65], v[56:57], v[12:13], v[64:65] op_sel_hi:[1,0,1] neg_lo:[0,0,1] neg_hi:[0,0,1]
  v_pk_fma_f32 v[66:67], v[58:59], v[12:13], v[66:67] op_sel_hi:[1,0,1] neg_lo:[0,0,1] neg_hi:[0,0,1]
  v_pk_fma_f32 v[68:69], v[60:61], v[12:13], v[68:69] op_sel_hi:[1,0,1] neg_lo:[0,0,1] neg_hi:[0,0,1]
  v_pk_fma_f32 v[70:71], v[62:63], v[12:13], v[70:71] op_sel_hi:[1,0,1] neg_lo:[0,0,1] neg_hi:[0,0,1]
  v_cvt_pk_bf16_f32 v236, v64, v65
  v_cvt_pk_bf16_f32 v237, v66, v67
  v_cvt_pk_bf16_f32 v238, v68, v69
  v_cvt_pk_bf16_f32 v239, v70, v71
L_nf2:
  buffer_load_dwordx4 v[16:19], v4, s[4:7], 0 offen offset:0
  buffer_load_dwordx4 v[20:23], v4, s[4:7], 0 offen offset:128
  buffer_load_dwordx4 v[24:27], v4, s[4:7], 0 offen offset:256
  buffer_load_dwordx4 v[28:31], v4, s[4:7], 0 offen offset:384
  buffer_load_dwordx4 v[32:35], v6, s[4:7], 0 offen offset:512
  buffer_load_dwordx4 v[36:39], v4, s[4:7], 0 offen offset:576
  buffer_load_dwordx4 v[40:43], v4, s[4:7], 0 offen offset:704
  buffer_load_dwordx4 v[44:47], v4, s[4:7], 0 offen offset:832
  buffer_load_dwordx4 v[48:51], v4, s[4:7], 0 offen offset:960
  buffer_load_dwordx4 v[52:55], v6, s[4:7], 0 offen offset:1088
  s_and_b32 s66, s61, 3
  s_lshr_b32 s67, s61, 2
  s_lshl_b32 s67, s67, 4
  s_add_u32 s66, s66, s67
  s_lshl_b32 s67, s65, 2
  s_add_u32 s66, s66, s67
  s_mul_i32 s68, s66, 4624
  s_mul_i32 s69, s60, 5120
  s_add_u32 s69, s69, 45056
  s_cmp_eq_u32 s64, 0
  s_cselect_b32 s20, s8, s12
  s_cselect_b32 s21, s9, s13
  s_cselect_b32 s22, s10, s14
  s_mov_b32 s23, 0x00020000
  s_mov_b32 s71, 0xffff0000
  s_mov_b32 s70, 0x3f803f80
  v_mov_b32 v72, 0
  v_mov_b32 v73, 0
  v_mov_b32 v74, 0
  v_mov_b32 v75, 0
  s_waitcnt vmcnt(9)
  v_dot2_f32_bf16 v72, v16, s70, v72
  v_dot2_f32_bf16 v74, v16, v16, v74
  v_dot2_f32_bf16 v73, v17, s70, v73
  v_dot2_f32_bf16 v75, v17, v17, v75
  v_dot2_f32_bf16 v72, v18, s70, v72
  v_dot2_f32_bf16 v74, v18, v18, v74
  v_dot2_f32_bf16 v73, v19, s70, v73
  v_dot2_f32_bf16 v75, v19, v19, v75
  s_waitcnt vmcnt(8)
  v_dot2_f32_bf16 v72, v20, s70, v72
  v_dot2_f32_bf16 v74, v20, v20, v74
  v_dot2_f32_bf16 v73, v21, s70, v73
  v_dot2_f32_bf16 v75, v21, v21, v75
  v_dot2_f32_bf16 v72, v22, s70, v72
  v_dot2_f32_bf16 v74, v22, v22, v74
  v_dot2_f32_bf16 v73, v23, s70, v73
  v_dot2_f32_bf16 v75, v23, v23, v75
  s_waitcnt vmcnt(7)
  v_dot2_f32_bf16 v72, v24, s70, v72
  v_dot2_f32_bf16 v74, v24, v24, v74
  v_dot2_f32_bf16 v73, v25, s70, v73
  v_dot2_f32_bf16 v75, v25, v25, v75
  v_dot2_f32_bf16 v72, v26, s70, v72
  v_dot2_f32_bf16 v74, v26, v26, v74
  v_dot2_f32_bf16 v73, v27, s70, v73
  v_dot2_f32_bf16 v75, v27, v27, v75
  s_waitcnt vmcnt(6)
  v_dot2_f32_bf16 v72, v28, s70, v72
  v_dot2_f32_bf16 v74, v28, v28, v74
  s_branch L_pj16
  .p2align 12
L_stub16:
  s_setpc_b64 s[58:59]
  s_nop 0
L_pj16:
  v_dot2_f32_bf16 v73, v29, s70, v73
  v_dot2_f32_bf16 v75, v29, v29, v75
  v_dot2_f32_bf16 v72, v30, s70, v72
  v_dot2_f32_bf16 v74, v30, v30, v74
  v_dot2_f32_bf16 v73, v31, s70, v73
  v_dot2_f32_bf16 v75, v31, v31, v75
  s_waitcnt vmcnt(5)
  v_dot2_f32_bf16 v72, v32, s70, v72
  v_dot2_f32_bf16 v74, v32, v32, v74
  v_dot2_f32_bf16 v73, v33, s70, v73
  v_dot2_f32_bf16 v75, v33, v33, v75
  v_dot2_f32_bf16 v72, v34, s70, v72
  v_dot2_f32_bf16 v74, v34, v34, v74
  v_dot2_f32_bf16 v73, v35, s70, v73
  v_dot2_f32_bf16 v75, v35, v35, v75
  s_waitcnt vmcnt(4)
  v_dot2_f32_bf16 v72, v36, s70, v72
  v_dot2_f32_bf16 v74, v36, v36, v74
  v_dot2_f32_bf16 v73, v37, s70, v73
  v_dot2_f32_bf16 v75, v37, v37, v75
  v_dot2_f32_bf16 v72, v38, s70, v72
  v_dot2_f32_bf16 v74, v38, v38, v74
  v_dot2_f32_bf16 v73, v39, s70, v73
  v_dot2_f32_bf16 v75, v39, v39, v75
  s_add_u32 m0, s69, 0
  s_add_u32 s74, s68, 0
  buffer_load_dwordx4 v7, s[20:23], s74 offen lds
  s_waitcnt vmcnt(4)
  v_dot2_f32_bf16 v72, v40, s70, v72
  v_dot2_f32_bf16 v74, v40, v40, v74
  v_dot2_f32_bf16 v73, v41, s70, v73
  v_dot2_f32_bf16 v75, v41, v41, v75
  v_dot2_f32_bf16 v72, v42, s70, v72
  v_dot2_f32_bf16 v74, v42, v42, v74
  v_dot2_f32_bf16 v73, v43, s70, v73
  v_dot2_f32_bf16 v75, v43, v43, v75
  s_add_u32 m0, s69, 1024
  s_add_u32 s74, s68, 1024
  buffer_load_dwordx4 v7, s[20:23], s74 offen lds
  s_waitcnt vmcnt(4)
  v_dot2_f32_bf16 v72, v44, s70, v72
  v_dot2_f32_bf16 v74, v44, v44, v74
  v_dot2_f32_bf16 v73, v45, s70, v73
  v_dot2_f32_bf16 v75, v45, v45, v75
  v_dot2_f32_bf16 v72, v46, s70, v72
  v_dot2_f32_bf16 v74, v46, v46, v74
  v_dot2_f32_bf16 v73, v47, s70, v73
  v_dot2_f32_bf16 v75, v47, v47, v75
  s_add_u32 m0, s69, 2048
  s_add_u32 s74, s68, 2048
  buffer_load_dwordx4 v7, s[20:23], s74 offen lds
  s_waitcnt vmcnt(4)
  v_dot2_f32_bf16 v72, v48, s70, v72
  v_dot2_f32_bf16 v74, v48, v48, v74
  v_dot2_f32_bf16 v73, v49, s70, v73
  v_dot2_f32_bf16 v75, v49, v49, v75
  v_dot2_f32_bf16 v72, v50, s70, v72
  v_dot2_f32_bf16 v74, v50, v50, v74
  v_dot2_f32_bf16 v73, v51, s70, v73
  v_dot2_f32_bf16 v75, v51, v51, v75
  s_add_u32 m0, s69, 3072
  s_add_u32 s74, s68, 3072
  buffer_load_dwordx4 v7, s[20:23], s74 offen lds
  s_waitcnt vmcnt(4)
  v_dot2_f32_bf16 v72, v52, s70, v72
  v_dot2_f32_bf16 v74, v52, v52, v74
  v_dot2_f32_bf16 v73, v53, s70, v73
  v_dot2_f32_bf16 v75, v53, v53, v75
  v_dot2_f32_bf16 v72, v54, s70, v72
  v_dot2_f32_bf16 v74, v54, v54, v74
  v_dot2_f32_bf16 v73, v55, s70, v73
  v_dot2_f32_bf16 v75, v55, v55, v75
  s_add_u32 m0, s69, 4096
  s_add_u32 s74, s68, 4096
  buffer_load_dwordx4 v7, s[20:23], s74 offen lds
  v_add_f32 v72, v72, v73
  v_add_f32 v74, v74, v75
  s_nop 0
  v_add_f32_dpp v72, v72, v72 quad_perm:[1,0,3,2] row_mask:0xf bank_mask:0xf
  v_add_f32_dpp v74, v74, v74 quad_perm:[1,0,3,2] row_mask:0xf bank_mask:0xf
  s_nop 0
  v_add_f32_dpp v72, v72, v72 quad_perm:[2,3,0,1] row_mask:0xf bank_mask:0xf
  v_add_f32_dpp v74, v74, v74 quad_perm:[2,3,0,1] row_mask:0xf bank_mask:0xf
  s_nop 0
  v_add_f32_dpp v72, v72, v72 row_half_mirror row_mask:0xf bank_mask:0xf
  v_add_f32_dpp v74, v74, v74 row_half_mirror row_mask:0xf bank_mask:0xf
  v_mul_f32 v72, 0x3ae38e39, v72
  v_mul_f32 v74, 0x3ae38e39, v74
  v_fma_f32 v74, -v72, v72, v74
  v_max_f32 v74, 0, v74
  v_cvt_pk_bf16_f32 v74, 0, v74
  v_cvt_pk_bf16_f32 v72, 0, v72
  v_add_f32 v74, 0x3727c5ac, v74
  v_cvt_pk_bf16_f32 v74, 0, v74
  v_sqrt_f32 v74, v74
  s_nop 0
  v_cvt_pk_bf16_f32 v74, 0, v74
  v_rcp_f32 v73, v74
  s_nop 0
  v_mul_f32 v73, 0x3f800000, v73
  v_mul_f32 v74, v72, v73
  v_sub_f32 v74, 0, v74
  v_mov_b32 v72, v73
  s_cmp_eq_u32 s63, 0
  s_cselect_b32 s66, 1.0, -1.0
  s_cselect_b32 s67, 2.0, 0
  v_mul_f32 v74, s67, v74
  v_mov_b32 v76, s66
  v_bfe_u32 v8, v1, 1, 2
  v_mul_u32_u24 v8, 2208, v8
  v_and_b32 v9, 1, v1
  v_mul_u32_u24 v9, 528, v9
  v_add_u32 v8, v8, v9
  v_lshrrev_b32 v9, 3, v1
  v_lshl_add_u32 v8, v9, 4, v8
  s_mul_i32 s66, s64, 1056
  s_lshl_b32 s67, s65, 7
  s_add_u32 s66, s66, s67
  v_add_u32 v8, s66, v8
  v_lshlrev_b32 v56, 16, v16
  v_and_b32 v57, s71, v16
  v_lshlrev_b32 v64, 16, v36
  v_and_b32 v65, s71, v36
  v_lshlrev_b32 v58, 16, v17
  v_and_b32 v59, s71, v17
  v_lshlrev_b32 v66, 16, v37
  v_and_b32 v67, s71, v37
  v_lshlrev_b32 v60, 16, v18
  v_and_b32 v61, s71, v18
  v_lshlrev_b32 v68, 16, v38
  v_and_b32 v69, s71, v38
  v_lshlrev_b32 v62, 16, v19
  v_and_b32 v63, s71, v19
  v_lshlrev_b32 v70, 16, v39
  v_and_b32 v71, s71, v39
  v_pk_fma_f32 v[56:57], v[64:65], v[76:77], v[56:57] op_sel_hi:[1,0,1]
  v_pk_fma_f32 v[58:59], v[66:67], v[76:77], v[58:59] op_sel_hi:[1,0,1]
  v_pk_fma_f32 v[60:61], v[68:69], v[76:77], v[60:61] op_sel_hi:[1,0,1]
  v_pk_fma_f32 v[62:63], v[70:71], v[76:77], v[62:63] op_sel_hi:[1,0,1]
  v_pk_fma_f32 v[56:57], v[56:57], v[72:73], v[74:75] op_sel_hi:[1,0,0]
  v_pk_fma_f32 v[58:59], v[58:59], v[72:73], v[74:75] op_sel_hi:[1,0,0]
  v_pk_fma_f32 v[60:61], v[60:61], v[72:73], v[74:75] op_sel_hi:[1,0,0]
  v_pk_fma_f32 v[62:63], v[62:63], v[72:73], v[74:75] op_sel_hi:[1,0,0]
  v_cvt_pk_bf16_f32 v16, v56, v57
  v_cvt_pk_bf16_f32 v17, v58, v59
  v_cvt_pk_bf16_f32 v18, v60, v61
  v_cvt_pk_bf16_f32 v19, v62, v63
  ds_write_b128 v8, v[16:19] offset:0
  v_lshlrev_b32 v80, 16, v20
  v_and_b32 v81, s71, v20
  v_lshlrev_b32 v88, 16, v40
  v_and_b32 v89, s71, v40
  v_lshlrev_b32 v82, 16, v21
  v_and_b32 v83, s71, v21
  v_lshlrev_b32 v90, 16, v41
  v_and_b32 v91, s71, v41
  v_lshlrev_b32 v84, 16, v22
  v_and_b32 v85, s71, v22
  v_lshlrev_b32 v92, 16, v42
  v_and_b32 v93, s71, v42
  v_lshlrev_b32 v86, 16, v23
  v_and_b32 v87, s71, v23
  v_lshlrev_b32 v94, 16, v43
  v_and_b32 v95, s71, v43
  v_pk_fma_f32 v[80:81], v[88:89], v[76:77], v[80:81] op_sel_hi:[1,0,1]
  v_pk_fma_f32 v[82:83], v[90:91], v[76:77], v[82:83] op_sel_hi:[1,0,1]
  v_pk_fma_f32 v[84:85], v[92:93], v[76:77], v[84:85] op_sel_hi:[1,0,1]
  v_pk_fma_f32 v[86:87], v[94:95], v[76:77], v[86:87] op_sel_hi:[1,0,1]
  v_pk_fma_f32 v[80:81], v[80:81], v[72:73], v[74:75] op_sel_hi:[1,0,0]
  v_pk_fma_f32 v[82:83], v[82:83], v[72:73], v[74:75] op_sel_hi:[1,0,0]
  v_pk_fma_f32 v[84:85], v[84:85], v[72:73], v[74:75] op_sel_hi:[1,0,0]
  v_pk_fma_f32 v[86:87], v[86:87], v[72:73], v[74:75] op_sel_hi:[1,0,0]
  v_cvt_pk_bf16_f32 v20, v80, v81
  v_cvt_pk_bf16_f32 v21, v82, v83
  v_cvt_pk_bf16_f32 v22, v84, v85
  v_cvt_pk_bf16_f32 v23, v86, v87
  ds_write_b128 v8, v[20:23] offset:8832
  v_lshlrev_b32 v56, 16, v24
  v_and_b32 v57, s71, v24
  v_lshlrev_b32 v64, 16, v44
  v_and_b32 v65, s71, v44
  v_lshlrev_b32 v58, 16, v25
  v_and_b32 v59, s71, v25
  v_lshlrev_b32 v66, 16, v45
  v_and_b32 v67, s71, v45
  v_lshlrev_b32 v60, 16, v26
  v_and_b32 v61, s71, v26
  v_lshlrev_b32 v68, 16, v46
  v_and_b32 v69, s71, v46
  v_lshlrev_b32 v62, 16, v27
  v_and_b32 v63, s71, v27
  v_lshlrev_b32 v70, 16, v47
  v_and_b32 v71, s71, v47
  v_pk_fma_f32 v[56:57], v[64:65], v[76:77], v[56:57] op_sel_hi:[1,0,1]
  v_pk_fma_f32 v[58:59], v[66:67], v[76:77], v[58:59] op_sel_hi:[1,0,1]
  v_pk_fma_f32 v[60:61], v[68:69], v[76:77], v[60:61] op_sel_hi:[1,0,1]
  v_pk_fma_f32 v[62:63], v[70:71], v[76:77], v[62:63] op_sel_hi:[1,0,1]
  v_pk_fma_f32 v[56:57], v[56:57], v[72:73], v[74:75] op_sel_hi:[1,0,0]
  v_pk_fma_f32 v[58:59], v[58:59], v[72:73], v[74:75] op_sel_hi:[1,0,0]
  v_pk_fma_f32 v[60:61], v[60:61], v[72:73], v[74:75] op_sel_hi:[1,0,0]
  v_pk_fma_f32 v[62:63], v[62:63], v[72:73], v[74:75] op_sel_hi:[1,0,0]
  v_cvt_pk_bf16_f32 v24, v56, v57
  v_cvt_pk_bf16_f32 v25, v58, v59
  v_cvt_pk_bf16_f32 v26, v60, v61
  v_cvt_pk_bf16_f32 v27, v62, v63
  ds_write_b128 v8, v[24:27] offset:17664
  v_lshlrev_b32 v80, 16, v28
  v_and_b32 v81, s71, v28
  v_lshlrev_b32 v88, 16, v48
  v_and_b32 v89, s71, v48
  v_lshlrev_b32 v82, 16, v29
  v_and_b32 v83, s71, v29
  v_lshlrev_b32 v90, 16, v49
  v_and_b32 v91, s71, v49
  v_lshlrev_b32 v84, 16, v30
  v_and_b32 v85, s71, v30
  v_lshlrev_b32 v92, 16, v50
  v_and_b32 v93, s71, v50
  v_lshlrev_b32 v86, 16, v31
  v_and_b32 v87, s71, v31
  v_lshlrev_b32 v94, 16, v51
  v_and_b32 v95, s71, v51
  v_pk_fma_f32 v[80:81], v[88:89], v[76:77], v[80:81] op_sel_hi:[1,0,1]
  v_pk_fma_f32 v[82:83], v[90:91], v[76:77], v[82:83] op_sel_hi:[1,0,1]
  v_pk_fma_f32 v[84:85], v[92:93], v[76:77], v[84:85] op_sel_hi:[1,0,1]
  v_pk_fma_f32 v[86:87], v[94:95], v[76:77], v[86:87] op_sel_hi:[1,0,1]
  v_pk_fma_f32 v[80:81], v[80:81], v[72:73], v[74:75] op_sel_hi:[1,0,0]
  v_pk_fma_f32 v[82:83], v[82:83], v[72:73], v[74:75] op_sel_hi:[1,0,0]
  v_pk_fma_f32 v[84:85], v[84:85], v[72:73], v[74:75] op_sel_hi:[1,0,0]
  v_pk_fma_f32 v[86:87], v[86:87], v[72:73], v[74:75] op_sel_hi:[1,0,0]
  v_cvt_pk_bf16_f32 v28, v80, v81
  v_cvt_pk_bf16_f32 v29, v82, v83
  v_cvt_pk_bf16_f32 v30, v84, v85
  v_cvt_pk_bf16_f32 v31, v86, v87
  ds_write_b128 v8, v[28:31] offset:26496
  v_lshlrev_b32 v56, 16, v32
  v_and_b32 v57, s71, v32
  v_lshlrev_b32 v64, 16, v52
  v_and_b32 v65, s71, v52
  v_lshlrev_b32 v58, 16, v33
  v_and_b32 v59, s71, v33
  v_lshlrev_b32 v66, 16, v53
  v_and_b32 v67, s71, v53
  v_lshlrev_b32 v60, 16, v34
  v_and_b32 v61, s71, v34
  v_lshlrev_b32 v68, 16, v54
  v_and_b32 v69, s71, v54
  v_lshlrev_b32 v62, 16, v35
  v_and_b32 v63, s71, v35
  v_lshlrev_b32 v70, 16, v55
  v_and_b32 v71, s71, v55
  v_pk_fma_f32 v[56:57], v[64:65], v[76:77], v[56:57] op_sel_hi:[1,0,1]
  v_pk_fma_f32 v[58:59], v[66:67], v[76:77], v[58:59] op_sel_hi:[1,0,1]
  v_pk_fma_f32 v[60:61], v[68:69], v[76:77], v[60:61] op_sel_hi:[1,0,1]
  v_pk_fma_f32 v[62:63], v[70:71], v[76:77], v[62:63] op_sel_hi:[1,0,1]
  v_pk_fma_f32 v[56:57], v[56:57], v[72:73], v[74:75] op_sel_hi:[1,0,0]
  v_pk_fma_f32 v[58:59], v[58:59], v[72:73], v[74:75] op_sel_hi:[1,0,0]
  v_pk_fma_f32 v[60:61], v[60:61], v[72:73], v[74:75] op_sel_hi:[1,0,0]
  v_pk_fma_f32 v[62:63], v[62:63], v[72:73], v[74:75] op_sel_hi:[1,0,0]
  v_cvt_pk_bf16_f32 v32, v56, v57
  v_cvt_pk_bf16_f32 v33, v58, v59
  v_cvt_pk_bf16_f32 v34, v60, v61
  v_cvt_pk_bf16_f32 v35, v62, v63
  ds_write_b128 v8, v[32:35] offset:35328
  v_lshrrev_b32 v8, 5, v1
  v_mul_u32_u24 v9, 528, v8
  v_and_b32 v10, 31, v1
  v_lshl_add_u32 v12, v10, 4, v9
  s_lshl_b32 s66, s60, 12
  s_add_u32 s66, s66, 86016
  v_and_b32 v9, 7, v10
  v_xor_b32 v9, v9, v8
  v_lshlrev_b32 v9, 4, v9
  v_lshl_add_u32 v9, v10, 7, v9
  v_add_u32 v4, s66, v9
  s_bfe_u32 s67, s62, 0x30001
  v_lshrrev_b32 v8, 3, v1
  v_and_b32 v9, 7, v1
  v_xor_b32 v10, v8, v9
  v_xor_b32 v10, s67, v10
  v_lshlrev_b32 v10, 4, v10
  v_lshl_add_u32 v10, v8, 7, v10
  v_add_u32 v5, s66, v10
  v_mul_u32_u24 v6, 4224, v8
  v_lshl_add_u32 v6, v9, 4, v6
  s_mul_i32 s78, s63, 1216512
  s_lshl_b32 s67, s62, 7
  s_add_u32 s78, s78, s67
  s_add_u32 s78, s78, 37748736
  s_cmp_eq_u32 s60, 0
  s_cbranch_scc0 L_iw_d
  v_and_b32 v15, 7, v1
  v_lshlrev_b32 v15, 5, v15
  s_mov_b32 s80, 400000
L_iw:
  buffer_load_dword v14, v15, s[24:27], 0 offen sc1
  s_waitcnt vmcnt(0)
  v_cmp_le_u32 vcc, 1, v14
  s_sub_u32 s80, s80, 1
  s_cmp_eq_u64 vcc, -1
  s_cbranch_scc1 L_iw_d
  s_cmp_eq_u32 s80, 0
  s_cbranch_scc1 L_iw_d
  s_sleep 4
  s_branch L_iw
L_iw_d:
  s_waitcnt vmcnt(0) lgkmcnt(0)
  s_barrier
  s_cmp_lt_u32 s77, 2
  s_cbranch_scc0 L_nt8
  s_setprio 2
  s_mul_i32 s67, s77, 1056
  v_add_u32 v13, s67, v12
  ds_read_b128 v[48:51], v13 offset:0
  ds_read_b128 v[52:55], v13 offset:2208
  ds_read_b128 v[56:59], v13 offset:4416
  ds_read_b128 v[60:63], v13 offset:6624
  ds_read_b128 v[64:67], v13 offset:8832
  ds_read_b128 v[68:71], v13 offset:11040
  ds_read_b128 v[72:75], v13 offset:13248
  s_waitcnt lgkmcnt(6)
  v_mfma_f32_32x32x16_bf16 v[16:31], v[48:51], v[168:171], 0
  ds_read_b128 v[76:79], v13 offset:15456
  s_waitcnt lgkmcnt(6)
  v_mfma_f32_32x32x16_bf16 v[16:31], v[52:55], v[172:175], v[16:31]
  ds_read_b128 v[48:51], v13 offset:17664
  s_waitcnt lgkmcnt(6)
  v_mfma_f32_32x32x16_bf16 v[16:31], v[56:59], v[176:179], v[16:31]
  ds_read_b128 v[52:55], v13 offset:19872
  s_waitcnt lgkmcnt(6)
  v_mfma_f32_32x32x16_bf16 v[16:31], v[60:63], v[180:183], v[16:31]
  ds_read_b128 v[56:59], v13 offset:22080
  s_waitcnt lgkmcnt(6)
  v_mfma_f32_32x32x16_bf16 v[16:31], v[64:67], v[184:187], v[16:31]
  ds_read_b128 v[60:63], v13 offset:24288
  s_waitcnt lgkmcnt(6)
  v_mfma_f32_32x32x16_bf16 v[16:31], v[68:71], v[188:191], v[16:31]
  ds_read_b128 v[64:67], v13 offset:26496
  s_waitcnt lgkmcnt(6)
  v_mfma_f32_32x32x16_bf16 v[16:31], v[72:75], v[192:195], v[16:31]
  ds_read_b128 v[68:71], v13 offset:28704
  s_waitcnt lgkmcnt(6)
  v_mfma_f32_32x32x16_bf16 v[16:31], v[76:79], v[196:199], v[16:31]
  ds_read_b128 v[72:75], v13 offset:30912
  s_waitcnt lgkmcnt(6)
  v_mfma_f32_32x32x16_bf16 v[16:31], v[48:51], v[200:203], v[16:31]
  ds_read_b128 v[76:79], v13 offset:33120
  s_waitcnt lgkmcnt(6)
  v_mfma_f32_32x32x16_bf16 v[16:31], v[52:55], v[204:207], v[16:31]
  ds_read_b128 v[48:51], v13 offset:35328
  s_waitcnt lgkmcnt(6)
  v_mfma_f32_32x32x16_bf16 v[16:31], v[56:59], v[208:211], v[16:31]
  ds_read_b128 v[52:55], v13 offset:37536
  s_waitcnt lgkmcnt(6)
  v_mfma_f32_32x32x16_bf16 v[16:31], v[60:63], v[212:215], v[16:31]
  s_waitcnt lgkmcnt(5)
  v_mfma_f32_32x32x16_bf16 v[16:31], v[64:67], v[216:219], v[16:31]
  s_waitcnt lgkmcnt(4)
  v_mfma_f32_32x32x16_bf16 v[16:31], v[68:71], v[220:223], v[16:31]
  s_waitcnt lgkmcnt(3)
  v_mfma_f32_32x32x16_bf16 v[16:31], v[72:75], v[224:227], v[16:31]
  s_waitcnt lgkmcnt(2)
  v_mfma_f32_32x32x16_bf16 v[16:31], v[76:79], v[228:231], v[16:31]
  s_waitcnt lgkmcnt(1)
  v_mfma_f32_32x32x16_bf16 v[16:31], v[48:51], v[232:235], v[16:31]
  s_waitcnt lgkmcnt(0)
  v_mfma_f32_32x32x16_bf16 v[16:31], v[52:55], v[236:239], v[16:31]
  s_nop 11
  v_cvt_pk_bf16_f32 v80, v16, v17
  v_cvt_pk_bf16_f32 v81, v18, v19
  v_cvt_pk_bf16_f32 v82, v20, v21
  v_cvt_pk_bf16_f32 v83, v22, v23
  v_cvt_pk_bf16_f32 v84, v24, v25
  v_cvt_pk_bf16_f32 v85, v26, v27
  v_cvt_pk_bf16_f32 v86, v28, v29
  v_cvt_pk_bf16_f32 v87, v30, v31
  s_sub_u32 s67, 8, s60
  s_lshl_b32 s67, s67, 12
  v_add_u32 v9, s67, v4
  s_lshl_b32 s66, s77, 6
  v_xor_b32 v9, s66, v9
  v_xor_b32 v8, 0, v9
  ds_write_b128 v8, v[80:83]
  v_xor_b32 v8, 32, v9
  ds_write_b128 v8, v[84:87]
  s_waitcnt lgkmcnt(0)
  v_mov_b32 v14, 130048
  v_mov_b32 v15, 1
  s_mov_b64 exec, 1
  ds_add_u32 v14, v15
  s_mov_b64 exec, -1
  s_waitcnt lgkmcnt(0)
L_nt8:
  ds_read_b128 v[48:51], v12 offset:0
  ds_read_b128 v[52:55], v12 offset:1056
  ds_read_b128 v[56:59], v12 offset:2208
  ds_read_b128 v[60:63], v12 offset:3264
  ds_read_b128 v[64:67], v12 offset:4416
  ds_read_b128 v[68:71], v12 offset:5472
  ds_read_b128 v[72:75], v12 offset:6624
  ds_read_b128 v[76:79], v12 offset:7680
  s_waitcnt lgkmcnt(6)
  v_mfma_f32_32x32x16_bf16 v[16:31], v[48:51], v[96:99], 0
  v_mfma_f32_32x32x16_bf16 v[32:47], v[52:55], v[96:99], 0
  ds_read_b128 v[48:51], v12 offset:8832
  ds_read_b128 v[52:55], v12 offset:9888
  s_waitcnt lgkmcnt(6)
  v_mfma_f32_32x32x16_bf16 v[16:31], v[56:59], v[100:103], v[16:31]
  v_mfma_f32_32x32x16_bf16 v[32:47], v[60:63], v[100:103], v[32:47]
  ds_read_b128 v[56:59], v12 offset:11040
  ds_read_b128 v[60:63], v12 offset:12096
  s_waitcnt lgkmcnt(6)
  v_mfma_f32_32x32x16_bf16 v[16:31], v[64:67], v[104:107], v[16:31]
  v_mfma_f32_32x32x16_bf16 v[32:47], v[68:71], v[104:107], v[32:47]
  ds_read_b128 v[64:67], v12 offset:13248
  ds_read_b128 v[68:71], v12 offset:14304
  s_waitcnt lgkmcnt(6)
  v_mfma_f32_32x32x16_bf16 v[16:31], v[72:75], v[108:111], v[16:31]
  v_mfma_f32_32x32x16_bf16 v[32:47], v[76:79], v[108:111], v[32:47]
  ds_read_b128 v[72:75], v12 offset:15456
  ds_read_b128 v[76:79], v12 offset:16512
  s_waitcnt lgkmcnt(6)
  v_mfma_f32_32x32x16_bf16 v[16:31], v[48:51], v[112:115], v[16:31]
  v_mfma_f32_32x32x16_bf16 v[32:47], v[52:55], v[112:115], v[32:47]
  ds_read_b128 v[48:51], v12 offset:17664
  ds_read_b128 v[52:55], v12 offset:18720
  s_waitcnt lgkmcnt(6)
  v_mfma_f32_32x32x16_bf16 v[16:31], v[56:59], v[116:119], v[16:31]
  v_mfma_f32_32x32x16_bf16 v[32:47], v[60:63], v[116:119], v[32:47]
  ds_read_b128 v[56:59], v12 offset:19872
  ds_read_b128 v[60:63], v12 offset:20928
  s_waitcnt lgkmcnt(6)
  v_mfma_f32_32x32x16_bf16 v[16:31], v[64:67], v[120:123], v[16:31]
  v_mfma_f32_32x32x16_bf16 v[32:47], v[68:71], v[120:123], v[32:47]
  ds_read_b128 v[64:67], v12 offset:22080
  ds_read_b128 v[68:71], v12 offset:23136
  s_waitcnt lgkmcnt(6)
  v_mfma_f32_32x32x16_bf16 v[16:31], v[72:75], v[124:127], v[16:31]
  v_mfma_f32_32x32x16_bf16 v[32:47], v[76:79], v[124:127], v[32:47]
  ds_read_b128 v[72:75], v12 offset:24288
  ds_read_b128 v[76:79], v12 offset:25344
  s_waitcnt lgkmcnt(6)
  v_mfma_f32_32x32x16_bf16 v[16:31], v[48:51], v[128:131], v[16:31]
  v_mfma_f32_32x32x16_bf16 v[32:47], v[52:55], v[128:131], v[32:47]
  ds_read_b128 v[48:51], v12 offset:26496
  ds_read_b128 v[52:55], v12 offset:27552
  s_waitcnt lgkmcnt(6)
  v_mfma_f32_32x32x16_bf16 v[16:31], v[56:59], v[132:135], v[16:31]
  v_mfma_f32_32x32x16_bf16 v[32:47], v[60:63], v[132:135], v[32:47]
  ds_read_b128 v[56:59], v12 offset:28704
  ds_read_b128 v[60:63], v12 offset:29760
  s_waitcnt lgkmcnt(6)
  v_mfma_f32_32x32x16_bf16 v[16:31], v[64:67], v[136:139], v[16:31]
  v_mfma_f32_32x32x16_bf16 v[32:47], v[68:71], v[136:139], v[32:47]
  ds_read_b128 v[64:67], v12 offset:30912
  ds_read_b128 v[68:71], v12 offset:31968
  s_waitcnt lgkmcnt(6)
  v_mfma_f32_32x32x16_bf16 v[16:31], v[72:75], v[140:143], v[16:31]
  v_mfma_f32_32x32x16_bf16 v[32:47], v[76:79], v[140:143], v[32:47]
  ds_read_b128 v[72:75], v12 offset:33120
  ds_read_b128 v[76:79], v12 offset:34176
  s_waitcnt lgkmcnt(6)
  v_mfma_f32_32x32x16_bf16 v[16:31], v[48:51], v[144:147], v[16:31]
  v_mfma_f32_32x32x16_bf16 v[32:47], v[52:55], v[144:147], v[32:47]
  ds_read_b128 v[48:51], v12 offset:35328
  ds_read_b128 v[52:55], v12 offset:36384
  s_waitcnt lgkmcnt(6)
  v_mfma_f32_32x32x16_bf16 v[16:31], v[56:59], v[148:151], v[16:31]
  v_mfma_f32_32x32x16_bf16 v[32:47], v[60:63], v[148:151], v[32:47]
  ds_read_b128 v[56:59], v12 offset:37536
  ds_read_b128 v[60:63], v12 offset:38592
  s_waitcnt lgkmcnt(6)
  v_mfma_f32_32x32x16_bf16 v[16:31], v[64:67], v[152:155], v[16:31]
  v_mfma_f32_32x32x16_bf16 v[32:47], v[68:71], v[152:155], v[32:47]
  s_waitcnt lgkmcnt(4)
  v_mfma_f32_32x32x16_bf16 v[16:31], v[72:75], v[156:159], v[16:31]
  v_mfma_f32_32x32x16_bf16 v[32:47], v[76:79], v[156:159], v[32:47]
  s_waitcnt lgkmcnt(2)
  v_mfma_f32_32x32x16_bf16 v[16:31], v[48:51], v[160:163], v[16:31]
  v_mfma_f32_32x32x16_bf16 v[32:47], v[52:55], v[160:163], v[32:47]
  s_waitcnt lgkmcnt(0)
  v_mfma_f32_32x32x16_bf16 v[16:31], v[56:59], v[164:167], v[16:31]
  v_mfma_f32_32x32x16_bf16 v[32:47], v[60:63], v[164:167], v[32:47]
  s_setprio 0
  s_nop 9
  v_cvt_pk_bf16_f32 v80, v16, v17
  v_cvt_pk_bf16_f32 v81, v18, v19
  v_cvt_pk_bf16_f32 v82, v20, v21
  v_cvt_pk_bf16_f32 v83, v22, v23
  v_cvt_pk_bf16_f32 v84, v24, v25
  v_cvt_pk_bf16_f32 v85, v26, v27
  v_cvt_pk_bf16_f32 v86, v28, v29
  v_cvt_pk_bf16_f32 v87, v30, v31
  v_xor_b32 v8, 0, v4
  ds_write_b128 v8, v[80:83]
  v_xor_b32 v8, 32, v4
  ds_write_b128 v8, v[84:87]
  v_cvt_pk_bf16_f32 v88, v32, v33
  v_cvt_pk_bf16_f32 v89, v34, v35
  v_cvt_pk_bf16_f32 v90, v36, v37
  v_cvt_pk_bf16_f32 v91, v38, v39
  v_cvt_pk_bf16_f32 v92, v40, v41
  v_cvt_pk_bf16_f32 v93, v42, v43
  v_cvt_pk_bf16_f32 v94, v44, v45
  v_cvt_pk_bf16_f32 v95, v46, v47
  v_xor_b32 v8, 64, v4
  ds_write_b128 v8, v[88:91]
  v_xor_b32 v8, 96, v4
  ds_write_b128 v8, v[92:95]
  s_waitcnt lgkmcnt(0)
  ds_read_b128 v[80:83], v5 offset:0
  ds_read_b128 v[84:87], v5 offset:1024
  ds_read_b128 v[88:91], v5 offset:2048
  ds_read_b128 v[92:95], v5 offset:3072
  s_mul_i32 s66, s60, 135168
  s_add_u32 s66, s66, s78
  s_waitcnt lgkmcnt(3)
  s_add_u32 s67, s66, 0
  buffer_store_dwordx4 v[80:83], v6, s[16:19], s67 offen sc1
  s_waitcnt lgkmcnt(2)
  s_add_u32 s67, s66, 33792
  buffer_store_dwordx4 v[84:87], v6, s[16:19], s67 offen sc1
  s_waitcnt lgkmcnt(1)
  s_add_u32 s67, s66, 67584
  buffer_store_dwordx4 v[88:91], v6, s[16:19], s67 offen sc1
  s_waitcnt lgkmcnt(0)
  s_add_u32 s67, s66, 101376
  buffer_store_dwordx4 v[92:95], v6, s[16:19], s67 offen sc1
  s_sub_u32 s66, s60, 1
  s_cmp_lt_u32 s66, 2
  s_cbranch_scc1 L_wtd
  s_cmp_lt_u32 s77, 2
  s_cbranch_scc0 L_wtr
  v_mov_b32 v14, 130048
  s_mov_b32 s80, 3200000
L_w8:
  ds_read_b32 v15, v14
  s_waitcnt lgkmcnt(0)
  v_readfirstlane_b32 s81, v15
  s_sub_u32 s80, s80, 1
  s_cmp_ge_u32 s81, 2
  s_cbranch_scc1 L_w8_d
  s_cmp_eq_u32 s80, 0
  s_cbranch_scc1 L_w8_d
  s_sleep 1
  s_branch L_w8
L_w8_d:
  s_sub_u32 s67, 8, s60
  s_lshl_b32 s67, s67, 12
  s_lshl_b32 s66, s77, 11
  s_add_u32 s67, s67, s66
  v_add_u32 v5, s67, v5
  ds_read_b128 v[16:19], v5 offset:0
  ds_read_b128 v[20:23], v5 offset:1024
  s_mul_i32 s66, s77, 67584
  s_add_u32 s66, s66, s78
  s_add_u32 s66, s66, 1081344
  s_waitcnt lgkmcnt(1)
  s_add_u32 s67, s66, 0
  buffer_store_dwordx4 v[16:19], v6, s[16:19], s67 offen sc1
  s_waitcnt lgkmcnt(0)
  s_add_u32 s67, s66, 33792
  buffer_store_dwordx4 v[20:23], v6, s[16:19], s67 offen sc1
L_wtr:
  s_sub_u32 s66, s60, 2
  s_cmp_eq_u32 s60, 0
  s_cselect_b32 s66, 0, s66
  s_lshl_b32 s66, s66, 3
  v_and_b32 v8, 7, v1
  v_lshrrev_b32 v9, 3, v1
  v_add_u32 v9, s66, v9
  v_mul_u32_u24 v10, 578, v8
  v_lshl_add_u32 v10, v9, 1, v10
  v_add_u32 v10, 45058, v10
  v_mul_u32_u24 v9, 8320, v9
  v_lshl_add_u32 v9, v8, 4, v9
  s_lshl_b32 s66, s61, 7
  s_add_u32 s66, s66, 46137344
  ds_read_u16 v24, v10 offset:0
  ds_read_u16 v25, v10 offset:5120
  ds_read_u16 v26, v10 offset:10240
  ds_read_u16 v27, v10 offset:15360
  ds_read_u16 v28, v10 offset:20480
  ds_read_u16 v29, v10 offset:25600
  ds_read_u16 v30, v10 offset:30720
  ds_read_u16 v31, v10 offset:35840
  ds_read_u16 v32, v10 offset:96
  ds_read_u16 v33, v10 offset:5216
  ds_read_u16 v34, v10 offset:10336
  ds_read_u16 v35, v10 offset:15456
  ds_read_u16 v36, v10 offset:20576
  ds_read_u16 v37, v10 offset:25696
  ds_read_u16 v38, v10 offset:30816
  ds_read_u16 v39, v10 offset:35936
  s_waitcnt lgkmcnt(8)
  v_lshl_or_b32 v24, v28, 16, v24
  v_lshl_or_b32 v25, v29, 16, v25
  v_lshl_or_b32 v26, v30, 16, v26
  v_lshl_or_b32 v27, v31, 16, v27
  s_add_u32 s67, s66, 0
  buffer_store_dwordx4 v[24:27], v9, s[16:19], s67 offen sc1
  ds_read_u16 v40, v10 offset:192
  ds_read_u16 v41, v10 offset:5312
  ds_read_u16 v42, v10 offset:10432
  ds_read_u16 v43, v10 offset:15552
  ds_read_u16 v44, v10 offset:20672
  ds_read_u16 v45, v10 offset:25792
  ds_read_u16 v46, v10 offset:30912
  ds_read_u16 v47, v10 offset:36032
  s_waitcnt lgkmcnt(8)
  v_lshl_or_b32 v32, v36, 16, v32
  v_lshl_or_b32 v33, v37, 16, v33
  v_lshl_or_b32 v34, v38, 16, v34
  v_lshl_or_b32 v35, v39, 16, v35
  s_add_u32 s67, s66, 399360
  buffer_store_dwordx4 v[32:35], v9, s[16:19], s67 offen sc1
  ds_read_u16 v48, v10 offset:288
  ds_read_u16 v49, v10 offset:5408
  ds_read_u16 v50, v10 offset:10528
  ds_read_u16 v51, v10 offset:15648
  ds_read_u16 v52, v10 offset:20768
  ds_read_u16 v53, v10 offset:25888
  ds_read_u16 v54, v10 offset:31008
  ds_read_u16 v55, v10 offset:36128
  s_waitcnt lgkmcnt(8)
  v_lshl_or_b32 v40, v44, 16, v40
  v_lshl_or_b32 v41, v45, 16, v41
  v_lshl_or_b32 v42, v46, 16, v42
  v_lshl_or_b32 v43, v47, 16, v43
  s_add_u32 s67, s66, 798720
  buffer_store_dwordx4 v[40:43], v9, s[16:19], s67 offen sc1
  ds_read_u16 v56, v10 offset:384
  ds_read_u16 v57, v10 offset:5504
  ds_read_u16 v58, v10 offset:10624
  ds_read_u16 v59, v10 offset:15744
  ds_read_u16 v60, v10 offset:20864
  ds_read_u16 v61, v10 offset:25984
  ds_read_u16 v62, v10 offset:31104
  s_branch L_pj17
  .p2align 12
L_stub17:
  s_setpc_b64 s[58:59]
  s_nop 0
L_pj17:
  ds_read_u16 v63, v10 offset:36224
  s_waitcnt lgkmcnt(8)
  v_lshl_or_b32 v48, v52, 16, v48
  v_lshl_or_b32 v49, v53, 16, v49
  v_lshl_or_b32 v50, v54, 16, v50
  v_lshl_or_b32 v51, v55, 16, v51
  s_add_u32 s67, s66, 1198080
  buffer_store_dwordx4 v[48:51], v9, s[16:19], s67 offen sc1
  ds_read_u16 v64, v10 offset:480
  ds_read_u16 v65, v10 offset:5600
  ds_read_u16 v66, v10 offset:10720
  ds_read_u16 v67, v10 offset:15840
  ds_read_u16 v68, v10 offset:20960
  ds_read_u16 v69, v10 offset:26080
  ds_read_u16 v70, v10 offset:31200
  ds_read_u16 v71, v10 offset:36320
  s_waitcnt lgkmcnt(8)
  v_lshl_or_b32 v56, v60, 16, v56
  v_lshl_or_b32 v57, v61, 16, v57
  v_lshl_or_b32 v58, v62, 16, v58
  v_lshl_or_b32 v59, v63, 16, v59
  s_add_u32 s67, s66, 1597440
  buffer_store_dwordx4 v[56:59], v9, s[16:19], s67 offen sc1
  s_waitcnt lgkmcnt(0)
  v_lshl_or_b32 v64, v68, 16, v64
  v_lshl_or_b32 v65, v69, 16, v65
  v_lshl_or_b32 v66, v70, 16, v66
  v_lshl_or_b32 v67, v71, 16, v67
  s_add_u32 s67, s66, 1996800
  buffer_store_dwordx4 v[64:67], v9, s[16:19], s67 offen sc1
L_wtd:
  s_waitcnt vmcnt(0) lgkmcnt(0)
  s_barrier
  s_cmp_eq_u32 s60, 0
  s_cbranch_scc0 L_pub2
  v_mov_b32 v14, 2
  v_mov_b32 v15, 0
  s_lshl_b32 s66, s61, 7
  s_add_u32 s66, s66, 49807360
  s_mov_b64 exec, 1
  buffer_store_dword v14, v15, s[16:19], s66 offen sc1
  s_mov_b64 exec, -1
L_pub2:
  s_cmp_lt_u32 s60, 4
  s_cbranch_scc0 L_fill_d
  s_mul_i32 s66, s61, 147584
  s_mul_i32 s67, s60, 36864
  s_add_u32 s66, s66, s67
  v_mov_b32 v32, -1
  v_mov_b32 v33, -1
  v_mov_b32 v34, -1
  v_mov_b32 v35, -1
  s_mov_b32 s67, 9
L_fill:
  buffer_store_dwordx4 v[32:35], v7, s[16:19], s66 offen offset:0 sc1
  buffer_store_dwordx4 v[32:35], v7, s[16:19], s66 offen offset:1024 sc1
  buffer_store_dwordx4 v[32:35], v7, s[16:19], s66 offen offset:2048 sc1
  buffer_store_dwordx4 v[32:35], v7, s[16:19], s66 offen offset:3072 sc1
  s_add_u32 s66, s66, 4096
  s_sub_u32 s67, s67, 1
  s_cmp_eq_u32 s67, 0
  s_cbranch_scc0 L_fill
L_fill_d:
  v_mul_f32 v9, 4.0, v3
  s_bfe_u32 s66, s60, 0x10001
  v_cvt_f32_u32 v10, s66
  s_and_b32 s66, s60, 1
  s_lshl_b32 s66, s66, 4
  v_cvt_f32_u32 v12, s66
  v_add_f32 v12, v12, v9
  s_cmp_eq_u32 s64, 0
  s_cselect_b32 s66, 0, 1.0
  s_cselect_b32 s67, 1.0, 0
  s_cselect_b32 s68, 1.0, 0x35e38e39
  v_mul_f32 v8, s66, v10
  v_fma_f32 v8, v2, 2.0, v8
  v_mul_f32 v10, s67, v10
  v_mul_f32 v10, v10, v2
  v_fma_f32 v10, v8, v12, v10
  v_mul_f32 v8, 0x3a000000, v8
  v_mul_f32 v10, 0x3a000000, v10
  v_fmamk_f32 v96, v8, 0x00000000, v10
  v_fmamk_f32 v97, v8, 0x3f800000, v10
  v_fmamk_f32 v98, v8, 0x40000000, v10
  v_fmamk_f32 v99, v8, 0x40400000, v10
  v_fmamk_f32 v100, v8, 0x41000000, v10
  v_fmamk_f32 v101, v8, 0x41100000, v10
  v_fmamk_f32 v102, v8, 0x41200000, v10
  v_fmamk_f32 v103, v8, 0x41300000, v10
  v_cos_f32 v104, v96
  v_cos_f32 v105, v97
  v_cos_f32 v106, v98
  v_cos_f32 v107, v99
  v_cos_f32 v108, v100
  v_cos_f32 v109, v101
  v_cos_f32 v110, v102
  v_cos_f32 v111, v103
  v_sin_f32 v96, v96
  v_sin_f32 v97, v97
  v_sin_f32 v98, v98
  v_sin_f32 v99, v99
  v_sin_f32 v100, v100
  v_sin_f32 v101, v101
  v_sin_f32 v102, v102
  v_sin_f32 v103, v103
  v_mul_f32 v96, s68, v96
  v_mul_f32 v97, s68, v97
  v_mul_f32 v98, s68, v98
  v_mul_f32 v99, s68, v99
  v_mul_f32 v100, s68, v100
  v_mul_f32 v101, s68, v101
  v_mul_f32 v102, s68, v102
  v_mul_f32 v103, s68, v103
  v_mul_f32 v104, s68, v104
  v_mul_f32 v105, s68, v105
  v_mul_f32 v106, s68, v106
  v_mul_f32 v107, s68, v107
  v_mul_f32 v108, s68, v108
  v_mul_f32 v109, s68, v109
  v_mul_f32 v110, s68, v110
  v_mul_f32 v111, s68, v111
  s_lshl_b32 s66, s60, 12
  s_add_u32 s66, s66, 131072
  v_add_u32 v8, s66, v7
  ds_write_b128 v8, v[104:107] offset:0
  ds_write_b128 v8, v[96:99] offset:1024
  ds_write_b128 v8, v[108:111] offset:2048
  ds_write_b128 v8, v[100:103] offset:3072
  s_cmp_lt_u32 s60, 6
  s_cbranch_scc0 L_ncon
  s_lshr_b32 s66, s60, 1
  s_cmp_eq_u32 s66, 2
  s_cselect_b32 s67, 0.5, 0
  s_cmp_eq_u32 s66, 1
  s_cselect_b32 s68, 0.5, 0
  v_add_f32 v8, s67, v2
  v_mul_f32 v8, 0x3d000000, v8
  v_add_f32 v10, s68, v12
  v_mul_f32 v10, v8, v10
  v_fmamk_f32 v112, v8, 0x00000000, v10
  v_fmamk_f32 v113, v8, 0x3f800000, v10
  v_fmamk_f32 v114, v8, 0x40000000, v10
  v_fmamk_f32 v115, v8, 0x40400000, v10
  v_fmamk_f32 v116, v8, 0x41000000, v10
  v_fmamk_f32 v117, v8, 0x41100000, v10
  v_fmamk_f32 v118, v8, 0x41200000, v10
  v_fmamk_f32 v119, v8, 0x41300000, v10
  v_cos_f32 v120, v112
  v_cos_f32 v121, v113
  v_cos_f32 v122, v114
  v_cos_f32 v123, v115
  v_cos_f32 v124, v116
  v_cos_f32 v125, v117
  v_cos_f32 v126, v118
  v_cos_f32 v127, v119
  v_sin_f32 v112, v112
  v_sin_f32 v113, v113
  v_sin_f32 v114, v114
  v_sin_f32 v115, v115
  v_sin_f32 v116, v116
  v_sin_f32 v117, v117
  v_sin_f32 v118, v118
  v_sin_f32 v119, v119
  v_cvt_pk_bf16_f32 v128, v120, v121
  v_cvt_pk_bf16_f32 v129, v122, v123
  v_cvt_pk_bf16_f32 v130, v124, v125
  v_cvt_pk_bf16_f32 v131, v126, v127
  v_cvt_pk_bf16_f32 v132, v112, v113
  v_cvt_pk_bf16_f32 v133, v114, v115
  v_cvt_pk_bf16_f32 v134, v116, v117
  v_cvt_pk_bf16_f32 v135, v118, v119
  s_lshl_b32 s66, s66, 12
  s_and_b32 s67, s60, 1
  s_lshl_b32 s67, s67, 10
  s_add_u32 s66, s66, s67
  s_add_u32 s66, s66, 114688
  v_add_u32 v8, s66, v7
  ds_write_b128 v8, v[128:131]
  ds_write_b128 v8, v[132:135] offset:2048
L_ncon:
  s_waitcnt lgkmcnt(0)
  s_cmp_eq_u32 s60, 7
  s_cbranch_scc0 L_np1
  s_mov_b32 s80, 400000
  s_mov_b32 s81, 49807360
  v_lshlrev_b32 v15, 7, v1
  s_mov_b32 exec_lo, -1
  s_mov_b32 exec_hi, -1
L_p1c:
  buffer_load_dword v14, v15, s[16:19], s81 offen sc1
  s_waitcnt vmcnt(0)
  v_cmp_gt_u32 vcc, 2, v14
  s_sub_u32 s80, s80, 1
  s_cmp_eq_u64 vcc, 0
  s_cbranch_scc1 L_p1c_x
  s_mov_b64 exec, vcc
  s_cmp_lt_i32 s80, 1
  s_cbranch_scc1 L_p1c_x
  s_sleep 8
  s_branch L_p1c
L_p1c_x:
  s_mov_b64 exec, -1
L_np1:
  s_barrier
  s_sub_u32 s75, 5, s63
  s_cmp_lt_u32 s60, s75
  s_cbranch_scc0 L_cdone
  s_lshl_b32 s76, s61, 2
  s_add_u32 s76, s76, s60
  s_add_u32 s66, s62, 256
  s_cmp_eq_u32 s60, 4
  s_cselect_b32 s76, s66, s76
  s_setprio 1
  s_cbranch_scc1 L_cp
  s_setprio 2
L_cp:
  s_lshr_b32 s77, s76, 1
  s_and_b32 s78, s76, 1
  s_xor_b32 s78, s78, 1
  s_mul_i32 s78, s78, 288
  s_add_u32 s77, s77, s78
  s_mul_i32 s66, s77, 4224
  s_add_u32 s66, s66, 37748736
  s_add_u32 s67, s66, 608256
  s_lshl_b32 s68, s60, 13
  s_add_u32 s68, s68, 73728
  s_add_u32 m0, s68, 0
  s_nop 0
  buffer_load_dwordx4 v7, s[16:19], s66 offen offset:0 sc1 lds
  buffer_load_dwordx4 v7, s[16:19], s66 offen offset:1024 sc1 lds
  buffer_load_dwordx4 v7, s[16:19], s66 offen offset:2048 sc1 lds
  buffer_load_dwordx4 v7, s[16:19], s66 offen offset:3072 sc1 lds
  s_add_u32 m0, s68, 4096
  s_nop 0
  buffer_load_dwordx4 v7, s[16:19], s67 offen offset:0 sc1 lds
  buffer_load_dwordx4 v7, s[16:19], s67 offen offset:1024 sc1 lds
  buffer_load_dwordx4 v7, s[16:19], s67 offen offset:2048 sc1 lds
  buffer_load_dwordx4 v7, s[16:19], s67 offen offset:3072 sc1 lds
  s_mul_i32 s66, s76, 8320
  s_add_u32 s66, s66, 46137344
  s_add_u32 s67, s66, 4096
  buffer_load_dwordx4 v[128:131], v7, s[16:19], s66 offen offset:0 sc1
  buffer_load_dwordx4 v[132:135], v7, s[16:19], s66 offen offset:1024 sc1
  buffer_load_dwordx4 v[136:139], v7, s[16:19], s66 offen offset:2048 sc1
  buffer_load_dwordx4 v[140:143], v7, s[16:19], s66 offen offset:3072 sc1
  buffer_load_dwordx4 v[144:147], v7, s[16:19], s67 offen offset:0 sc1
  buffer_load_dwordx4 v[148:151], v7, s[16:19], s67 offen offset:1024 sc1
  buffer_load_dwordx4 v[152:155], v7, s[16:19], s67 offen offset:2048 sc1
  buffer_load_dwordx4 v[156:159], v7, s[16:19], s67 offen offset:3072 sc1
  v_and_b32 v8, 31, v1
  v_bfe_u32 v9, v1, 1, 3
  v_lshrrev_b32 v10, 5, v1
  v_xor_b32 v9, v9, v10
  v_lshlrev_b32 v9, 4, v9
  v_lshl_add_u32 v8, v8, 7, v9
  v_add_u32 v4, s68, v8
  v_xor_b32 v5, 32, v4
  v_xor_b32 v6, 64, v4
  v_xor_b32 v8, 96, v4
  v_add_u32 v9, 131072, v7
  s_mov_b32 s79, 0x80008000
  v_add_u32 v10, 114688, v7
  ds_read_b128 v[200:203], v10 offset:0
  ds_read_b128 v[204:207], v10 offset:1024
  ds_read_b128 v[208:211], v10 offset:2048
  ds_read_b128 v[212:215], v10 offset:3072
  ds_read_b128 v[216:219], v10 offset:4096
  ds_read_b128 v[220:223], v10 offset:5120
  ds_read_b128 v[224:227], v10 offset:6144
  ds_read_b128 v[228:231], v10 offset:7168
  ds_read_b128 v[232:235], v10 offset:8192
  ds_read_b128 v[236:239], v10 offset:9216
  ds_read_b128 v[240:243], v10 offset:10240
  ds_read_b128 v[244:247], v10 offset:11264
  s_waitcnt vmcnt(8)
  ds_read_b128 v[16:19], v4
  ds_read_b128 v[32:35], v4 offset:4096
  ds_read_b128 v[20:23], v5
  ds_read_b128 v[36:39], v5 offset:4096
  ds_read_b128 v[24:27], v6
  ds_read_b128 v[40:43], v6 offset:4096
  ds_read_b128 v[28:31], v8
  ds_read_b128 v[44:47], v8 offset:4096
  ds_read_b128 v[160:163], v9 offset:0
  ds_read_b128 v[164:167], v9 offset:1024
  ds_read_b128 v[168:171], v9 offset:2048
  ds_read_b128 v[172:175], v9 offset:3072
  ds_read_b128 v[176:179], v9 offset:4096
  ds_read_b128 v[180:183], v9 offset:5120
  ds_read_b128 v[184:187], v9 offset:6144
  ds_read_b128 v[188:191], v9 offset:7168
  s_waitcnt lgkmcnt(12)
  v_xor_b32 v48, s79, v16
  v_xor_b32 v49, s79, v17
  v_xor_b32 v50, s79, v18
  v_xor_b32 v51, s79, v19
  v_xor_b32 v52, s79, v20
  v_xor_b32 v53, s79, v21
  v_xor_b32 v54, s79, v22
  v_xor_b32 v55, s79, v23
  v_mfma_f32_32x32x16_bf16 v[64:79], v[16:19], v[200:203], 0
  v_mfma_f32_32x32x16_bf16 v[80:95], v[32:35], v[200:203], 0
  v_mfma_f32_32x32x16_bf16 v[64:79], v[32:35], v[208:211], v[64:79]
  v_mfma_f32_32x32x16_bf16 v[80:95], v[48:51], v[208:211], v[80:95]
  v_mfma_f32_32x32x16_bf16 v[64:79], v[20:23], v[204:207], v[64:79]
  v_mfma_f32_32x32x16_bf16 v[80:95], v[36:39], v[204:207], v[80:95]
  v_mfma_f32_32x32x16_bf16 v[64:79], v[36:39], v[212:215], v[64:79]
  v_mfma_f32_32x32x16_bf16 v[80:95], v[52:55], v[212:215], v[80:95]
  s_waitcnt lgkmcnt(8)
  v_xor_b32 v56, s79, v24
  v_xor_b32 v57, s79, v25
  v_xor_b32 v58, s79, v26
  v_xor_b32 v59, s79, v27
  v_xor_b32 v60, s79, v28
  v_xor_b32 v61, s79, v29
  v_xor_b32 v62, s79, v30
  v_xor_b32 v63, s79, v31
  v_mfma_f32_32x32x16_bf16 v[96:111], v[24:27], v[200:203], 0
  v_mfma_f32_32x32x16_bf16 v[112:127], v[40:43], v[200:203], 0
  v_mfma_f32_32x32x16_bf16 v[96:111], v[40:43], v[208:211], v[96:111]
  v_mfma_f32_32x32x16_bf16 v[112:127], v[56:59], v[208:211], v[112:127]
  v_mfma_f32_32x32x16_bf16 v[96:111], v[28:31], v[204:207], v[96:111]
  v_mfma_f32_32x32x16_bf16 v[112:127], v[44:47], v[204:207], v[112:127]
  v_mfma_f32_32x32x16_bf16 v[96:111], v[44:47], v[212:215], v[96:111]
  v_mfma_f32_32x32x16_bf16 v[112:127], v[60:63], v[212:215], v[112:127]
  s_waitcnt lgkmcnt(6)
  v_pk_mul_f32 v[192:193], v[64:65], v[160:161]
  v_pk_mul_f32 v[194:195], v[66:67], v[162:163]
  v_pk_mul_f32 v[196:197], v[80:81], v[160:161]
  v_pk_mul_f32 v[198:199], v[82:83], v[162:163]
  v_pk_fma_f32 v[192:193], v[80:81], v[164:165], v[192:193]
  v_pk_fma_f32 v[194:195], v[82:83], v[166:167], v[194:195]
  v_pk_fma_f32 v[196:197], v[64:65], v[164:165], v[196:197] neg_lo:[1,0,0] neg_hi:[1,0,0]
  v_pk_fma_f32 v[198:199], v[66:67], v[166:167], v[198:199] neg_lo:[1,0,0] neg_hi:[1,0,0]
  v_cvt_pk_bf16_f32 v16, v192, v193
  v_cvt_pk_bf16_f32 v32, v196, v197
  v_cvt_pk_bf16_f32 v17, v194, v195
  v_cvt_pk_bf16_f32 v33, v198, v199
  v_xor_b32 v48, s79, v16
  v_xor_b32 v49, s79, v17
  s_waitcnt lgkmcnt(4)
  v_pk_mul_f32 v[192:193], v[68:69], v[168:169]
  v_pk_mul_f32 v[194:195], v[70:71], v[170:171]
  v_pk_mul_f32 v[196:197], v[84:85], v[168:169]
  v_pk_mul_f32 v[198:199], v[86:87], v[170:171]
  v_pk_fma_f32 v[192:193], v[84:85], v[172:173], v[192:193]
  v_pk_fma_f32 v[194:195], v[86:87], v[174:175], v[194:195]
  v_pk_fma_f32 v[196:197], v[68:69], v[172:173], v[196:197] neg_lo:[1,0,0] neg_hi:[1,0,0]
  v_pk_fma_f32 v[198:199], v[70:71], v[174:175], v[198:199] neg_lo:[1,0,0] neg_hi:[1,0,0]
  v_cvt_pk_bf16_f32 v18, v192, v193
  v_cvt_pk_bf16_f32 v34, v196, v197
  v_cvt_pk_bf16_f32 v19, v194, v195
  v_cvt_pk_bf16_f32 v35, v198, v199
  v_xor_b32 v50, s79, v18
  v_xor_b32 v51, s79, v19
  s_waitcnt lgkmcnt(2)
  v_pk_mul_f32 v[192:193], v[72:73], v[176:177]
  v_pk_mul_f32 v[194:195], v[74:75], v[178:179]
  v_pk_mul_f32 v[196:197], v[88:89], v[176:177]
  v_pk_mul_f32 v[198:199], v[90:91], v[178:179]
  v_pk_fma_f32 v[192:193], v[88:89], v[180:181], v[192:193]
  v_pk_fma_f32 v[194:195], v[90:91], v[182:183], v[194:195]
  v_pk_fma_f32 v[196:197], v[72:73], v[180:181], v[196:197] neg_lo:[1,0,0] neg_hi:[1,0,0]
  v_pk_fma_f32 v[198:199], v[74:75], v[182:183], v[198:199] neg_lo:[1,0,0] neg_hi:[1,0,0]
  v_cvt_pk_bf16_f32 v20, v192, v193
  v_cvt_pk_bf16_f32 v36, v196, v197
  v_cvt_pk_bf16_f32 v21, v194, v195
  v_cvt_pk_bf16_f32 v37, v198, v199
  v_xor_b32 v52, s79, v20
  v_xor_b32 v53, s79, v21
  s_waitcnt lgkmcnt(0)
  v_pk_mul_f32 v[192:193], v[76:77], v[184:185]
  v_pk_mul_f32 v[194:195], v[78:79], v[186:187]
  v_pk_mul_f32 v[196:197], v[92:93], v[184:185]
  v_pk_mul_f32 v[198:199], v[94:95], v[186:187]
  v_pk_fma_f32 v[192:193], v[92:93], v[188:189], v[192:193]
  v_pk_fma_f32 v[194:195], v[94:95], v[190:191], v[194:195]
  v_pk_fma_f32 v[196:197], v[76:77], v[188:189], v[196:197] neg_lo:[1,0,0] neg_hi:[1,0,0]
  v_pk_fma_f32 v[198:199], v[78:79], v[190:191], v[198:199] neg_lo:[1,0,0] neg_hi:[1,0,0]
  v_cvt_pk_bf16_f32 v22, v192, v193
  v_cvt_pk_bf16_f32 v38, v196, v197
  v_cvt_pk_bf16_f32 v23, v194, v195
  v_cvt_pk_bf16_f32 v39, v198, v199
  v_xor_b32 v54, s79, v22
  v_xor_b32 v55, s79, v23
  ds_read_b128 v[160:163], v9 offset:8192
  ds_read_b128 v[164:167], v9 offset:9216
  ds_read_b128 v[168:171], v9 offset:10240
  ds_read_b128 v[172:175], v9 offset:11264
  ds_read_b128 v[176:179], v9 offset:12288
  ds_read_b128 v[180:183], v9 offset:13312
  ds_read_b128 v[184:187], v9 offset:14336
  ds_read_b128 v[188:191], v9 offset:15360
  v_mfma_f32_32x32x16_bf16 v[64:79], v[200:203], v[16:19], 0
  v_mfma_f32_32x32x16_bf16 v[80:95], v[200:203], v[32:35], 0
  v_mfma_f32_32x32x16_bf16 v[64:79], v[208:211], v[32:35], v[64:79]
  v_mfma_f32_32x32x16_bf16 v[80:95], v[208:211], v[48:51], v[80:95]
  v_mfma_f32_32x32x16_bf16 v[64:79], v[204:207], v[20:23], v[64:79]
  v_mfma_f32_32x32x16_bf16 v[80:95], v[204:207], v[36:39], v[80:95]
  v_mfma_f32_32x32x16_bf16 v[64:79], v[212:215], v[36:39], v[64:79]
  v_mfma_f32_32x32x16_bf16 v[80:95], v[212:215], v[52:55], v[80:95]
  s_waitcnt lgkmcnt(6)
  v_pk_mul_f32 v[192:193], v[96:97], v[160:161]
  v_pk_mul_f32 v[194:195], v[98:99], v[162:163]
  v_pk_mul_f32 v[196:197], v[112:113], v[160:161]
  v_pk_mul_f32 v[198:199], v[114:115], v[162:163]
  v_pk_fma_f32 v[192:193], v[112:113], v[164:165], v[192:193]
  v_pk_fma_f32 v[194:195], v[114:115], v[166:167], v[194:195]
  v_pk_fma_f32 v[196:197], v[96:97], v[164:165], v[196:197] neg_lo:[1,0,0] neg_hi:[1,0,0]
  v_pk_fma_f32 v[198:199], v[98:99], v[166:167], v[198:199] neg_lo:[1,0,0] neg_hi:[1,0,0]
  v_cvt_pk_bf16_f32 v24, v192, v193
  v_cvt_pk_bf16_f32 v40, v196, v197
  v_cvt_pk_bf16_f32 v25, v194, v195
  v_cvt_pk_bf16_f32 v41, v198, v199
  v_xor_b32 v56, s79, v24
  v_xor_b32 v57, s79, v25
  s_waitcnt lgkmcnt(4)
  v_pk_mul_f32 v[192:193], v[100:101], v[168:169]
  v_pk_mul_f32 v[194:195], v[102:103], v[170:171]
  v_pk_mul_f32 v[196:197], v[116:117], v[168:169]
  v_pk_mul_f32 v[198:199], v[118:119], v[170:171]
  v_pk_fma_f32 v[192:193], v[116:117], v[172:173], v[192:193]
  v_pk_fma_f32 v[194:195], v[118:119], v[174:175], v[194:195]
  v_pk_fma_f32 v[196:197], v[100:101], v[172:173], v[196:197] neg_lo:[1,0,0] neg_hi:[1,0,0]
  v_pk_fma_f32 v[198:199], v[102:103], v[174:175], v[198:199] neg_lo:[1,0,0] neg_hi:[1,0,0]
  v_cvt_pk_bf16_f32 v26, v192, v193
  v_cvt_pk_bf16_f32 v42, v196, v197
  v_cvt_pk_bf16_f32 v27, v194, v195
  v_cvt_pk_bf16_f32 v43, v198, v199
  v_xor_b32 v58, s79, v26
  v_xor_b32 v59, s79, v27
  s_waitcnt lgkmcnt(2)
  v_pk_mul_f32 v[192:193], v[104:105], v[176:177]
  v_pk_mul_f32 v[194:195], v[106:107], v[178:179]
  v_pk_mul_f32 v[196:197], v[120:121], v[176:177]
  v_pk_mul_f32 v[198:199], v[122:123], v[178:179]
  v_pk_fma_f32 v[192:193], v[120:121], v[180:181], v[192:193]
  v_pk_fma_f32 v[194:195], v[122:123], v[182:183], v[194:195]
  v_pk_fma_f32 v[196:197], v[104:105], v[180:181], v[196:197] neg_lo:[1,0,0] neg_hi:[1,0,0]
  v_pk_fma_f32 v[198:199], v[106:107], v[182:183], v[198:199] neg_lo:[1,0,0] neg_hi:[1,0,0]
  v_cvt_pk_bf16_f32 v28, v192, v193
  v_cvt_pk_bf16_f32 v44, v196, v197
  v_cvt_pk_bf16_f32 v29, v194, v195
  v_cvt_pk_bf16_f32 v45, v198, v199
  v_xor_b32 v60, s79, v28
  v_xor_b32 v61, s79, v29
  s_waitcnt lgkmcnt(0)
  v_pk_mul_f32 v[192:193], v[108:109], v[184:185]
  v_pk_mul_f32 v[194:195], v[110:111], v[186:187]
  v_pk_mul_f32 v[196:197], v[124:125], v[184:185]
  v_pk_mul_f32 v[198:199], v[126:127], v[186:187]
  v_pk_fma_f32 v[192:193], v[124:125], v[188:189], v[192:193]
  v_pk_fma_f32 v[194:195], v[126:127], v[190:191], v[194:195]
  v_pk_fma_f32 v[196:197], v[108:109], v[188:189], v[196:197] neg_lo:[1,0,0] neg_hi:[1,0,0]
  v_pk_fma_f32 v[198:199], v[110:111], v[190:191], v[198:199] neg_lo:[1,0,0] neg_hi:[1,0,0]
  v_cvt_pk_bf16_f32 v30, v192, v193
  v_cvt_pk_bf16_f32 v46, v196, v197
  v_cvt_pk_bf16_f32 v31, v194, v195
  v_cvt_pk_bf16_f32 v47, v198, v199
  v_xor_b32 v62, s79, v30
  v_xor_b32 v63, s79, v31
  ds_read_b128 v[160:163], v9 offset:16384
  ds_read_b128 v[164:167], v9 offset:17408
  ds_read_b128 v[168:171], v9 offset:18432
  ds_read_b128 v[172:175], v9 offset:19456
  ds_read_b128 v[176:179], v9 offset:20480
  ds_read_b128 v[180:183], v9 offset:21504
  ds_read_b128 v[184:187], v9 offset:22528
  ds_read_b128 v[188:191], v9 offset:23552
  v_mfma_f32_32x32x16_bf16 v[96:111], v[216:219], v[24:27], 0
  v_mfma_f32_32x32x16_bf16 v[112:127], v[216:219], v[40:43], 0
  v_mfma_f32_32x32x16_bf16 v[96:111], v[224:227], v[40:43], v[96:111]
  v_mfma_f32_32x32x16_bf16 v[112:127], v[224:227], v[56:59], v[112:127]
  v_mfma_f32_32x32x16_bf16 v[96:111], v[220:223], v[28:31], v[96:111]
  v_mfma_f32_32x32x16_bf16 v[112:127], v[220:223], v[44:47], v[112:127]
  v_mfma_f32_32x32x16_bf16 v[96:111], v[228:231], v[44:47], v[96:111]
  v_mfma_f32_32x32x16_bf16 v[112:127], v[228:231], v[60:63], v[112:127]
  s_waitcnt vmcnt(0)
  v_lshlrev_b32 v248, 16, v128
  v_lshlrev_b32 v249, 16, v129
  v_lshlrev_b32 v250, 16, v130
  v_lshlrev_b32 v251, 16, v131
  v_and_b32 v128, s71, v128
  v_and_b32 v129, s71, v129
  v_and_b32 v130, s71, v130
  v_and_b32 v131, s71, v131
  v_lshlrev_b32 v252, 16, v144
  v_lshlrev_b32 v253, 16, v145
  v_lshlrev_b32 v254, 16, v146
  v_lshlrev_b32 v255, 16, v147
  v_and_b32 v144, s71, v144
  v_and_b32 v145, s71, v145
  v_and_b32 v146, s71, v146
  v_and_b32 v147, s71, v147
  v_pk_add_f32 v[192:193], v[64:65], v[96:97]
  v_pk_add_f32 v[194:195], v[66:67], v[98:99]
  v_pk_add_f32 v[196:197], v[80:81], v[112:113]
  v_pk_add_f32 v[198:199], v[82:83], v[114:115]
  v_pk_add_f32 v[96:97], v[64:65], v[96:97] neg_lo:[0,1] neg_hi:[0,1]
  v_pk_add_f32 v[98:99], v[66:67], v[98:99] neg_lo:[0,1] neg_hi:[0,1]
  v_pk_add_f32 v[112:113], v[80:81], v[112:113] neg_lo:[0,1] neg_hi:[0,1]
  v_pk_add_f32 v[114:115], v[82:83], v[114:115] neg_lo:[0,1] neg_hi:[0,1]
  v_pk_mul_f32 v[64:65], v[192:193], v[248:249]
  v_pk_mul_f32 v[66:67], v[194:195], v[250:251]
  v_pk_mul_f32 v[80:81], v[196:197], v[248:249]
  v_pk_mul_f32 v[82:83], v[198:199], v[250:251]
  v_pk_fma_f32 v[64:65], v[196:197], v[128:129], v[64:65] neg_lo:[1,0,0] neg_hi:[1,0,0]
  v_pk_fma_f32 v[66:67], v[198:199], v[130:131], v[66:67] neg_lo:[1,0,0] neg_hi:[1,0,0]
  v_pk_fma_f32 v[80:81], v[192:193], v[128:129], v[80:81]
  v_pk_fma_f32 v[82:83], v[194:195], v[130:131], v[82:83]
  v_pk_mul_f32 v[192:193], v[96:97], v[252:253]
  v_pk_mul_f32 v[194:195], v[98:99], v[254:255]
  v_pk_mul_f32 v[196:197], v[112:113], v[252:253]
  v_pk_mul_f32 v[198:199], v[114:115], v[254:255]
  v_pk_fma_f32 v[192:193], v[112:113], v[144:145], v[192:193] neg_lo:[1,0,0] neg_hi:[1,0,0]
  v_pk_fma_f32 v[194:195], v[114:115], v[146:147], v[194:195] neg_lo:[1,0,0] neg_hi:[1,0,0]
  v_pk_fma_f32 v[196:197], v[96:97], v[144:145], v[196:197]
  v_pk_fma_f32 v[198:199], v[98:99], v[146:147], v[198:199]
  v_pk_add_f32 v[96:97], v[64:65], v[192:193] neg_lo:[0,1] neg_hi:[0,1]
  v_pk_add_f32 v[98:99], v[66:67], v[194:195] neg_lo:[0,1] neg_hi:[0,1]
  v_pk_add_f32 v[112:113], v[80:81], v[196:197] neg_lo:[0,1] neg_hi:[0,1]
  v_pk_add_f32 v[114:115], v[82:83], v[198:199] neg_lo:[0,1] neg_hi:[0,1]
  v_pk_add_f32 v[64:65], v[64:65], v[192:193]
  v_pk_add_f32 v[66:67], v[66:67], v[194:195]
  v_pk_add_f32 v[80:81], v[80:81], v[196:197]
  v_pk_add_f32 v[82:83], v[82:83], v[198:199]
  v_cvt_pk_bf16_f32 v16, v64, v65
  v_cvt_pk_bf16_f32 v32, v80, v81
  v_cvt_pk_bf16_f32 v17, v66, v67
  v_cvt_pk_bf16_f32 v33, v82, v83
  v_xor_b32 v48, s79, v32
  v_xor_b32 v49, s79, v33
  v_cvt_pk_bf16_f32 v24, v96, v97
  v_cvt_pk_bf16_f32 v40, v112, v113
  v_cvt_pk_bf16_f32 v25, v98, v99
  v_cvt_pk_bf16_f32 v41, v114, v115
  v_xor_b32 v56, s79, v40
  v_xor_b32 v57, s79, v41
  v_lshlrev_b32 v248, 16, v132
  v_lshlrev_b32 v249, 16, v133
  v_lshlrev_b32 v250, 16, v134
  v_lshlrev_b32 v251, 16, v135
  v_and_b32 v132, s71, v132
  v_and_b32 v133, s71, v133
  v_and_b32 v134, s71, v134
  v_and_b32 v135, s71, v135
  v_lshlrev_b32 v252, 16, v148
  v_lshlrev_b32 v253, 16, v149
  v_lshlrev_b32 v254, 16, v150
  v_lshlrev_b32 v255, 16, v151
  v_and_b32 v148, s71, v148
  v_and_b32 v149, s71, v149
  v_and_b32 v150, s71, v150
  v_and_b32 v151, s71, v151
  v_pk_add_f32 v[192:193], v[68:69], v[100:101]
  v_pk_add_f32 v[194:195], v[70:71], v[102:103]
  v_pk_add_f32 v[196:197], v[84:85], v[116:117]
  v_pk_add_f32 v[198:199], v[86:87], v[118:119]
  v_pk_add_f32 v[100:101], v[68:69], v[100:101] neg_lo:[0,1] neg_hi:[0,1]
  v_pk_add_f32 v[102:103], v[70:71], v[102:103] neg_lo:[0,1] neg_hi:[0,1]
  v_pk_add_f32 v[116:117], v[84:85], v[116:117] neg_lo:[0,1] neg_hi:[0,1]
  v_pk_add_f32 v[118:119], v[86:87], v[118:119] neg_lo:[0,1] neg_hi:[0,1]
  v_pk_mul_f32 v[68:69], v[192:193], v[248:249]
  v_pk_mul_f32 v[70:71], v[194:195], v[250:251]
  v_pk_mul_f32 v[84:85], v[196:197], v[248:249]
  v_pk_mul_f32 v[86:87], v[198:199], v[250:251]
  v_pk_fma_f32 v[68:69], v[196:197], v[132:133], v[68:69] neg_lo:[1,0,0] neg_hi:[1,0,0]
  v_pk_fma_f32 v[70:71], v[198:199], v[134:135], v[70:71] neg_lo:[1,0,0] neg_hi:[1,0,0]
  v_pk_fma_f32 v[84:85], v[192:193], v[132:133], v[84:85]
  v_pk_fma_f32 v[86:87], v[194:195], v[134:135], v[86:87]
  v_pk_mul_f32 v[192:193], v[100:101], v[252:253]
  v_pk_mul_f32 v[194:195], v[102:103], v[254:255]
  v_pk_mul_f32 v[196:197], v[116:117], v[252:253]
  v_pk_mul_f32 v[198:199], v[118:119], v[254:255]
  v_pk_fma_f32 v[192:193], v[116:117], v[148:149], v[192:193] neg_lo:[1,0,0] neg_hi:[1,0,0]
  v_pk_fma_f32 v[194:195], v[118:119], v[150:151], v[194:195] neg_lo:[1,0,0] neg_hi:[1,0,0]
  v_pk_fma_f32 v[196:197], v[100:101], v[148:149], v[196:197]
  v_pk_fma_f32 v[198:199], v[102:103], v[150:151], v[198:199]
  v_pk_add_f32 v[100:101], v[68:69], v[192:193] neg_lo:[0,1] neg_hi:[0,1]
  v_pk_add_f32 v[102:103], v[70:71], v[194:195] neg_lo:[0,1] neg_hi:[0,1]
  v_pk_add_f32 v[116:117], v[84:85], v[196:197] neg_lo:[0,1] neg_hi:[0,1]
  v_pk_add_f32 v[118:119], v[86:87], v[198:199] neg_lo:[0,1] neg_hi:[0,1]
  v_pk_add_f32 v[68:69], v[68:69], v[192:193]
  v_pk_add_f32 v[70:71], v[70:71], v[194:195]
  v_pk_add_f32 v[84:85], v[84:85], v[196:197]
  v_pk_add_f32 v[86:87], v[86:87], v[198:199]
  v_cvt_pk_bf16_f32 v18, v68, v69
  v_cvt_pk_bf16_f32 v34, v84, v85
  v_cvt_pk_bf16_f32 v19, v70, v71
  v_cvt_pk_bf16_f32 v35, v86, v87
  v_xor_b32 v50, s79, v34
  v_xor_b32 v51, s79, v35
  v_cvt_pk_bf16_f32 v26, v100, v101
  v_cvt_pk_bf16_f32 v42, v116, v117
  v_cvt_pk_bf16_f32 v27, v102, v103
  v_cvt_pk_bf16_f32 v43, v118, v119
  v_xor_b32 v58, s79, v42
  v_xor_b32 v59, s79, v43
  v_lshlrev_b32 v248, 16, v136
  v_lshlrev_b32 v249, 16, v137
  v_lshlrev_b32 v250, 16, v138
  v_lshlrev_b32 v251, 16, v139
  v_and_b32 v136, s71, v136
  v_and_b32 v137, s71, v137
  v_and_b32 v138, s71, v138
  v_and_b32 v139, s71, v139
  v_lshlrev_b32 v252, 16, v152
  v_lshlrev_b32 v253, 16, v153
  v_lshlrev_b32 v254, 16, v154
  v_lshlrev_b32 v255, 16, v155
  v_and_b32 v152, s71, v152
  v_and_b32 v153, s71, v153
  v_and_b32 v154, s71, v154
  v_and_b32 v155, s71, v155
  v_pk_add_f32 v[192:193], v[72:73], v[104:105]
  v_pk_add_f32 v[194:195], v[74:75], v[106:107]
  v_pk_add_f32 v[196:197], v[88:89], v[120:121]
  v_pk_add_f32 v[198:199], v[90:91], v[122:123]
  v_pk_add_f32 v[104:105], v[72:73], v[104:105] neg_lo:[0,1] neg_hi:[0,1]
  v_pk_add_f32 v[106:107], v[74:75], v[106:107] neg_lo:[0,1] neg_hi:[0,1]
  v_pk_add_f32 v[120:121], v[88:89], v[120:121] neg_lo:[0,1] neg_hi:[0,1]
  v_pk_add_f32 v[122:123], v[90:91], v[122:123] neg_lo:[0,1] neg_hi:[0,1]
  v_pk_mul_f32 v[72:73], v[192:193], v[248:249]
  v_pk_mul_f32 v[74:75], v[194:195], v[250:251]
  v_pk_mul_f32 v[88:89], v[196:197], v[248:249]
  v_pk_mul_f32 v[90:91], v[198:199], v[250:251]
  v_pk_fma_f32 v[72:73], v[196:197], v[136:137], v[72:73] neg_lo:[1,0,0] neg_hi:[1,0,0]
  v_pk_fma_f32 v[74:75], v[198:199], v[138:139], v[74:75] neg_lo:[1,0,0] neg_hi:[1,0,0]
  v_pk_fma_f32 v[88:89], v[192:193], v[136:137], v[88:89]
  v_pk_fma_f32 v[90:91], v[194:195], v[138:139], v[90:91]
  v_pk_mul_f32 v[192:193], v[104:105], v[252:253]
  v_pk_mul_f32 v[194:195], v[106:107], v[254:255]
  v_pk_mul_f32 v[196:197], v[120:121], v[252:253]
  v_pk_mul_f32 v[198:199], v[122:123], v[254:255]
  v_pk_fma_f32 v[192:193], v[120:121], v[152:153], v[192:193] neg_lo:[1,0,0] neg_hi:[1,0,0]
  v_pk_fma_f32 v[194:195], v[122:123], v[154:155], v[194:195] neg_lo:[1,0,0] neg_hi:[1,0,0]
  v_pk_fma_f32 v[196:197], v[104:105], v[152:153], v[196:197]
  v_pk_fma_f32 v[198:199], v[106:107], v[154:155], v[198:199]
  v_pk_add_f32 v[104:105], v[72:73], v[192:193] neg_lo:[0,1] neg_hi:[0,1]
  v_pk_add_f32 v[106:107], v[74:75], v[194:195] neg_lo:[0,1] neg_hi:[0,1]
  v_pk_add_f32 v[120:121], v[88:89], v[196:197] neg_lo:[0,1] neg_hi:[0,1]
  s_branch L_pj18
  .p2align 12
L_stub18:
  s_setpc_b64 s[58:59]
  s_nop 0
L_pj18:
  v_pk_add_f32 v[122:123], v[90:91], v[198:199] neg_lo:[0,1] neg_hi:[0,1]
  v_pk_add_f32 v[72:73], v[72:73], v[192:193]
  v_pk_add_f32 v[74:75], v[74:75], v[194:195]
  v_pk_add_f32 v[88:89], v[88:89], v[196:197]
  v_pk_add_f32 v[90:91], v[90:91], v[198:199]
  v_cvt_pk_bf16_f32 v20, v72, v73
  v_cvt_pk_bf16_f32 v36, v88, v89
  v_cvt_pk_bf16_f32 v21, v74, v75
  v_cvt_pk_bf16_f32 v37, v90, v91
  v_xor_b32 v52, s79, v36
  v_xor_b32 v53, s79, v37
  v_cvt_pk_bf16_f32 v28, v104, v105
  v_cvt_pk_bf16_f32 v44, v120, v121
  v_cvt_pk_bf16_f32 v29, v106, v107
  v_cvt_pk_bf16_f32 v45, v122, v123
  v_xor_b32 v60, s79, v44
  v_xor_b32 v61, s79, v45
  v_lshlrev_b32 v248, 16, v140
  v_lshlrev_b32 v249, 16, v141
  v_lshlrev_b32 v250, 16, v142
  v_lshlrev_b32 v251, 16, v143
  v_and_b32 v140, s71, v140
  v_and_b32 v141, s71, v141
  v_and_b32 v142, s71, v142
  v_and_b32 v143, s71, v143
  v_lshlrev_b32 v252, 16, v156
  v_lshlrev_b32 v253, 16, v157
  v_lshlrev_b32 v254, 16, v158
  v_lshlrev_b32 v255, 16, v159
  v_and_b32 v156, s71, v156
  v_and_b32 v157, s71, v157
  v_and_b32 v158, s71, v158
  v_and_b32 v159, s71, v159
  v_pk_add_f32 v[192:193], v[76:77], v[108:109]
  v_pk_add_f32 v[194:195], v[78:79], v[110:111]
  v_pk_add_f32 v[196:197], v[92:93], v[124:125]
  v_pk_add_f32 v[198:199], v[94:95], v[126:127]
  v_pk_add_f32 v[108:109], v[76:77], v[108:109] neg_lo:[0,1] neg_hi:[0,1]
  v_pk_add_f32 v[110:111], v[78:79], v[110:111] neg_lo:[0,1] neg_hi:[0,1]
  v_pk_add_f32 v[124:125], v[92:93], v[124:125] neg_lo:[0,1] neg_hi:[0,1]
  v_pk_add_f32 v[126:127], v[94:95], v[126:127] neg_lo:[0,1] neg_hi:[0,1]
  v_pk_mul_f32 v[76:77], v[192:193], v[248:249]
  v_pk_mul_f32 v[78:79], v[194:195], v[250:251]
  v_pk_mul_f32 v[92:93], v[196:197], v[248:249]
  v_pk_mul_f32 v[94:95], v[198:199], v[250:251]
  v_pk_fma_f32 v[76:77], v[196:197], v[140:141], v[76:77] neg_lo:[1,0,0] neg_hi:[1,0,0]
  v_pk_fma_f32 v[78:79], v[198:199], v[142:143], v[78:79] neg_lo:[1,0,0] neg_hi:[1,0,0]
  v_pk_fma_f32 v[92:93], v[192:193], v[140:141], v[92:93]
  v_pk_fma_f32 v[94:95], v[194:195], v[142:143], v[94:95]
  v_pk_mul_f32 v[192:193], v[108:109], v[252:253]
  v_pk_mul_f32 v[194:195], v[110:111], v[254:255]
  v_pk_mul_f32 v[196:197], v[124:125], v[252:253]
  v_pk_mul_f32 v[198:199], v[126:127], v[254:255]
  v_pk_fma_f32 v[192:193], v[124:125], v[156:157], v[192:193] neg_lo:[1,0,0] neg_hi:[1,0,0]
  v_pk_fma_f32 v[194:195], v[126:127], v[158:159], v[194:195] neg_lo:[1,0,0] neg_hi:[1,0,0]
  v_pk_fma_f32 v[196:197], v[108:109], v[156:157], v[196:197]
  v_pk_fma_f32 v[198:199], v[110:111], v[158:159], v[198:199]
  v_pk_add_f32 v[108:109], v[76:77], v[192:193] neg_lo:[0,1] neg_hi:[0,1]
  v_pk_add_f32 v[110:111], v[78:79], v[194:195] neg_lo:[0,1] neg_hi:[0,1]
  v_pk_add_f32 v[124:125], v[92:93], v[196:197] neg_lo:[0,1] neg_hi:[0,1]
  v_pk_add_f32 v[126:127], v[94:95], v[198:199] neg_lo:[0,1] neg_hi:[0,1]
  v_pk_add_f32 v[76:77], v[76:77], v[192:193]
  v_pk_add_f32 v[78:79], v[78:79], v[194:195]
  v_pk_add_f32 v[92:93], v[92:93], v[196:197]
  v_pk_add_f32 v[94:95], v[94:95], v[198:199]
  v_cvt_pk_bf16_f32 v22, v76, v77
  v_cvt_pk_bf16_f32 v38, v92, v93
  v_cvt_pk_bf16_f32 v23, v78, v79
  v_cvt_pk_bf16_f32 v39, v94, v95
  v_xor_b32 v54, s79, v38
  v_xor_b32 v55, s79, v39
  v_cvt_pk_bf16_f32 v30, v108, v109
  v_cvt_pk_bf16_f32 v46, v124, v125
  v_cvt_pk_bf16_f32 v31, v110, v111
  v_cvt_pk_bf16_f32 v47, v126, v127
  v_xor_b32 v62, s79, v46
  v_xor_b32 v63, s79, v47
  v_mfma_f32_32x32x16_bf16 v[64:79], v[16:19], v[200:203], 0
  v_mfma_f32_32x32x16_bf16 v[80:95], v[32:35], v[200:203], 0
  v_mfma_f32_32x32x16_bf16 v[64:79], v[48:51], v[208:211], v[64:79]
  v_mfma_f32_32x32x16_bf16 v[80:95], v[16:19], v[208:211], v[80:95]
  v_mfma_f32_32x32x16_bf16 v[64:79], v[20:23], v[204:207], v[64:79]
  v_mfma_f32_32x32x16_bf16 v[80:95], v[36:39], v[204:207], v[80:95]
  v_mfma_f32_32x32x16_bf16 v[64:79], v[52:55], v[212:215], v[64:79]
  v_mfma_f32_32x32x16_bf16 v[80:95], v[20:23], v[212:215], v[80:95]
  v_mfma_f32_32x32x16_bf16 v[96:111], v[24:27], v[232:235], 0
  v_mfma_f32_32x32x16_bf16 v[112:127], v[40:43], v[232:235], 0
  v_mfma_f32_32x32x16_bf16 v[96:111], v[56:59], v[240:243], v[96:111]
  v_mfma_f32_32x32x16_bf16 v[112:127], v[24:27], v[240:243], v[112:127]
  v_mfma_f32_32x32x16_bf16 v[96:111], v[28:31], v[236:239], v[96:111]
  v_mfma_f32_32x32x16_bf16 v[112:127], v[44:47], v[236:239], v[112:127]
  v_mfma_f32_32x32x16_bf16 v[96:111], v[60:63], v[244:247], v[96:111]
  v_mfma_f32_32x32x16_bf16 v[112:127], v[28:31], v[244:247], v[112:127]
  s_waitcnt lgkmcnt(6)
  s_nop 1
  v_pk_mul_f32 v[192:193], v[64:65], v[160:161]
  v_pk_mul_f32 v[194:195], v[66:67], v[162:163]
  v_pk_mul_f32 v[196:197], v[80:81], v[160:161]
  v_pk_mul_f32 v[198:199], v[82:83], v[162:163]
  v_pk_fma_f32 v[192:193], v[80:81], v[164:165], v[192:193] neg_lo:[1,0,0] neg_hi:[1,0,0]
  v_pk_fma_f32 v[194:195], v[82:83], v[166:167], v[194:195] neg_lo:[1,0,0] neg_hi:[1,0,0]
  v_pk_fma_f32 v[196:197], v[64:65], v[164:165], v[196:197]
  v_pk_fma_f32 v[198:199], v[66:67], v[166:167], v[198:199]
  v_cvt_pk_bf16_f32 v16, v192, v193
  v_cvt_pk_bf16_f32 v32, v196, v197
  v_cvt_pk_bf16_f32 v17, v194, v195
  v_cvt_pk_bf16_f32 v33, v198, v199
  v_xor_b32 v48, s79, v32
  v_xor_b32 v49, s79, v33
  s_waitcnt lgkmcnt(4)
  v_pk_mul_f32 v[192:193], v[68:69], v[168:169]
  v_pk_mul_f32 v[194:195], v[70:71], v[170:171]
  v_pk_mul_f32 v[196:197], v[84:85], v[168:169]
  v_pk_mul_f32 v[198:199], v[86:87], v[170:171]
  v_pk_fma_f32 v[192:193], v[84:85], v[172:173], v[192:193] neg_lo:[1,0,0] neg_hi:[1,0,0]
  v_pk_fma_f32 v[194:195], v[86:87], v[174:175], v[194:195] neg_lo:[1,0,0] neg_hi:[1,0,0]
  v_pk_fma_f32 v[196:197], v[68:69], v[172:173], v[196:197]
  v_pk_fma_f32 v[198:199], v[70:71], v[174:175], v[198:199]
  v_cvt_pk_bf16_f32 v18, v192, v193
  v_cvt_pk_bf16_f32 v34, v196, v197
  v_cvt_pk_bf16_f32 v19, v194, v195
  v_cvt_pk_bf16_f32 v35, v198, v199
  v_xor_b32 v50, s79, v34
  v_xor_b32 v51, s79, v35
  s_waitcnt lgkmcnt(2)
  v_pk_mul_f32 v[192:193], v[72:73], v[176:177]
  v_pk_mul_f32 v[194:195], v[74:75], v[178:179]
  v_pk_mul_f32 v[196:197], v[88:89], v[176:177]
  v_pk_mul_f32 v[198:199], v[90:91], v[178:179]
  v_pk_fma_f32 v[192:193], v[88:89], v[180:181], v[192:193] neg_lo:[1,0,0] neg_hi:[1,0,0]
  v_pk_fma_f32 v[194:195], v[90:91], v[182:183], v[194:195] neg_lo:[1,0,0] neg_hi:[1,0,0]
  v_pk_fma_f32 v[196:197], v[72:73], v[180:181], v[196:197]
  v_pk_fma_f32 v[198:199], v[74:75], v[182:183], v[198:199]
  v_cvt_pk_bf16_f32 v20, v192, v193
  v_cvt_pk_bf16_f32 v36, v196, v197
  v_cvt_pk_bf16_f32 v21, v194, v195
  v_cvt_pk_bf16_f32 v37, v198, v199
  v_xor_b32 v52, s79, v36
  v_xor_b32 v53, s79, v37
  s_waitcnt lgkmcnt(0)
  v_pk_mul_f32 v[192:193], v[76:77], v[184:185]
  v_pk_mul_f32 v[194:195], v[78:79], v[186:187]
  v_pk_mul_f32 v[196:197], v[92:93], v[184:185]
  v_pk_mul_f32 v[198:199], v[94:95], v[186:187]
  v_pk_fma_f32 v[192:193], v[92:93], v[188:189], v[192:193] neg_lo:[1,0,0] neg_hi:[1,0,0]
  v_pk_fma_f32 v[194:195], v[94:95], v[190:191], v[194:195] neg_lo:[1,0,0] neg_hi:[1,0,0]
  v_pk_fma_f32 v[196:197], v[76:77], v[188:189], v[196:197]
  v_pk_fma_f32 v[198:199], v[78:79], v[190:191], v[198:199]
  v_cvt_pk_bf16_f32 v22, v192, v193
  v_cvt_pk_bf16_f32 v38, v196, v197
  v_cvt_pk_bf16_f32 v23, v194, v195
  v_cvt_pk_bf16_f32 v39, v198, v199
  v_xor_b32 v54, s79, v38
  v_xor_b32 v55, s79, v39
  ds_read_b128 v[160:163], v9 offset:24576
  ds_read_b128 v[164:167], v9 offset:25600
  ds_read_b128 v[168:171], v9 offset:26624
  ds_read_b128 v[172:175], v9 offset:27648
  ds_read_b128 v[176:179], v9 offset:28672
  ds_read_b128 v[180:183], v9 offset:29696
  ds_read_b128 v[184:187], v9 offset:30720
  ds_read_b128 v[188:191], v9 offset:31744
  v_mfma_f32_32x32x16_bf16 v[64:79], v[16:19], v[200:203], 0
  v_mfma_f32_32x32x16_bf16 v[80:95], v[32:35], v[200:203], 0
  v_mfma_f32_32x32x16_bf16 v[64:79], v[48:51], v[208:211], v[64:79]
  v_mfma_f32_32x32x16_bf16 v[80:95], v[16:19], v[208:211], v[80:95]
  v_mfma_f32_32x32x16_bf16 v[64:79], v[20:23], v[204:207], v[64:79]
  v_mfma_f32_32x32x16_bf16 v[80:95], v[36:39], v[204:207], v[80:95]
  v_mfma_f32_32x32x16_bf16 v[64:79], v[52:55], v[212:215], v[64:79]
  v_mfma_f32_32x32x16_bf16 v[80:95], v[20:23], v[212:215], v[80:95]
  s_waitcnt lgkmcnt(6)
  v_pk_mul_f32 v[192:193], v[96:97], v[160:161]
  v_pk_mul_f32 v[194:195], v[98:99], v[162:163]
  v_pk_mul_f32 v[196:197], v[112:113], v[160:161]
  v_pk_mul_f32 v[198:199], v[114:115], v[162:163]
  v_pk_fma_f32 v[192:193], v[112:113], v[164:165], v[192:193] neg_lo:[1,0,0] neg_hi:[1,0,0]
  v_pk_fma_f32 v[194:195], v[114:115], v[166:167], v[194:195] neg_lo:[1,0,0] neg_hi:[1,0,0]
  v_pk_fma_f32 v[196:197], v[96:97], v[164:165], v[196:197]
  v_pk_fma_f32 v[198:199], v[98:99], v[166:167], v[198:199]
  v_cvt_pk_bf16_f32 v24, v192, v193
  v_cvt_pk_bf16_f32 v40, v196, v197
  v_cvt_pk_bf16_f32 v25, v194, v195
  v_cvt_pk_bf16_f32 v41, v198, v199
  v_xor_b32 v56, s79, v40
  v_xor_b32 v57, s79, v41
  s_waitcnt lgkmcnt(4)
  v_pk_mul_f32 v[192:193], v[100:101], v[168:169]
  v_pk_mul_f32 v[194:195], v[102:103], v[170:171]
  v_pk_mul_f32 v[196:197], v[116:117], v[168:169]
  v_pk_mul_f32 v[198:199], v[118:119], v[170:171]
  v_pk_fma_f32 v[192:193], v[116:117], v[172:173], v[192:193] neg_lo:[1,0,0] neg_hi:[1,0,0]
  v_pk_fma_f32 v[194:195], v[118:119], v[174:175], v[194:195] neg_lo:[1,0,0] neg_hi:[1,0,0]
  v_pk_fma_f32 v[196:197], v[100:101], v[172:173], v[196:197]
  v_pk_fma_f32 v[198:199], v[102:103], v[174:175], v[198:199]
  v_cvt_pk_bf16_f32 v26, v192, v193
  v_cvt_pk_bf16_f32 v42, v196, v197
  v_cvt_pk_bf16_f32 v27, v194, v195
  v_cvt_pk_bf16_f32 v43, v198, v199
  v_xor_b32 v58, s79, v42
  v_xor_b32 v59, s79, v43
  s_waitcnt lgkmcnt(2)
  v_pk_mul_f32 v[192:193], v[104:105], v[176:177]
  v_pk_mul_f32 v[194:195], v[106:107], v[178:179]
  v_pk_mul_f32 v[196:197], v[120:121], v[176:177]
  v_pk_mul_f32 v[198:199], v[122:123], v[178:179]
  v_pk_fma_f32 v[192:193], v[120:121], v[180:181], v[192:193] neg_lo:[1,0,0] neg_hi:[1,0,0]
  v_pk_fma_f32 v[194:195], v[122:123], v[182:183], v[194:195] neg_lo:[1,0,0] neg_hi:[1,0,0]
  v_pk_fma_f32 v[196:197], v[104:105], v[180:181], v[196:197]
  v_pk_fma_f32 v[198:199], v[106:107], v[182:183], v[198:199]
  v_cvt_pk_bf16_f32 v28, v192, v193
  v_cvt_pk_bf16_f32 v44, v196, v197
  v_cvt_pk_bf16_f32 v29, v194, v195
  v_cvt_pk_bf16_f32 v45, v198, v199
  v_xor_b32 v60, s79, v44
  v_xor_b32 v61, s79, v45
  s_waitcnt lgkmcnt(0)
  v_pk_mul_f32 v[192:193], v[108:109], v[184:185]
  v_pk_mul_f32 v[194:195], v[110:111], v[186:187]
  v_pk_mul_f32 v[196:197], v[124:125], v[184:185]
  v_pk_mul_f32 v[198:199], v[126:127], v[186:187]
  v_pk_fma_f32 v[192:193], v[124:125], v[188:189], v[192:193] neg_lo:[1,0,0] neg_hi:[1,0,0]
  v_pk_fma_f32 v[194:195], v[126:127], v[190:191], v[194:195] neg_lo:[1,0,0] neg_hi:[1,0,0]
  v_pk_fma_f32 v[196:197], v[108:109], v[188:189], v[196:197]
  v_pk_fma_f32 v[198:199], v[110:111], v[190:191], v[198:199]
  v_cvt_pk_bf16_f32 v30, v192, v193
  v_cvt_pk_bf16_f32 v46, v196, v197
  v_cvt_pk_bf16_f32 v31, v194, v195
  v_cvt_pk_bf16_f32 v47, v198, v199
  v_xor_b32 v62, s79, v46
  v_xor_b32 v63, s79, v47
  v_mfma_f32_32x32x16_bf16 v[96:111], v[24:27], v[200:203], 0
  v_mfma_f32_32x32x16_bf16 v[112:127], v[40:43], v[200:203], 0
  v_mfma_f32_32x32x16_bf16 v[96:111], v[56:59], v[208:211], v[96:111]
  v_mfma_f32_32x32x16_bf16 v[112:127], v[24:27], v[208:211], v[112:127]
  v_mfma_f32_32x32x16_bf16 v[96:111], v[28:31], v[204:207], v[96:111]
  v_mfma_f32_32x32x16_bf16 v[112:127], v[44:47], v[204:207], v[112:127]
  v_mfma_f32_32x32x16_bf16 v[96:111], v[60:63], v[212:215], v[96:111]
  v_mfma_f32_32x32x16_bf16 v[112:127], v[28:31], v[212:215], v[112:127]
  s_mul_i32 s66, s77, 4224
  s_add_u32 s66, s66, 41943040
  s_add_u32 s67, s66, 608256
  v_cvt_pk_bf16_f32 v128, v64, v65
  v_cvt_pk_bf16_f32 v129, v66, v67
  v_cvt_pk_bf16_f32 v130, v68, v69
  v_cvt_pk_bf16_f32 v131, v70, v71
  v_cvt_pk_bf16_f32 v132, v72, v73
  v_cvt_pk_bf16_f32 v133, v74, v75
  v_cvt_pk_bf16_f32 v134, v76, v77
  v_cvt_pk_bf16_f32 v135, v78, v79
  buffer_store_dwordx4 v[128:131], v7, s[16:19], s66 offen offset:0 sc1
  buffer_store_dwordx4 v[132:135], v7, s[16:19], s66 offen offset:1024 sc1
  v_cvt_pk_bf16_f32 v136, v80, v81
  v_cvt_pk_bf16_f32 v137, v82, v83
  v_cvt_pk_bf16_f32 v138, v84, v85
  v_cvt_pk_bf16_f32 v139, v86, v87
  v_cvt_pk_bf16_f32 v140, v88, v89
  v_cvt_pk_bf16_f32 v141, v90, v91
  v_cvt_pk_bf16_f32 v142, v92, v93
  v_cvt_pk_bf16_f32 v143, v94, v95
  buffer_store_dwordx4 v[136:139], v7, s[16:19], s67 offen offset:0 sc1
  buffer_store_dwordx4 v[140:143], v7, s[16:19], s67 offen offset:1024 sc1
  v_cvt_pk_bf16_f32 v144, v96, v97
  v_cvt_pk_bf16_f32 v145, v98, v99
  v_cvt_pk_bf16_f32 v146, v100, v101
  v_cvt_pk_bf16_f32 v147, v102, v103
  v_cvt_pk_bf16_f32 v148, v104, v105
  v_cvt_pk_bf16_f32 v149, v106, v107
  v_cvt_pk_bf16_f32 v150, v108, v109
  v_cvt_pk_bf16_f32 v151, v110, v111
  buffer_store_dwordx4 v[144:147], v7, s[16:19], s66 offen offset:2048 sc1
  buffer_store_dwordx4 v[148:151], v7, s[16:19], s66 offen offset:3072 sc1
  v_cvt_pk_bf16_f32 v152, v112, v113
  v_cvt_pk_bf16_f32 v153, v114, v115
  v_cvt_pk_bf16_f32 v154, v116, v117
  v_cvt_pk_bf16_f32 v155, v118, v119
  v_cvt_pk_bf16_f32 v156, v120, v121
  v_cvt_pk_bf16_f32 v157, v122, v123
  v_cvt_pk_bf16_f32 v158, v124, v125
  v_cvt_pk_bf16_f32 v159, v126, v127
  buffer_store_dwordx4 v[152:155], v7, s[16:19], s67 offen offset:2048 sc1
  buffer_store_dwordx4 v[156:159], v7, s[16:19], s67 offen offset:3072 sc1
  s_cmp_eq_u32 s60, 4
  s_cbranch_scc0 L_cmain
  s_waitcnt vmcnt(0)
  v_mov_b32 v14, 1
  v_mov_b32 v15, 0
  s_lshl_b32 s66, s61, 7
  s_add_u32 s66, s66, 49815552
  s_mov_b64 exec, 1
  buffer_store_dword v14, v15, s[16:19], s66 offen sc1
  s_mov_b64 exec, -1
  s_branch L_cdone
L_cmain:
  s_waitcnt vmcnt(0) lgkmcnt(0)
  v_mov_b32 v14, 130056
  v_mov_b32 v15, 1
  s_mov_b64 exec, 1
  ds_add_rtn_u32 v15, v14, v15
  s_waitcnt lgkmcnt(0)
  v_readfirstlane_b32 s83, v15
  s_nop 0
  s_cmp_eq_u32 s83, 3
  s_cbranch_scc0 L_publ3
  v_mov_b32 v14, 3
  v_mov_b32 v15, 0
  s_lshl_b32 s66, s61, 7
  s_add_u32 s66, s66, 49807360
  buffer_store_dword v14, v15, s[16:19], s66 offen sc1
L_publ3:
  s_mov_b64 exec, -1
L_cdone:
  s_setprio 0
  s_cmp_eq_u32 s60, 4
  s_cbranch_scc1 L_idone
  s_cmp_eq_u32 s60, 7
  s_cbranch_scc1 L_zld
  v_bfe_u32 v8, v1, 3, 1
  v_lshlrev_b32 v8, 6, v8
  v_bfe_u32 v9, v1, 4, 1
  v_lshl_add_u32 v8, v9, 5, v8
  v_and_b32 v9, 3, v1
  v_lshl_add_u32 v8, v9, 3, v8
  v_bfe_u32 v9, v1, 2, 2
  v_lshl_add_u32 v8, v9, 7, v8
  v_lshrrev_b32 v9, 5, v1
  v_lshl_add_u32 v5, v9, 10, v8
  v_xor_b32 v6, 64, v5
  s_mul_i32 s76, s63, 5
  s_add_u32 s76, s76, s60
  s_cmp_eq_u32 s64, 1
  s_cselect_b32 s76, 4, s76
  s_sub_u32 s77, s60, 5
  s_cmp_eq_u32 s64, 1
  s_cselect_b32 s77, s77, 0
  s_lshl_b32 s66, s76, 5
  v_and_b32 v9, 3, v1
  v_add_u32 v9, s66, v9
  v_bfe_u32 v10, v1, 2, 1
  v_lshl_add_u32 v9, v10, 4, v9
  v_bfe_u32 v10, v1, 3, 2
  v_lshl_add_u32 v9, v10, 2, v9
  v_cvt_f32_u32 v9, v9
  v_mul_f32 v9, 0x3ae38e39, v9
  v_mul_f32 v12, 0x42000000, v9
  v_cos_f32 v12, v12
  v_mul_f32 v10, 0x41800000, v3
  v_add_f32 v12, v12, v12
  v_mul_f32 v10, v10, v9
  v_cvt_f32_u32 v13, s77
  v_fma_f32 v10, -v13, v9, v10
  v_add_f32 v13, 0x3e800000, v10
  v_fmamk_f32 v16, v9, 0x40000000, v10
  v_fmamk_f32 v17, v9, 0x40800000, v10
  v_fmamk_f32 v18, v9, 0x40c00000, v10
  v_fmamk_f32 v19, v9, 0x41000000, v10
  v_fmamk_f32 v20, v9, 0x41200000, v10
  v_fmamk_f32 v21, v9, 0x41400000, v10
  v_fmamk_f32 v22, v9, 0x41600000, v10
  v_fmamk_f32 v23, v9, 0x41800000, v10
  v_fmamk_f32 v24, v9, 0x42080000, v10
  v_fmamk_f32 v25, v9, 0x42100000, v10
  v_fmamk_f32 v26, v9, 0x42180000, v10
  v_fmamk_f32 v27, v9, 0x42200000, v10
  v_fmamk_f32 v28, v9, 0x42280000, v10
  v_fmamk_f32 v29, v9, 0x42300000, v10
  v_fmamk_f32 v30, v9, 0x42380000, v10
  v_fmamk_f32 v31, v9, 0x42400000, v10
  v_cos_f32 v16, v16
  v_cos_f32 v17, v17
  v_cos_f32 v18, v18
  v_cos_f32 v19, v19
  v_cos_f32 v20, v20
  v_cos_f32 v21, v21
  v_cos_f32 v22, v22
  v_cos_f32 v23, v23
  v_cos_f32 v24, v24
  v_cos_f32 v25, v25
  v_cos_f32 v26, v26
  v_cos_f32 v27, v27
  v_cos_f32 v28, v28
  v_cos_f32 v29, v29
  v_cos_f32 v30, v30
  v_cos_f32 v31, v31
  v_cvt_pk_bf16_f32 v112, v16, v17
  v_cvt_pk_bf16_f32 v113, v18, v19
  v_cvt_pk_bf16_f32 v114, v20, v21
  v_cvt_pk_bf16_f32 v115, v22, v23
  v_cvt_pk_bf16_f32 v116, v24, v25
  v_cvt_pk_bf16_f32 v117, v26, v27
  v_cvt_pk_bf16_f32 v118, v28, v29
  v_cvt_pk_bf16_f32 v119, v30, v31
  v_pk_fma_f32 v[16:17], v[24:25], v[12:13], v[16:17] op_sel_hi:[1,0,1] neg_lo:[0,0,1] neg_hi:[0,0,1]
  v_pk_fma_f32 v[18:19], v[26:27], v[12:13], v[18:19] op_sel_hi:[1,0,1] neg_lo:[0,0,1] neg_hi:[0,0,1]
  v_pk_fma_f32 v[20:21], v[28:29], v[12:13], v[20:21] op_sel_hi:[1,0,1] neg_lo:[0,0,1] neg_hi:[0,0,1]
  v_pk_fma_f32 v[22:23], v[30:31], v[12:13], v[22:23] op_sel_hi:[1,0,1] neg_lo:[0,0,1] neg_hi:[0,0,1]
  v_cvt_pk_bf16_f32 v120, v16, v17
  v_cvt_pk_bf16_f32 v121, v18, v19
  v_cvt_pk_bf16_f32 v122, v20, v21
  v_cvt_pk_bf16_f32 v123, v22, v23
  v_pk_fma_f32 v[24:25], v[16:17], v[12:13], v[24:25] op_sel_hi:[1,0,1] neg_lo:[0,0,1] neg_hi:[0,0,1]
  v_pk_fma_f32 v[26:27], v[18:19], v[12:13], v[26:27] op_sel_hi:[1,0,1] neg_lo:[0,0,1] neg_hi:[0,0,1]
  v_pk_fma_f32 v[28:29], v[20:21], v[12:13], v[28:29] op_sel_hi:[1,0,1] neg_lo:[0,0,1] neg_hi:[0,0,1]
  v_pk_fma_f32 v[30:31], v[22:23], v[12:13], v[30:31] op_sel_hi:[1,0,1] neg_lo:[0,0,1] neg_hi:[0,0,1]
  v_cvt_pk_bf16_f32 v124, v24, v25
  v_cvt_pk_bf16_f32 v125, v26, v27
  v_cvt_pk_bf16_f32 v126, v28, v29
  v_cvt_pk_bf16_f32 v127, v30, v31
  v_pk_fma_f32 v[16:17], v[24:25], v[12:13], v[16:17] op_sel_hi:[1,0,1] neg_lo:[0,0,1] neg_hi:[0,0,1]
  v_pk_fma_f32 v[18:19], v[26:27], v[12:13], v[18:19] op_sel_hi:[1,0,1] neg_lo:[0,0,1] neg_hi:[0,0,1]
  v_pk_fma_f32 v[20:21], v[28:29], v[12:13], v[20:21] op_sel_hi:[1,0,1] neg_lo:[0,0,1] neg_hi:[0,0,1]
  v_pk_fma_f32 v[22:23], v[30:31], v[12:13], v[22:23] op_sel_hi:[1,0,1] neg_lo:[0,0,1] neg_hi:[0,0,1]
  v_cvt_pk_bf16_f32 v128, v16, v17
  v_cvt_pk_bf16_f32 v129, v18, v19
  v_cvt_pk_bf16_f32 v130, v20, v21
  v_cvt_pk_bf16_f32 v131, v22, v23
  v_pk_fma_f32 v[24:25], v[16:17], v[12:13], v[24:25] op_sel_hi:[1,0,1] neg_lo:[0,0,1] neg_hi:[0,0,1]
  v_pk_fma_f32 v[26:27], v[18:19], v[12:13], v[26:27] op_sel_hi:[1,0,1] neg_lo:[0,0,1] neg_hi:[0,0,1]
  v_pk_fma_f32 v[28:29], v[20:21], v[12:13], v[28:29] op_sel_hi:[1,0,1] neg_lo:[0,0,1] neg_hi:[0,0,1]
  v_pk_fma_f32 v[30:31], v[22:23], v[12:13], v[30:31] op_sel_hi:[1,0,1] neg_lo:[0,0,1] neg_hi:[0,0,1]
  v_cvt_pk_bf16_f32 v132, v24, v25
  v_cvt_pk_bf16_f32 v133, v26, v27
  v_cvt_pk_bf16_f32 v134, v28, v29
  v_cvt_pk_bf16_f32 v135, v30, v31
  v_pk_fma_f32 v[16:17], v[24:25], v[12:13], v[16:17] op_sel_hi:[1,0,1] neg_lo:[0,0,1] neg_hi:[0,0,1]
  v_pk_fma_f32 v[18:19], v[26:27], v[12:13], v[18:19] op_sel_hi:[1,0,1] neg_lo:[0,0,1] neg_hi:[0,0,1]
  v_pk_fma_f32 v[20:21], v[28:29], v[12:13], v[20:21] op_sel_hi:[1,0,1] neg_lo:[0,0,1] neg_hi:[0,0,1]
  v_pk_fma_f32 v[22:23], v[30:31], v[12:13], v[22:23] op_sel_hi:[1,0,1] neg_lo:[0,0,1] neg_hi:[0,0,1]
  v_cvt_pk_bf16_f32 v136, v16, v17
  v_cvt_pk_bf16_f32 v137, v18, v19
  v_cvt_pk_bf16_f32 v138, v20, v21
  v_cvt_pk_bf16_f32 v139, v22, v23
  v_pk_fma_f32 v[24:25], v[16:17], v[12:13], v[24:25] op_sel_hi:[1,0,1] neg_lo:[0,0,1] neg_hi:[0,0,1]
  v_pk_fma_f32 v[26:27], v[18:19], v[12:13], v[26:27] op_sel_hi:[1,0,1] neg_lo:[0,0,1] neg_hi:[0,0,1]
  v_pk_fma_f32 v[28:29], v[20:21], v[12:13], v[28:29] op_sel_hi:[1,0,1] neg_lo:[0,0,1] neg_hi:[0,0,1]
  v_pk_fma_f32 v[30:31], v[22:23], v[12:13], v[30:31] op_sel_hi:[1,0,1] neg_lo:[0,0,1] neg_hi:[0,0,1]
  v_cvt_pk_bf16_f32 v140, v24, v25
  v_cvt_pk_bf16_f32 v141, v26, v27
  v_cvt_pk_bf16_f32 v142, v28, v29
  v_cvt_pk_bf16_f32 v143, v30, v31
  v_pk_fma_f32 v[16:17], v[24:25], v[12:13], v[16:17] op_sel_hi:[1,0,1] neg_lo:[0,0,1] neg_hi:[0,0,1]
  v_pk_fma_f32 v[18:19], v[26:27], v[12:13], v[18:19] op_sel_hi:[1,0,1] neg_lo:[0,0,1] neg_hi:[0,0,1]
  v_pk_fma_f32 v[20:21], v[28:29], v[12:13], v[20:21] op_sel_hi:[1,0,1] neg_lo:[0,0,1] neg_hi:[0,0,1]
  v_pk_fma_f32 v[22:23], v[30:31], v[12:13], v[22:23] op_sel_hi:[1,0,1] neg_lo:[0,0,1] neg_hi:[0,0,1]
  v_cvt_pk_bf16_f32 v144, v16, v17
  v_cvt_pk_bf16_f32 v145, v18, v19
  v_cvt_pk_bf16_f32 v146, v20, v21
  v_cvt_pk_bf16_f32 v147, v22, v23
  v_fmamk_f32 v16, v9, 0x40000000, v13
  v_fmamk_f32 v17, v9, 0x40800000, v13
  v_fmamk_f32 v18, v9, 0x40c00000, v13
  v_fmamk_f32 v19, v9, 0x41000000, v13
  v_fmamk_f32 v20, v9, 0x41200000, v13
  v_fmamk_f32 v21, v9, 0x41400000, v13
  v_fmamk_f32 v22, v9, 0x41600000, v13
  v_fmamk_f32 v23, v9, 0x41800000, v13
  v_fmamk_f32 v24, v9, 0x42080000, v13
  v_fmamk_f32 v25, v9, 0x42100000, v13
  v_fmamk_f32 v26, v9, 0x42180000, v13
  v_fmamk_f32 v27, v9, 0x42200000, v13
  v_fmamk_f32 v28, v9, 0x42280000, v13
  v_fmamk_f32 v29, v9, 0x42300000, v13
  v_fmamk_f32 v30, v9, 0x42380000, v13
  v_fmamk_f32 v31, v9, 0x42400000, v13
  v_cos_f32 v16, v16
  v_cos_f32 v17, v17
  v_cos_f32 v18, v18
  v_cos_f32 v19, v19
  v_cos_f32 v20, v20
  v_cos_f32 v21, v21
  v_cos_f32 v22, v22
  v_cos_f32 v23, v23
  v_cos_f32 v24, v24
  v_cos_f32 v25, v25
  v_cos_f32 v26, v26
  v_cos_f32 v27, v27
  v_cos_f32 v28, v28
  v_cos_f32 v29, v29
  v_cos_f32 v30, v30
  v_cos_f32 v31, v31
  v_cvt_pk_bf16_f32 v148, v16, v17
  v_cvt_pk_bf16_f32 v149, v18, v19
  v_cvt_pk_bf16_f32 v150, v20, v21
  v_cvt_pk_bf16_f32 v151, v22, v23
  v_cvt_pk_bf16_f32 v152, v24, v25
  v_cvt_pk_bf16_f32 v153, v26, v27
  v_cvt_pk_bf16_f32 v154, v28, v29
  v_cvt_pk_bf16_f32 v155, v30, v31
  v_pk_fma_f32 v[16:17], v[24:25], v[12:13], v[16:17] op_sel_hi:[1,0,1] neg_lo:[0,0,1] neg_hi:[0,0,1]
  v_pk_fma_f32 v[18:19], v[26:27], v[12:13], v[18:19] op_sel_hi:[1,0,1] neg_lo:[0,0,1] neg_hi:[0,0,1]
  v_pk_fma_f32 v[20:21], v[28:29], v[12:13], v[20:21] op_sel_hi:[1,0,1] neg_lo:[0,0,1] neg_hi:[0,0,1]
  v_pk_fma_f32 v[22:23], v[30:31], v[12:13], v[22:23] op_sel_hi:[1,0,1] neg_lo:[0,0,1] neg_hi:[0,0,1]
  v_cvt_pk_bf16_f32 v156, v16, v17
  v_cvt_pk_bf16_f32 v157, v18, v19
  v_cvt_pk_bf16_f32 v158, v20, v21
  v_cvt_pk_bf16_f32 v159, v22, v23
  v_pk_fma_f32 v[24:25], v[16:17], v[12:13], v[24:25] op_sel_hi:[1,0,1] neg_lo:[0,0,1] neg_hi:[0,0,1]
  v_pk_fma_f32 v[26:27], v[18:19], v[12:13], v[26:27] op_sel_hi:[1,0,1] neg_lo:[0,0,1] neg_hi:[0,0,1]
  v_pk_fma_f32 v[28:29], v[20:21], v[12:13], v[28:29] op_sel_hi:[1,0,1] neg_lo:[0,0,1] neg_hi:[0,0,1]
  v_pk_fma_f32 v[30:31], v[22:23], v[12:13], v[30:31] op_sel_hi:[1,0,1] neg_lo:[0,0,1] neg_hi:[0,0,1]
  v_cvt_pk_bf16_f32 v160, v24, v25
  v_cvt_pk_bf16_f32 v161, v26, v27
  v_cvt_pk_bf16_f32 v162, v28, v29
  v_cvt_pk_bf16_f32 v163, v30, v31
  v_pk_fma_f32 v[16:17], v[24:25], v[12:13], v[16:17] op_sel_hi:[1,0,1] neg_lo:[0,0,1] neg_hi:[0,0,1]
  v_pk_fma_f32 v[18:19], v[26:27], v[12:13], v[18:19] op_sel_hi:[1,0,1] neg_lo:[0,0,1] neg_hi:[0,0,1]
  v_pk_fma_f32 v[20:21], v[28:29], v[12:13], v[20:21] op_sel_hi:[1,0,1] neg_lo:[0,0,1] neg_hi:[0,0,1]
  v_pk_fma_f32 v[22:23], v[30:31], v[12:13], v[22:23] op_sel_hi:[1,0,1] neg_lo:[0,0,1] neg_hi:[0,0,1]
  v_cvt_pk_bf16_f32 v164, v16, v17
  v_cvt_pk_bf16_f32 v165, v18, v19
  v_cvt_pk_bf16_f32 v166, v20, v21
  v_cvt_pk_bf16_f32 v167, v22, v23
  v_pk_fma_f32 v[24:25], v[16:17], v[12:13], v[24:25] op_sel_hi:[1,0,1] neg_lo:[0,0,1] neg_hi:[0,0,1]
  v_pk_fma_f32 v[26:27], v[18:19], v[12:13], v[26:27] op_sel_hi:[1,0,1] neg_lo:[0,0,1] neg_hi:[0,0,1]
  v_pk_fma_f32 v[28:29], v[20:21], v[12:13], v[28:29] op_sel_hi:[1,0,1] neg_lo:[0,0,1] neg_hi:[0,0,1]
  v_pk_fma_f32 v[30:31], v[22:23], v[12:13], v[30:31] op_sel_hi:[1,0,1] neg_lo:[0,0,1] neg_hi:[0,0,1]
  v_cvt_pk_bf16_f32 v168, v24, v25
  v_cvt_pk_bf16_f32 v169, v26, v27
  v_cvt_pk_bf16_f32 v170, v28, v29
  v_cvt_pk_bf16_f32 v171, v30, v31
  v_pk_fma_f32 v[16:17], v[24:25], v[12:13], v[16:17] op_sel_hi:[1,0,1] neg_lo:[0,0,1] neg_hi:[0,0,1]
  v_pk_fma_f32 v[18:19], v[26:27], v[12:13], v[18:19] op_sel_hi:[1,0,1] neg_lo:[0,0,1] neg_hi:[0,0,1]
  v_pk_fma_f32 v[20:21], v[28:29], v[12:13], v[20:21] op_sel_hi:[1,0,1] neg_lo:[0,0,1] neg_hi:[0,0,1]
  v_pk_fma_f32 v[22:23], v[30:31], v[12:13], v[22:23] op_sel_hi:[1,0,1] neg_lo:[0,0,1] neg_hi:[0,0,1]
  v_cvt_pk_bf16_f32 v172, v16, v17
  v_cvt_pk_bf16_f32 v173, v18, v19
  v_cvt_pk_bf16_f32 v174, v20, v21
  v_cvt_pk_bf16_f32 v175, v22, v23
  v_pk_fma_f32 v[24:25], v[16:17], v[12:13], v[24:25] op_sel_hi:[1,0,1] neg_lo:[0,0,1] neg_hi:[0,0,1]
  v_pk_fma_f32 v[26:27], v[18:19], v[12:13], v[26:27] op_sel_hi:[1,0,1] neg_lo:[0,0,1] neg_hi:[0,0,1]
  v_pk_fma_f32 v[28:29], v[20:21], v[12:13], v[28:29] op_sel_hi:[1,0,1] neg_lo:[0,0,1] neg_hi:[0,0,1]
  v_pk_fma_f32 v[30:31], v[22:23], v[12:13], v[30:31] op_sel_hi:[1,0,1] neg_lo:[0,0,1] neg_hi:[0,0,1]
  v_cvt_pk_bf16_f32 v176, v24, v25
  v_cvt_pk_bf16_f32 v177, v26, v27
  v_cvt_pk_bf16_f32 v178, v28, v29
  v_cvt_pk_bf16_f32 v179, v30, v31
  v_pk_fma_f32 v[16:17], v[24:25], v[12:13], v[16:17] op_sel_hi:[1,0,1] neg_lo:[0,0,1] neg_hi:[0,0,1]
  v_pk_fma_f32 v[18:19], v[26:27], v[12:13], v[18:19] op_sel_hi:[1,0,1] neg_lo:[0,0,1] neg_hi:[0,0,1]
  v_pk_fma_f32 v[20:21], v[28:29], v[12:13], v[20:21] op_sel_hi:[1,0,1] neg_lo:[0,0,1] neg_hi:[0,0,1]
  v_pk_fma_f32 v[22:23], v[30:31], v[12:13], v[22:23] op_sel_hi:[1,0,1] neg_lo:[0,0,1] neg_hi:[0,0,1]
  v_cvt_pk_bf16_f32 v180, v16, v17
  v_cvt_pk_bf16_f32 v181, v18, v19
  v_cvt_pk_bf16_f32 v182, v20, v21
  v_cvt_pk_bf16_f32 v183, v22, v23
  s_mul_i32 s66, s62, 73984
  s_lshl_b32 s78, s76, 11
  s_add_u32 s66, s66, s78
  s_add_u32 s78, s66, 33554432
  s_cmp_eq_u32 s64, 1
  s_cbranch_scc1 L_iseg
  v_fmamk_f32 v16, v9, 0x3f800000, v10
  v_fmamk_f32 v17, v9, 0x40400000, v10
  v_fmamk_f32 v18, v9, 0x40a00000, v10
  v_fmamk_f32 v19, v9, 0x40e00000, v10
  v_fmamk_f32 v20, v9, 0x41100000, v10
  v_fmamk_f32 v21, v9, 0x41300000, v10
  v_fmamk_f32 v22, v9, 0x41500000, v10
  v_fmamk_f32 v23, v9, 0x41700000, v10
  v_fmamk_f32 v24, v9, 0x42040000, v10
  v_fmamk_f32 v25, v9, 0x420c0000, v10
  v_fmamk_f32 v26, v9, 0x42140000, v10
  v_fmamk_f32 v27, v9, 0x421c0000, v10
  v_fmamk_f32 v28, v9, 0x42240000, v10
  v_fmamk_f32 v29, v9, 0x422c0000, v10
  v_fmamk_f32 v30, v9, 0x42340000, v10
  v_fmamk_f32 v31, v9, 0x423c0000, v10
  v_cos_f32 v16, v16
  v_cos_f32 v17, v17
  v_cos_f32 v18, v18
  v_cos_f32 v19, v19
  v_cos_f32 v20, v20
  v_cos_f32 v21, v21
  v_cos_f32 v22, v22
  v_cos_f32 v23, v23
  v_cos_f32 v24, v24
  v_cos_f32 v25, v25
  v_cos_f32 v26, v26
  v_cos_f32 v27, v27
  v_cos_f32 v28, v28
  v_cos_f32 v29, v29
  v_cos_f32 v30, v30
  v_cos_f32 v31, v31
  v_cvt_pk_bf16_f32 v184, v16, v17
  v_cvt_pk_bf16_f32 v185, v18, v19
  v_cvt_pk_bf16_f32 v186, v20, v21
  v_cvt_pk_bf16_f32 v187, v22, v23
  v_cvt_pk_bf16_f32 v188, v24, v25
  s_branch L_pj19
  .p2align 12
L_stub19:
  s_setpc_b64 s[58:59]
  s_nop 0
L_pj19:
  v_cvt_pk_bf16_f32 v189, v26, v27
  v_cvt_pk_bf16_f32 v190, v28, v29
  v_cvt_pk_bf16_f32 v191, v30, v31
  v_pk_fma_f32 v[16:17], v[24:25], v[12:13], v[16:17] op_sel_hi:[1,0,1] neg_lo:[0,0,1] neg_hi:[0,0,1]
  v_pk_fma_f32 v[18:19], v[26:27], v[12:13], v[18:19] op_sel_hi:[1,0,1] neg_lo:[0,0,1] neg_hi:[0,0,1]
  v_pk_fma_f32 v[20:21], v[28:29], v[12:13], v[20:21] op_sel_hi:[1,0,1] neg_lo:[0,0,1] neg_hi:[0,0,1]
  v_pk_fma_f32 v[22:23], v[30:31], v[12:13], v[22:23] op_sel_hi:[1,0,1] neg_lo:[0,0,1] neg_hi:[0,0,1]
  v_cvt_pk_bf16_f32 v192, v16, v17
  v_cvt_pk_bf16_f32 v193, v18, v19
  v_cvt_pk_bf16_f32 v194, v20, v21
  v_cvt_pk_bf16_f32 v195, v22, v23
  v_pk_fma_f32 v[24:25], v[16:17], v[12:13], v[24:25] op_sel_hi:[1,0,1] neg_lo:[0,0,1] neg_hi:[0,0,1]
  v_pk_fma_f32 v[26:27], v[18:19], v[12:13], v[26:27] op_sel_hi:[1,0,1] neg_lo:[0,0,1] neg_hi:[0,0,1]
  v_pk_fma_f32 v[28:29], v[20:21], v[12:13], v[28:29] op_sel_hi:[1,0,1] neg_lo:[0,0,1] neg_hi:[0,0,1]
  v_pk_fma_f32 v[30:31], v[22:23], v[12:13], v[30:31] op_sel_hi:[1,0,1] neg_lo:[0,0,1] neg_hi:[0,0,1]
  v_cvt_pk_bf16_f32 v196, v24, v25
  v_cvt_pk_bf16_f32 v197, v26, v27
  v_cvt_pk_bf16_f32 v198, v28, v29
  v_cvt_pk_bf16_f32 v199, v30, v31
  v_pk_fma_f32 v[16:17], v[24:25], v[12:13], v[16:17] op_sel_hi:[1,0,1] neg_lo:[0,0,1] neg_hi:[0,0,1]
  v_pk_fma_f32 v[18:19], v[26:27], v[12:13], v[18:19] op_sel_hi:[1,0,1] neg_lo:[0,0,1] neg_hi:[0,0,1]
  v_pk_fma_f32 v[20:21], v[28:29], v[12:13], v[20:21] op_sel_hi:[1,0,1] neg_lo:[0,0,1] neg_hi:[0,0,1]
  v_pk_fma_f32 v[22:23], v[30:31], v[12:13], v[22:23] op_sel_hi:[1,0,1] neg_lo:[0,0,1] neg_hi:[0,0,1]
  v_cvt_pk_bf16_f32 v200, v16, v17
  v_cvt_pk_bf16_f32 v201, v18, v19
  v_cvt_pk_bf16_f32 v202, v20, v21
  v_cvt_pk_bf16_f32 v203, v22, v23
  v_pk_fma_f32 v[24:25], v[16:17], v[12:13], v[24:25] op_sel_hi:[1,0,1] neg_lo:[0,0,1] neg_hi:[0,0,1]
  v_pk_fma_f32 v[26:27], v[18:19], v[12:13], v[26:27] op_sel_hi:[1,0,1] neg_lo:[0,0,1] neg_hi:[0,0,1]
  v_pk_fma_f32 v[28:29], v[20:21], v[12:13], v[28:29] op_sel_hi:[1,0,1] neg_lo:[0,0,1] neg_hi:[0,0,1]
  v_pk_fma_f32 v[30:31], v[22:23], v[12:13], v[30:31] op_sel_hi:[1,0,1] neg_lo:[0,0,1] neg_hi:[0,0,1]
  v_cvt_pk_bf16_f32 v204, v24, v25
  v_cvt_pk_bf16_f32 v205, v26, v27
  v_cvt_pk_bf16_f32 v206, v28, v29
  v_cvt_pk_bf16_f32 v207, v30, v31
  v_pk_fma_f32 v[16:17], v[24:25], v[12:13], v[16:17] op_sel_hi:[1,0,1] neg_lo:[0,0,1] neg_hi:[0,0,1]
  v_pk_fma_f32 v[18:19], v[26:27], v[12:13], v[18:19] op_sel_hi:[1,0,1] neg_lo:[0,0,1] neg_hi:[0,0,1]
  v_pk_fma_f32 v[20:21], v[28:29], v[12:13], v[20:21] op_sel_hi:[1,0,1] neg_lo:[0,0,1] neg_hi:[0,0,1]
  v_pk_fma_f32 v[22:23], v[30:31], v[12:13], v[22:23] op_sel_hi:[1,0,1] neg_lo:[0,0,1] neg_hi:[0,0,1]
  v_cvt_pk_bf16_f32 v208, v16, v17
  v_cvt_pk_bf16_f32 v209, v18, v19
  v_cvt_pk_bf16_f32 v210, v20, v21
  v_cvt_pk_bf16_f32 v211, v22, v23
  v_pk_fma_f32 v[24:25], v[16:17], v[12:13], v[24:25] op_sel_hi:[1,0,1] neg_lo:[0,0,1] neg_hi:[0,0,1]
  v_pk_fma_f32 v[26:27], v[18:19], v[12:13], v[26:27] op_sel_hi:[1,0,1] neg_lo:[0,0,1] neg_hi:[0,0,1]
  v_pk_fma_f32 v[28:29], v[20:21], v[12:13], v[28:29] op_sel_hi:[1,0,1] neg_lo:[0,0,1] neg_hi:[0,0,1]
  v_pk_fma_f32 v[30:31], v[22:23], v[12:13], v[30:31] op_sel_hi:[1,0,1] neg_lo:[0,0,1] neg_hi:[0,0,1]
  v_cvt_pk_bf16_f32 v212, v24, v25
  v_cvt_pk_bf16_f32 v213, v26, v27
  v_cvt_pk_bf16_f32 v214, v28, v29
  v_cvt_pk_bf16_f32 v215, v30, v31
  v_pk_fma_f32 v[16:17], v[24:25], v[12:13], v[16:17] op_sel_hi:[1,0,1] neg_lo:[0,0,1] neg_hi:[0,0,1]
  v_pk_fma_f32 v[18:19], v[26:27], v[12:13], v[18:19] op_sel_hi:[1,0,1] neg_lo:[0,0,1] neg_hi:[0,0,1]
  v_pk_fma_f32 v[20:21], v[28:29], v[12:13], v[20:21] op_sel_hi:[1,0,1] neg_lo:[0,0,1] neg_hi:[0,0,1]
  v_pk_fma_f32 v[22:23], v[30:31], v[12:13], v[22:23] op_sel_hi:[1,0,1] neg_lo:[0,0,1] neg_hi:[0,0,1]
  v_cvt_pk_bf16_f32 v216, v16, v17
  v_cvt_pk_bf16_f32 v217, v18, v19
  v_cvt_pk_bf16_f32 v218, v20, v21
  v_cvt_pk_bf16_f32 v219, v22, v23
  v_fmamk_f32 v16, v9, 0x3f800000, v13
  v_fmamk_f32 v17, v9, 0x40400000, v13
  v_fmamk_f32 v18, v9, 0x40a00000, v13
  v_fmamk_f32 v19, v9, 0x40e00000, v13
  v_fmamk_f32 v20, v9, 0x41100000, v13
  v_fmamk_f32 v21, v9, 0x41300000, v13
  v_fmamk_f32 v22, v9, 0x41500000, v13
  v_fmamk_f32 v23, v9, 0x41700000, v13
  v_fmamk_f32 v24, v9, 0x42040000, v13
  v_fmamk_f32 v25, v9, 0x420c0000, v13
  v_fmamk_f32 v26, v9, 0x42140000, v13
  v_fmamk_f32 v27, v9, 0x421c0000, v13
  v_fmamk_f32 v28, v9, 0x42240000, v13
  v_fmamk_f32 v29, v9, 0x422c0000, v13
  v_fmamk_f32 v30, v9, 0x42340000, v13
  v_fmamk_f32 v31, v9, 0x423c0000, v13
  v_cos_f32 v16, v16
  v_cos_f32 v17, v17
  v_cos_f32 v18, v18
  v_cos_f32 v19, v19
  v_cos_f32 v20, v20
  v_cos_f32 v21, v21
  v_cos_f32 v22, v22
  v_cos_f32 v23, v23
  v_cos_f32 v24, v24
  v_cos_f32 v25, v25
  v_cos_f32 v26, v26
  v_cos_f32 v27, v27
  v_cos_f32 v28, v28
  v_cos_f32 v29, v29
  v_cos_f32 v30, v30
  v_cos_f32 v31, v31
  v_cvt_pk_bf16_f32 v220, v16, v17
  v_cvt_pk_bf16_f32 v221, v18, v19
  v_cvt_pk_bf16_f32 v222, v20, v21
  v_cvt_pk_bf16_f32 v223, v22, v23
  v_cvt_pk_bf16_f32 v224, v24, v25
  v_cvt_pk_bf16_f32 v225, v26, v27
  v_cvt_pk_bf16_f32 v226, v28, v29
  v_cvt_pk_bf16_f32 v227, v30, v31
  v_pk_fma_f32 v[16:17], v[24:25], v[12:13], v[16:17] op_sel_hi:[1,0,1] neg_lo:[0,0,1] neg_hi:[0,0,1]
  v_pk_fma_f32 v[18:19], v[26:27], v[12:13], v[18:19] op_sel_hi:[1,0,1] neg_lo:[0,0,1] neg_hi:[0,0,1]
  v_pk_fma_f32 v[20:21], v[28:29], v[12:13], v[20:21] op_sel_hi:[1,0,1] neg_lo:[0,0,1] neg_hi:[0,0,1]
  v_pk_fma_f32 v[22:23], v[30:31], v[12:13], v[22:23] op_sel_hi:[1,0,1] neg_lo:[0,0,1] neg_hi:[0,0,1]
  v_cvt_pk_bf16_f32 v228, v16, v17
  v_cvt_pk_bf16_f32 v229, v18, v19
  v_cvt_pk_bf16_f32 v230, v20, v21
  v_cvt_pk_bf16_f32 v231, v22, v23
  v_pk_fma_f32 v[24:25], v[16:17], v[12:13], v[24:25] op_sel_hi:[1,0,1] neg_lo:[0,0,1] neg_hi:[0,0,1]
  v_pk_fma_f32 v[26:27], v[18:19], v[12:13], v[26:27] op_sel_hi:[1,0,1] neg_lo:[0,0,1] neg_hi:[0,0,1]
  v_pk_fma_f32 v[28:29], v[20:21], v[12:13], v[28:29] op_sel_hi:[1,0,1] neg_lo:[0,0,1] neg_hi:[0,0,1]
  v_pk_fma_f32 v[30:31], v[22:23], v[12:13], v[30:31] op_sel_hi:[1,0,1] neg_lo:[0,0,1] neg_hi:[0,0,1]
  v_cvt_pk_bf16_f32 v232, v24, v25
  v_cvt_pk_bf16_f32 v233, v26, v27
  v_cvt_pk_bf16_f32 v234, v28, v29
  v_cvt_pk_bf16_f32 v235, v30, v31
  v_pk_fma_f32 v[16:17], v[24:25], v[12:13], v[16:17] op_sel_hi:[1,0,1] neg_lo:[0,0,1] neg_hi:[0,0,1]
  v_pk_fma_f32 v[18:19], v[26:27], v[12:13], v[18:19] op_sel_hi:[1,0,1] neg_lo:[0,0,1] neg_hi:[0,0,1]
  v_pk_fma_f32 v[20:21], v[28:29], v[12:13], v[20:21] op_sel_hi:[1,0,1] neg_lo:[0,0,1] neg_hi:[0,0,1]
  v_pk_fma_f32 v[22:23], v[30:31], v[12:13], v[22:23] op_sel_hi:[1,0,1] neg_lo:[0,0,1] neg_hi:[0,0,1]
  v_cvt_pk_bf16_f32 v236, v16, v17
  v_cvt_pk_bf16_f32 v237, v18, v19
  v_cvt_pk_bf16_f32 v238, v20, v21
  v_cvt_pk_bf16_f32 v239, v22, v23
  v_pk_fma_f32 v[24:25], v[16:17], v[12:13], v[24:25] op_sel_hi:[1,0,1] neg_lo:[0,0,1] neg_hi:[0,0,1]
  v_pk_fma_f32 v[26:27], v[18:19], v[12:13], v[26:27] op_sel_hi:[1,0,1] neg_lo:[0,0,1] neg_hi:[0,0,1]
  v_pk_fma_f32 v[28:29], v[20:21], v[12:13], v[28:29] op_sel_hi:[1,0,1] neg_lo:[0,0,1] neg_hi:[0,0,1]
  v_pk_fma_f32 v[30:31], v[22:23], v[12:13], v[30:31] op_sel_hi:[1,0,1] neg_lo:[0,0,1] neg_hi:[0,0,1]
  v_cvt_pk_bf16_f32 v240, v24, v25
  v_cvt_pk_bf16_f32 v241, v26, v27
  v_cvt_pk_bf16_f32 v242, v28, v29
  v_cvt_pk_bf16_f32 v243, v30, v31
  v_pk_fma_f32 v[16:17], v[24:25], v[12:13], v[16:17] op_sel_hi:[1,0,1] neg_lo:[0,0,1] neg_hi:[0,0,1]
  v_pk_fma_f32 v[18:19], v[26:27], v[12:13], v[18:19] op_sel_hi:[1,0,1] neg_lo:[0,0,1] neg_hi:[0,0,1]
  v_pk_fma_f32 v[20:21], v[28:29], v[12:13], v[20:21] op_sel_hi:[1,0,1] neg_lo:[0,0,1] neg_hi:[0,0,1]
  v_pk_fma_f32 v[22:23], v[30:31], v[12:13], v[22:23] op_sel_hi:[1,0,1] neg_lo:[0,0,1] neg_hi:[0,0,1]
  v_cvt_pk_bf16_f32 v244, v16, v17
  v_cvt_pk_bf16_f32 v245, v18, v19
  v_cvt_pk_bf16_f32 v246, v20, v21
  v_cvt_pk_bf16_f32 v247, v22, v23
  v_pk_fma_f32 v[24:25], v[16:17], v[12:13], v[24:25] op_sel_hi:[1,0,1] neg_lo:[0,0,1] neg_hi:[0,0,1]
  v_pk_fma_f32 v[26:27], v[18:19], v[12:13], v[26:27] op_sel_hi:[1,0,1] neg_lo:[0,0,1] neg_hi:[0,0,1]
  v_pk_fma_f32 v[28:29], v[20:21], v[12:13], v[28:29] op_sel_hi:[1,0,1] neg_lo:[0,0,1] neg_hi:[0,0,1]
  v_pk_fma_f32 v[30:31], v[22:23], v[12:13], v[30:31] op_sel_hi:[1,0,1] neg_lo:[0,0,1] neg_hi:[0,0,1]
  v_cvt_pk_bf16_f32 v248, v24, v25
  v_cvt_pk_bf16_f32 v249, v26, v27
  v_cvt_pk_bf16_f32 v250, v28, v29
  v_cvt_pk_bf16_f32 v251, v30, v31
  v_pk_fma_f32 v[16:17], v[24:25], v[12:13], v[16:17] op_sel_hi:[1,0,1] neg_lo:[0,0,1] neg_hi:[0,0,1]
  v_pk_fma_f32 v[18:19], v[26:27], v[12:13], v[18:19] op_sel_hi:[1,0,1] neg_lo:[0,0,1] neg_hi:[0,0,1]
  v_pk_fma_f32 v[20:21], v[28:29], v[12:13], v[20:21] op_sel_hi:[1,0,1] neg_lo:[0,0,1] neg_hi:[0,0,1]
  v_pk_fma_f32 v[22:23], v[30:31], v[12:13], v[22:23] op_sel_hi:[1,0,1] neg_lo:[0,0,1] neg_hi:[0,0,1]
  v_cvt_pk_bf16_f32 v252, v16, v17
  v_cvt_pk_bf16_f32 v253, v18, v19
  v_cvt_pk_bf16_f32 v254, v20, v21
  v_cvt_pk_bf16_f32 v255, v22, v23
  v_add_u32 v13, 0x8000, v5
  v_add_u32 v8, 0x8000, v6
  v_mov_b32 v14, 130060
  s_mov_b32 s80, 3200000
L_zw0:
  ds_read_b32 v15, v14
  s_waitcnt lgkmcnt(0)
  v_readfirstlane_b32 s81, v15
  s_sub_u32 s80, s80, 1
  s_cmp_ge_u32 s81, 1
  s_cbranch_scc1 L_zw0_d
  s_cmp_eq_u32 s80, 0
  s_cbranch_scc1 L_zw0_d
  s_sleep 1
  s_branch L_zw0
L_zw0_d:
  ds_read_b64_tr_b16 v[80:81], v5 offset:0
  ds_read_b64_tr_b16 v[82:83], v5 offset:512
  ds_read_b64_tr_b16 v[84:85], v6 offset:0
  ds_read_b64_tr_b16 v[86:87], v6 offset:512
  ds_read_b64_tr_b16 v[88:89], v5 offset:2048
  ds_read_b64_tr_b16 v[90:91], v5 offset:2560
  ds_read_b64_tr_b16 v[92:93], v6 offset:2048
  ds_read_b64_tr_b16 v[94:95], v6 offset:2560
  ds_read_b64_tr_b16 v[96:97], v5 offset:4096
  ds_read_b64_tr_b16 v[98:99], v5 offset:4608
  ds_read_b64_tr_b16 v[100:101], v6 offset:4096
  ds_read_b64_tr_b16 v[102:103], v6 offset:4608
  s_waitcnt lgkmcnt(8)
  v_mfma_f32_32x32x16_bf16 v[16:31], v[112:115], v[80:83], 0
  ds_read_b64_tr_b16 v[104:105], v5 offset:6144
  ds_read_b64_tr_b16 v[106:107], v5 offset:6656
  ds_read_b64_tr_b16 v[108:109], v6 offset:6144
  ds_read_b64_tr_b16 v[110:111], v6 offset:6656
  v_mfma_f32_32x32x16_bf16 v[32:47], v[112:115], v[84:87], 0
  s_waitcnt lgkmcnt(8)
  v_mfma_f32_32x32x16_bf16 v[16:31], v[116:119], v[88:91], v[16:31]
  ds_read_b64_tr_b16 v[80:81], v5 offset:8192
  ds_read_b64_tr_b16 v[82:83], v5 offset:8704
  ds_read_b64_tr_b16 v[84:85], v6 offset:8192
  ds_read_b64_tr_b16 v[86:87], v6 offset:8704
  v_mfma_f32_32x32x16_bf16 v[32:47], v[116:119], v[92:95], v[32:47]
  s_waitcnt lgkmcnt(8)
  v_mfma_f32_32x32x16_bf16 v[16:31], v[120:123], v[96:99], v[16:31]
  ds_read_b64_tr_b16 v[88:89], v5 offset:10240
  ds_read_b64_tr_b16 v[90:91], v5 offset:10752
  ds_read_b64_tr_b16 v[92:93], v6 offset:10240
  ds_read_b64_tr_b16 v[94:95], v6 offset:10752
  v_mfma_f32_32x32x16_bf16 v[32:47], v[120:123], v[100:103], v[32:47]
  s_waitcnt lgkmcnt(8)
  v_mfma_f32_32x32x16_bf16 v[16:31], v[124:127], v[104:107], v[16:31]
  ds_read_b64_tr_b16 v[96:97], v5 offset:12288
  ds_read_b64_tr_b16 v[98:99], v5 offset:12800
  ds_read_b64_tr_b16 v[100:101], v6 offset:12288
  ds_read_b64_tr_b16 v[102:103], v6 offset:12800
  v_mfma_f32_32x32x16_bf16 v[32:47], v[124:127], v[108:111], v[32:47]
  s_waitcnt lgkmcnt(8)
  v_mfma_f32_32x32x16_bf16 v[16:31], v[128:131], v[80:83], v[16:31]
  ds_read_b64_tr_b16 v[104:105], v5 offset:14336
  ds_read_b64_tr_b16 v[106:107], v5 offset:14848
  ds_read_b64_tr_b16 v[108:109], v6 offset:14336
  ds_read_b64_tr_b16 v[110:111], v6 offset:14848
  v_mfma_f32_32x32x16_bf16 v[32:47], v[128:131], v[84:87], v[32:47]
  s_waitcnt lgkmcnt(8)
  v_mfma_f32_32x32x16_bf16 v[16:31], v[132:135], v[88:91], v[16:31]
  v_mfma_f32_32x32x16_bf16 v[32:47], v[132:135], v[92:95], v[32:47]
  s_waitcnt lgkmcnt(4)
  v_mfma_f32_32x32x16_bf16 v[16:31], v[136:139], v[96:99], v[16:31]
  v_mfma_f32_32x32x16_bf16 v[32:47], v[136:139], v[100:103], v[32:47]
  s_waitcnt lgkmcnt(0)
  v_mfma_f32_32x32x16_bf16 v[16:31], v[140:143], v[104:107], v[16:31]
  v_mfma_f32_32x32x16_bf16 v[32:47], v[140:143], v[108:111], v[32:47]
  v_mov_b32 v14, 130060
  s_mov_b32 s80, 3200000
L_zw1:
  ds_read_b32 v15, v14
  s_waitcnt lgkmcnt(0)
  v_readfirstlane_b32 s81, v15
  s_sub_u32 s80, s80, 1
  s_cmp_ge_u32 s81, 2
  s_cbranch_scc1 L_zw1_d
  s_cmp_eq_u32 s80, 0
  s_cbranch_scc1 L_zw1_d
  s_sleep 1
  s_branch L_zw1
L_zw1_d:
  ds_read_b64_tr_b16 v[80:81], v5 offset:18432
  ds_read_b64_tr_b16 v[82:83], v5 offset:18944
  ds_read_b64_tr_b16 v[84:85], v6 offset:18432
  ds_read_b64_tr_b16 v[86:87], v6 offset:18944
  ds_read_b64_tr_b16 v[88:89], v5 offset:20480
  ds_read_b64_tr_b16 v[90:91], v5 offset:20992
  ds_read_b64_tr_b16 v[92:93], v6 offset:20480
  ds_read_b64_tr_b16 v[94:95], v6 offset:20992
  ds_read_b64_tr_b16 v[96:97], v5 offset:22528
  ds_read_b64_tr_b16 v[98:99], v5 offset:23040
  ds_read_b64_tr_b16 v[100:101], v6 offset:22528
  ds_read_b64_tr_b16 v[102:103], v6 offset:23040
  s_waitcnt lgkmcnt(8)
  v_mfma_f32_32x32x16_bf16 v[16:31], v[148:151], v[80:83], v[16:31]
  ds_read_b64_tr_b16 v[104:105], v5 offset:24576
  ds_read_b64_tr_b16 v[106:107], v5 offset:25088
  ds_read_b64_tr_b16 v[108:109], v6 offset:24576
  ds_read_b64_tr_b16 v[110:111], v6 offset:25088
  v_mfma_f32_32x32x16_bf16 v[32:47], v[148:151], v[84:87], v[32:47]
  s_waitcnt lgkmcnt(8)
  v_mfma_f32_32x32x16_bf16 v[16:31], v[152:155], v[88:91], v[16:31]
  ds_read_b64_tr_b16 v[80:81], v5 offset:26624
  ds_read_b64_tr_b16 v[82:83], v5 offset:27136
  ds_read_b64_tr_b16 v[84:85], v6 offset:26624
  ds_read_b64_tr_b16 v[86:87], v6 offset:27136
  v_mfma_f32_32x32x16_bf16 v[32:47], v[152:155], v[92:95], v[32:47]
  s_waitcnt lgkmcnt(8)
  v_mfma_f32_32x32x16_bf16 v[16:31], v[156:159], v[96:99], v[16:31]
  ds_read_b64_tr_b16 v[88:89], v5 offset:28672
  ds_read_b64_tr_b16 v[90:91], v5 offset:29184
  ds_read_b64_tr_b16 v[92:93], v6 offset:28672
  ds_read_b64_tr_b16 v[94:95], v6 offset:29184
  v_mfma_f32_32x32x16_bf16 v[32:47], v[156:159], v[100:103], v[32:47]
  s_waitcnt lgkmcnt(8)
  v_mfma_f32_32x32x16_bf16 v[16:31], v[160:163], v[104:107], v[16:31]
  ds_read_b64_tr_b16 v[96:97], v5 offset:30720
  ds_read_b64_tr_b16 v[98:99], v5 offset:31232
  ds_read_b64_tr_b16 v[100:101], v6 offset:30720
  ds_read_b64_tr_b16 v[102:103], v6 offset:31232
  v_mfma_f32_32x32x16_bf16 v[32:47], v[160:163], v[108:111], v[32:47]
  s_waitcnt lgkmcnt(8)
  v_mfma_f32_32x32x16_bf16 v[16:31], v[164:167], v[80:83], v[16:31]
  ds_read_b64_tr_b16 v[104:105], v13 offset:0
  ds_read_b64_tr_b16 v[106:107], v13 offset:512
  ds_read_b64_tr_b16 v[108:109], v8 offset:0
  ds_read_b64_tr_b16 v[110:111], v8 offset:512
  v_mfma_f32_32x32x16_bf16 v[32:47], v[164:167], v[84:87], v[32:47]
  s_waitcnt lgkmcnt(8)
  v_mfma_f32_32x32x16_bf16 v[16:31], v[168:171], v[88:91], v[16:31]
  v_mfma_f32_32x32x16_bf16 v[32:47], v[168:171], v[92:95], v[32:47]
  s_waitcnt lgkmcnt(4)
  v_mfma_f32_32x32x16_bf16 v[16:31], v[172:175], v[96:99], v[16:31]
  v_mfma_f32_32x32x16_bf16 v[32:47], v[172:175], v[100:103], v[32:47]
  s_waitcnt lgkmcnt(0)
  v_mfma_f32_32x32x16_bf16 v[16:31], v[176:179], v[104:107], v[16:31]
  v_mfma_f32_32x32x16_bf16 v[32:47], v[176:179], v[108:111], v[32:47]
  v_mov_b32 v14, 130060
  s_mov_b32 s80, 3200000
L_zw2:
  ds_read_b32 v15, v14
  s_waitcnt lgkmcnt(0)
  v_readfirstlane_b32 s81, v15
  s_sub_u32 s80, s80, 1
  s_cmp_ge_u32 s81, 3
  s_cbranch_scc1 L_zw2_d
  s_cmp_eq_u32 s80, 0
  s_cbranch_scc1 L_zw2_d
  s_sleep 1
  s_branch L_zw2
L_zw2_d:
  ds_read_b64_tr_b16 v[80:81], v13 offset:4096
  ds_read_b64_tr_b16 v[82:83], v13 offset:4608
  ds_read_b64_tr_b16 v[84:85], v8 offset:4096
  ds_read_b64_tr_b16 v[86:87], v8 offset:4608
  ds_read_b64_tr_b16 v[88:89], v13 offset:6144
  ds_read_b64_tr_b16 v[90:91], v13 offset:6656
  ds_read_b64_tr_b16 v[92:93], v8 offset:6144
  ds_read_b64_tr_b16 v[94:95], v8 offset:6656
  ds_read_b64_tr_b16 v[96:97], v13 offset:8192
  ds_read_b64_tr_b16 v[98:99], v13 offset:8704
  ds_read_b64_tr_b16 v[100:101], v8 offset:8192
  ds_read_b64_tr_b16 v[102:103], v8 offset:8704
  s_waitcnt lgkmcnt(8)
  v_mfma_f32_32x32x16_bf16 v[48:63], v[184:187], v[80:83], 0
  ds_read_b64_tr_b16 v[104:105], v13 offset:10240
  ds_read_b64_tr_b16 v[106:107], v13 offset:10752
  ds_read_b64_tr_b16 v[108:109], v8 offset:10240
  ds_read_b64_tr_b16 v[110:111], v8 offset:10752
  v_mfma_f32_32x32x16_bf16 v[64:79], v[184:187], v[84:87], 0
  s_waitcnt lgkmcnt(8)
  v_mfma_f32_32x32x16_bf16 v[48:63], v[188:191], v[88:91], v[48:63]
  ds_read_b64_tr_b16 v[80:81], v13 offset:12288
  ds_read_b64_tr_b16 v[82:83], v13 offset:12800
  ds_read_b64_tr_b16 v[84:85], v8 offset:12288
  ds_read_b64_tr_b16 v[86:87], v8 offset:12800
  v_mfma_f32_32x32x16_bf16 v[64:79], v[188:191], v[92:95], v[64:79]
  s_waitcnt lgkmcnt(8)
  v_mfma_f32_32x32x16_bf16 v[48:63], v[192:195], v[96:99], v[48:63]
  ds_read_b64_tr_b16 v[88:89], v13 offset:14336
  ds_read_b64_tr_b16 v[90:91], v13 offset:14848
  ds_read_b64_tr_b16 v[92:93], v8 offset:14336
  ds_read_b64_tr_b16 v[94:95], v8 offset:14848
  v_mfma_f32_32x32x16_bf16 v[64:79], v[192:195], v[100:103], v[64:79]
  s_waitcnt lgkmcnt(8)
  v_mfma_f32_32x32x16_bf16 v[48:63], v[196:199], v[104:107], v[48:63]
  ds_read_b64_tr_b16 v[96:97], v13 offset:16384
  ds_read_b64_tr_b16 v[98:99], v13 offset:16896
  ds_read_b64_tr_b16 v[100:101], v8 offset:16384
  ds_read_b64_tr_b16 v[102:103], v8 offset:16896
  v_mfma_f32_32x32x16_bf16 v[64:79], v[196:199], v[108:111], v[64:79]
  s_waitcnt lgkmcnt(8)
  v_mfma_f32_32x32x16_bf16 v[48:63], v[200:203], v[80:83], v[48:63]
  ds_read_b64_tr_b16 v[104:105], v13 offset:18432
  ds_read_b64_tr_b16 v[106:107], v13 offset:18944
  ds_read_b64_tr_b16 v[108:109], v8 offset:18432
  ds_read_b64_tr_b16 v[110:111], v8 offset:18944
  v_mfma_f32_32x32x16_bf16 v[64:79], v[200:203], v[84:87], v[64:79]
  s_waitcnt lgkmcnt(8)
  v_mfma_f32_32x32x16_bf16 v[48:63], v[204:207], v[88:91], v[48:63]
  v_mfma_f32_32x32x16_bf16 v[64:79], v[204:207], v[92:95], v[64:79]
  s_waitcnt lgkmcnt(4)
  v_mfma_f32_32x32x16_bf16 v[48:63], v[208:211], v[96:99], v[48:63]
  v_mfma_f32_32x32x16_bf16 v[64:79], v[208:211], v[100:103], v[64:79]
  s_waitcnt lgkmcnt(0)
  v_mfma_f32_32x32x16_bf16 v[48:63], v[212:215], v[104:107], v[48:63]
  v_mfma_f32_32x32x16_bf16 v[64:79], v[212:215], v[108:111], v[64:79]
  v_mov_b32 v14, 130060
  s_mov_b32 s80, 3200000
L_zw3:
  ds_read_b32 v15, v14
  s_waitcnt lgkmcnt(0)
  v_readfirstlane_b32 s81, v15
  s_sub_u32 s80, s80, 1
  s_cmp_ge_u32 s81, 4
  s_cbranch_scc1 L_zw3_d
  s_cmp_eq_u32 s80, 0
  s_cbranch_scc1 L_zw3_d
  s_sleep 1
  s_branch L_zw3
L_zw3_d:
  ds_read_b64_tr_b16 v[80:81], v13 offset:22528
  ds_read_b64_tr_b16 v[82:83], v13 offset:23040
  ds_read_b64_tr_b16 v[84:85], v8 offset:22528
  ds_read_b64_tr_b16 v[86:87], v8 offset:23040
  ds_read_b64_tr_b16 v[88:89], v13 offset:24576
  ds_read_b64_tr_b16 v[90:91], v13 offset:25088
  ds_read_b64_tr_b16 v[92:93], v8 offset:24576
  ds_read_b64_tr_b16 v[94:95], v8 offset:25088
  ds_read_b64_tr_b16 v[96:97], v13 offset:26624
  ds_read_b64_tr_b16 v[98:99], v13 offset:27136
  ds_read_b64_tr_b16 v[100:101], v8 offset:26624
  ds_read_b64_tr_b16 v[102:103], v8 offset:27136
  s_waitcnt lgkmcnt(8)
  v_mfma_f32_32x32x16_bf16 v[48:63], v[220:223], v[80:83], v[48:63]
  ds_read_b64_tr_b16 v[104:105], v13 offset:28672
  ds_read_b64_tr_b16 v[106:107], v13 offset:29184
  ds_read_b64_tr_b16 v[108:109], v8 offset:28672
  ds_read_b64_tr_b16 v[110:111], v8 offset:29184
  v_mfma_f32_32x32x16_bf16 v[64:79], v[220:223], v[84:87], v[64:79]
  s_waitcnt lgkmcnt(8)
  v_mfma_f32_32x32x16_bf16 v[48:63], v[224:227], v[88:91], v[48:63]
  ds_read_b64_tr_b16 v[80:81], v13 offset:30720
  ds_read_b64_tr_b16 v[82:83], v13 offset:31232
  ds_read_b64_tr_b16 v[84:85], v8 offset:30720
  ds_read_b64_tr_b16 v[86:87], v8 offset:31232
  v_mfma_f32_32x32x16_bf16 v[64:79], v[224:227], v[92:95], v[64:79]
  s_waitcnt lgkmcnt(8)
  v_mfma_f32_32x32x16_bf16 v[48:63], v[228:231], v[96:99], v[48:63]
  ds_read_b64_tr_b16 v[88:89], v13 offset:32768
  ds_read_b64_tr_b16 v[90:91], v13 offset:33280
  ds_read_b64_tr_b16 v[92:93], v8 offset:32768
  ds_read_b64_tr_b16 v[94:95], v8 offset:33280
  v_mfma_f32_32x32x16_bf16 v[64:79], v[228:231], v[100:103], v[64:79]
  s_waitcnt lgkmcnt(8)
  v_mfma_f32_32x32x16_bf16 v[48:63], v[232:235], v[104:107], v[48:63]
  ds_read_b64_tr_b16 v[96:97], v13 offset:34816
  ds_read_b64_tr_b16 v[98:99], v13 offset:35328
  ds_read_b64_tr_b16 v[100:101], v8 offset:34816
  ds_read_b64_tr_b16 v[102:103], v8 offset:35328
  v_mfma_f32_32x32x16_bf16 v[64:79], v[232:235], v[108:111], v[64:79]
  s_waitcnt lgkmcnt(8)
  v_mfma_f32_32x32x16_bf16 v[48:63], v[236:239], v[80:83], v[48:63]
  ds_read_b64_tr_b16 v[104:105], v13 offset:36864
  ds_read_b64_tr_b16 v[106:107], v13 offset:37376
  ds_read_b64_tr_b16 v[108:109], v8 offset:36864
  ds_read_b64_tr_b16 v[110:111], v8 offset:37376
  v_mfma_f32_32x32x16_bf16 v[64:79], v[236:239], v[84:87], v[64:79]
  s_waitcnt lgkmcnt(8)
  v_mfma_f32_32x32x16_bf16 v[48:63], v[240:243], v[88:91], v[48:63]
  v_mfma_f32_32x32x16_bf16 v[64:79], v[240:243], v[92:95], v[64:79]
  s_waitcnt lgkmcnt(4)
  v_mfma_f32_32x32x16_bf16 v[48:63], v[244:247], v[96:99], v[48:63]
  v_mfma_f32_32x32x16_bf16 v[64:79], v[244:247], v[100:103], v[64:79]
  s_waitcnt lgkmcnt(0)
  v_mfma_f32_32x32x16_bf16 v[48:63], v[248:251], v[104:107], v[48:63]
  v_mfma_f32_32x32x16_bf16 v[64:79], v[248:251], v[108:111], v[64:79]
  v_mov_b32 v14, 130060
  s_mov_b32 s80, 3200000
L_zw4:
  ds_read_b32 v15, v14
  s_waitcnt lgkmcnt(0)
  v_readfirstlane_b32 s81, v15
  s_sub_u32 s80, s80, 1
  s_cmp_ge_u32 s81, 5
  s_cbranch_scc1 L_zw4_d
  s_cmp_eq_u32 s80, 0
  s_cbranch_scc1 L_zw4_d
  s_sleep 1
  s_branch L_zw4
L_zw4_d:
  ds_read_b64_tr_b16 v[80:81], v5 offset:16384
  ds_read_b64_tr_b16 v[82:83], v5 offset:16896
  ds_read_b64_tr_b16 v[84:85], v6 offset:16384
  ds_read_b64_tr_b16 v[86:87], v6 offset:16896
  ds_read_b64_tr_b16 v[88:89], v13 offset:2048
  ds_read_b64_tr_b16 v[90:91], v13 offset:2560
  ds_read_b64_tr_b16 v[92:93], v8 offset:2048
  ds_read_b64_tr_b16 v[94:95], v8 offset:2560
  ds_read_b64_tr_b16 v[96:97], v13 offset:20480
  ds_read_b64_tr_b16 v[98:99], v13 offset:20992
  ds_read_b64_tr_b16 v[100:101], v8 offset:20480
  ds_read_b64_tr_b16 v[102:103], v8 offset:20992
  s_waitcnt lgkmcnt(8)
  v_mfma_f32_32x32x16_bf16 v[16:31], v[144:147], v[80:83], v[16:31]
  ds_read_b64_tr_b16 v[104:105], v13 offset:38912
  ds_read_b64_tr_b16 v[106:107], v13 offset:39424
  ds_read_b64_tr_b16 v[108:109], v8 offset:38912
  ds_read_b64_tr_b16 v[110:111], v8 offset:39424
  v_mfma_f32_32x32x16_bf16 v[32:47], v[144:147], v[84:87], v[32:47]
  s_waitcnt lgkmcnt(8)
  v_mfma_f32_32x32x16_bf16 v[16:31], v[180:183], v[88:91], v[16:31]
  v_mfma_f32_32x32x16_bf16 v[32:47], v[180:183], v[92:95], v[32:47]
  s_waitcnt lgkmcnt(4)
  v_mfma_f32_32x32x16_bf16 v[48:63], v[216:219], v[96:99], v[48:63]
  v_mfma_f32_32x32x16_bf16 v[64:79], v[216:219], v[100:103], v[64:79]
  s_waitcnt lgkmcnt(0)
  v_mfma_f32_32x32x16_bf16 v[48:63], v[252:255], v[104:107], v[48:63]
  v_mfma_f32_32x32x16_bf16 v[64:79], v[252:255], v[108:111], v[64:79]
  s_nop 10
  v_pk_add_f32 v[112:113], v[16:17], v[48:49]
  v_pk_add_f32 v[114:115], v[18:19], v[50:51]
  v_pk_add_f32 v[116:117], v[20:21], v[52:53]
  v_pk_add_f32 v[118:119], v[22:23], v[54:55]
  v_pk_add_f32 v[120:121], v[24:25], v[56:57]
  v_pk_add_f32 v[122:123], v[26:27], v[58:59]
  v_pk_add_f32 v[124:125], v[28:29], v[60:61]
  v_pk_add_f32 v[126:127], v[30:31], v[62:63]
  v_pk_add_f32 v[128:129], v[16:17], v[48:49] neg_lo:[0,1] neg_hi:[0,1]
  v_pk_add_f32 v[130:131], v[18:19], v[50:51] neg_lo:[0,1] neg_hi:[0,1]
  v_pk_add_f32 v[132:133], v[20:21], v[52:53] neg_lo:[0,1] neg_hi:[0,1]
  v_pk_add_f32 v[134:135], v[22:23], v[54:55] neg_lo:[0,1] neg_hi:[0,1]
  v_pk_add_f32 v[136:137], v[24:25], v[56:57] neg_lo:[0,1] neg_hi:[0,1]
  v_pk_add_f32 v[138:139], v[26:27], v[58:59] neg_lo:[0,1] neg_hi:[0,1]
  v_pk_add_f32 v[140:141], v[28:29], v[60:61] neg_lo:[0,1] neg_hi:[0,1]
  v_pk_add_f32 v[142:143], v[30:31], v[62:63] neg_lo:[0,1] neg_hi:[0,1]
  v_cvt_pk_bf16_f32 v144, v112, v113
  v_cvt_pk_bf16_f32 v145, v114, v115
  v_cvt_pk_bf16_f32 v146, v116, v117
  v_cvt_pk_bf16_f32 v147, v118, v119
  v_cvt_pk_bf16_f32 v148, v120, v121
  v_cvt_pk_bf16_f32 v149, v122, v123
  v_cvt_pk_bf16_f32 v150, v124, v125
  v_cvt_pk_bf16_f32 v151, v126, v127
  s_add_u32 s67, s78, 0
  buffer_store_dwordx4 v[144:147], v7, s[16:19], s67 offen offset:0 sc1
  buffer_store_dwordx4 v[148:151], v7, s[16:19], s67 offen offset:1024 sc1
  v_cvt_pk_bf16_f32 v152, v128, v129
  v_cvt_pk_bf16_f32 v153, v130, v131
  v_cvt_pk_bf16_f32 v154, v132, v133
  v_cvt_pk_bf16_f32 v155, v134, v135
  v_cvt_pk_bf16_f32 v156, v136, v137
  v_cvt_pk_bf16_f32 v157, v138, v139
  v_cvt_pk_bf16_f32 v158, v140, v141
  v_cvt_pk_bf16_f32 v159, v142, v143
  s_add_u32 s67, s78, 18432
  buffer_store_dwordx4 v[152:155], v7, s[16:19], s67 offen offset:0 sc1
  buffer_store_dwordx4 v[156:159], v7, s[16:19], s67 offen offset:1024 sc1
  v_pk_add_f32 v[112:113], v[32:33], v[64:65]
  v_pk_add_f32 v[114:115], v[34:35], v[66:67]
  v_pk_add_f32 v[116:117], v[36:37], v[68:69]
  v_pk_add_f32 v[118:119], v[38:39], v[70:71]
  v_pk_add_f32 v[120:121], v[40:41], v[72:73]
  v_pk_add_f32 v[122:123], v[42:43], v[74:75]
  v_pk_add_f32 v[124:125], v[44:45], v[76:77]
  v_pk_add_f32 v[126:127], v[46:47], v[78:79]
  v_pk_add_f32 v[128:129], v[32:33], v[64:65] neg_lo:[0,1] neg_hi:[0,1]
  v_pk_add_f32 v[130:131], v[34:35], v[66:67] neg_lo:[0,1] neg_hi:[0,1]
  v_pk_add_f32 v[132:133], v[36:37], v[68:69] neg_lo:[0,1] neg_hi:[0,1]
  v_pk_add_f32 v[134:135], v[38:39], v[70:71] neg_lo:[0,1] neg_hi:[0,1]
  v_pk_add_f32 v[136:137], v[40:41], v[72:73] neg_lo:[0,1] neg_hi:[0,1]
  v_pk_add_f32 v[138:139], v[42:43], v[74:75] neg_lo:[0,1] neg_hi:[0,1]
  v_pk_add_f32 v[140:141], v[44:45], v[76:77] neg_lo:[0,1] neg_hi:[0,1]
  v_pk_add_f32 v[142:143], v[46:47], v[78:79] neg_lo:[0,1] neg_hi:[0,1]
  v_cvt_pk_bf16_f32 v160, v112, v113
  v_cvt_pk_bf16_f32 v161, v114, v115
  v_cvt_pk_bf16_f32 v162, v116, v117
  v_cvt_pk_bf16_f32 v163, v118, v119
  v_cvt_pk_bf16_f32 v164, v120, v121
  v_cvt_pk_bf16_f32 v165, v122, v123
  v_cvt_pk_bf16_f32 v166, v124, v125
  v_cvt_pk_bf16_f32 v167, v126, v127
  s_add_u32 s67, s78, 36992
  buffer_store_dwordx4 v[160:163], v7, s[16:19], s67 offen offset:0 sc1
  buffer_store_dwordx4 v[164:167], v7, s[16:19], s67 offen offset:1024 sc1
  v_cvt_pk_bf16_f32 v168, v128, v129
  v_cvt_pk_bf16_f32 v169, v130, v131
  v_cvt_pk_bf16_f32 v170, v132, v133
  v_cvt_pk_bf16_f32 v171, v134, v135
  v_cvt_pk_bf16_f32 v172, v136, v137
  v_cvt_pk_bf16_f32 v173, v138, v139
  v_cvt_pk_bf16_f32 v174, v140, v141
  v_cvt_pk_bf16_f32 v175, v142, v143
  s_add_u32 s67, s78, 55424
  buffer_store_dwordx4 v[168:171], v7, s[16:19], s67 offen offset:0 sc1
  buffer_store_dwordx4 v[172:175], v7, s[16:19], s67 offen offset:1024 sc1
  s_branch L_idone
L_iseg:
  s_mov_b32 s8, s48
  s_and_b32 s9, s49, 0xffff
  s_mov_b32 s10, 5308416
  s_mov_b32 s11, 0x00020000
  s_bfe_u32 s66, s61, 0x20003
  s_lshl_b32 s66, s66, 4
  s_lshr_b32 s67, s61, 5
  s_lshl_b32 s67, s67, 3
  s_add_u32 s66, s66, s67
  s_and_b32 s67, s61, 7
  s_add_u32 s66, s66, s67
  s_mul_i32 s66, s66, 82944
  s_sub_u32 s67, s60, 5
  s_mul_i32 s67, s67, 41472
  s_add_u32 s66, s66, s67
  v_min_u32 v8, 53, v1
  v_lshlrev_b32 v8, 7, v8
  buffer_load_dword v40, v8, s[8:11], s66 offen
  s_add_u32 s66, s66, 6912
  s_branch L_pj20
  .p2align 12
L_stub20:
  s_setpc_b64 s[58:59]
  s_nop 0
L_pj20:
  buffer_load_dword v41, v8, s[8:11], s66 offen
  s_add_u32 s66, s66, 6912
  buffer_load_dword v42, v8, s[8:11], s66 offen
  s_add_u32 s66, s66, 6912
  buffer_load_dword v43, v8, s[8:11], s66 offen
  s_add_u32 s66, s66, 6912
  buffer_load_dword v44, v8, s[8:11], s66 offen
  s_add_u32 s66, s66, 6912
  buffer_load_dword v45, v8, s[8:11], s66 offen
  s_add_u32 s66, s66, 6912
  s_waitcnt vmcnt(0)
  s_setprio 3
  s_lshl_b32 s66, s63, 6
  v_xor_b32 v5, s66, v5
  s_mul_i32 s66, s77, 36864
  v_add_u32 v5, s66, v5
  v_mov_b32 v14, 130060
  s_mov_b32 s80, 3200000
L_zs0:
  ds_read_b32 v15, v14
  s_waitcnt lgkmcnt(0)
  v_readfirstlane_b32 s81, v15
  s_sub_u32 s80, s80, 1
  s_cmp_ge_u32 s81, 4
  s_cbranch_scc1 L_zs0_d
  s_cmp_eq_u32 s80, 0
  s_cbranch_scc1 L_zs0_d
  s_sleep 1
  s_branch L_zs0
L_zs0_d:
  ds_read_b64_tr_b16 v[32:33], v5 offset:0
  ds_read_b64_tr_b16 v[34:35], v5 offset:512
  ds_read_b64_tr_b16 v[36:37], v5 offset:2048
  ds_read_b64_tr_b16 v[38:39], v5 offset:2560
  ds_read_b64_tr_b16 v[40:41], v5 offset:4096
  ds_read_b64_tr_b16 v[42:43], v5 offset:4608
  ds_read_b64_tr_b16 v[44:45], v5 offset:6144
  ds_read_b64_tr_b16 v[46:47], v5 offset:6656
  ds_read_b64_tr_b16 v[48:49], v5 offset:8192
  ds_read_b64_tr_b16 v[50:51], v5 offset:8704
  ds_read_b64_tr_b16 v[52:53], v5 offset:10240
  ds_read_b64_tr_b16 v[54:55], v5 offset:10752
  ds_read_b64_tr_b16 v[56:57], v5 offset:12288
  ds_read_b64_tr_b16 v[58:59], v5 offset:12800
  ds_read_b64_tr_b16 v[60:61], v5 offset:14336
  ds_read_b64_tr_b16 v[62:63], v5 offset:14848
  ds_read_b64_tr_b16 v[64:65], v5 offset:18432
  ds_read_b64_tr_b16 v[66:67], v5 offset:18944
  ds_read_b64_tr_b16 v[68:69], v5 offset:20480
  ds_read_b64_tr_b16 v[70:71], v5 offset:20992
  ds_read_b64_tr_b16 v[72:73], v5 offset:22528
  ds_read_b64_tr_b16 v[74:75], v5 offset:23040
  ds_read_b64_tr_b16 v[76:77], v5 offset:24576
  ds_read_b64_tr_b16 v[78:79], v5 offset:25088
  ds_read_b64_tr_b16 v[80:81], v5 offset:26624
  ds_read_b64_tr_b16 v[82:83], v5 offset:27136
  ds_read_b64_tr_b16 v[84:85], v5 offset:28672
  ds_read_b64_tr_b16 v[86:87], v5 offset:29184
  ds_read_b64_tr_b16 v[88:89], v5 offset:30720
  ds_read_b64_tr_b16 v[90:91], v5 offset:31232
  ds_read_b64_tr_b16 v[92:93], v5 offset:32768
  ds_read_b64_tr_b16 v[94:95], v5 offset:33280
  s_waitcnt lgkmcnt(15)
  v_mfma_f32_32x32x16_bf16 v[16:31], v[112:115], v[32:35], 0
  v_mfma_f32_32x32x16_bf16 v[16:31], v[116:119], v[36:39], v[16:31]
  v_mfma_f32_32x32x16_bf16 v[16:31], v[120:123], v[40:43], v[16:31]
  v_mfma_f32_32x32x16_bf16 v[16:31], v[124:127], v[44:47], v[16:31]
  v_mfma_f32_32x32x16_bf16 v[16:31], v[128:131], v[48:51], v[16:31]
  v_mfma_f32_32x32x16_bf16 v[16:31], v[132:135], v[52:55], v[16:31]
  v_mfma_f32_32x32x16_bf16 v[16:31], v[136:139], v[56:59], v[16:31]
  v_mfma_f32_32x32x16_bf16 v[16:31], v[140:143], v[60:63], v[16:31]
  s_waitcnt lgkmcnt(14)
  v_mfma_f32_32x32x16_bf16 v[16:31], v[148:151], v[64:67], v[16:31]
  s_waitcnt lgkmcnt(12)
  v_mfma_f32_32x32x16_bf16 v[16:31], v[152:155], v[68:71], v[16:31]
  s_waitcnt lgkmcnt(10)
  v_mfma_f32_32x32x16_bf16 v[16:31], v[156:159], v[72:75], v[16:31]
  s_waitcnt lgkmcnt(8)
  v_mfma_f32_32x32x16_bf16 v[16:31], v[160:163], v[76:79], v[16:31]
  s_waitcnt lgkmcnt(6)
  v_mfma_f32_32x32x16_bf16 v[16:31], v[164:167], v[80:83], v[16:31]
  s_waitcnt lgkmcnt(4)
  v_mfma_f32_32x32x16_bf16 v[16:31], v[168:171], v[84:87], v[16:31]
  s_waitcnt lgkmcnt(2)
  v_mfma_f32_32x32x16_bf16 v[16:31], v[172:175], v[88:91], v[16:31]
  s_waitcnt lgkmcnt(0)
  v_mfma_f32_32x32x16_bf16 v[16:31], v[176:179], v[92:95], v[16:31]
  v_mov_b32 v14, 130060
  s_mov_b32 s80, 3200000
L_zs1:
  ds_read_b32 v15, v14
  s_waitcnt lgkmcnt(0)
  v_readfirstlane_b32 s81, v15
  s_sub_u32 s80, s80, 1
  s_cmp_ge_u32 s81, 5
  s_cbranch_scc1 L_zs1_d
  s_cmp_eq_u32 s80, 0
  s_cbranch_scc1 L_zs1_d
  s_sleep 1
  s_branch L_zs1
L_zs1_d:
  ds_read_b64_tr_b16 v[32:33], v5 offset:16384
  ds_read_b64_tr_b16 v[34:35], v5 offset:16896
  ds_read_b64_tr_b16 v[36:37], v5 offset:34816
  ds_read_b64_tr_b16 v[38:39], v5 offset:35328
  s_waitcnt lgkmcnt(2)
  v_mfma_f32_32x32x16_bf16 v[16:31], v[144:147], v[32:35], v[16:31]
  s_waitcnt lgkmcnt(0)
  v_mfma_f32_32x32x16_bf16 v[16:31], v[180:183], v[36:39], v[16:31]
  s_lshl_b32 s66, s77, 12
  s_add_u32 s67, s66, 73728
  v_add_u32 v8, s67, v7
  v_xor_b32 v9, 0x1000, v8
  s_nop 7
  ds_write_b128 v8, v[16:19] offset:0
  ds_write_b128 v8, v[20:23] offset:1024
  ds_write_b128 v8, v[24:27] offset:2048
  ds_write_b128 v8, v[28:31] offset:3072
  s_waitcnt lgkmcnt(0)
  v_mov_b32 v14, 130064
  v_mov_b32 v15, 1
  s_mov_b64 exec, 1
  ds_add_u32 v14, v15
  s_mov_b64 exec, -1
  v_mov_b32 v14, 130064
  s_mov_b32 s80, 3200000
L_t4:
  ds_read_b32 v15, v14
  s_waitcnt lgkmcnt(0)
  v_readfirstlane_b32 s81, v15
  s_sub_u32 s80, s80, 1
  s_cmp_ge_u32 s81, 2
  s_cbranch_scc1 L_t4_d
  s_cmp_eq_u32 s80, 0
  s_cbranch_scc1 L_t4_d
  s_sleep 1
  s_branch L_t4
L_t4_d:
  ds_read_b128 v[32:35], v9 offset:0
  ds_read_b128 v[36:39], v9 offset:1024
  ds_read_b128 v[40:43], v9 offset:2048
  ds_read_b128 v[44:47], v9 offset:3072
  s_cmp_eq_u32 s77, 0
  s_cselect_b32 s68, 1.0, -1.0
  s_cselect_b32 s69, 0, 18432
  s_mul_i32 s66, s63, 36992
  s_add_u32 s69, s69, s66
  s_add_u32 s69, s69, s78
  s_waitcnt lgkmcnt(0)
  v_fma_f32 v32, v16, s68, v32
  v_fma_f32 v33, v17, s68, v33
  v_fma_f32 v34, v18, s68, v34
  v_fma_f32 v35, v19, s68, v35
  v_fma_f32 v36, v20, s68, v36
  v_fma_f32 v37, v21, s68, v37
  v_fma_f32 v38, v22, s68, v38
  v_fma_f32 v39, v23, s68, v39
  v_fma_f32 v40, v24, s68, v40
  v_fma_f32 v41, v25, s68, v41
  v_fma_f32 v42, v26, s68, v42
  v_fma_f32 v43, v27, s68, v43
  v_fma_f32 v44, v28, s68, v44
  v_fma_f32 v45, v29, s68, v45
  v_fma_f32 v46, v30, s68, v46
  v_fma_f32 v47, v31, s68, v47
  v_cvt_pk_bf16_f32 v64, v32, v33
  v_cvt_pk_bf16_f32 v65, v34, v35
  v_cvt_pk_bf16_f32 v66, v36, v37
  v_cvt_pk_bf16_f32 v67, v38, v39
  v_cvt_pk_bf16_f32 v68, v40, v41
  v_cvt_pk_bf16_f32 v69, v42, v43
  v_cvt_pk_bf16_f32 v70, v44, v45
  v_cvt_pk_bf16_f32 v71, v46, v47
  buffer_store_dwordx4 v[64:67], v7, s[16:19], s69 offen offset:0 sc1
  buffer_store_dwordx4 v[68:71], v7, s[16:19], s69 offen offset:1024 sc1
  s_setprio 0
  s_branch L_idone
L_zld:
  s_setprio 3
  v_lshrrev_b32 v8, 2, v1
  v_lshrrev_b32 v9, 4, v1
  v_xor_b32 v8, v8, v9
  v_and_b32 v8, 1, v8
  v_lshlrev_b32 v8, 6, v8
  v_and_b32 v9, 3, v1
  v_lshl_add_u32 v8, v9, 4, v8
  v_lshrrev_b32 v9, 3, v1
  v_mul_u32_u24 v9, 4224, v9
  v_add_u32 v4, v9, v8
  s_lshl_b32 s68, s62, 7
  s_add_u32 s68, s68, 41943040
  v_mov_b32 v14, 130056
  s_mov_b32 s80, 3200000
L_zown:
  ds_read_b32 v15, v14
  s_waitcnt lgkmcnt(0)
  v_readfirstlane_b32 s81, v15
  s_sub_u32 s80, s80, 1
  s_cmp_ge_u32 s81, 4
  s_cbranch_scc1 L_zown_d
  s_cmp_eq_u32 s80, 0
  s_cbranch_scc1 L_zown_d
  s_sleep 1
  s_branch L_zown
L_zown_d:
  s_mov_b32 s80, 400000
  s_mov_b32 s81, 49807360
  v_lshlrev_b32 v15, 7, v1
  s_mov_b32 exec_lo, -1
  s_mov_b32 exec_hi, -1
L_p2c:
  buffer_load_dword v14, v15, s[16:19], s81 offen sc1
  s_waitcnt vmcnt(0)
  v_cmp_gt_u32 vcc, 3, v14
  s_sub_u32 s80, s80, 1
  s_cmp_eq_u64 vcc, 0
  s_cbranch_scc1 L_p2c_x
  s_mov_b64 exec, vcc
  s_cmp_lt_i32 s80, 1
  s_cbranch_scc1 L_p2c_x
  s_sleep 8
  s_branch L_p2c
L_p2c_x:
  s_mov_b64 exec, -1
  s_mov_b32 m0, 0
  s_add_u32 s66, s68, 0
  buffer_load_dwordx4 v4, s[16:19], s66 offen sc1 lds
  s_mov_b32 m0, 1024
  s_add_u32 s66, s68, 33792
  buffer_load_dwordx4 v4, s[16:19], s66 offen sc1 lds
  s_mov_b32 m0, 2048
  s_add_u32 s66, s68, 67584
  buffer_load_dwordx4 v4, s[16:19], s66 offen sc1 lds
  s_mov_b32 m0, 3072
  s_add_u32 s66, s68, 101376
  buffer_load_dwordx4 v4, s[16:19], s66 offen sc1 lds
  s_mov_b32 m0, 4096
  s_add_u32 s66, s68, 135168
  buffer_load_dwordx4 v4, s[16:19], s66 offen sc1 lds
  s_mov_b32 m0, 5120
  s_add_u32 s66, s68, 168960
  buffer_load_dwordx4 v4, s[16:19], s66 offen sc1 lds
  s_mov_b32 m0, 6144
  s_add_u32 s66, s68, 202752
  buffer_load_dwordx4 v4, s[16:19], s66 offen sc1 lds
  s_mov_b32 m0, 7168
  s_add_u32 s66, s68, 236544
  buffer_load_dwordx4 v4, s[16:19], s66 offen sc1 lds
  s_mov_b32 m0, 8192
  s_add_u32 s66, s68, 270336
  buffer_load_dwordx4 v4, s[16:19], s66 offen sc1 lds
  s_mov_b32 m0, 9216
  s_add_u32 s66, s68, 304128
  buffer_load_dwordx4 v4, s[16:19], s66 offen sc1 lds
  s_mov_b32 m0, 10240
  s_add_u32 s66, s68, 337920
  buffer_load_dwordx4 v4, s[16:19], s66 offen sc1 lds
  s_mov_b32 m0, 11264
  s_add_u32 s66, s68, 371712
  buffer_load_dwordx4 v4, s[16:19], s66 offen sc1 lds
  s_mov_b32 m0, 12288
  s_add_u32 s66, s68, 405504
  buffer_load_dwordx4 v4, s[16:19], s66 offen sc1 lds
  s_mov_b32 m0, 13312
  s_add_u32 s66, s68, 439296
  buffer_load_dwordx4 v4, s[16:19], s66 offen sc1 lds
  s_mov_b32 m0, 14336
  s_add_u32 s66, s68, 473088
  buffer_load_dwordx4 v4, s[16:19], s66 offen sc1 lds
  s_mov_b32 m0, 15360
  s_add_u32 s66, s68, 506880
  buffer_load_dwordx4 v4, s[16:19], s66 offen sc1 lds
  s_mov_b32 m0, 18432
  s_add_u32 s66, s68, 608256
  buffer_load_dwordx4 v4, s[16:19], s66 offen sc1 lds
  s_mov_b32 m0, 19456
  s_add_u32 s66, s68, 642048
  buffer_load_dwordx4 v4, s[16:19], s66 offen sc1 lds
  s_mov_b32 m0, 20480
  s_add_u32 s66, s68, 675840
  buffer_load_dwordx4 v4, s[16:19], s66 offen sc1 lds
  s_mov_b32 m0, 21504
  s_add_u32 s66, s68, 709632
  buffer_load_dwordx4 v4, s[16:19], s66 offen sc1 lds
  s_mov_b32 m0, 22528
  s_add_u32 s66, s68, 743424
  buffer_load_dwordx4 v4, s[16:19], s66 offen sc1 lds
  s_mov_b32 m0, 23552
  s_add_u32 s66, s68, 777216
  buffer_load_dwordx4 v4, s[16:19], s66 offen sc1 lds
  s_mov_b32 m0, 24576
  s_add_u32 s66, s68, 811008
  buffer_load_dwordx4 v4, s[16:19], s66 offen sc1 lds
  s_mov_b32 m0, 25600
  s_add_u32 s66, s68, 844800
  buffer_load_dwordx4 v4, s[16:19], s66 offen sc1 lds
  s_mov_b32 m0, 26624
  s_add_u32 s66, s68, 878592
  buffer_load_dwordx4 v4, s[16:19], s66 offen sc1 lds
  s_mov_b32 m0, 27648
  s_add_u32 s66, s68, 912384
  buffer_load_dwordx4 v4, s[16:19], s66 offen sc1 lds
  s_mov_b32 m0, 28672
  s_add_u32 s66, s68, 946176
  buffer_load_dwordx4 v4, s[16:19], s66 offen sc1 lds
  s_mov_b32 m0, 29696
  s_add_u32 s66, s68, 979968
  buffer_load_dwordx4 v4, s[16:19], s66 offen sc1 lds
  s_mov_b32 m0, 30720
  s_add_u32 s66, s68, 1013760
  buffer_load_dwordx4 v4, s[16:19], s66 offen sc1 lds
  s_mov_b32 m0, 31744
  s_add_u32 s66, s68, 1047552
  buffer_load_dwordx4 v4, s[16:19], s66 offen sc1 lds
  s_mov_b32 m0, 32768
  s_add_u32 s66, s68, 1081344
  buffer_load_dwordx4 v4, s[16:19], s66 offen sc1 lds
  s_mov_b32 m0, 33792
  s_add_u32 s66, s68, 1115136
  buffer_load_dwordx4 v4, s[16:19], s66 offen sc1 lds
  s_waitcnt vmcnt(16)
  v_mov_b32 v14, 130060
  v_mov_b32 v15, 1
  s_mov_b64 exec, 1
  ds_add_u32 v14, v15
  s_mov_b64 exec, -1
  s_mov_b32 m0, 36864
  s_add_u32 s66, s68, 1216512
  buffer_load_dwordx4 v4, s[16:19], s66 offen sc1 lds
  s_mov_b32 m0, 37888
  s_add_u32 s66, s68, 1250304
  buffer_load_dwordx4 v4, s[16:19], s66 offen sc1 lds
  s_mov_b32 m0, 38912
  s_add_u32 s66, s68, 1284096
  buffer_load_dwordx4 v4, s[16:19], s66 offen sc1 lds
  s_mov_b32 m0, 39936
  s_add_u32 s66, s68, 1317888
  buffer_load_dwordx4 v4, s[16:19], s66 offen sc1 lds
  s_mov_b32 m0, 40960
  s_add_u32 s66, s68, 1351680
  buffer_load_dwordx4 v4, s[16:19], s66 offen sc1 lds
  s_mov_b32 m0, 41984
  s_add_u32 s66, s68, 1385472
  buffer_load_dwordx4 v4, s[16:19], s66 offen sc1 lds
  s_mov_b32 m0, 43008
  s_add_u32 s66, s68, 1419264
  buffer_load_dwordx4 v4, s[16:19], s66 offen sc1 lds
  s_mov_b32 m0, 44032
  s_add_u32 s66, s68, 1453056
  buffer_load_dwordx4 v4, s[16:19], s66 offen sc1 lds
  s_mov_b32 m0, 45056
  s_add_u32 s66, s68, 1486848
  buffer_load_dwordx4 v4, s[16:19], s66 offen sc1 lds
  s_mov_b32 m0, 46080
  s_add_u32 s66, s68, 1520640
  buffer_load_dwordx4 v4, s[16:19], s66 offen sc1 lds
  s_mov_b32 m0, 47104
  s_add_u32 s66, s68, 1554432
  buffer_load_dwordx4 v4, s[16:19], s66 offen sc1 lds
  s_mov_b32 m0, 48128
  s_add_u32 s66, s68, 1588224
  buffer_load_dwordx4 v4, s[16:19], s66 offen sc1 lds
  s_mov_b32 m0, 49152
  s_add_u32 s66, s68, 1622016
  buffer_load_dwordx4 v4, s[16:19], s66 offen sc1 lds
  s_mov_b32 m0, 50176
  s_add_u32 s66, s68, 1655808
  buffer_load_dwordx4 v4, s[16:19], s66 offen sc1 lds
  s_mov_b32 m0, 51200
  s_add_u32 s66, s68, 1689600
  buffer_load_dwordx4 v4, s[16:19], s66 offen sc1 lds
  s_mov_b32 m0, 52224
  s_add_u32 s66, s68, 1723392
  buffer_load_dwordx4 v4, s[16:19], s66 offen sc1 lds
  s_waitcnt vmcnt(16)
  v_mov_b32 v14, 130060
  v_mov_b32 v15, 1
  s_mov_b64 exec, 1
  ds_add_u32 v14, v15
  s_mov_b64 exec, -1
  s_mov_b32 m0, 55296
  s_add_u32 s66, s68, 1824768
  buffer_load_dwordx4 v4, s[16:19], s66 offen sc1 lds
  s_mov_b32 m0, 56320
  s_add_u32 s66, s68, 1858560
  buffer_load_dwordx4 v4, s[16:19], s66 offen sc1 lds
  s_mov_b32 m0, 57344
  s_add_u32 s66, s68, 1892352
  buffer_load_dwordx4 v4, s[16:19], s66 offen sc1 lds
  s_mov_b32 m0, 58368
  s_add_u32 s66, s68, 1926144
  buffer_load_dwordx4 v4, s[16:19], s66 offen sc1 lds
  s_mov_b32 m0, 59392
  s_add_u32 s66, s68, 1959936
  buffer_load_dwordx4 v4, s[16:19], s66 offen sc1 lds
  s_mov_b32 m0, 60416
  s_add_u32 s66, s68, 1993728
  buffer_load_dwordx4 v4, s[16:19], s66 offen sc1 lds
  s_mov_b32 m0, 61440
  s_add_u32 s66, s68, 2027520
  buffer_load_dwordx4 v4, s[16:19], s66 offen sc1 lds
  s_mov_b32 m0, 62464
  s_add_u32 s66, s68, 2061312
  buffer_load_dwordx4 v4, s[16:19], s66 offen sc1 lds
  s_mov_b32 m0, 63488
  s_add_u32 s66, s68, 2095104
  buffer_load_dwordx4 v4, s[16:19], s66 offen sc1 lds
  s_mov_b32 m0, 64512
  s_add_u32 s66, s68, 2128896
  buffer_load_dwordx4 v4, s[16:19], s66 offen sc1 lds
  s_mov_b32 m0, 65536
  s_add_u32 s66, s68, 2162688
  buffer_load_dwordx4 v4, s[16:19], s66 offen sc1 lds
  s_mov_b32 m0, 66560
  s_add_u32 s66, s68, 2196480
  buffer_load_dwordx4 v4, s[16:19], s66 offen sc1 lds
  s_mov_b32 m0, 67584
  s_add_u32 s66, s68, 2230272
  buffer_load_dwordx4 v4, s[16:19], s66 offen sc1 lds
  s_mov_b32 m0, 68608
  s_add_u32 s66, s68, 2264064
  buffer_load_dwordx4 v4, s[16:19], s66 offen sc1 lds
  s_mov_b32 m0, 69632
  s_add_u32 s66, s68, 2297856
  buffer_load_dwordx4 v4, s[16:19], s66 offen sc1 lds
  s_mov_b32 m0, 70656
  s_add_u32 s66, s68, 2331648
  buffer_load_dwordx4 v4, s[16:19], s66 offen sc1 lds
  s_waitcnt vmcnt(16)
  v_mov_b32 v14, 130060
  v_mov_b32 v15, 1
  s_mov_b64 exec, 1
  ds_add_u32 v14, v15
  s_mov_b64 exec, -1
  s_waitcnt vmcnt(0)
  v_mov_b32 v14, 130060
  v_mov_b32 v15, 1
  s_mov_b64 exec, 1
  ds_add_u32 v14, v15
  s_mov_b64 exec, -1
  s_mov_b32 s80, 400000
  s_mov_b32 s81, 49815552
  v_lshlrev_b32 v15, 7, v1
  s_xor_b32 s82, s61, 32
  s_and_b32 s82, s82, 62
  s_lshl_b64 exec, 1, s82
L_p3r:
  buffer_load_dword v14, v15, s[16:19], s81 offen sc1
  s_waitcnt vmcnt(0)
  v_cmp_gt_u32 vcc, 1, v14
  s_sub_u32 s80, s80, 1
  s_cmp_eq_u64 vcc, 0
  s_cbranch_scc1 L_p3r_x
  s_mov_b64 exec, vcc
  s_cmp_lt_i32 s80, 1
  s_cbranch_scc1 L_p3r_x
  s_sleep 8
  s_branch L_p3r
L_p3r_x:
  s_mov_b32 exec_lo, 0x55555555
  s_mov_b32 exec_hi, 0x55555555
L_p3c:
  buffer_load_dword v14, v15, s[16:19], s81 offen sc1
  s_waitcnt vmcnt(0)
  v_cmp_gt_u32 vcc, 1, v14
  s_sub_u32 s80, s80, 1
  s_cmp_eq_u64 vcc, 0
  s_cbranch_scc1 L_p3c_x
  s_mov_b64 exec, vcc
  s_cmp_lt_i32 s80, 1
  s_cbranch_scc1 L_p3c_x
  s_sleep 8
  s_branch L_p3c
L_p3c_x:
  s_mov_b64 exec, -1
  s_mov_b32 m0, 16384
  s_add_u32 s66, s68, 540672
  buffer_load_dwordx4 v4, s[16:19], s66 offen sc1 lds
  s_mov_b32 m0, 17408
  s_add_u32 s66, s68, 574464
  buffer_load_dwordx4 v4, s[16:19], s66 offen sc1 lds
  s_mov_b32 m0, 34816
  s_add_u32 s66, s68, 1148928
  buffer_load_dwordx4 v4, s[16:19], s66 offen sc1 lds
  s_mov_b32 m0, 35840
  s_add_u32 s66, s68, 1182720
  buffer_load_dwordx4 v4, s[16:19], s66 offen sc1 lds
  s_mov_b32 m0, 53248
  s_add_u32 s66, s68, 1757184
  buffer_load_dwordx4 v4, s[16:19], s66 offen sc1 lds
  s_mov_b32 m0, 54272
  s_add_u32 s66, s68, 1790976
  buffer_load_dwordx4 v4, s[16:19], s66 offen sc1 lds
  s_mov_b32 m0, 71680
  s_add_u32 s66, s68, 2365440
  buffer_load_dwordx4 v4, s[16:19], s66 offen sc1 lds
  s_mov_b32 m0, 72704
  s_add_u32 s66, s68, 2399232
  buffer_load_dwordx4 v4, s[16:19], s66 offen sc1 lds
  s_waitcnt vmcnt(0)
  v_mov_b32 v14, 130060
  v_mov_b32 v15, 1
  s_mov_b64 exec, 1
  ds_add_u32 v14, v15
  s_mov_b64 exec, -1
  s_setprio 0
L_idone:
  s_waitcnt vmcnt(0) lgkmcnt(0)
  v_mov_b32 v14, 130052
  v_mov_b32 v15, 1
  s_mov_b64 exec, 1
  ds_add_rtn_u32 v15, v14, v15
  s_waitcnt lgkmcnt(0)
  v_readfirstlane_b32 s83, v15
  s_nop 0
  s_cmp_eq_u32 s83, 7
  s_cbranch_scc0 L_publ4
  v_mov_b32 v14, 4
  v_mov_b32 v15, 0
  s_lshl_b32 s66, s61, 7
  s_add_u32 s66, s66, 49807360
  buffer_store_dword v14, v15, s[16:19], s66 offen sc1
L_publ4:
  s_mov_b64 exec, -1
  s_lshr_b32 s62, s61, 2
  s_xor_b32 s62, s62, 8
  s_and_b32 s63, s61, 3
  s_lshl_b32 s63, s63, 2
  s_and_b32 s66, s60, 3
  s_add_u32 s63, s63, s66
  s_lshr_b32 s64, s60, 2
  s_mov_b32 s20, s50
  s_and_b32 s21, s51, 0xffff
  s_mov_b32 s22, 1152
  s_mov_b32 s23, 0x00020000
  s_mov_b32 s28, s52
  s_and_b32 s29, s53, 0xffff
  s_mov_b32 s30, 2359296
  s_mov_b32 s31, 0x00020000
  s_lshl_b32 s79, s62, 2
  s_lshr_b32 s66, s63, 2
  s_add_u32 s79, s79, s66
  s_lshl_b32 s78, s62, 3
  s_lshr_b32 s66, s63, 1
  s_add_u32 s78, s78, s66
  s_lshl_b32 s78, s78, 7
  s_add_u32 s78, s78, 49283072
  s_and_b32 s70, s63, 1
  s_lshl_b32 s66, s70, 8
  v_and_b32 v2, 15, v1
  v_lshl_add_u32 v2, v2, 4, s66
  v_bfe_u32 v14, v1, 4, 1
  v_lshl_add_u32 v2, v14, 9, v2
  v_lshrrev_b32 v15, 5, v1
  v_lshl_add_u32 v3, v15, 10, v2
  v_mul_u32_u24 v5, 4096, v15
  v_add_u32 v2, v2, v5
  v_lshlrev_b32 v5, 5, v14
  v_lshl_add_u32 v5, v15, 4, v5
  s_and_b32 s65, s79, 7
  s_lshl_b32 s65, s65, 8
  s_lshl_b32 s70, s70, 7
  s_add_u32 s65, s65, s70
  s_lshr_b32 s66, s79, 5
  s_add_u32 s65, s65, s66
  s_and_b32 s66, s79, 16
  s_lshl_b32 s66, s66, 1
  s_add_u32 s65, s65, s66
  s_and_b32 s66, s79, 8
  s_add_u32 s65, s65, s66
  v_lshl_add_u32 v4, v15, 6, s65
  v_lshl_add_u32 v4, v14, 4, v4
  v_bfe_u32 v14, v1, 2, 2
  v_lshl_add_u32 v4, v14, 1, v4
  v_mul_u32_u24 v4, 1152, v4
  v_and_b32 v7, 3, v1
  v_lshl_add_u32 v4, v7, 4, v4
  v_lshrrev_b32 v8, 2, v1
  v_and_b32 v14, 1, v1
  v_lshl_add_u32 v8, v14, 5, v8
  v_bfe_u32 v14, v1, 1, 1
  v_lshl_add_u32 v8, v14, 4, v8
  v_lshlrev_b32 v8, 2, v8
  v_mul_u32_u24 v6, 12, v7
  v_lshlrev_b32 v7, 7, v7
  s_mov_b32 s71, 0xffff0000
  s_mov_b32 s72, 0xbfb8aa3b
  s_add_u32 s66, s62, 0
  s_mul_hi_u32 s65, s66, 0x55555556
  s_mul_i32 s65, s65, 3
  s_sub_u32 s66, s66, s65
  s_mul_i32 s65, s64, 3
  s_add_u32 s66, s66, s65
  s_lshl_b32 s66, s66, 1
  s_bfe_u32 s65, s63, 0x10001
  s_add_u32 s66, s66, s65
  s_lshl_b32 s86, s66, 6
  s_mul_i32 s65, s79, 147584
  s_lshl_b32 s84, s66, 13
  s_add_u32 s84, s84, s65
  s_mul_i32 s65, s79, 36992
  s_lshl_b32 s85, s66, 11
  s_add_u32 s85, s85, s65
  s_add_u32 s85, s85, 33554432
  s_add_u32 s66, s62, 0
  s_mul_hi_u32 s65, s66, 0x55555556
  s_mul_i32 s65, s65, 3
  s_sub_u32 s66, s66, s65
  s_mul_i32 s65, 2, 3
  s_add_u32 s66, s66, s65
  s_lshl_b32 s66, s66, 1
  s_bfe_u32 s65, s63, 0x10001
  s_add_u32 s66, s66, s65
  s_lshl_b32 s90, s66, 6
  s_mul_i32 s65, s79, 147584
  s_lshl_b32 s88, s66, 13
  s_add_u32 s88, s88, s65
  s_mul_i32 s65, s79, 36992
  s_lshl_b32 s89, s66, 11
  s_add_u32 s89, s89, s65
  s_add_u32 s89, s89, 33554432
  s_lshl_b32 s77, s62, 9
  s_add_u32 s77, s77, 49807360
  s_cmp_eq_u32 s83, 7
  s_cbranch_scc0 L_tsw
  s_mov_b32 s76, 400000
L_ts:
  buffer_load_dword v14, v7, s[16:19], s77 offen sc1
  s_waitcnt vmcnt(0)
  v_cmp_le_u32 vcc, 4, v14
  s_sub_u32 s76, s76, 1
  s_cmp_eq_u64 vcc, -1
  s_cbranch_scc1 L_ts_d
  s_cmp_eq_u32 s76, 0
  s_cbranch_scc1 L_ts_d
  s_sleep 8
  s_branch L_ts
L_ts_d:
  v_mov_b32 v14, 130068
  v_mov_b32 v15, 1
  s_mov_b64 exec, 1
  ds_add_u32 v14, v15
  s_mov_b64 exec, -1
L_tsw:
  s_branch L_pj21
  .p2align 12
L_stub21:
  s_setpc_b64 s[58:59]
  s_nop 0
L_pj21:
  v_mov_b32 v14, 130068
  s_mov_b32 s80, 3200000
L_tsl:
  ds_read_b32 v15, v14
  s_waitcnt lgkmcnt(0)
  v_readfirstlane_b32 s81, v15
  s_sub_u32 s80, s80, 1
  s_cmp_ge_u32 s81, 1
  s_cbranch_scc1 L_tsl_d
  s_cmp_eq_u32 s80, 0
  s_cbranch_scc1 L_tsl_d
  s_sleep 4
  s_branch L_tsl
L_tsl_d:
  s_cmp_eq_u32 s64, 0
  s_cselect_b32 s88, s88, 1879048192
  s_cselect_b32 s89, s89, 1879048192
  s_cselect_b32 s90, s90, 1879048192
  buffer_load_dwordx4 v[36:39], v4, s[4:7], s86 offen
  buffer_load_dwordx4 v[40:43], v5, s[20:23], s86 offen
  buffer_load_dwordx4 v[32:35], v3, s[16:19], s85 offen sc1
  buffer_load_dwordx4 v[68:71], v4, s[4:7], s90 offen
  buffer_load_dwordx4 v[72:75], v5, s[20:23], s90 offen
  buffer_load_dwordx4 v[64:67], v3, s[16:19], s89 offen sc1
  s_mov_b32 s76, 400000
  v_readlane_b32 s66, v2, 63
  v_and_b32 v15, 3, v1
  v_lshlrev_b32 v15, 10, v15
  v_add_u32 v15, s66, v15
L_twp:
  buffer_load_dword v14, v15, s[16:19], s84 offen sc1
  s_waitcnt vmcnt(0)
  v_cmp_eq_u32 vcc, -1, v14
  s_sub_u32 s76, s76, 1
  s_cmp_eq_u64 vcc, 0
  s_cbranch_scc1 L_twp_d
  s_cmp_lt_i32 s76, 1
  s_cbranch_scc1 L_twp_d
  s_sleep 16
  s_branch L_twp
L_twp_d:
  s_add_u32 s66, s84, 0
  buffer_load_dwordx4 v[16:19], v2, s[16:19], s66 offen offset:0 sc1
  buffer_load_dwordx4 v[20:23], v2, s[16:19], s66 offen offset:1024 sc1
  buffer_load_dwordx4 v[24:27], v2, s[16:19], s66 offen offset:2048 sc1
  buffer_load_dwordx4 v[28:31], v2, s[16:19], s66 offen offset:3072 sc1
  s_add_u32 s66, s88, 0
  buffer_load_dwordx4 v[48:51], v2, s[16:19], s66 offen offset:0 sc1
  buffer_load_dwordx4 v[52:55], v2, s[16:19], s66 offen offset:1024 sc1
  buffer_load_dwordx4 v[56:59], v2, s[16:19], s66 offen offset:2048 sc1
  buffer_load_dwordx4 v[60:63], v2, s[16:19], s66 offen offset:3072 sc1
L_tw:
  s_waitcnt vmcnt(0)
  s_mov_b32 s73, 0
  v_max3_u32 v15, v16, v17, v18
  v_max_u32 v15, v15, v19
  v_cmp_eq_u32 vcc, -1, v15
  s_nop 0
  s_cmp_eq_u64 vcc, 0
  s_cbranch_scc1 L_tw_00
  buffer_load_dwordx4 v[16:19], v2, s[16:19], s84 offen offset:0 sc1
  s_mov_b32 s73, 1
L_tw_00:
  v_max3_u32 v15, v20, v21, v22
  v_max_u32 v15, v15, v23
  v_cmp_eq_u32 vcc, -1, v15
  s_nop 0
  s_cmp_eq_u64 vcc, 0
  s_cbranch_scc1 L_tw_01
  buffer_load_dwordx4 v[20:23], v2, s[16:19], s84 offen offset:1024 sc1
  s_mov_b32 s73, 1
L_tw_01:
  v_max3_u32 v15, v24, v25, v26
  v_max_u32 v15, v15, v27
  v_cmp_eq_u32 vcc, -1, v15
  s_nop 0
  s_cmp_eq_u64 vcc, 0
  s_cbranch_scc1 L_tw_02
  buffer_load_dwordx4 v[24:27], v2, s[16:19], s84 offen offset:2048 sc1
  s_mov_b32 s73, 1
L_tw_02:
  v_max3_u32 v15, v28, v29, v30
  v_max_u32 v15, v15, v31
  v_cmp_eq_u32 vcc, -1, v15
  s_nop 0
  s_cmp_eq_u64 vcc, 0
  s_cbranch_scc1 L_tw_03
  buffer_load_dwordx4 v[28:31], v2, s[16:19], s84 offen offset:3072 sc1
  s_mov_b32 s73, 1
L_tw_03:
  v_max3_u32 v15, v48, v49, v50
  v_max_u32 v15, v15, v51
  v_cmp_eq_u32 vcc, -1, v15
  s_nop 0
  s_cmp_eq_u64 vcc, 0
  s_cbranch_scc1 L_tw_10
  buffer_load_dwordx4 v[48:51], v2, s[16:19], s88 offen offset:0 sc1
  s_mov_b32 s73, 1
L_tw_10:
  v_max3_u32 v15, v52, v53, v54
  v_max_u32 v15, v15, v55
  v_cmp_eq_u32 vcc, -1, v15
  s_nop 0
  s_cmp_eq_u64 vcc, 0
  s_cbranch_scc1 L_tw_11
  buffer_load_dwordx4 v[52:55], v2, s[16:19], s88 offen offset:1024 sc1
  s_mov_b32 s73, 1
L_tw_11:
  v_max3_u32 v15, v56, v57, v58
  v_max_u32 v15, v15, v59
  v_cmp_eq_u32 vcc, -1, v15
  s_nop 0
  s_cmp_eq_u64 vcc, 0
  s_cbranch_scc1 L_tw_12
  buffer_load_dwordx4 v[56:59], v2, s[16:19], s88 offen offset:2048 sc1
  s_mov_b32 s73, 1
L_tw_12:
  v_max3_u32 v15, v60, v61, v62
  v_max_u32 v15, v15, v63
  v_cmp_eq_u32 vcc, -1, v15
  s_nop 0
  s_cmp_eq_u64 vcc, 0
  s_cbranch_scc1 L_tw_13
  buffer_load_dwordx4 v[60:63], v2, s[16:19], s88 offen offset:3072 sc1
  s_mov_b32 s73, 1
L_tw_13:
  s_sub_u32 s76, s76, 1
  s_cmp_eq_u32 s73, 0
  s_cbranch_scc1 L_tw_d
  s_cmp_lt_i32 s76, 1
  s_cbranch_scc0 L_tw
  s_waitcnt vmcnt(0)
L_tw_d:
  v_lshlrev_b32 v80, 16, v40
  v_and_b32 v81, s71, v40
  v_lshlrev_b32 v82, 16, v41
  v_and_b32 v83, s71, v41
  v_lshlrev_b32 v84, 16, v42
  v_and_b32 v85, s71, v42
  v_lshlrev_b32 v86, 16, v43
  v_and_b32 v87, s71, v43
  v_lshlrev_b32 v88, 16, v16
  v_and_b32 v89, s71, v16
  v_lshlrev_b32 v90, 16, v17
  v_and_b32 v91, s71, v17
  v_lshlrev_b32 v92, 16, v18
  v_and_b32 v93, s71, v18
  v_lshlrev_b32 v94, 16, v19
  v_and_b32 v95, s71, v19
  v_pk_add_f32 v[80:81], v[80:81], v[88:89]
  v_pk_add_f32 v[82:83], v[82:83], v[90:91]
  v_pk_add_f32 v[84:85], v[84:85], v[92:93]
  v_pk_add_f32 v[86:87], v[86:87], v[94:95]
  v_lshlrev_b32 v96, 16, v20
  v_and_b32 v97, s71, v20
  v_lshlrev_b32 v98, 16, v21
  v_and_b32 v99, s71, v21
  v_lshlrev_b32 v100, 16, v22
  v_and_b32 v101, s71, v22
  v_lshlrev_b32 v102, 16, v23
  v_and_b32 v103, s71, v23
  v_pk_add_f32 v[80:81], v[80:81], v[96:97]
  v_pk_add_f32 v[82:83], v[82:83], v[98:99]
  v_pk_add_f32 v[84:85], v[84:85], v[100:101]
  v_pk_add_f32 v[86:87], v[86:87], v[102:103]
  v_lshlrev_b32 v88, 16, v24
  v_and_b32 v89, s71, v24
  v_lshlrev_b32 v90, 16, v25
  v_and_b32 v91, s71, v25
  v_lshlrev_b32 v92, 16, v26
  v_and_b32 v93, s71, v26
  v_lshlrev_b32 v94, 16, v27
  v_and_b32 v95, s71, v27
  v_pk_add_f32 v[80:81], v[80:81], v[88:89]
  v_pk_add_f32 v[82:83], v[82:83], v[90:91]
  v_pk_add_f32 v[84:85], v[84:85], v[92:93]
  v_pk_add_f32 v[86:87], v[86:87], v[94:95]
  v_lshlrev_b32 v96, 16, v28
  v_and_b32 v97, s71, v28
  v_lshlrev_b32 v98, 16, v29
  v_and_b32 v99, s71, v29
  v_lshlrev_b32 v100, 16, v30
  v_and_b32 v101, s71, v30
  v_lshlrev_b32 v102, 16, v31
  v_and_b32 v103, s71, v31
  v_pk_add_f32 v[80:81], v[80:81], v[96:97]
  v_pk_add_f32 v[82:83], v[82:83], v[98:99]
  v_pk_add_f32 v[84:85], v[84:85], v[100:101]
  v_pk_add_f32 v[86:87], v[86:87], v[102:103]
  v_mul_f32 v88, s72, v80
  v_mul_f32 v89, s72, v81
  v_mul_f32 v90, s72, v82
  v_mul_f32 v91, s72, v83
  v_mul_f32 v92, s72, v84
  v_mul_f32 v93, s72, v85
  v_mul_f32 v94, s72, v86
  v_mul_f32 v95, s72, v87
  v_exp_f32 v88, v88
  v_exp_f32 v89, v89
  v_exp_f32 v90, v90
  v_exp_f32 v91, v91
  v_exp_f32 v92, v92
  v_exp_f32 v93, v93
  v_exp_f32 v94, v94
  v_exp_f32 v95, v95
  v_lshlrev_b32 v96, 16, v32
  v_and_b32 v97, s71, v32
  v_lshlrev_b32 v98, 16, v33
  v_and_b32 v99, s71, v33
  v_lshlrev_b32 v100, 16, v34
  v_and_b32 v101, s71, v34
  v_lshlrev_b32 v102, 16, v35
  v_and_b32 v103, s71, v35
  v_add_f32 v88, 1.0, v88
  v_add_f32 v89, 1.0, v89
  v_add_f32 v90, 1.0, v90
  v_add_f32 v91, 1.0, v91
  v_add_f32 v92, 1.0, v92
  v_add_f32 v93, 1.0, v93
  v_add_f32 v94, 1.0, v94
  v_add_f32 v95, 1.0, v95
  v_rcp_f32 v88, v88
  v_rcp_f32 v89, v89
  v_rcp_f32 v90, v90
  v_rcp_f32 v91, v91
  v_rcp_f32 v92, v92
  v_rcp_f32 v93, v93
  v_rcp_f32 v94, v94
  v_rcp_f32 v95, v95
  v_pk_mul_f32 v[80:81], v[80:81], v[96:97]
  v_pk_mul_f32 v[82:83], v[82:83], v[98:99]
  v_pk_mul_f32 v[84:85], v[84:85], v[100:101]
  v_pk_mul_f32 v[86:87], v[86:87], v[102:103]
  v_pk_mul_f32 v[80:81], v[80:81], v[88:89]
  v_pk_mul_f32 v[82:83], v[82:83], v[90:91]
  v_pk_mul_f32 v[84:85], v[84:85], v[92:93]
  v_pk_mul_f32 v[86:87], v[86:87], v[94:95]
  v_cvt_pk_bf16_f32 v88, v80, v81
  v_cvt_pk_bf16_f32 v89, v82, v83
  v_cvt_pk_bf16_f32 v90, v84, v85
  v_cvt_pk_bf16_f32 v91, v86, v87
  ds_bpermute_b32 v92, v8, v88
  ds_bpermute_b32 v93, v8, v89
  ds_bpermute_b32 v94, v8, v90
  ds_bpermute_b32 v95, v8, v91
  v_lshlrev_b32 v80, 16, v36
  v_and_b32 v81, s71, v36
  v_lshlrev_b32 v82, 16, v37
  v_and_b32 v83, s71, v37
  v_lshlrev_b32 v84, 16, v38
  v_and_b32 v85, s71, v38
  v_lshlrev_b32 v86, 16, v39
  v_and_b32 v87, s71, v39
  s_waitcnt lgkmcnt(0)
  v_lshlrev_b32 v96, 16, v92
  v_and_b32 v97, s71, v92
  v_lshlrev_b32 v98, 16, v93
  v_and_b32 v99, s71, v93
  v_lshlrev_b32 v100, 16, v94
  v_and_b32 v101, s71, v94
  v_lshlrev_b32 v102, 16, v95
  v_and_b32 v103, s71, v95
  v_pk_add_f32 v[80:81], v[80:81], v[96:97]
  v_pk_add_f32 v[82:83], v[82:83], v[98:99]
  v_pk_add_f32 v[84:85], v[84:85], v[100:101]
  v_pk_add_f32 v[86:87], v[86:87], v[102:103]
  v_cvt_pk_bf16_f32 v44, v80, v81
  v_cvt_pk_bf16_f32 v45, v82, v83
  v_cvt_pk_bf16_f32 v46, v84, v85
  v_cvt_pk_bf16_f32 v47, v86, v87
  buffer_store_dwordx4 v[44:47], v4, s[28:31], s86 offen sc1
  s_cmp_eq_u32 s64, 0
  s_cbranch_scc0 L_tend
  v_lshlrev_b32 v80, 16, v72
  v_and_b32 v81, s71, v72
  v_lshlrev_b32 v82, 16, v73
  v_and_b32 v83, s71, v73
  v_lshlrev_b32 v84, 16, v74
  v_and_b32 v85, s71, v74
  v_lshlrev_b32 v86, 16, v75
  v_and_b32 v87, s71, v75
  v_lshlrev_b32 v88, 16, v48
  v_and_b32 v89, s71, v48
  v_lshlrev_b32 v90, 16, v49
  v_and_b32 v91, s71, v49
  v_lshlrev_b32 v92, 16, v50
  v_and_b32 v93, s71, v50
  v_lshlrev_b32 v94, 16, v51
  v_and_b32 v95, s71, v51
  v_pk_add_f32 v[80:81], v[80:81], v[88:89]
  v_pk_add_f32 v[82:83], v[82:83], v[90:91]
  v_pk_add_f32 v[84:85], v[84:85], v[92:93]
  v_pk_add_f32 v[86:87], v[86:87], v[94:95]
  v_lshlrev_b32 v96, 16, v52
  v_and_b32 v97, s71, v52
  v_lshlrev_b32 v98, 16, v53
  v_and_b32 v99, s71, v53
  v_lshlrev_b32 v100, 16, v54
  v_and_b32 v101, s71, v54
  v_lshlrev_b32 v102, 16, v55
  v_and_b32 v103, s71, v55
  v_pk_add_f32 v[80:81], v[80:81], v[96:97]
  v_pk_add_f32 v[82:83], v[82:83], v[98:99]
  v_pk_add_f32 v[84:85], v[84:85], v[100:101]
  v_pk_add_f32 v[86:87], v[86:87], v[102:103]
  v_lshlrev_b32 v88, 16, v56
  v_and_b32 v89, s71, v56
  v_lshlrev_b32 v90, 16, v57
  v_and_b32 v91, s71, v57
  v_lshlrev_b32 v92, 16, v58
  v_and_b32 v93, s71, v58
  v_lshlrev_b32 v94, 16, v59
  v_and_b32 v95, s71, v59
  v_pk_add_f32 v[80:81], v[80:81], v[88:89]
  v_pk_add_f32 v[82:83], v[82:83], v[90:91]
  v_pk_add_f32 v[84:85], v[84:85], v[92:93]
  v_pk_add_f32 v[86:87], v[86:87], v[94:95]
  v_lshlrev_b32 v96, 16, v60
  v_and_b32 v97, s71, v60
  v_lshlrev_b32 v98, 16, v61
  v_and_b32 v99, s71, v61
  v_lshlrev_b32 v100, 16, v62
  v_and_b32 v101, s71, v62
  v_lshlrev_b32 v102, 16, v63
  v_and_b32 v103, s71, v63
  v_pk_add_f32 v[80:81], v[80:81], v[96:97]
  v_pk_add_f32 v[82:83], v[82:83], v[98:99]
  v_pk_add_f32 v[84:85], v[84:85], v[100:101]
  v_pk_add_f32 v[86:87], v[86:87], v[102:103]
  v_mul_f32 v88, s72, v80
  v_mul_f32 v89, s72, v81
  v_mul_f32 v90, s72, v82
  v_mul_f32 v91, s72, v83
  v_mul_f32 v92, s72, v84
  v_mul_f32 v93, s72, v85
  v_mul_f32 v94, s72, v86
  v_mul_f32 v95, s72, v87
  v_exp_f32 v88, v88
  v_exp_f32 v89, v89
  v_exp_f32 v90, v90
  v_exp_f32 v91, v91
  v_exp_f32 v92, v92
  v_exp_f32 v93, v93
  v_exp_f32 v94, v94
  v_exp_f32 v95, v95
  v_lshlrev_b32 v96, 16, v64
  v_and_b32 v97, s71, v64
  v_lshlrev_b32 v98, 16, v65
  v_and_b32 v99, s71, v65
  v_lshlrev_b32 v100, 16, v66
  v_and_b32 v101, s71, v66
  v_lshlrev_b32 v102, 16, v67
  v_and_b32 v103, s71, v67
  v_add_f32 v88, 1.0, v88
  v_add_f32 v89, 1.0, v89
  v_add_f32 v90, 1.0, v90
  v_add_f32 v91, 1.0, v91
  v_add_f32 v92, 1.0, v92
  v_add_f32 v93, 1.0, v93
  v_add_f32 v94, 1.0, v94
  v_add_f32 v95, 1.0, v95
  v_rcp_f32 v88, v88
  v_rcp_f32 v89, v89
  v_rcp_f32 v90, v90
  v_rcp_f32 v91, v91
  v_rcp_f32 v92, v92
  v_rcp_f32 v93, v93
  v_rcp_f32 v94, v94
  v_rcp_f32 v95, v95
  v_pk_mul_f32 v[80:81], v[80:81], v[96:97]
  v_pk_mul_f32 v[82:83], v[82:83], v[98:99]
  v_pk_mul_f32 v[84:85], v[84:85], v[100:101]
  v_pk_mul_f32 v[86:87], v[86:87], v[102:103]
  v_pk_mul_f32 v[80:81], v[80:81], v[88:89]
  v_pk_mul_f32 v[82:83], v[82:83], v[90:91]
  v_pk_mul_f32 v[84:85], v[84:85], v[92:93]
  v_pk_mul_f32 v[86:87], v[86:87], v[94:95]
  v_cvt_pk_bf16_f32 v88, v80, v81
  v_cvt_pk_bf16_f32 v89, v82, v83
  v_cvt_pk_bf16_f32 v90, v84, v85
  v_cvt_pk_bf16_f32 v91, v86, v87
  ds_bpermute_b32 v92, v8, v88
  ds_bpermute_b32 v93, v8, v89
  ds_bpermute_b32 v94, v8, v90
  ds_bpermute_b32 v95, v8, v91
  v_lshlrev_b32 v80, 16, v68
  v_and_b32 v81, s71, v68
  v_lshlrev_b32 v82, 16, v69
  v_and_b32 v83, s71, v69
  v_lshlrev_b32 v84, 16, v70
  v_and_b32 v85, s71, v70
  v_lshlrev_b32 v86, 16, v71
  v_and_b32 v87, s71, v71
  s_waitcnt lgkmcnt(0)
  v_lshlrev_b32 v96, 16, v92
  v_and_b32 v97, s71, v92
  v_lshlrev_b32 v98, 16, v93
  v_and_b32 v99, s71, v93
  v_lshlrev_b32 v100, 16, v94
  v_and_b32 v101, s71, v94
  v_lshlrev_b32 v102, 16, v95
  v_and_b32 v103, s71, v95
  v_pk_add_f32 v[80:81], v[80:81], v[96:97]
  v_pk_add_f32 v[82:83], v[82:83], v[98:99]
  v_pk_add_f32 v[84:85], v[84:85], v[100:101]
  v_pk_add_f32 v[86:87], v[86:87], v[102:103]
  v_cvt_pk_bf16_f32 v76, v80, v81
  v_cvt_pk_bf16_f32 v77, v82, v83
  v_cvt_pk_bf16_f32 v78, v84, v85
  v_cvt_pk_bf16_f32 v79, v86, v87
  buffer_store_dwordx4 v[76:79], v4, s[28:31], s90 offen sc1
L_tend:
  s_endpgm
L_codeend:
.section .rodata,"a"
.p2align 6
.amdhsa_kernel recurrent_scan__spectral_gfnet__dense_activation_gelu__prompt_kernel
  .amdhsa_next_free_vgpr 256
  .amdhsa_next_free_sgpr 102
  .amdhsa_accum_offset 256
  .amdhsa_group_segment_fixed_size 0
  .amdhsa_kernarg_size 88
  .amdhsa_user_sgpr_count 2
  .amdhsa_user_sgpr_kernarg_segment_ptr 1
  .amdhsa_system_sgpr_workgroup_id_x 1
.end_amdhsa_kernel
```
